```python
import torch

def _softmax(x, axis=-1):
    return torch.softmax(x, dim=axis)
def _gelu(x):
    return torch.nn.functional.gelu(x, approximate="tanh")
def _silu(x):
    return torch.nn.functional.silu(x)
def _sigmoid(x):
    return torch.sigmoid(x)
def _layernorm(x, axis=-1, eps=1e-5):
    m = x.mean(dim=axis, keepdim=True)
    v = x.var(dim=axis, keepdim=True, unbiased=False)
    return (x - m) / torch.sqrt(v + eps)
def _scatter_add(tgt, idx, src, axis=0):
    return tgt.clone().index_add_(axis, idx, src)
def _segment_sum(src, seg, n):
    out = torch.zeros((n,) + src.shape[1:], dtype=src.dtype)
    return out.index_add_(0, seg, src)
def _pad(x, pw):
    flat = tuple(v for pair in reversed(pw) for v in pair)
    return torch.nn.functional.pad(x, flat)

kernel_name = 'concat_heads__gqa_block_cached__gqa_block_cached__near_ridge'

def setup_inputs():

    _w = (lambda a: (lambda t: t.to(torch.bfloat16) if t.is_floating_point() else t)(torch.as_tensor(a)))
    def _A_setup():
        B, Sq, D = 16, 64, 640
        Hq, Hkv, Sk, Dh = 32, 32, 512, 192
        assert Hq % Hkv == 0, (Hq, Hkv)
        return {
            "x": _w((lambda *s: torch.randn(*s, dtype=torch.bfloat16) * 0.8)(B, Sq, D)),
            "k_cache": _w((lambda *s: torch.randn(*s, dtype=torch.bfloat16) * 0.8)(B, Hkv, Sk, Dh)),
            "v_cache": _w((lambda *s: torch.randn(*s, dtype=torch.bfloat16) * 0.05)(B, Hkv, Sk, Dh)),
            "wq": _w((lambda *s: torch.randn(*s, dtype=torch.bfloat16) * 0.8)(D, Hq * Dh) * (D ** -0.5)),
            "wo": _w((lambda *s: torch.randn(*s, dtype=torch.bfloat16) * 0.05)(Hq * Dh, D) * ((Hq * Dh) ** -0.5)),
        }
    _A_in = _A_setup()

    def _B_setup():
        B, Sq, D = 16, 64, 640
        Hq, Hkv, Sk, Dh = 32, 32, 512, 192
        assert Hq % Hkv == 0, (Hq, Hkv)
        return {
            "x": _w((lambda *s: torch.randn(*s, dtype=torch.bfloat16) * 0.8)(B, Sq, D)),
            "k_cache": _w((lambda *s: torch.randn(*s, dtype=torch.bfloat16) * 0.8)(B, Hkv, Sk, Dh)),
            "v_cache": _w((lambda *s: torch.randn(*s, dtype=torch.bfloat16) * 0.05)(B, Hkv, Sk, Dh)),
            "wq": _w((lambda *s: torch.randn(*s, dtype=torch.bfloat16) * 0.8)(D, Hq * Dh) * (D ** -0.5)),
            "wo": _w((lambda *s: torch.randn(*s, dtype=torch.bfloat16) * 0.05)(Hq * Dh, D) * ((Hq * Dh) ** -0.5)),
        }
    _B_in = _B_setup()

    return {
        "A_x": _A_in["x"],
        "A_k_cache": _A_in["k_cache"],
        "A_v_cache": _A_in["v_cache"],
        "A_wq": _A_in["wq"],
        "A_wo": _A_in["wo"],
        "B_x": _B_in["x"],
        "B_k_cache": _B_in["k_cache"],
        "B_v_cache": _B_in["v_cache"],
        "B_wq": _B_in["wq"],
        "B_wo": _B_in["wo"],
    }

def reference(A_x, A_k_cache, A_v_cache, A_wq, A_wo, B_x, B_k_cache, B_v_cache, B_wq, B_wo):
    def _A_ref(x, k_cache, v_cache, wq, wo):
        B, Sq, D = x.shape
        Hq, Dh = 32, 192
        Hkv = k_cache.shape[1]
        rep = Hq // Hkv
        q = (lambda x, *d: x.permute(*d))((x @ wq).reshape(B, Sq, Hq, Dh), 0, 2, 1, 3)
        k = (lambda x, n, axis: torch.repeat_interleave(x, n, dim=axis))(k_cache, rep, axis=1)
        v = (lambda x, n, axis: torch.repeat_interleave(x, n, dim=axis))(v_cache, rep, axis=1)
        scores = torch.einsum("bhqd,bhkd->bhqk", q, k) * (Dh ** -0.5)
        p = _softmax(scores, axis=-1)
        o = torch.einsum("bhqk,bhkd->bhqd", p, v)
        return (lambda x, *d: x.permute(*d))(o, 0, 2, 1, 3).reshape(B, Sq, Hq * Dh) @ wo

    def _B_ref(x, k_cache, v_cache, wq, wo):
        B, Sq, D = x.shape
        Hq, Dh = 32, 192
        Hkv = k_cache.shape[1]
        rep = Hq // Hkv
        q = (lambda x, *d: x.permute(*d))((x @ wq).reshape(B, Sq, Hq, Dh), 0, 2, 1, 3)
        k = (lambda x, n, axis: torch.repeat_interleave(x, n, dim=axis))(k_cache, rep, axis=1)
        v = (lambda x, n, axis: torch.repeat_interleave(x, n, dim=axis))(v_cache, rep, axis=1)
        scores = torch.einsum("bhqd,bhkd->bhqk", q, k) * (Dh ** -0.5)
        p = _softmax(scores, axis=-1)
        o = torch.einsum("bhqk,bhkd->bhqd", p, v)
        return (lambda x, *d: x.permute(*d))(o, 0, 2, 1, 3).reshape(B, Sq, Hq * Dh) @ wo

    a = _A_ref(A_x, A_k_cache, A_v_cache, A_wq, A_wo)
    b = _B_ref(B_x, B_k_cache, B_v_cache, B_wq, B_wo)
    return torch.concatenate([a, b], axis=-1)
```

```asm
; @launch grid=(256,1,1) block=(256,1,1) lds=163840
.amdgcn_target "amdgcn-amd-amdhsa--gfx950"
.text
.globl concat_heads__gqa_block_cached__gqa_block_cached__near_ridge_kernel
.p2align 8
.type concat_heads__gqa_block_cached__gqa_block_cached__near_ridge_kernel,@function
concat_heads__gqa_block_cached__gqa_block_cached__near_ridge_kernel:
s_cmp_ge_u32 s2, 256
s_cbranch_scc0 L_main_go
s_endpgm
L_main_go:
s_load_dwordx8 s[4:11], s[0:1], 0
s_load_dwordx4 s[12:15], s[0:1], 32
s_load_dwordx8 s[16:23], s[0:1], 48
s_load_dwordx4 s[96:99], s[0:1], 80
s_load_dwordx2 s[44:45], s[0:1], 96
v_lshrrev_b32 v1, 6, v0
v_and_b32 v2, 63, v0
v_readfirstlane_b32 s58, v1
v_lshrrev_b32 v4, 3, v2
v_lshl_or_b32 v4, v1, 4, v4
v_add_u32 v7, 8, v4
v_bfe_u32 v5, v2, 4, 1
v_bfe_u32 v6, v2, 5, 1
v_lshlrev_b32 v6, 1, v6
v_lshl_or_b32 v5, v5, 2, v6
v_and_b32 v6, 7, v2
v_xor_b32 v5, v5, v6
v_lshlrev_b32 v5, 4, v5
v_xor_b32 v6, 48, v5
v_subrev_u32 v6, 1024, v6
s_movk_i32 s3, 1280
v_mad_u32_u24 v228, v4, s3, v5
v_mad_u32_u24 v229, v7, s3, v6
s_movk_i32 s3, 12288
v_mad_u32_u24 v226, v4, s3, v5
v_mad_u32_u24 v227, v7, s3, v6
s_bfe_u32 s92, s2, 0x40003
s_and_b32 s90, s2, 6
s_lshr_b32 s3, s2, 7
s_or_b32 s90, s90, s3
s_lshl_b32 s48, s58, 11
s_mul_i32 s59, s3, 5
s_add_u32 s59, s59, s92
s_mul_i32 s3, s59, 26
s_lshr_b32 s3, s3, 8
s_mul_i32 s3, s3, 10
s_sub_u32 s59, s59, s3
s_lshl_b32 s60, s59, 7
s_mul_i32 s100, s92, 81920
s_mul_i32 s101, s90, 384
s_and_b32 s93, s2, 1
s_waitcnt lgkmcnt(0)
s_cmp_eq_u32 s93, 0
s_cselect_b32 s40, s4, s14
s_cselect_b32 s41, s5, s15
s_cselect_b32 s32, s10, s20
s_cselect_b32 s33, s11, s21
s_add_u32 s40, s40, s100
s_addc_u32 s41, s41, 0
s_mov_b32 s42, 81920
s_mov_b32 s43, 0x20000
s_add_u32 s32, s32, s101
s_addc_u32 s33, s33, 0
s_mov_b32 s34, 7861632
s_mov_b32 s35, 0x20000
s_add_u32 m0, s48, 0
s_nop 0
buffer_load_dwordx4 v228, s[40:43], s60 offen lds
buffer_load_dwordx4 v229, s[40:43], s60 offen offset:1024 lds
s_mul_i32 s52, s60, 6144
s_add_u32 m0, s48, 65536
s_nop 0
buffer_load_dwordx4 v226, s[32:35], s52 offen lds
buffer_load_dwordx4 v227, s[32:35], s52 offen offset:1024 lds
s_add_u32 m0, s48, 73600
s_nop 0
buffer_load_dwordx4 v226, s[32:35], s52 offen offset:128 lds
buffer_load_dwordx4 v227, s[32:35], s52 offen offset:1152 lds
s_add_u32 m0, s48, 81664
s_nop 0
buffer_load_dwordx4 v226, s[32:35], s52 offen offset:256 lds
buffer_load_dwordx4 v227, s[32:35], s52 offen offset:1280 lds
s_getpc_b64 s[80:81]
L_main_pc:
s_mov_b32 s82, L_main_end-L_main_pc
s_mov_b32 s83, 0x20000
s_lshr_b32 s3, s2, 3
s_mul_i32 s3, s3, 3536
s_lshl_b32 s59, s58, 10
s_add_u32 m0, s59, 32768
v_lshlrev_b32 v3, 4, v0
buffer_load_dwordx4 v3, s[80:83], s3 offen lds
s_movk_i32 s3, 384
v_mad_u32_u24 v224, v4, s3, v5
v_mad_u32_u24 v225, v7, s3, v6
s_mov_b32 s70, s60
s_add_u32 s3, s60, 128
s_cmpk_eq_i32 s3, 1280
s_cselect_b32 s61, 0, s3
s_cselect_b32 s71, 0, s3
s_add_u32 s3, s61, 128
s_cmpk_eq_i32 s3, 1280
s_cselect_b32 s62, 0, s3
s_cselect_b32 s72, 0, s3
s_add_u32 s3, s62, 128
s_cmpk_eq_i32 s3, 1280
s_cselect_b32 s63, 0, s3
s_cselect_b32 s73, 0, s3
s_add_u32 s3, s63, 128
s_cmpk_eq_i32 s3, 1280
s_cselect_b32 s64, 0, s3
s_cselect_b32 s74, 0, s3
s_add_u32 s3, s64, 128
s_cmpk_eq_i32 s3, 1280
s_cselect_b32 s65, 0, s3
s_cselect_b32 s75, 0, s3
s_add_u32 s3, s65, 128
s_cmpk_eq_i32 s3, 1280
s_cselect_b32 s66, 0, s3
s_cselect_b32 s76, 0, s3
s_add_u32 s3, s66, 128
s_cmpk_eq_i32 s3, 1280
s_cselect_b32 s67, 0, s3
s_cselect_b32 s77, 0, s3
s_add_u32 s3, s67, 128
s_cmpk_eq_i32 s3, 1280
s_cselect_b32 s68, 0, s3
s_cselect_b32 s78, 0, s3
s_add_u32 s3, s68, 128
s_cmpk_eq_i32 s3, 1280
s_cselect_b32 s69, 0, s3
s_cselect_b32 s79, 0, s3
s_lshl_b32 s91, s93, 4
s_or_b32 s91, s91, s92
s_lshr_b32 s94, s58, 1
s_and_b32 s95, s58, 1
s_mul_i32 s49, s94, 4096
s_lshl_b32 s50, s95, 12
s_mov_b32 s51, 0x3dd53b95
v_and_b32 v4, 15, v2
v_lshrrev_b32 v6, 4, v2
v_bfe_u32 v8, v4, 3, 1
v_bfe_u32 v9, v4, 2, 1
v_xor_b32 v9, v9, v8
v_lshl_or_b32 v8, v9, 1, v8
v_bfe_u32 v9, v4, 1, 1
v_lshl_or_b32 v5, v9, 2, v8
v_xor_b32 v5, v5, v6
v_lshlrev_b32 v5, 4, v5
v_lshl_or_b32 v231, v4, 7, v5
v_bfe_u32 v7, v2, 1, 1
s_lshl_b32 s3, s94, 2
v_or_b32 v7, s3, v7
v_and_b32 v10, 1, v2
v_lshlrev_b32 v10, 3, v10
v_lshrrev_b32 v4, 2, v2
v_bfe_u32 v8, v4, 3, 1
v_bfe_u32 v9, v4, 2, 1
v_xor_b32 v9, v9, v8
v_lshl_or_b32 v8, v9, 1, v8
v_bfe_u32 v9, v4, 1, 1
v_lshl_or_b32 v5, v9, 2, v8
v_xor_b32 v5, v5, v7
v_lshl_or_b32 v5, v5, 4, v10
v_lshl_or_b32 v250, v4, 7, v5
v_bfe_u32 v4, v2, 2, 2
v_lshl_or_b32 v4, v6, 3, v4
v_bfe_u32 v8, v4, 3, 1
v_bfe_u32 v9, v4, 2, 1
v_xor_b32 v9, v9, v8
v_lshl_or_b32 v8, v9, 1, v8
v_bfe_u32 v9, v4, 1, 1
v_lshl_or_b32 v5, v9, 2, v8
v_xor_b32 v5, v5, v7
v_lshl_or_b32 v5, v5, 4, v10
v_lshl_or_b32 v230, v4, 7, v5
v_lshlrev_b32 v4, 4, v2
v_add_u32 v238, s50, v4
s_lshl_b32 s3, s94, 11
v_add_u32 v239, s3, v238
v_xor_b32 v234, 0x800, v239
v_add_u32 v250, s49, v250
v_add_u32 v254, s48, v4
v_and_b32 v4, 15, v2
v_lshlrev_b32 v4, 4, v4
v_bfe_u32 v5, v2, 5, 1
v_lshl_or_b32 v4, v5, 8, v4
v_bfe_u32 v5, v2, 4, 1
v_lshl_or_b32 v4, v5, 3, v4
s_add_u32 s3, s3, s50
v_add_u32 v251, s3, v4
v_mov_b32 v252, 0
s_add_u32 m0, s48, 8192
s_nop 0
buffer_load_dwordx4 v228, s[40:43], s61 offen lds
buffer_load_dwordx4 v229, s[40:43], s61 offen offset:1024 lds
s_cmp_eq_u32 s93, 0
s_cselect_b32 s24, s6, s16
s_cselect_b32 s25, s7, s17
s_cselect_b32 s28, s8, s18
s_cselect_b32 s29, s9, s19
s_cselect_b32 s36, s12, s22
s_cselect_b32 s37, s13, s23
s_mul_i32 s3, s92, 6291456
s_mul_i32 s59, s90, 196608
s_add_u32 s3, s3, s59
s_add_u32 s24, s24, s3
s_addc_u32 s25, s25, 0
s_mov_b32 s26, 4915200
s_mov_b32 s27, 0x20000
s_add_u32 s28, s28, s3
s_addc_u32 s29, s29, 0
s_mov_b32 s30, 4915200
s_mov_b32 s31, 0x20000
s_mul_i32 s3, s90, 245760
s_add_u32 s36, s36, s3
s_addc_u32 s37, s37, 0
s_mov_b32 s38, 6144000
s_mov_b32 s39, 0x20000
s_mov_b32 s8, s44
s_mov_b32 s9, s45
s_mov_b32 s16, s44
s_mov_b32 s17, s45
s_lshl_b32 s3, s91, 10
s_add_u32 s3, s3, 25165824
s_add_u32 s8, s8, s3
s_addc_u32 s9, s9, 0
s_mov_b32 s10, 1024
s_mov_b32 s11, 0x20000
s_mul_i32 s3, s91, 655360
s_add_u32 s16, s16, s3
s_addc_u32 s17, s17, 0
s_mov_b32 s18, 655360
s_mov_b32 s19, 0x20000
s_mov_b32 s4, s96
s_mov_b32 s5, s97
s_mov_b32 s6, 2621440
s_mov_b32 s7, 0x20000
s_mov_b32 s12, s98
s_mov_b32 s13, s99
s_and_b32 s3, s91, 1
s_lshl_b32 s3, s3, 7
s_lshr_b32 s59, s91, 1
s_lshl_b32 s59, s59, 2
s_add_u32 s3, s3, s59
s_add_u32 s12, s12, s3
s_addc_u32 s13, s13, 0
s_mov_b32 s14, 4
s_mov_b32 s15, 0x20000
s_lshl_b32 s3, s91, 3
s_add_u32 s3, s3, s90
s_mul_i32 s3, s3, 81920
s_add_u32 s44, s44, s3
s_addc_u32 s45, s45, 0
s_mov_b32 s46, 81920
s_mov_b32 s47, 0x20000
s_cmp_eq_u32 s58, 0
s_cbranch_scc0 L_clr_skip
s_lshl_b32 s3, s90, 7
s_mov_b64 exec, 1
buffer_store_dword v252, v252, s[8:11], s3 offen sc1
s_mov_b64 exec, -1
L_clr_skip:
s_mul_i32 s52, s61, 6144
s_add_u32 m0, s48, 90112
s_nop 0
buffer_load_dwordx4 v226, s[32:35], s52 offen lds
buffer_load_dwordx4 v227, s[32:35], s52 offen offset:1024 lds
s_add_u32 m0, s48, 98176
s_nop 0
buffer_load_dwordx4 v226, s[32:35], s52 offen offset:128 lds
buffer_load_dwordx4 v227, s[32:35], s52 offen offset:1152 lds
s_add_u32 m0, s48, 106240
s_nop 0
buffer_load_dwordx4 v226, s[32:35], s52 offen offset:256 lds
buffer_load_dwordx4 v227, s[32:35], s52 offen offset:1280 lds
s_add_u32 m0, s48, 16384
s_nop 0
buffer_load_dwordx4 v228, s[40:43], s62 offen lds
buffer_load_dwordx4 v229, s[40:43], s62 offen offset:1024 lds
s_mul_i32 s52, s62, 6144
s_add_u32 m0, s48, 114688
s_nop 0
buffer_load_dwordx4 v226, s[32:35], s52 offen lds
buffer_load_dwordx4 v227, s[32:35], s52 offen offset:1024 lds
s_add_u32 m0, s48, 122752
s_nop 0
buffer_load_dwordx4 v226, s[32:35], s52 offen offset:128 lds
buffer_load_dwordx4 v227, s[32:35], s52 offen offset:1152 lds
s_add_u32 m0, s48, 130816
s_nop 0
buffer_load_dwordx4 v226, s[32:35], s52 offen offset:256 lds
buffer_load_dwordx4 v227, s[32:35], s52 offen offset:1280 lds
s_bitcmp1_b32 s90, 0
s_cbranch_scc1 L_head_odd
s_add_u32 s53, s50, 0
v_add_u32 v232, s53, v231
v_xor_b32 v233, 64, v232
v_add_u32 v236, 65536, v230
v_xor_b32 v237, 32, v236
s_waitcnt vmcnt(17)
s_barrier
ds_read_b128 a[0:3], v232 offset:0
ds_read_b128 a[4:7], v232 offset:2048
ds_read_b64_tr_b16 v[176:177], v236 offset:0
ds_read_b64_tr_b16 v[178:179], v237 offset:512
ds_read_b64_tr_b16 v[180:181], v237 offset:0
ds_read_b64_tr_b16 v[182:183], v236 offset:512
ds_read_b64_tr_b16 v[184:185], v236 offset:8192
ds_read_b64_tr_b16 v[186:187], v237 offset:8704
ds_read_b64_tr_b16 v[188:189], v237 offset:8192
ds_read_b64_tr_b16 v[190:191], v236 offset:8704
ds_read_b64_tr_b16 v[192:193], v236 offset:16384
ds_read_b64_tr_b16 v[194:195], v237 offset:16896
ds_read_b64_tr_b16 v[196:197], v237 offset:16384
ds_read_b64_tr_b16 v[198:199], v236 offset:16896
s_waitcnt lgkmcnt(8)
v_mfma_f32_16x16x32_bf16 v[128:131], v[176:179], a[0:3], 0
s_add_u32 m0, s48, 24576
s_nop 0
buffer_load_dwordx4 v228, s[40:43], s63 offen lds
v_mfma_f32_16x16x32_bf16 v[136:139], v[176:179], a[4:7], 0
ds_read_b128 a[8:11], v233 offset:0
ds_read_b128 a[12:15], v233 offset:2048
buffer_load_dwordx4 v229, s[40:43], s63 offen offset:1024 lds
v_mfma_f32_16x16x32_bf16 v[132:135], v[180:183], a[0:3], 0
ds_read_b64_tr_b16 v[200:201], v236 offset:4096
ds_read_b64_tr_b16 v[202:203], v237 offset:4608
s_mul_i32 s52, s63, 6144
s_add_u32 m0, s48, 139264
v_mfma_f32_16x16x32_bf16 v[140:143], v[180:183], a[4:7], 0
ds_read_b64_tr_b16 v[204:205], v237 offset:4096
buffer_load_dwordx4 v226, s[32:35], s52 offen lds
s_waitcnt lgkmcnt(9)
v_mfma_f32_16x16x32_bf16 v[144:147], v[184:187], a[0:3], 0
ds_read_b64_tr_b16 v[206:207], v236 offset:4608
v_mfma_f32_16x16x32_bf16 v[152:155], v[184:187], a[4:7], 0
ds_read_b64_tr_b16 v[176:177], v236 offset:12288
buffer_load_dwordx4 v227, s[32:35], s52 offen offset:1024 lds
v_mfma_f32_16x16x32_bf16 v[148:151], v[188:191], a[0:3], 0
ds_read_b64_tr_b16 v[178:179], v237 offset:12800
s_add_u32 m0, s48, 147328
v_mfma_f32_16x16x32_bf16 v[156:159], v[188:191], a[4:7], 0
ds_read_b64_tr_b16 v[180:181], v237 offset:12288
buffer_load_dwordx4 v226, s[32:35], s52 offen offset:128 lds
s_waitcnt lgkmcnt(9)
v_mfma_f32_16x16x32_bf16 v[160:163], v[192:195], a[0:3], 0
ds_read_b64_tr_b16 v[182:183], v236 offset:12800
v_mfma_f32_16x16x32_bf16 v[168:171], v[192:195], a[4:7], 0
ds_read_b64_tr_b16 v[184:185], v236 offset:20480
buffer_load_dwordx4 v227, s[32:35], s52 offen offset:1152 lds
v_mfma_f32_16x16x32_bf16 v[164:167], v[196:199], a[0:3], 0
ds_read_b64_tr_b16 v[186:187], v237 offset:20992
s_add_u32 m0, s48, 155392
v_mfma_f32_16x16x32_bf16 v[172:175], v[196:199], a[4:7], 0
ds_read_b64_tr_b16 v[188:189], v237 offset:20480
buffer_load_dwordx4 v226, s[32:35], s52 offen offset:256 lds
s_waitcnt lgkmcnt(7)
v_mfma_f32_16x16x32_bf16 v[128:131], v[200:203], a[8:11], v[128:131]
ds_read_b64_tr_b16 v[190:191], v236 offset:20992
v_mfma_f32_16x16x32_bf16 v[136:139], v[200:203], a[12:15], v[136:139]
buffer_load_dwordx4 v227, s[32:35], s52 offen offset:1280 lds
v_mfma_f32_16x16x32_bf16 v[132:135], v[204:207], a[8:11], v[132:135]
v_mfma_f32_16x16x32_bf16 v[140:143], v[204:207], a[12:15], v[140:143]
s_add_u32 s53, s50, 8192
v_add_u32 v232, s53, v231
s_waitcnt lgkmcnt(4)
v_mfma_f32_16x16x32_bf16 v[144:147], v[176:179], a[8:11], v[144:147]
v_xor_b32 v233, 64, v232
v_add_u32 v236, 90112, v230
v_mfma_f32_16x16x32_bf16 v[152:155], v[176:179], a[12:15], v[152:155]
v_xor_b32 v237, 32, v236
s_waitcnt vmcnt(16) lgkmcnt(0)
s_barrier
ds_read_b128 a[16:19], v232 offset:0
ds_read_b128 a[20:23], v232 offset:2048
ds_read_b64_tr_b16 v[192:193], v236 offset:0
ds_read_b64_tr_b16 v[194:195], v237 offset:512
ds_read_b64_tr_b16 v[196:197], v237 offset:0
ds_read_b64_tr_b16 v[198:199], v236 offset:512
ds_read_b64_tr_b16 v[200:201], v236 offset:8192
ds_read_b64_tr_b16 v[202:203], v237 offset:8704
v_mfma_f32_16x16x32_bf16 v[148:151], v[180:183], a[8:11], v[148:151]
s_add_u32 m0, s48, 0
s_nop 0
buffer_load_dwordx4 v228, s[40:43], s64 offen lds
v_mfma_f32_16x16x32_bf16 v[156:159], v[180:183], a[12:15], v[156:159]
ds_read_b64_tr_b16 v[204:205], v237 offset:8192
v_mfma_f32_16x16x32_bf16 v[160:163], v[184:187], a[8:11], v[160:163]
ds_read_b64_tr_b16 v[206:207], v236 offset:8704
buffer_load_dwordx4 v229, s[40:43], s64 offen offset:1024 lds
v_mfma_f32_16x16x32_bf16 v[168:171], v[184:187], a[12:15], v[168:171]
ds_read_b64_tr_b16 v[176:177], v236 offset:16384
v_mfma_f32_16x16x32_bf16 v[164:167], v[188:191], a[8:11], v[164:167]
ds_read_b64_tr_b16 v[178:179], v237 offset:16896
s_mul_i32 s52, s64, 6144
s_add_u32 m0, s48, 65536
v_mfma_f32_16x16x32_bf16 v[172:175], v[188:191], a[12:15], v[172:175]
ds_read_b64_tr_b16 v[180:181], v237 offset:16384
buffer_load_dwordx4 v226, s[32:35], s52 offen lds
s_waitcnt lgkmcnt(7)
v_mfma_f32_16x16x32_bf16 v[128:131], v[192:195], a[16:19], v[128:131]
ds_read_b64_tr_b16 v[182:183], v236 offset:16896
v_mfma_f32_16x16x32_bf16 v[136:139], v[192:195], a[20:23], v[136:139]
ds_read_b128 a[24:27], v233 offset:0
ds_read_b128 a[28:31], v233 offset:2048
buffer_load_dwordx4 v227, s[32:35], s52 offen offset:1024 lds
v_mfma_f32_16x16x32_bf16 v[132:135], v[196:199], a[16:19], v[132:135]
ds_read_b64_tr_b16 v[184:185], v236 offset:4096
ds_read_b64_tr_b16 v[186:187], v237 offset:4608
v_mfma_f32_16x16x32_bf16 v[140:143], v[196:199], a[20:23], v[140:143]
ds_read_b64_tr_b16 v[188:189], v237 offset:4096
s_add_u32 m0, s48, 73600
s_waitcnt lgkmcnt(9)
v_mfma_f32_16x16x32_bf16 v[144:147], v[200:203], a[16:19], v[144:147]
ds_read_b64_tr_b16 v[190:191], v236 offset:4608
buffer_load_dwordx4 v226, s[32:35], s52 offen offset:128 lds
v_mfma_f32_16x16x32_bf16 v[152:155], v[200:203], a[20:23], v[152:155]
ds_read_b64_tr_b16 v[192:193], v236 offset:12288
v_mfma_f32_16x16x32_bf16 v[148:151], v[204:207], a[16:19], v[148:151]
ds_read_b64_tr_b16 v[194:195], v237 offset:12800
buffer_load_dwordx4 v227, s[32:35], s52 offen offset:1152 lds
v_mfma_f32_16x16x32_bf16 v[156:159], v[204:207], a[20:23], v[156:159]
ds_read_b64_tr_b16 v[196:197], v237 offset:12288
s_waitcnt lgkmcnt(9)
v_mfma_f32_16x16x32_bf16 v[160:163], v[176:179], a[16:19], v[160:163]
ds_read_b64_tr_b16 v[198:199], v236 offset:12800
s_add_u32 m0, s48, 81664
v_mfma_f32_16x16x32_bf16 v[168:171], v[176:179], a[20:23], v[168:171]
ds_read_b64_tr_b16 v[200:201], v236 offset:20480
buffer_load_dwordx4 v226, s[32:35], s52 offen offset:256 lds
v_mfma_f32_16x16x32_bf16 v[164:167], v[180:183], a[16:19], v[164:167]
ds_read_b64_tr_b16 v[202:203], v237 offset:20992
v_mfma_f32_16x16x32_bf16 v[172:175], v[180:183], a[20:23], v[172:175]
ds_read_b64_tr_b16 v[204:205], v237 offset:20480
s_waitcnt lgkmcnt(7)
v_mfma_f32_16x16x32_bf16 v[128:131], v[184:187], a[24:27], v[128:131]
ds_read_b64_tr_b16 v[206:207], v236 offset:20992
buffer_load_dwordx4 v227, s[32:35], s52 offen offset:1280 lds
v_mfma_f32_16x16x32_bf16 v[136:139], v[184:187], a[28:31], v[136:139]
v_mfma_f32_16x16x32_bf16 v[132:135], v[188:191], a[24:27], v[132:135]
v_mfma_f32_16x16x32_bf16 v[140:143], v[188:191], a[28:31], v[140:143]
s_add_u32 s53, s50, 16384
v_add_u32 v232, s53, v231
s_waitcnt lgkmcnt(4)
v_mfma_f32_16x16x32_bf16 v[144:147], v[192:195], a[24:27], v[144:147]
v_xor_b32 v233, 64, v232
v_add_u32 v236, 114688, v230
v_mfma_f32_16x16x32_bf16 v[152:155], v[192:195], a[28:31], v[152:155]
v_xor_b32 v237, 32, v236
s_waitcnt vmcnt(16) lgkmcnt(0)
s_barrier
ds_read_b128 a[32:35], v232 offset:0
ds_read_b128 a[36:39], v232 offset:2048
ds_read_b64_tr_b16 v[176:177], v236 offset:0
ds_read_b64_tr_b16 v[178:179], v237 offset:512
ds_read_b64_tr_b16 v[180:181], v237 offset:0
ds_read_b64_tr_b16 v[182:183], v236 offset:512
ds_read_b64_tr_b16 v[184:185], v236 offset:8192
ds_read_b64_tr_b16 v[186:187], v237 offset:8704
v_mfma_f32_16x16x32_bf16 v[148:151], v[196:199], a[24:27], v[148:151]
s_add_u32 m0, s48, 8192
s_nop 0
buffer_load_dwordx4 v228, s[40:43], s65 offen lds
v_mfma_f32_16x16x32_bf16 v[156:159], v[196:199], a[28:31], v[156:159]
ds_read_b64_tr_b16 v[188:189], v237 offset:8192
v_mfma_f32_16x16x32_bf16 v[160:163], v[200:203], a[24:27], v[160:163]
ds_read_b64_tr_b16 v[190:191], v236 offset:8704
buffer_load_dwordx4 v229, s[40:43], s65 offen offset:1024 lds
v_mfma_f32_16x16x32_bf16 v[168:171], v[200:203], a[28:31], v[168:171]
ds_read_b64_tr_b16 v[192:193], v236 offset:16384
v_mfma_f32_16x16x32_bf16 v[164:167], v[204:207], a[24:27], v[164:167]
ds_read_b64_tr_b16 v[194:195], v237 offset:16896
s_mul_i32 s52, s65, 6144
s_add_u32 m0, s48, 90112
v_mfma_f32_16x16x32_bf16 v[172:175], v[204:207], a[28:31], v[172:175]
ds_read_b64_tr_b16 v[196:197], v237 offset:16384
buffer_load_dwordx4 v226, s[32:35], s52 offen lds
s_waitcnt lgkmcnt(7)
v_mfma_f32_16x16x32_bf16 v[128:131], v[176:179], a[32:35], v[128:131]
ds_read_b64_tr_b16 v[198:199], v236 offset:16896
v_mfma_f32_16x16x32_bf16 v[136:139], v[176:179], a[36:39], v[136:139]
ds_read_b128 a[40:43], v233 offset:0
ds_read_b128 a[44:47], v233 offset:2048
buffer_load_dwordx4 v227, s[32:35], s52 offen offset:1024 lds
v_mfma_f32_16x16x32_bf16 v[132:135], v[180:183], a[32:35], v[132:135]
ds_read_b64_tr_b16 v[200:201], v236 offset:4096
ds_read_b64_tr_b16 v[202:203], v237 offset:4608
v_mfma_f32_16x16x32_bf16 v[140:143], v[180:183], a[36:39], v[140:143]
ds_read_b64_tr_b16 v[204:205], v237 offset:4096
s_add_u32 m0, s48, 98176
s_waitcnt lgkmcnt(9)
v_mfma_f32_16x16x32_bf16 v[144:147], v[184:187], a[32:35], v[144:147]
ds_read_b64_tr_b16 v[206:207], v236 offset:4608
buffer_load_dwordx4 v226, s[32:35], s52 offen offset:128 lds
v_mfma_f32_16x16x32_bf16 v[152:155], v[184:187], a[36:39], v[152:155]
ds_read_b64_tr_b16 v[176:177], v236 offset:12288
v_mfma_f32_16x16x32_bf16 v[148:151], v[188:191], a[32:35], v[148:151]
ds_read_b64_tr_b16 v[178:179], v237 offset:12800
buffer_load_dwordx4 v227, s[32:35], s52 offen offset:1152 lds
v_mfma_f32_16x16x32_bf16 v[156:159], v[188:191], a[36:39], v[156:159]
ds_read_b64_tr_b16 v[180:181], v237 offset:12288
s_waitcnt lgkmcnt(9)
v_mfma_f32_16x16x32_bf16 v[160:163], v[192:195], a[32:35], v[160:163]
ds_read_b64_tr_b16 v[182:183], v236 offset:12800
s_add_u32 m0, s48, 106240
v_mfma_f32_16x16x32_bf16 v[168:171], v[192:195], a[36:39], v[168:171]
ds_read_b64_tr_b16 v[184:185], v236 offset:20480
buffer_load_dwordx4 v226, s[32:35], s52 offen offset:256 lds
v_mfma_f32_16x16x32_bf16 v[164:167], v[196:199], a[32:35], v[164:167]
ds_read_b64_tr_b16 v[186:187], v237 offset:20992
v_mfma_f32_16x16x32_bf16 v[172:175], v[196:199], a[36:39], v[172:175]
ds_read_b64_tr_b16 v[188:189], v237 offset:20480
s_waitcnt lgkmcnt(7)
v_mfma_f32_16x16x32_bf16 v[128:131], v[200:203], a[40:43], v[128:131]
ds_read_b64_tr_b16 v[190:191], v236 offset:20992
buffer_load_dwordx4 v227, s[32:35], s52 offen offset:1280 lds
v_mfma_f32_16x16x32_bf16 v[136:139], v[200:203], a[44:47], v[136:139]
v_mfma_f32_16x16x32_bf16 v[132:135], v[204:207], a[40:43], v[132:135]
v_mfma_f32_16x16x32_bf16 v[140:143], v[204:207], a[44:47], v[140:143]
s_add_u32 s53, s50, 24576
v_add_u32 v232, s53, v231
s_waitcnt lgkmcnt(4)
v_mfma_f32_16x16x32_bf16 v[144:147], v[176:179], a[40:43], v[144:147]
v_xor_b32 v233, 64, v232
v_add_u32 v236, 139264, v230
v_mfma_f32_16x16x32_bf16 v[152:155], v[176:179], a[44:47], v[152:155]
v_xor_b32 v237, 32, v236
s_waitcnt vmcnt(16) lgkmcnt(0)
s_barrier
ds_read_b128 a[48:51], v232 offset:0
ds_read_b128 a[52:55], v232 offset:2048
ds_read_b64_tr_b16 v[192:193], v236 offset:0
ds_read_b64_tr_b16 v[194:195], v237 offset:512
ds_read_b64_tr_b16 v[196:197], v237 offset:0
ds_read_b64_tr_b16 v[198:199], v236 offset:512
ds_read_b64_tr_b16 v[200:201], v236 offset:8192
ds_read_b64_tr_b16 v[202:203], v237 offset:8704
v_mfma_f32_16x16x32_bf16 v[148:151], v[180:183], a[40:43], v[148:151]
s_add_u32 m0, s48, 16384
s_nop 0
buffer_load_dwordx4 v228, s[40:43], s66 offen lds
v_mfma_f32_16x16x32_bf16 v[156:159], v[180:183], a[44:47], v[156:159]
ds_read_b64_tr_b16 v[204:205], v237 offset:8192
v_mfma_f32_16x16x32_bf16 v[160:163], v[184:187], a[40:43], v[160:163]
ds_read_b64_tr_b16 v[206:207], v236 offset:8704
buffer_load_dwordx4 v229, s[40:43], s66 offen offset:1024 lds
v_mfma_f32_16x16x32_bf16 v[168:171], v[184:187], a[44:47], v[168:171]
ds_read_b64_tr_b16 v[176:177], v236 offset:16384
v_mfma_f32_16x16x32_bf16 v[164:167], v[188:191], a[40:43], v[164:167]
ds_read_b64_tr_b16 v[178:179], v237 offset:16896
s_mul_i32 s52, s66, 6144
s_add_u32 m0, s48, 114688
v_mfma_f32_16x16x32_bf16 v[172:175], v[188:191], a[44:47], v[172:175]
ds_read_b64_tr_b16 v[180:181], v237 offset:16384
buffer_load_dwordx4 v226, s[32:35], s52 offen lds
s_waitcnt lgkmcnt(7)
v_mfma_f32_16x16x32_bf16 v[128:131], v[192:195], a[48:51], v[128:131]
ds_read_b64_tr_b16 v[182:183], v236 offset:16896
v_mfma_f32_16x16x32_bf16 v[136:139], v[192:195], a[52:55], v[136:139]
ds_read_b128 a[56:59], v233 offset:0
ds_read_b128 a[60:63], v233 offset:2048
buffer_load_dwordx4 v227, s[32:35], s52 offen offset:1024 lds
v_mfma_f32_16x16x32_bf16 v[132:135], v[196:199], a[48:51], v[132:135]
ds_read_b64_tr_b16 v[184:185], v236 offset:4096
ds_read_b64_tr_b16 v[186:187], v237 offset:4608
v_mfma_f32_16x16x32_bf16 v[140:143], v[196:199], a[52:55], v[140:143]
ds_read_b64_tr_b16 v[188:189], v237 offset:4096
s_add_u32 m0, s48, 122752
s_waitcnt lgkmcnt(9)
v_mfma_f32_16x16x32_bf16 v[144:147], v[200:203], a[48:51], v[144:147]
ds_read_b64_tr_b16 v[190:191], v236 offset:4608
buffer_load_dwordx4 v226, s[32:35], s52 offen offset:128 lds
v_mfma_f32_16x16x32_bf16 v[152:155], v[200:203], a[52:55], v[152:155]
ds_read_b64_tr_b16 v[192:193], v236 offset:12288
v_mfma_f32_16x16x32_bf16 v[148:151], v[204:207], a[48:51], v[148:151]
ds_read_b64_tr_b16 v[194:195], v237 offset:12800
buffer_load_dwordx4 v227, s[32:35], s52 offen offset:1152 lds
v_mfma_f32_16x16x32_bf16 v[156:159], v[204:207], a[52:55], v[156:159]
ds_read_b64_tr_b16 v[196:197], v237 offset:12288
s_waitcnt lgkmcnt(9)
v_mfma_f32_16x16x32_bf16 v[160:163], v[176:179], a[48:51], v[160:163]
ds_read_b64_tr_b16 v[198:199], v236 offset:12800
s_add_u32 m0, s48, 130816
v_mfma_f32_16x16x32_bf16 v[168:171], v[176:179], a[52:55], v[168:171]
ds_read_b64_tr_b16 v[200:201], v236 offset:20480
buffer_load_dwordx4 v226, s[32:35], s52 offen offset:256 lds
v_mfma_f32_16x16x32_bf16 v[164:167], v[180:183], a[48:51], v[164:167]
ds_read_b64_tr_b16 v[202:203], v237 offset:20992
v_mfma_f32_16x16x32_bf16 v[172:175], v[180:183], a[52:55], v[172:175]
ds_read_b64_tr_b16 v[204:205], v237 offset:20480
s_waitcnt lgkmcnt(7)
v_mfma_f32_16x16x32_bf16 v[128:131], v[184:187], a[56:59], v[128:131]
ds_read_b64_tr_b16 v[206:207], v236 offset:20992
buffer_load_dwordx4 v227, s[32:35], s52 offen offset:1280 lds
v_mfma_f32_16x16x32_bf16 v[136:139], v[184:187], a[60:63], v[136:139]
v_mfma_f32_16x16x32_bf16 v[132:135], v[188:191], a[56:59], v[132:135]
v_mfma_f32_16x16x32_bf16 v[140:143], v[188:191], a[60:63], v[140:143]
s_add_u32 s53, s50, 0
v_add_u32 v232, s53, v231
s_waitcnt lgkmcnt(4)
v_mfma_f32_16x16x32_bf16 v[144:147], v[192:195], a[56:59], v[144:147]
v_xor_b32 v233, 64, v232
v_add_u32 v236, 65536, v230
v_mfma_f32_16x16x32_bf16 v[152:155], v[192:195], a[60:63], v[152:155]
v_xor_b32 v237, 32, v236
s_waitcnt vmcnt(16) lgkmcnt(0)
s_barrier
ds_read_b128 a[64:67], v232 offset:0
ds_read_b128 a[68:71], v232 offset:2048
ds_read_b64_tr_b16 v[176:177], v236 offset:0
ds_read_b64_tr_b16 v[178:179], v237 offset:512
ds_read_b64_tr_b16 v[180:181], v237 offset:0
ds_read_b64_tr_b16 v[182:183], v236 offset:512
ds_read_b64_tr_b16 v[184:185], v236 offset:8192
ds_read_b64_tr_b16 v[186:187], v237 offset:8704
v_mfma_f32_16x16x32_bf16 v[148:151], v[196:199], a[56:59], v[148:151]
s_add_u32 m0, s48, 24576
s_nop 0
buffer_load_dwordx4 v228, s[40:43], s67 offen lds
v_mfma_f32_16x16x32_bf16 v[156:159], v[196:199], a[60:63], v[156:159]
ds_read_b64_tr_b16 v[188:189], v237 offset:8192
v_mfma_f32_16x16x32_bf16 v[160:163], v[200:203], a[56:59], v[160:163]
ds_read_b64_tr_b16 v[190:191], v236 offset:8704
buffer_load_dwordx4 v229, s[40:43], s67 offen offset:1024 lds
v_mfma_f32_16x16x32_bf16 v[168:171], v[200:203], a[60:63], v[168:171]
ds_read_b64_tr_b16 v[192:193], v236 offset:16384
v_mfma_f32_16x16x32_bf16 v[164:167], v[204:207], a[56:59], v[164:167]
ds_read_b64_tr_b16 v[194:195], v237 offset:16896
s_mul_i32 s52, s67, 6144
s_add_u32 m0, s48, 139264
v_mfma_f32_16x16x32_bf16 v[172:175], v[204:207], a[60:63], v[172:175]
ds_read_b64_tr_b16 v[196:197], v237 offset:16384
buffer_load_dwordx4 v226, s[32:35], s52 offen lds
s_waitcnt lgkmcnt(7)
v_mfma_f32_16x16x32_bf16 v[128:131], v[176:179], a[64:67], v[128:131]
ds_read_b64_tr_b16 v[198:199], v236 offset:16896
v_mfma_f32_16x16x32_bf16 v[136:139], v[176:179], a[68:71], v[136:139]
ds_read_b128 a[72:75], v233 offset:0
ds_read_b128 a[76:79], v233 offset:2048
buffer_load_dwordx4 v227, s[32:35], s52 offen offset:1024 lds
v_mfma_f32_16x16x32_bf16 v[132:135], v[180:183], a[64:67], v[132:135]
ds_read_b64_tr_b16 v[200:201], v236 offset:4096
ds_read_b64_tr_b16 v[202:203], v237 offset:4608
v_mfma_f32_16x16x32_bf16 v[140:143], v[180:183], a[68:71], v[140:143]
ds_read_b64_tr_b16 v[204:205], v237 offset:4096
s_add_u32 m0, s48, 147328
s_waitcnt lgkmcnt(9)
v_mfma_f32_16x16x32_bf16 v[144:147], v[184:187], a[64:67], v[144:147]
ds_read_b64_tr_b16 v[206:207], v236 offset:4608
buffer_load_dwordx4 v226, s[32:35], s52 offen offset:128 lds
v_mfma_f32_16x16x32_bf16 v[152:155], v[184:187], a[68:71], v[152:155]
ds_read_b64_tr_b16 v[176:177], v236 offset:12288
v_mfma_f32_16x16x32_bf16 v[148:151], v[188:191], a[64:67], v[148:151]
ds_read_b64_tr_b16 v[178:179], v237 offset:12800
buffer_load_dwordx4 v227, s[32:35], s52 offen offset:1152 lds
v_mfma_f32_16x16x32_bf16 v[156:159], v[188:191], a[68:71], v[156:159]
ds_read_b64_tr_b16 v[180:181], v237 offset:12288
s_waitcnt lgkmcnt(9)
v_mfma_f32_16x16x32_bf16 v[160:163], v[192:195], a[64:67], v[160:163]
ds_read_b64_tr_b16 v[182:183], v236 offset:12800
s_add_u32 m0, s48, 155392
v_mfma_f32_16x16x32_bf16 v[168:171], v[192:195], a[68:71], v[168:171]
ds_read_b64_tr_b16 v[184:185], v236 offset:20480
buffer_load_dwordx4 v226, s[32:35], s52 offen offset:256 lds
v_mfma_f32_16x16x32_bf16 v[164:167], v[196:199], a[64:67], v[164:167]
ds_read_b64_tr_b16 v[186:187], v237 offset:20992
v_mfma_f32_16x16x32_bf16 v[172:175], v[196:199], a[68:71], v[172:175]
ds_read_b64_tr_b16 v[188:189], v237 offset:20480
s_waitcnt lgkmcnt(7)
v_mfma_f32_16x16x32_bf16 v[128:131], v[200:203], a[72:75], v[128:131]
ds_read_b64_tr_b16 v[190:191], v236 offset:20992
buffer_load_dwordx4 v227, s[32:35], s52 offen offset:1280 lds
v_mfma_f32_16x16x32_bf16 v[136:139], v[200:203], a[76:79], v[136:139]
v_mfma_f32_16x16x32_bf16 v[132:135], v[204:207], a[72:75], v[132:135]
v_mfma_f32_16x16x32_bf16 v[140:143], v[204:207], a[76:79], v[140:143]
s_add_u32 s53, s50, 8192
v_add_u32 v232, s53, v231
s_waitcnt lgkmcnt(4)
v_mfma_f32_16x16x32_bf16 v[144:147], v[176:179], a[72:75], v[144:147]
v_xor_b32 v233, 64, v232
v_add_u32 v236, 90112, v230
v_mfma_f32_16x16x32_bf16 v[152:155], v[176:179], a[76:79], v[152:155]
v_xor_b32 v237, 32, v236
s_waitcnt vmcnt(16) lgkmcnt(0)
s_barrier
ds_read_b128 a[80:83], v232 offset:0
ds_read_b128 a[84:87], v232 offset:2048
ds_read_b64_tr_b16 v[192:193], v236 offset:0
ds_read_b64_tr_b16 v[194:195], v237 offset:512
ds_read_b64_tr_b16 v[196:197], v237 offset:0
ds_read_b64_tr_b16 v[198:199], v236 offset:512
ds_read_b64_tr_b16 v[200:201], v236 offset:8192
ds_read_b64_tr_b16 v[202:203], v237 offset:8704
v_mfma_f32_16x16x32_bf16 v[148:151], v[180:183], a[72:75], v[148:151]
s_add_u32 m0, s48, 0
s_nop 0
buffer_load_dwordx4 v228, s[40:43], s68 offen lds
v_mfma_f32_16x16x32_bf16 v[156:159], v[180:183], a[76:79], v[156:159]
ds_read_b64_tr_b16 v[204:205], v237 offset:8192
v_mfma_f32_16x16x32_bf16 v[160:163], v[184:187], a[72:75], v[160:163]
ds_read_b64_tr_b16 v[206:207], v236 offset:8704
buffer_load_dwordx4 v229, s[40:43], s68 offen offset:1024 lds
v_mfma_f32_16x16x32_bf16 v[168:171], v[184:187], a[76:79], v[168:171]
ds_read_b64_tr_b16 v[176:177], v236 offset:16384
v_mfma_f32_16x16x32_bf16 v[164:167], v[188:191], a[72:75], v[164:167]
ds_read_b64_tr_b16 v[178:179], v237 offset:16896
s_mul_i32 s52, s68, 6144
s_add_u32 m0, s48, 65536
v_mfma_f32_16x16x32_bf16 v[172:175], v[188:191], a[76:79], v[172:175]
ds_read_b64_tr_b16 v[180:181], v237 offset:16384
buffer_load_dwordx4 v226, s[32:35], s52 offen lds
s_waitcnt lgkmcnt(7)
v_mfma_f32_16x16x32_bf16 v[128:131], v[192:195], a[80:83], v[128:131]
ds_read_b64_tr_b16 v[182:183], v236 offset:16896
v_mfma_f32_16x16x32_bf16 v[136:139], v[192:195], a[84:87], v[136:139]
ds_read_b128 a[88:91], v233 offset:0
ds_read_b128 a[92:95], v233 offset:2048
buffer_load_dwordx4 v227, s[32:35], s52 offen offset:1024 lds
v_mfma_f32_16x16x32_bf16 v[132:135], v[196:199], a[80:83], v[132:135]
ds_read_b64_tr_b16 v[184:185], v236 offset:4096
ds_read_b64_tr_b16 v[186:187], v237 offset:4608
v_mfma_f32_16x16x32_bf16 v[140:143], v[196:199], a[84:87], v[140:143]
ds_read_b64_tr_b16 v[188:189], v237 offset:4096
s_add_u32 m0, s48, 73600
s_waitcnt lgkmcnt(9)
v_mfma_f32_16x16x32_bf16 v[144:147], v[200:203], a[80:83], v[144:147]
ds_read_b64_tr_b16 v[190:191], v236 offset:4608
buffer_load_dwordx4 v226, s[32:35], s52 offen offset:128 lds
v_mfma_f32_16x16x32_bf16 v[152:155], v[200:203], a[84:87], v[152:155]
ds_read_b64_tr_b16 v[192:193], v236 offset:12288
v_mfma_f32_16x16x32_bf16 v[148:151], v[204:207], a[80:83], v[148:151]
ds_read_b64_tr_b16 v[194:195], v237 offset:12800
buffer_load_dwordx4 v227, s[32:35], s52 offen offset:1152 lds
v_mfma_f32_16x16x32_bf16 v[156:159], v[204:207], a[84:87], v[156:159]
ds_read_b64_tr_b16 v[196:197], v237 offset:12288
s_waitcnt lgkmcnt(9)
v_mfma_f32_16x16x32_bf16 v[160:163], v[176:179], a[80:83], v[160:163]
ds_read_b64_tr_b16 v[198:199], v236 offset:12800
s_add_u32 m0, s48, 81664
v_mfma_f32_16x16x32_bf16 v[168:171], v[176:179], a[84:87], v[168:171]
ds_read_b64_tr_b16 v[200:201], v236 offset:20480
buffer_load_dwordx4 v226, s[32:35], s52 offen offset:256 lds
v_mfma_f32_16x16x32_bf16 v[164:167], v[180:183], a[80:83], v[164:167]
ds_read_b64_tr_b16 v[202:203], v237 offset:20992
v_mfma_f32_16x16x32_bf16 v[172:175], v[180:183], a[84:87], v[172:175]
ds_read_b64_tr_b16 v[204:205], v237 offset:20480
s_waitcnt lgkmcnt(7)
v_mfma_f32_16x16x32_bf16 v[128:131], v[184:187], a[88:91], v[128:131]
ds_read_b64_tr_b16 v[206:207], v236 offset:20992
buffer_load_dwordx4 v227, s[32:35], s52 offen offset:1280 lds
v_mfma_f32_16x16x32_bf16 v[136:139], v[184:187], a[92:95], v[136:139]
v_mfma_f32_16x16x32_bf16 v[132:135], v[188:191], a[88:91], v[132:135]
v_mfma_f32_16x16x32_bf16 v[140:143], v[188:191], a[92:95], v[140:143]
s_add_u32 s53, s50, 16384
v_add_u32 v232, s53, v231
s_waitcnt lgkmcnt(4)
v_mfma_f32_16x16x32_bf16 v[144:147], v[192:195], a[88:91], v[144:147]
v_xor_b32 v233, 64, v232
v_add_u32 v236, 114688, v230
v_mfma_f32_16x16x32_bf16 v[152:155], v[192:195], a[92:95], v[152:155]
v_xor_b32 v237, 32, v236
s_waitcnt vmcnt(16) lgkmcnt(0)
s_barrier
ds_read_b128 a[96:99], v232 offset:0
ds_read_b128 a[100:103], v232 offset:2048
ds_read_b64_tr_b16 v[176:177], v236 offset:0
ds_read_b64_tr_b16 v[178:179], v237 offset:512
ds_read_b64_tr_b16 v[180:181], v237 offset:0
ds_read_b64_tr_b16 v[182:183], v236 offset:512
ds_read_b64_tr_b16 v[184:185], v236 offset:8192
ds_read_b64_tr_b16 v[186:187], v237 offset:8704
v_mfma_f32_16x16x32_bf16 v[148:151], v[196:199], a[88:91], v[148:151]
s_add_u32 m0, s48, 8192
s_nop 0
buffer_load_dwordx4 v228, s[40:43], s69 offen lds
v_mfma_f32_16x16x32_bf16 v[156:159], v[196:199], a[92:95], v[156:159]
ds_read_b64_tr_b16 v[188:189], v237 offset:8192
v_mfma_f32_16x16x32_bf16 v[160:163], v[200:203], a[88:91], v[160:163]
ds_read_b64_tr_b16 v[190:191], v236 offset:8704
buffer_load_dwordx4 v229, s[40:43], s69 offen offset:1024 lds
v_mfma_f32_16x16x32_bf16 v[168:171], v[200:203], a[92:95], v[168:171]
ds_read_b64_tr_b16 v[192:193], v236 offset:16384
v_mfma_f32_16x16x32_bf16 v[164:167], v[204:207], a[88:91], v[164:167]
ds_read_b64_tr_b16 v[194:195], v237 offset:16896
s_mul_i32 s52, s69, 6144
s_add_u32 m0, s48, 90112
v_mfma_f32_16x16x32_bf16 v[172:175], v[204:207], a[92:95], v[172:175]
ds_read_b64_tr_b16 v[196:197], v237 offset:16384
buffer_load_dwordx4 v226, s[32:35], s52 offen lds
s_waitcnt lgkmcnt(7)
v_mfma_f32_16x16x32_bf16 v[128:131], v[176:179], a[96:99], v[128:131]
ds_read_b64_tr_b16 v[198:199], v236 offset:16896
v_mfma_f32_16x16x32_bf16 v[136:139], v[176:179], a[100:103], v[136:139]
ds_read_b128 a[104:107], v233 offset:0
ds_read_b128 a[108:111], v233 offset:2048
buffer_load_dwordx4 v227, s[32:35], s52 offen offset:1024 lds
v_mfma_f32_16x16x32_bf16 v[132:135], v[180:183], a[96:99], v[132:135]
ds_read_b64_tr_b16 v[200:201], v236 offset:4096
ds_read_b64_tr_b16 v[202:203], v237 offset:4608
v_mfma_f32_16x16x32_bf16 v[140:143], v[180:183], a[100:103], v[140:143]
ds_read_b64_tr_b16 v[204:205], v237 offset:4096
s_add_u32 m0, s48, 98176
s_waitcnt lgkmcnt(9)
v_mfma_f32_16x16x32_bf16 v[144:147], v[184:187], a[96:99], v[144:147]
ds_read_b64_tr_b16 v[206:207], v236 offset:4608
buffer_load_dwordx4 v226, s[32:35], s52 offen offset:128 lds
v_mfma_f32_16x16x32_bf16 v[152:155], v[184:187], a[100:103], v[152:155]
ds_read_b64_tr_b16 v[176:177], v236 offset:12288
v_mfma_f32_16x16x32_bf16 v[148:151], v[188:191], a[96:99], v[148:151]
ds_read_b64_tr_b16 v[178:179], v237 offset:12800
buffer_load_dwordx4 v227, s[32:35], s52 offen offset:1152 lds
v_mfma_f32_16x16x32_bf16 v[156:159], v[188:191], a[100:103], v[156:159]
ds_read_b64_tr_b16 v[180:181], v237 offset:12288
s_waitcnt lgkmcnt(9)
v_mfma_f32_16x16x32_bf16 v[160:163], v[192:195], a[96:99], v[160:163]
ds_read_b64_tr_b16 v[182:183], v236 offset:12800
s_add_u32 m0, s48, 106240
v_mfma_f32_16x16x32_bf16 v[168:171], v[192:195], a[100:103], v[168:171]
ds_read_b64_tr_b16 v[184:185], v236 offset:20480
buffer_load_dwordx4 v226, s[32:35], s52 offen offset:256 lds
v_mfma_f32_16x16x32_bf16 v[164:167], v[196:199], a[96:99], v[164:167]
ds_read_b64_tr_b16 v[186:187], v237 offset:20992
v_mfma_f32_16x16x32_bf16 v[172:175], v[196:199], a[100:103], v[172:175]
ds_read_b64_tr_b16 v[188:189], v237 offset:20480
s_waitcnt lgkmcnt(7)
v_mfma_f32_16x16x32_bf16 v[128:131], v[200:203], a[104:107], v[128:131]
ds_read_b64_tr_b16 v[190:191], v236 offset:20992
buffer_load_dwordx4 v227, s[32:35], s52 offen offset:1280 lds
v_mfma_f32_16x16x32_bf16 v[136:139], v[200:203], a[108:111], v[136:139]
v_mfma_f32_16x16x32_bf16 v[132:135], v[204:207], a[104:107], v[132:135]
v_mfma_f32_16x16x32_bf16 v[140:143], v[204:207], a[108:111], v[140:143]
s_add_u32 s53, s50, 24576
v_add_u32 v232, s53, v231
s_waitcnt lgkmcnt(4)
v_mfma_f32_16x16x32_bf16 v[144:147], v[176:179], a[104:107], v[144:147]
v_xor_b32 v233, 64, v232
v_add_u32 v236, 139264, v230
v_mfma_f32_16x16x32_bf16 v[152:155], v[176:179], a[108:111], v[152:155]
v_xor_b32 v237, 32, v236
s_waitcnt vmcnt(16) lgkmcnt(0)
s_barrier
s_bitcmp1_b32 s90, 0
s_cbranch_scc0 L_noswap
s_mov_b32 s20, s60
s_mov_b32 s60, s65
s_mov_b32 s65, s20
s_mov_b32 s20, s61
s_mov_b32 s61, s66
s_mov_b32 s66, s20
s_mov_b32 s20, s62
s_mov_b32 s62, s67
s_mov_b32 s67, s20
s_mov_b32 s20, s63
s_mov_b32 s63, s68
s_mov_b32 s68, s20
s_mov_b32 s20, s64
s_mov_b32 s64, s69
s_mov_b32 s69, s20
L_noswap:
ds_read_b128 a[112:115], v232 offset:0
ds_read_b128 a[116:119], v232 offset:2048
ds_read_b64_tr_b16 v[192:193], v236 offset:0
ds_read_b64_tr_b16 v[194:195], v237 offset:512
ds_read_b64_tr_b16 v[196:197], v237 offset:0
ds_read_b64_tr_b16 v[198:199], v236 offset:512
ds_read_b64_tr_b16 v[200:201], v236 offset:8192
ds_read_b64_tr_b16 v[202:203], v237 offset:8704
v_mfma_f32_16x16x32_bf16 v[148:151], v[180:183], a[104:107], v[148:151]
s_mov_b32 s52, 0
s_add_u32 m0, s48, 114688
s_nop 0
buffer_load_dwordx4 v224, s[24:27], s52 offen nt lds
v_mfma_f32_16x16x32_bf16 v[156:159], v[180:183], a[108:111], v[156:159]
ds_read_b64_tr_b16 v[204:205], v237 offset:8192
v_mfma_f32_16x16x32_bf16 v[160:163], v[184:187], a[104:107], v[160:163]
ds_read_b64_tr_b16 v[206:207], v236 offset:8704
buffer_load_dwordx4 v225, s[24:27], s52 offen offset:1024 nt lds
v_mfma_f32_16x16x32_bf16 v[168:171], v[184:187], a[108:111], v[168:171]
ds_read_b64_tr_b16 v[176:177], v236 offset:16384
s_add_u32 m0, s48, 122752
v_mfma_f32_16x16x32_bf16 v[164:167], v[188:191], a[104:107], v[164:167]
ds_read_b64_tr_b16 v[178:179], v237 offset:16896
buffer_load_dwordx4 v224, s[24:27], s52 offen offset:128 nt lds
v_mfma_f32_16x16x32_bf16 v[172:175], v[188:191], a[108:111], v[172:175]
ds_read_b64_tr_b16 v[180:181], v237 offset:16384
s_waitcnt lgkmcnt(7)
v_mfma_f32_16x16x32_bf16 v[128:131], v[192:195], a[112:115], v[128:131]
ds_read_b64_tr_b16 v[182:183], v236 offset:16896
buffer_load_dwordx4 v225, s[24:27], s52 offen offset:1152 nt lds
v_mfma_f32_16x16x32_bf16 v[136:139], v[192:195], a[116:119], v[136:139]
ds_read_b128 a[120:123], v233 offset:0
ds_read_b128 a[124:127], v233 offset:2048
s_add_u32 m0, s48, 130816
v_mfma_f32_16x16x32_bf16 v[132:135], v[196:199], a[112:115], v[132:135]
ds_read_b64_tr_b16 v[184:185], v236 offset:4096
ds_read_b64_tr_b16 v[186:187], v237 offset:4608
buffer_load_dwordx4 v224, s[24:27], s52 offen offset:256 nt lds
v_mfma_f32_16x16x32_bf16 v[140:143], v[196:199], a[116:119], v[140:143]
ds_read_b64_tr_b16 v[188:189], v237 offset:4096
s_waitcnt lgkmcnt(9)
v_mfma_f32_16x16x32_bf16 v[144:147], v[200:203], a[112:115], v[144:147]
ds_read_b64_tr_b16 v[190:191], v236 offset:4608
v_mfma_f32_16x16x32_bf16 v[152:155], v[200:203], a[116:119], v[152:155]
ds_read_b64_tr_b16 v[192:193], v236 offset:12288
buffer_load_dwordx4 v225, s[24:27], s52 offen offset:1280 nt lds
v_mfma_f32_16x16x32_bf16 v[148:151], v[204:207], a[112:115], v[148:151]
ds_read_b64_tr_b16 v[194:195], v237 offset:12800
v_mfma_f32_16x16x32_bf16 v[156:159], v[204:207], a[116:119], v[156:159]
ds_read_b64_tr_b16 v[196:197], v237 offset:12288
s_waitcnt lgkmcnt(9)
v_mfma_f32_16x16x32_bf16 v[160:163], v[176:179], a[112:115], v[160:163]
ds_read_b64_tr_b16 v[198:199], v236 offset:12800
v_mfma_f32_16x16x32_bf16 v[168:171], v[176:179], a[116:119], v[168:171]
ds_read_b64_tr_b16 v[200:201], v236 offset:20480
v_mfma_f32_16x16x32_bf16 v[164:167], v[180:183], a[112:115], v[164:167]
ds_read_b64_tr_b16 v[202:203], v237 offset:20992
v_mfma_f32_16x16x32_bf16 v[172:175], v[180:183], a[116:119], v[172:175]
ds_read_b64_tr_b16 v[204:205], v237 offset:20480
s_waitcnt lgkmcnt(7)
v_mfma_f32_16x16x32_bf16 v[128:131], v[184:187], a[120:123], v[128:131]
ds_read_b64_tr_b16 v[206:207], v236 offset:20992
v_mfma_f32_16x16x32_bf16 v[136:139], v[184:187], a[124:127], v[136:139]
v_mfma_f32_16x16x32_bf16 v[132:135], v[188:191], a[120:123], v[132:135]
v_mfma_f32_16x16x32_bf16 v[140:143], v[188:191], a[124:127], v[140:143]
s_add_u32 s53, s50, 0
v_add_u32 v232, s53, v231
s_waitcnt lgkmcnt(4)
v_mfma_f32_16x16x32_bf16 v[144:147], v[192:195], a[120:123], v[144:147]
v_xor_b32 v233, 64, v232
v_add_u32 v236, 65536, v230
v_mfma_f32_16x16x32_bf16 v[152:155], v[192:195], a[124:127], v[152:155]
v_xor_b32 v237, 32, v236
s_waitcnt vmcnt(14) lgkmcnt(0)
s_barrier
ds_read_b128 a[128:131], v232 offset:0
ds_read_b128 a[132:135], v232 offset:2048
ds_read_b64_tr_b16 v[176:177], v236 offset:0
ds_read_b64_tr_b16 v[178:179], v237 offset:512
ds_read_b64_tr_b16 v[180:181], v237 offset:0
ds_read_b64_tr_b16 v[182:183], v236 offset:512
ds_read_b64_tr_b16 v[184:185], v236 offset:8192
ds_read_b64_tr_b16 v[186:187], v237 offset:8704
v_mfma_f32_16x16x32_bf16 v[148:151], v[196:199], a[120:123], v[148:151]
s_mov_b32 s52, 24576
s_add_u32 m0, s48, 139264
s_nop 0
buffer_load_dwordx4 v224, s[24:27], s52 offen nt lds
v_mfma_f32_16x16x32_bf16 v[156:159], v[196:199], a[124:127], v[156:159]
ds_read_b64_tr_b16 v[188:189], v237 offset:8192
v_mfma_f32_16x16x32_bf16 v[160:163], v[200:203], a[120:123], v[160:163]
ds_read_b64_tr_b16 v[190:191], v236 offset:8704
buffer_load_dwordx4 v225, s[24:27], s52 offen offset:1024 nt lds
v_mfma_f32_16x16x32_bf16 v[168:171], v[200:203], a[124:127], v[168:171]
ds_read_b64_tr_b16 v[192:193], v236 offset:16384
s_add_u32 m0, s48, 147328
v_mfma_f32_16x16x32_bf16 v[164:167], v[204:207], a[120:123], v[164:167]
ds_read_b64_tr_b16 v[194:195], v237 offset:16896
buffer_load_dwordx4 v224, s[24:27], s52 offen offset:128 nt lds
v_mfma_f32_16x16x32_bf16 v[172:175], v[204:207], a[124:127], v[172:175]
ds_read_b64_tr_b16 v[196:197], v237 offset:16384
s_waitcnt lgkmcnt(7)
v_mfma_f32_16x16x32_bf16 v[128:131], v[176:179], a[128:131], v[128:131]
ds_read_b64_tr_b16 v[198:199], v236 offset:16896
buffer_load_dwordx4 v225, s[24:27], s52 offen offset:1152 nt lds
v_mfma_f32_16x16x32_bf16 v[136:139], v[176:179], a[132:135], v[136:139]
ds_read_b128 a[136:139], v233 offset:0
ds_read_b128 a[140:143], v233 offset:2048
s_add_u32 m0, s48, 155392
v_mfma_f32_16x16x32_bf16 v[132:135], v[180:183], a[128:131], v[132:135]
ds_read_b64_tr_b16 v[200:201], v236 offset:4096
ds_read_b64_tr_b16 v[202:203], v237 offset:4608
buffer_load_dwordx4 v224, s[24:27], s52 offen offset:256 nt lds
v_mfma_f32_16x16x32_bf16 v[140:143], v[180:183], a[132:135], v[140:143]
ds_read_b64_tr_b16 v[204:205], v237 offset:4096
s_waitcnt lgkmcnt(9)
v_mfma_f32_16x16x32_bf16 v[144:147], v[184:187], a[128:131], v[144:147]
ds_read_b64_tr_b16 v[206:207], v236 offset:4608
v_mfma_f32_16x16x32_bf16 v[152:155], v[184:187], a[132:135], v[152:155]
ds_read_b64_tr_b16 v[176:177], v236 offset:12288
buffer_load_dwordx4 v225, s[24:27], s52 offen offset:1280 nt lds
v_mfma_f32_16x16x32_bf16 v[148:151], v[188:191], a[128:131], v[148:151]
ds_read_b64_tr_b16 v[178:179], v237 offset:12800
v_mfma_f32_16x16x32_bf16 v[156:159], v[188:191], a[132:135], v[156:159]
ds_read_b64_tr_b16 v[180:181], v237 offset:12288
s_waitcnt lgkmcnt(9)
v_mfma_f32_16x16x32_bf16 v[160:163], v[192:195], a[128:131], v[160:163]
ds_read_b64_tr_b16 v[182:183], v236 offset:12800
v_mfma_f32_16x16x32_bf16 v[168:171], v[192:195], a[132:135], v[168:171]
ds_read_b64_tr_b16 v[184:185], v236 offset:20480
v_mfma_f32_16x16x32_bf16 v[164:167], v[196:199], a[128:131], v[164:167]
ds_read_b64_tr_b16 v[186:187], v237 offset:20992
v_mfma_f32_16x16x32_bf16 v[172:175], v[196:199], a[132:135], v[172:175]
ds_read_b64_tr_b16 v[188:189], v237 offset:20480
s_waitcnt lgkmcnt(7)
v_mfma_f32_16x16x32_bf16 v[128:131], v[200:203], a[136:139], v[128:131]
ds_read_b64_tr_b16 v[190:191], v236 offset:20992
v_mfma_f32_16x16x32_bf16 v[136:139], v[200:203], a[140:143], v[136:139]
v_mfma_f32_16x16x32_bf16 v[132:135], v[204:207], a[136:139], v[132:135]
v_mfma_f32_16x16x32_bf16 v[140:143], v[204:207], a[140:143], v[140:143]
s_add_u32 s53, s50, 8192
v_add_u32 v232, s53, v231
s_waitcnt lgkmcnt(4)
v_mfma_f32_16x16x32_bf16 v[144:147], v[176:179], a[136:139], v[144:147]
v_xor_b32 v233, 64, v232
v_add_u32 v236, 90112, v230
v_mfma_f32_16x16x32_bf16 v[152:155], v[176:179], a[140:143], v[152:155]
v_xor_b32 v237, 32, v236
s_waitcnt vmcnt(12) lgkmcnt(0)
s_barrier
ds_read_b128 a[144:147], v232 offset:0
ds_read_b128 a[148:151], v232 offset:2048
ds_read_b64_tr_b16 v[192:193], v236 offset:0
ds_read_b64_tr_b16 v[194:195], v237 offset:512
ds_read_b64_tr_b16 v[196:197], v237 offset:0
ds_read_b64_tr_b16 v[198:199], v236 offset:512
ds_read_b64_tr_b16 v[200:201], v236 offset:8192
ds_read_b64_tr_b16 v[202:203], v237 offset:8704
v_mfma_f32_16x16x32_bf16 v[148:151], v[180:183], a[136:139], v[148:151]
v_mfma_f32_16x16x32_bf16 v[156:159], v[180:183], a[140:143], v[156:159]
ds_read_b64_tr_b16 v[204:205], v237 offset:8192
v_mfma_f32_16x16x32_bf16 v[160:163], v[184:187], a[136:139], v[160:163]
ds_read_b64_tr_b16 v[206:207], v236 offset:8704
v_mfma_f32_16x16x32_bf16 v[168:171], v[184:187], a[140:143], v[168:171]
ds_read_b64_tr_b16 v[176:177], v236 offset:16384
v_mfma_f32_16x16x32_bf16 v[164:167], v[188:191], a[136:139], v[164:167]
ds_read_b64_tr_b16 v[178:179], v237 offset:16896
v_mfma_f32_16x16x32_bf16 v[172:175], v[188:191], a[140:143], v[172:175]
ds_read_b64_tr_b16 v[180:181], v237 offset:16384
s_waitcnt lgkmcnt(7)
v_mfma_f32_16x16x32_bf16 v[128:131], v[192:195], a[144:147], v[128:131]
ds_read_b64_tr_b16 v[182:183], v236 offset:16896
v_mfma_f32_16x16x32_bf16 v[136:139], v[192:195], a[148:151], v[136:139]
ds_read_b128 a[152:155], v233 offset:0
ds_read_b128 a[156:159], v233 offset:2048
v_mfma_f32_16x16x32_bf16 v[132:135], v[196:199], a[144:147], v[132:135]
ds_read_b64_tr_b16 v[184:185], v236 offset:4096
ds_read_b64_tr_b16 v[186:187], v237 offset:4608
s_mul_i32 s52, s60, 6144
s_add_u32 s52, s52, 3072
s_add_u32 m0, s48, 65536
v_mfma_f32_16x16x32_bf16 v[140:143], v[196:199], a[148:151], v[140:143]
ds_read_b64_tr_b16 v[188:189], v237 offset:4096
buffer_load_dwordx4 v226, s[32:35], s52 offen lds
s_waitcnt lgkmcnt(9)
v_mfma_f32_16x16x32_bf16 v[144:147], v[200:203], a[144:147], v[144:147]
ds_read_b64_tr_b16 v[190:191], v236 offset:4608
v_mfma_f32_16x16x32_bf16 v[152:155], v[200:203], a[148:151], v[152:155]
ds_read_b64_tr_b16 v[192:193], v236 offset:12288
buffer_load_dwordx4 v227, s[32:35], s52 offen offset:1024 lds
v_mfma_f32_16x16x32_bf16 v[148:151], v[204:207], a[144:147], v[148:151]
ds_read_b64_tr_b16 v[194:195], v237 offset:12800
v_mfma_f32_16x16x32_bf16 v[156:159], v[204:207], a[148:151], v[156:159]
ds_read_b64_tr_b16 v[196:197], v237 offset:12288
s_add_u32 m0, s48, 73600
s_waitcnt lgkmcnt(9)
v_mfma_f32_16x16x32_bf16 v[160:163], v[176:179], a[144:147], v[160:163]
ds_read_b64_tr_b16 v[198:199], v236 offset:12800
buffer_load_dwordx4 v226, s[32:35], s52 offen offset:128 lds
v_mfma_f32_16x16x32_bf16 v[168:171], v[176:179], a[148:151], v[168:171]
ds_read_b64_tr_b16 v[200:201], v236 offset:20480
v_mfma_f32_16x16x32_bf16 v[164:167], v[180:183], a[144:147], v[164:167]
ds_read_b64_tr_b16 v[202:203], v237 offset:20992
v_mfma_f32_16x16x32_bf16 v[172:175], v[180:183], a[148:151], v[172:175]
ds_read_b64_tr_b16 v[204:205], v237 offset:20480
buffer_load_dwordx4 v227, s[32:35], s52 offen offset:1152 lds
s_waitcnt lgkmcnt(7)
v_mfma_f32_16x16x32_bf16 v[128:131], v[184:187], a[152:155], v[128:131]
ds_read_b64_tr_b16 v[206:207], v236 offset:20992
v_mfma_f32_16x16x32_bf16 v[136:139], v[184:187], a[156:159], v[136:139]
s_add_u32 m0, s48, 81664
v_mfma_f32_16x16x32_bf16 v[132:135], v[188:191], a[152:155], v[132:135]
buffer_load_dwordx4 v226, s[32:35], s52 offen offset:256 lds
v_mfma_f32_16x16x32_bf16 v[140:143], v[188:191], a[156:159], v[140:143]
s_waitcnt lgkmcnt(4)
v_mfma_f32_16x16x32_bf16 v[144:147], v[192:195], a[152:155], v[144:147]
v_mfma_f32_16x16x32_bf16 v[152:155], v[192:195], a[156:159], v[152:155]
buffer_load_dwordx4 v227, s[32:35], s52 offen offset:1280 lds
s_waitcnt lgkmcnt(0)
s_barrier
s_mov_b32 s52, 49152
s_add_u32 m0, s48, 90112
s_nop 0
buffer_load_dwordx4 v224, s[24:27], s52 offen nt lds
buffer_load_dwordx4 v225, s[24:27], s52 offen offset:1024 nt lds
v_mfma_f32_16x16x32_bf16 v[148:151], v[196:199], a[152:155], v[148:151]
s_add_u32 m0, s48, 98176
s_nop 0
buffer_load_dwordx4 v224, s[24:27], s52 offen offset:128 nt lds
buffer_load_dwordx4 v225, s[24:27], s52 offen offset:1152 nt lds
v_mfma_f32_16x16x32_bf16 v[156:159], v[196:199], a[156:159], v[156:159]
s_add_u32 m0, s48, 106240
s_nop 0
buffer_load_dwordx4 v224, s[24:27], s52 offen offset:256 nt lds
v_mfma_f32_16x16x32_bf16 v[160:163], v[200:203], a[152:155], v[160:163]
buffer_load_dwordx4 v225, s[24:27], s52 offen offset:1280 nt lds
v_mfma_f32_16x16x32_bf16 v[168:171], v[200:203], a[156:159], v[168:171]
s_add_u32 s53, s49, 114688
v_add_u32 v232, s53, v231
v_mfma_f32_16x16x32_bf16 v[164:167], v[204:207], a[152:155], v[164:167]
v_xor_b32 v233, 64, v232
v_mfma_f32_16x16x32_bf16 v[172:175], v[204:207], a[156:159], v[172:175]
v_cvt_pk_bf16_f32 v128, v128, v129
v_cvt_pk_bf16_f32 v129, v130, v131
v_cvt_pk_bf16_f32 v130, v132, v133
v_cvt_pk_bf16_f32 v131, v134, v135
v_cvt_pk_bf16_f32 v136, v136, v137
v_cvt_pk_bf16_f32 v137, v138, v139
v_cvt_pk_bf16_f32 v138, v140, v141
v_cvt_pk_bf16_f32 v139, v142, v143
v_cvt_pk_bf16_f32 v144, v144, v145
v_cvt_pk_bf16_f32 v145, v146, v147
v_cvt_pk_bf16_f32 v146, v148, v149
v_cvt_pk_bf16_f32 v147, v150, v151
v_cvt_pk_bf16_f32 v152, v152, v153
v_cvt_pk_bf16_f32 v153, v154, v155
v_cvt_pk_bf16_f32 v154, v156, v157
v_cvt_pk_bf16_f32 v155, v158, v159
v_cvt_pk_bf16_f32 v160, v160, v161
v_cvt_pk_bf16_f32 v161, v162, v163
v_cvt_pk_bf16_f32 v162, v164, v165
v_cvt_pk_bf16_f32 v163, v166, v167
v_cvt_pk_bf16_f32 v168, v168, v169
v_cvt_pk_bf16_f32 v169, v170, v171
v_cvt_pk_bf16_f32 v170, v172, v173
v_cvt_pk_bf16_f32 v171, v174, v175
ds_write_b64 v251, v[128:129] offset:32768
ds_write_b64 v251, v[130:131] offset:33280
ds_write_b64 v251, v[136:137] offset:33792
ds_write_b64 v251, v[138:139] offset:34304
ds_write_b64 v251, v[144:145] offset:40960
ds_write_b64 v251, v[146:147] offset:41472
ds_write_b64 v251, v[152:153] offset:41984
ds_write_b64 v251, v[154:155] offset:42496
ds_write_b64 v251, v[160:161] offset:49152
ds_write_b64 v251, v[162:163] offset:49664
ds_write_b64 v251, v[168:169] offset:50176
ds_write_b64 v251, v[170:171] offset:50688
s_branch L_head_done
L_head_odd:
s_add_u32 s53, s50, 0
v_add_u32 v232, s53, v231
v_xor_b32 v233, 64, v232
v_add_u32 v236, 65536, v230
v_xor_b32 v237, 32, v236
s_waitcnt vmcnt(17)
s_barrier
ds_read_b128 a[80:83], v232 offset:0
ds_read_b128 a[84:87], v232 offset:2048
ds_read_b64_tr_b16 v[176:177], v236 offset:0
ds_read_b64_tr_b16 v[178:179], v237 offset:512
ds_read_b64_tr_b16 v[180:181], v237 offset:0
ds_read_b64_tr_b16 v[182:183], v236 offset:512
ds_read_b64_tr_b16 v[184:185], v236 offset:8192
ds_read_b64_tr_b16 v[186:187], v237 offset:8704
ds_read_b64_tr_b16 v[188:189], v237 offset:8192
ds_read_b64_tr_b16 v[190:191], v236 offset:8704
ds_read_b64_tr_b16 v[192:193], v236 offset:16384
ds_read_b64_tr_b16 v[194:195], v237 offset:16896
ds_read_b64_tr_b16 v[196:197], v237 offset:16384
ds_read_b64_tr_b16 v[198:199], v236 offset:16896
s_waitcnt lgkmcnt(8)
v_mfma_f32_16x16x32_bf16 v[128:131], v[176:179], a[80:83], 0
s_add_u32 m0, s48, 24576
s_nop 0
buffer_load_dwordx4 v228, s[40:43], s63 offen lds
v_mfma_f32_16x16x32_bf16 v[136:139], v[176:179], a[84:87], 0
ds_read_b128 a[88:91], v233 offset:0
ds_read_b128 a[92:95], v233 offset:2048
buffer_load_dwordx4 v229, s[40:43], s63 offen offset:1024 lds
v_mfma_f32_16x16x32_bf16 v[132:135], v[180:183], a[80:83], 0
ds_read_b64_tr_b16 v[200:201], v236 offset:4096
ds_read_b64_tr_b16 v[202:203], v237 offset:4608
s_mul_i32 s52, s63, 6144
s_add_u32 m0, s48, 139264
v_mfma_f32_16x16x32_bf16 v[140:143], v[180:183], a[84:87], 0
ds_read_b64_tr_b16 v[204:205], v237 offset:4096
buffer_load_dwordx4 v226, s[32:35], s52 offen lds
s_waitcnt lgkmcnt(9)
v_mfma_f32_16x16x32_bf16 v[144:147], v[184:187], a[80:83], 0
ds_read_b64_tr_b16 v[206:207], v236 offset:4608
v_mfma_f32_16x16x32_bf16 v[152:155], v[184:187], a[84:87], 0
ds_read_b64_tr_b16 v[176:177], v236 offset:12288
buffer_load_dwordx4 v227, s[32:35], s52 offen offset:1024 lds
v_mfma_f32_16x16x32_bf16 v[148:151], v[188:191], a[80:83], 0
ds_read_b64_tr_b16 v[178:179], v237 offset:12800
s_add_u32 m0, s48, 147328
v_mfma_f32_16x16x32_bf16 v[156:159], v[188:191], a[84:87], 0
ds_read_b64_tr_b16 v[180:181], v237 offset:12288
buffer_load_dwordx4 v226, s[32:35], s52 offen offset:128 lds
s_waitcnt lgkmcnt(9)
v_mfma_f32_16x16x32_bf16 v[160:163], v[192:195], a[80:83], 0
ds_read_b64_tr_b16 v[182:183], v236 offset:12800
v_mfma_f32_16x16x32_bf16 v[168:171], v[192:195], a[84:87], 0
ds_read_b64_tr_b16 v[184:185], v236 offset:20480
buffer_load_dwordx4 v227, s[32:35], s52 offen offset:1152 lds
v_mfma_f32_16x16x32_bf16 v[164:167], v[196:199], a[80:83], 0
ds_read_b64_tr_b16 v[186:187], v237 offset:20992
s_add_u32 m0, s48, 155392
v_mfma_f32_16x16x32_bf16 v[172:175], v[196:199], a[84:87], 0
ds_read_b64_tr_b16 v[188:189], v237 offset:20480
buffer_load_dwordx4 v226, s[32:35], s52 offen offset:256 lds
s_waitcnt lgkmcnt(7)
v_mfma_f32_16x16x32_bf16 v[128:131], v[200:203], a[88:91], v[128:131]
ds_read_b64_tr_b16 v[190:191], v236 offset:20992
v_mfma_f32_16x16x32_bf16 v[136:139], v[200:203], a[92:95], v[136:139]
buffer_load_dwordx4 v227, s[32:35], s52 offen offset:1280 lds
v_mfma_f32_16x16x32_bf16 v[132:135], v[204:207], a[88:91], v[132:135]
v_mfma_f32_16x16x32_bf16 v[140:143], v[204:207], a[92:95], v[140:143]
s_add_u32 s53, s50, 8192
v_add_u32 v232, s53, v231
s_waitcnt lgkmcnt(4)
v_mfma_f32_16x16x32_bf16 v[144:147], v[176:179], a[88:91], v[144:147]
v_xor_b32 v233, 64, v232
v_add_u32 v236, 90112, v230
v_mfma_f32_16x16x32_bf16 v[152:155], v[176:179], a[92:95], v[152:155]
v_xor_b32 v237, 32, v236
s_waitcnt vmcnt(16) lgkmcnt(0)
s_barrier
ds_read_b128 a[96:99], v232 offset:0
ds_read_b128 a[100:103], v232 offset:2048
ds_read_b64_tr_b16 v[192:193], v236 offset:0
ds_read_b64_tr_b16 v[194:195], v237 offset:512
ds_read_b64_tr_b16 v[196:197], v237 offset:0
ds_read_b64_tr_b16 v[198:199], v236 offset:512
ds_read_b64_tr_b16 v[200:201], v236 offset:8192
ds_read_b64_tr_b16 v[202:203], v237 offset:8704
v_mfma_f32_16x16x32_bf16 v[148:151], v[180:183], a[88:91], v[148:151]
s_add_u32 m0, s48, 0
s_nop 0
buffer_load_dwordx4 v228, s[40:43], s64 offen lds
v_mfma_f32_16x16x32_bf16 v[156:159], v[180:183], a[92:95], v[156:159]
ds_read_b64_tr_b16 v[204:205], v237 offset:8192
v_mfma_f32_16x16x32_bf16 v[160:163], v[184:187], a[88:91], v[160:163]
ds_read_b64_tr_b16 v[206:207], v236 offset:8704
buffer_load_dwordx4 v229, s[40:43], s64 offen offset:1024 lds
v_mfma_f32_16x16x32_bf16 v[168:171], v[184:187], a[92:95], v[168:171]
ds_read_b64_tr_b16 v[176:177], v236 offset:16384
v_mfma_f32_16x16x32_bf16 v[164:167], v[188:191], a[88:91], v[164:167]
ds_read_b64_tr_b16 v[178:179], v237 offset:16896
s_mul_i32 s52, s64, 6144
s_add_u32 m0, s48, 65536
v_mfma_f32_16x16x32_bf16 v[172:175], v[188:191], a[92:95], v[172:175]
ds_read_b64_tr_b16 v[180:181], v237 offset:16384
buffer_load_dwordx4 v226, s[32:35], s52 offen lds
s_waitcnt lgkmcnt(7)
v_mfma_f32_16x16x32_bf16 v[128:131], v[192:195], a[96:99], v[128:131]
ds_read_b64_tr_b16 v[182:183], v236 offset:16896
v_mfma_f32_16x16x32_bf16 v[136:139], v[192:195], a[100:103], v[136:139]
ds_read_b128 a[104:107], v233 offset:0
ds_read_b128 a[108:111], v233 offset:2048
buffer_load_dwordx4 v227, s[32:35], s52 offen offset:1024 lds
v_mfma_f32_16x16x32_bf16 v[132:135], v[196:199], a[96:99], v[132:135]
ds_read_b64_tr_b16 v[184:185], v236 offset:4096
ds_read_b64_tr_b16 v[186:187], v237 offset:4608
v_mfma_f32_16x16x32_bf16 v[140:143], v[196:199], a[100:103], v[140:143]
ds_read_b64_tr_b16 v[188:189], v237 offset:4096
s_add_u32 m0, s48, 73600
s_waitcnt lgkmcnt(9)
v_mfma_f32_16x16x32_bf16 v[144:147], v[200:203], a[96:99], v[144:147]
ds_read_b64_tr_b16 v[190:191], v236 offset:4608
buffer_load_dwordx4 v226, s[32:35], s52 offen offset:128 lds
v_mfma_f32_16x16x32_bf16 v[152:155], v[200:203], a[100:103], v[152:155]
ds_read_b64_tr_b16 v[192:193], v236 offset:12288
v_mfma_f32_16x16x32_bf16 v[148:151], v[204:207], a[96:99], v[148:151]
ds_read_b64_tr_b16 v[194:195], v237 offset:12800
buffer_load_dwordx4 v227, s[32:35], s52 offen offset:1152 lds
v_mfma_f32_16x16x32_bf16 v[156:159], v[204:207], a[100:103], v[156:159]
ds_read_b64_tr_b16 v[196:197], v237 offset:12288
s_waitcnt lgkmcnt(9)
v_mfma_f32_16x16x32_bf16 v[160:163], v[176:179], a[96:99], v[160:163]
ds_read_b64_tr_b16 v[198:199], v236 offset:12800
s_add_u32 m0, s48, 81664
v_mfma_f32_16x16x32_bf16 v[168:171], v[176:179], a[100:103], v[168:171]
ds_read_b64_tr_b16 v[200:201], v236 offset:20480
buffer_load_dwordx4 v226, s[32:35], s52 offen offset:256 lds
v_mfma_f32_16x16x32_bf16 v[164:167], v[180:183], a[96:99], v[164:167]
ds_read_b64_tr_b16 v[202:203], v237 offset:20992
v_mfma_f32_16x16x32_bf16 v[172:175], v[180:183], a[100:103], v[172:175]
ds_read_b64_tr_b16 v[204:205], v237 offset:20480
s_waitcnt lgkmcnt(7)
v_mfma_f32_16x16x32_bf16 v[128:131], v[184:187], a[104:107], v[128:131]
ds_read_b64_tr_b16 v[206:207], v236 offset:20992
buffer_load_dwordx4 v227, s[32:35], s52 offen offset:1280 lds
v_mfma_f32_16x16x32_bf16 v[136:139], v[184:187], a[108:111], v[136:139]
v_mfma_f32_16x16x32_bf16 v[132:135], v[188:191], a[104:107], v[132:135]
v_mfma_f32_16x16x32_bf16 v[140:143], v[188:191], a[108:111], v[140:143]
s_add_u32 s53, s50, 16384
v_add_u32 v232, s53, v231
s_waitcnt lgkmcnt(4)
v_mfma_f32_16x16x32_bf16 v[144:147], v[192:195], a[104:107], v[144:147]
v_xor_b32 v233, 64, v232
v_add_u32 v236, 114688, v230
v_mfma_f32_16x16x32_bf16 v[152:155], v[192:195], a[108:111], v[152:155]
v_xor_b32 v237, 32, v236
s_waitcnt vmcnt(16) lgkmcnt(0)
s_barrier
ds_read_b128 a[112:115], v232 offset:0
ds_read_b128 a[116:119], v232 offset:2048
ds_read_b64_tr_b16 v[176:177], v236 offset:0
ds_read_b64_tr_b16 v[178:179], v237 offset:512
ds_read_b64_tr_b16 v[180:181], v237 offset:0
ds_read_b64_tr_b16 v[182:183], v236 offset:512
ds_read_b64_tr_b16 v[184:185], v236 offset:8192
ds_read_b64_tr_b16 v[186:187], v237 offset:8704
v_mfma_f32_16x16x32_bf16 v[148:151], v[196:199], a[104:107], v[148:151]
s_add_u32 m0, s48, 8192
s_nop 0
buffer_load_dwordx4 v228, s[40:43], s65 offen lds
v_mfma_f32_16x16x32_bf16 v[156:159], v[196:199], a[108:111], v[156:159]
ds_read_b64_tr_b16 v[188:189], v237 offset:8192
v_mfma_f32_16x16x32_bf16 v[160:163], v[200:203], a[104:107], v[160:163]
ds_read_b64_tr_b16 v[190:191], v236 offset:8704
buffer_load_dwordx4 v229, s[40:43], s65 offen offset:1024 lds
v_mfma_f32_16x16x32_bf16 v[168:171], v[200:203], a[108:111], v[168:171]
ds_read_b64_tr_b16 v[192:193], v236 offset:16384
v_mfma_f32_16x16x32_bf16 v[164:167], v[204:207], a[104:107], v[164:167]
ds_read_b64_tr_b16 v[194:195], v237 offset:16896
s_mul_i32 s52, s65, 6144
s_add_u32 m0, s48, 90112
v_mfma_f32_16x16x32_bf16 v[172:175], v[204:207], a[108:111], v[172:175]
ds_read_b64_tr_b16 v[196:197], v237 offset:16384
buffer_load_dwordx4 v226, s[32:35], s52 offen lds
s_waitcnt lgkmcnt(7)
v_mfma_f32_16x16x32_bf16 v[128:131], v[176:179], a[112:115], v[128:131]
ds_read_b64_tr_b16 v[198:199], v236 offset:16896
v_mfma_f32_16x16x32_bf16 v[136:139], v[176:179], a[116:119], v[136:139]
ds_read_b128 a[120:123], v233 offset:0
ds_read_b128 a[124:127], v233 offset:2048
buffer_load_dwordx4 v227, s[32:35], s52 offen offset:1024 lds
v_mfma_f32_16x16x32_bf16 v[132:135], v[180:183], a[112:115], v[132:135]
ds_read_b64_tr_b16 v[200:201], v236 offset:4096
ds_read_b64_tr_b16 v[202:203], v237 offset:4608
v_mfma_f32_16x16x32_bf16 v[140:143], v[180:183], a[116:119], v[140:143]
ds_read_b64_tr_b16 v[204:205], v237 offset:4096
s_add_u32 m0, s48, 98176
s_waitcnt lgkmcnt(9)
v_mfma_f32_16x16x32_bf16 v[144:147], v[184:187], a[112:115], v[144:147]
ds_read_b64_tr_b16 v[206:207], v236 offset:4608
buffer_load_dwordx4 v226, s[32:35], s52 offen offset:128 lds
v_mfma_f32_16x16x32_bf16 v[152:155], v[184:187], a[116:119], v[152:155]
ds_read_b64_tr_b16 v[176:177], v236 offset:12288
v_mfma_f32_16x16x32_bf16 v[148:151], v[188:191], a[112:115], v[148:151]
ds_read_b64_tr_b16 v[178:179], v237 offset:12800
buffer_load_dwordx4 v227, s[32:35], s52 offen offset:1152 lds
v_mfma_f32_16x16x32_bf16 v[156:159], v[188:191], a[116:119], v[156:159]
ds_read_b64_tr_b16 v[180:181], v237 offset:12288
s_waitcnt lgkmcnt(9)
v_mfma_f32_16x16x32_bf16 v[160:163], v[192:195], a[112:115], v[160:163]
ds_read_b64_tr_b16 v[182:183], v236 offset:12800
s_add_u32 m0, s48, 106240
v_mfma_f32_16x16x32_bf16 v[168:171], v[192:195], a[116:119], v[168:171]
ds_read_b64_tr_b16 v[184:185], v236 offset:20480
buffer_load_dwordx4 v226, s[32:35], s52 offen offset:256 lds
v_mfma_f32_16x16x32_bf16 v[164:167], v[196:199], a[112:115], v[164:167]
ds_read_b64_tr_b16 v[186:187], v237 offset:20992
v_mfma_f32_16x16x32_bf16 v[172:175], v[196:199], a[116:119], v[172:175]
ds_read_b64_tr_b16 v[188:189], v237 offset:20480
s_waitcnt lgkmcnt(7)
v_mfma_f32_16x16x32_bf16 v[128:131], v[200:203], a[120:123], v[128:131]
ds_read_b64_tr_b16 v[190:191], v236 offset:20992
buffer_load_dwordx4 v227, s[32:35], s52 offen offset:1280 lds
v_mfma_f32_16x16x32_bf16 v[136:139], v[200:203], a[124:127], v[136:139]
v_mfma_f32_16x16x32_bf16 v[132:135], v[204:207], a[120:123], v[132:135]
v_mfma_f32_16x16x32_bf16 v[140:143], v[204:207], a[124:127], v[140:143]
s_add_u32 s53, s50, 24576
v_add_u32 v232, s53, v231
s_waitcnt lgkmcnt(4)
v_mfma_f32_16x16x32_bf16 v[144:147], v[176:179], a[120:123], v[144:147]
v_xor_b32 v233, 64, v232
v_add_u32 v236, 139264, v230
v_mfma_f32_16x16x32_bf16 v[152:155], v[176:179], a[124:127], v[152:155]
v_xor_b32 v237, 32, v236
s_waitcnt vmcnt(16) lgkmcnt(0)
s_barrier
ds_read_b128 a[128:131], v232 offset:0
ds_read_b128 a[132:135], v232 offset:2048
ds_read_b64_tr_b16 v[192:193], v236 offset:0
ds_read_b64_tr_b16 v[194:195], v237 offset:512
ds_read_b64_tr_b16 v[196:197], v237 offset:0
ds_read_b64_tr_b16 v[198:199], v236 offset:512
ds_read_b64_tr_b16 v[200:201], v236 offset:8192
ds_read_b64_tr_b16 v[202:203], v237 offset:8704
v_mfma_f32_16x16x32_bf16 v[148:151], v[180:183], a[120:123], v[148:151]
s_add_u32 m0, s48, 16384
s_nop 0
buffer_load_dwordx4 v228, s[40:43], s66 offen lds
v_mfma_f32_16x16x32_bf16 v[156:159], v[180:183], a[124:127], v[156:159]
ds_read_b64_tr_b16 v[204:205], v237 offset:8192
v_mfma_f32_16x16x32_bf16 v[160:163], v[184:187], a[120:123], v[160:163]
ds_read_b64_tr_b16 v[206:207], v236 offset:8704
buffer_load_dwordx4 v229, s[40:43], s66 offen offset:1024 lds
v_mfma_f32_16x16x32_bf16 v[168:171], v[184:187], a[124:127], v[168:171]
ds_read_b64_tr_b16 v[176:177], v236 offset:16384
v_mfma_f32_16x16x32_bf16 v[164:167], v[188:191], a[120:123], v[164:167]
ds_read_b64_tr_b16 v[178:179], v237 offset:16896
s_mul_i32 s52, s66, 6144
s_add_u32 m0, s48, 114688
v_mfma_f32_16x16x32_bf16 v[172:175], v[188:191], a[124:127], v[172:175]
ds_read_b64_tr_b16 v[180:181], v237 offset:16384
buffer_load_dwordx4 v226, s[32:35], s52 offen lds
s_waitcnt lgkmcnt(7)
v_mfma_f32_16x16x32_bf16 v[128:131], v[192:195], a[128:131], v[128:131]
ds_read_b64_tr_b16 v[182:183], v236 offset:16896
v_mfma_f32_16x16x32_bf16 v[136:139], v[192:195], a[132:135], v[136:139]
ds_read_b128 a[136:139], v233 offset:0
ds_read_b128 a[140:143], v233 offset:2048
buffer_load_dwordx4 v227, s[32:35], s52 offen offset:1024 lds
v_mfma_f32_16x16x32_bf16 v[132:135], v[196:199], a[128:131], v[132:135]
ds_read_b64_tr_b16 v[184:185], v236 offset:4096
ds_read_b64_tr_b16 v[186:187], v237 offset:4608
v_mfma_f32_16x16x32_bf16 v[140:143], v[196:199], a[132:135], v[140:143]
ds_read_b64_tr_b16 v[188:189], v237 offset:4096
s_add_u32 m0, s48, 122752
s_waitcnt lgkmcnt(9)
v_mfma_f32_16x16x32_bf16 v[144:147], v[200:203], a[128:131], v[144:147]
ds_read_b64_tr_b16 v[190:191], v236 offset:4608
buffer_load_dwordx4 v226, s[32:35], s52 offen offset:128 lds
v_mfma_f32_16x16x32_bf16 v[152:155], v[200:203], a[132:135], v[152:155]
ds_read_b64_tr_b16 v[192:193], v236 offset:12288
v_mfma_f32_16x16x32_bf16 v[148:151], v[204:207], a[128:131], v[148:151]
ds_read_b64_tr_b16 v[194:195], v237 offset:12800
buffer_load_dwordx4 v227, s[32:35], s52 offen offset:1152 lds
v_mfma_f32_16x16x32_bf16 v[156:159], v[204:207], a[132:135], v[156:159]
ds_read_b64_tr_b16 v[196:197], v237 offset:12288
s_waitcnt lgkmcnt(9)
v_mfma_f32_16x16x32_bf16 v[160:163], v[176:179], a[128:131], v[160:163]
ds_read_b64_tr_b16 v[198:199], v236 offset:12800
s_add_u32 m0, s48, 130816
v_mfma_f32_16x16x32_bf16 v[168:171], v[176:179], a[132:135], v[168:171]
ds_read_b64_tr_b16 v[200:201], v236 offset:20480
buffer_load_dwordx4 v226, s[32:35], s52 offen offset:256 lds
v_mfma_f32_16x16x32_bf16 v[164:167], v[180:183], a[128:131], v[164:167]
ds_read_b64_tr_b16 v[202:203], v237 offset:20992
v_mfma_f32_16x16x32_bf16 v[172:175], v[180:183], a[132:135], v[172:175]
ds_read_b64_tr_b16 v[204:205], v237 offset:20480
s_waitcnt lgkmcnt(7)
v_mfma_f32_16x16x32_bf16 v[128:131], v[184:187], a[136:139], v[128:131]
ds_read_b64_tr_b16 v[206:207], v236 offset:20992
buffer_load_dwordx4 v227, s[32:35], s52 offen offset:1280 lds
v_mfma_f32_16x16x32_bf16 v[136:139], v[184:187], a[140:143], v[136:139]
v_mfma_f32_16x16x32_bf16 v[132:135], v[188:191], a[136:139], v[132:135]
v_mfma_f32_16x16x32_bf16 v[140:143], v[188:191], a[140:143], v[140:143]
s_add_u32 s53, s50, 0
v_add_u32 v232, s53, v231
s_waitcnt lgkmcnt(4)
v_mfma_f32_16x16x32_bf16 v[144:147], v[192:195], a[136:139], v[144:147]
v_xor_b32 v233, 64, v232
v_add_u32 v236, 65536, v230
v_mfma_f32_16x16x32_bf16 v[152:155], v[192:195], a[140:143], v[152:155]
v_xor_b32 v237, 32, v236
s_waitcnt vmcnt(16) lgkmcnt(0)
s_barrier
ds_read_b128 a[144:147], v232 offset:0
ds_read_b128 a[148:151], v232 offset:2048
ds_read_b64_tr_b16 v[176:177], v236 offset:0
ds_read_b64_tr_b16 v[178:179], v237 offset:512
ds_read_b64_tr_b16 v[180:181], v237 offset:0
ds_read_b64_tr_b16 v[182:183], v236 offset:512
ds_read_b64_tr_b16 v[184:185], v236 offset:8192
ds_read_b64_tr_b16 v[186:187], v237 offset:8704
v_mfma_f32_16x16x32_bf16 v[148:151], v[196:199], a[136:139], v[148:151]
s_add_u32 m0, s48, 24576
s_nop 0
buffer_load_dwordx4 v228, s[40:43], s67 offen lds
v_mfma_f32_16x16x32_bf16 v[156:159], v[196:199], a[140:143], v[156:159]
ds_read_b64_tr_b16 v[188:189], v237 offset:8192
v_mfma_f32_16x16x32_bf16 v[160:163], v[200:203], a[136:139], v[160:163]
ds_read_b64_tr_b16 v[190:191], v236 offset:8704
buffer_load_dwordx4 v229, s[40:43], s67 offen offset:1024 lds
v_mfma_f32_16x16x32_bf16 v[168:171], v[200:203], a[140:143], v[168:171]
ds_read_b64_tr_b16 v[192:193], v236 offset:16384
v_mfma_f32_16x16x32_bf16 v[164:167], v[204:207], a[136:139], v[164:167]
ds_read_b64_tr_b16 v[194:195], v237 offset:16896
s_mul_i32 s52, s67, 6144
s_add_u32 m0, s48, 139264
v_mfma_f32_16x16x32_bf16 v[172:175], v[204:207], a[140:143], v[172:175]
ds_read_b64_tr_b16 v[196:197], v237 offset:16384
buffer_load_dwordx4 v226, s[32:35], s52 offen lds
s_waitcnt lgkmcnt(7)
v_mfma_f32_16x16x32_bf16 v[128:131], v[176:179], a[144:147], v[128:131]
ds_read_b64_tr_b16 v[198:199], v236 offset:16896
v_mfma_f32_16x16x32_bf16 v[136:139], v[176:179], a[148:151], v[136:139]
ds_read_b128 a[152:155], v233 offset:0
ds_read_b128 a[156:159], v233 offset:2048
buffer_load_dwordx4 v227, s[32:35], s52 offen offset:1024 lds
v_mfma_f32_16x16x32_bf16 v[132:135], v[180:183], a[144:147], v[132:135]
ds_read_b64_tr_b16 v[200:201], v236 offset:4096
ds_read_b64_tr_b16 v[202:203], v237 offset:4608
v_mfma_f32_16x16x32_bf16 v[140:143], v[180:183], a[148:151], v[140:143]
ds_read_b64_tr_b16 v[204:205], v237 offset:4096
s_add_u32 m0, s48, 147328
s_waitcnt lgkmcnt(9)
v_mfma_f32_16x16x32_bf16 v[144:147], v[184:187], a[144:147], v[144:147]
ds_read_b64_tr_b16 v[206:207], v236 offset:4608
buffer_load_dwordx4 v226, s[32:35], s52 offen offset:128 lds
v_mfma_f32_16x16x32_bf16 v[152:155], v[184:187], a[148:151], v[152:155]
ds_read_b64_tr_b16 v[176:177], v236 offset:12288
v_mfma_f32_16x16x32_bf16 v[148:151], v[188:191], a[144:147], v[148:151]
ds_read_b64_tr_b16 v[178:179], v237 offset:12800
buffer_load_dwordx4 v227, s[32:35], s52 offen offset:1152 lds
v_mfma_f32_16x16x32_bf16 v[156:159], v[188:191], a[148:151], v[156:159]
ds_read_b64_tr_b16 v[180:181], v237 offset:12288
s_waitcnt lgkmcnt(9)
v_mfma_f32_16x16x32_bf16 v[160:163], v[192:195], a[144:147], v[160:163]
ds_read_b64_tr_b16 v[182:183], v236 offset:12800
s_add_u32 m0, s48, 155392
v_mfma_f32_16x16x32_bf16 v[168:171], v[192:195], a[148:151], v[168:171]
ds_read_b64_tr_b16 v[184:185], v236 offset:20480
buffer_load_dwordx4 v226, s[32:35], s52 offen offset:256 lds
v_mfma_f32_16x16x32_bf16 v[164:167], v[196:199], a[144:147], v[164:167]
ds_read_b64_tr_b16 v[186:187], v237 offset:20992
v_mfma_f32_16x16x32_bf16 v[172:175], v[196:199], a[148:151], v[172:175]
ds_read_b64_tr_b16 v[188:189], v237 offset:20480
s_waitcnt lgkmcnt(7)
v_mfma_f32_16x16x32_bf16 v[128:131], v[200:203], a[152:155], v[128:131]
ds_read_b64_tr_b16 v[190:191], v236 offset:20992
buffer_load_dwordx4 v227, s[32:35], s52 offen offset:1280 lds
v_mfma_f32_16x16x32_bf16 v[136:139], v[200:203], a[156:159], v[136:139]
v_mfma_f32_16x16x32_bf16 v[132:135], v[204:207], a[152:155], v[132:135]
v_mfma_f32_16x16x32_bf16 v[140:143], v[204:207], a[156:159], v[140:143]
s_add_u32 s53, s50, 8192
v_add_u32 v232, s53, v231
s_waitcnt lgkmcnt(4)
v_mfma_f32_16x16x32_bf16 v[144:147], v[176:179], a[152:155], v[144:147]
v_xor_b32 v233, 64, v232
v_add_u32 v236, 90112, v230
v_mfma_f32_16x16x32_bf16 v[152:155], v[176:179], a[156:159], v[152:155]
v_xor_b32 v237, 32, v236
s_waitcnt vmcnt(16) lgkmcnt(0)
s_barrier
ds_read_b128 a[0:3], v232 offset:0
ds_read_b128 a[4:7], v232 offset:2048
ds_read_b64_tr_b16 v[192:193], v236 offset:0
ds_read_b64_tr_b16 v[194:195], v237 offset:512
ds_read_b64_tr_b16 v[196:197], v237 offset:0
ds_read_b64_tr_b16 v[198:199], v236 offset:512
ds_read_b64_tr_b16 v[200:201], v236 offset:8192
ds_read_b64_tr_b16 v[202:203], v237 offset:8704
v_mfma_f32_16x16x32_bf16 v[148:151], v[180:183], a[152:155], v[148:151]
s_add_u32 m0, s48, 0
s_nop 0
buffer_load_dwordx4 v228, s[40:43], s68 offen lds
v_mfma_f32_16x16x32_bf16 v[156:159], v[180:183], a[156:159], v[156:159]
ds_read_b64_tr_b16 v[204:205], v237 offset:8192
v_mfma_f32_16x16x32_bf16 v[160:163], v[184:187], a[152:155], v[160:163]
ds_read_b64_tr_b16 v[206:207], v236 offset:8704
buffer_load_dwordx4 v229, s[40:43], s68 offen offset:1024 lds
v_mfma_f32_16x16x32_bf16 v[168:171], v[184:187], a[156:159], v[168:171]
ds_read_b64_tr_b16 v[176:177], v236 offset:16384
v_mfma_f32_16x16x32_bf16 v[164:167], v[188:191], a[152:155], v[164:167]
ds_read_b64_tr_b16 v[178:179], v237 offset:16896
s_mul_i32 s52, s68, 6144
s_add_u32 m0, s48, 65536
v_mfma_f32_16x16x32_bf16 v[172:175], v[188:191], a[156:159], v[172:175]
ds_read_b64_tr_b16 v[180:181], v237 offset:16384
buffer_load_dwordx4 v226, s[32:35], s52 offen lds
s_waitcnt lgkmcnt(7)
v_mfma_f32_16x16x32_bf16 v[128:131], v[192:195], a[0:3], v[128:131]
ds_read_b64_tr_b16 v[182:183], v236 offset:16896
v_mfma_f32_16x16x32_bf16 v[136:139], v[192:195], a[4:7], v[136:139]
ds_read_b128 a[8:11], v233 offset:0
ds_read_b128 a[12:15], v233 offset:2048
buffer_load_dwordx4 v227, s[32:35], s52 offen offset:1024 lds
v_mfma_f32_16x16x32_bf16 v[132:135], v[196:199], a[0:3], v[132:135]
ds_read_b64_tr_b16 v[184:185], v236 offset:4096
ds_read_b64_tr_b16 v[186:187], v237 offset:4608
v_mfma_f32_16x16x32_bf16 v[140:143], v[196:199], a[4:7], v[140:143]
ds_read_b64_tr_b16 v[188:189], v237 offset:4096
s_add_u32 m0, s48, 73600
s_waitcnt lgkmcnt(9)
v_mfma_f32_16x16x32_bf16 v[144:147], v[200:203], a[0:3], v[144:147]
ds_read_b64_tr_b16 v[190:191], v236 offset:4608
buffer_load_dwordx4 v226, s[32:35], s52 offen offset:128 lds
v_mfma_f32_16x16x32_bf16 v[152:155], v[200:203], a[4:7], v[152:155]
ds_read_b64_tr_b16 v[192:193], v236 offset:12288
v_mfma_f32_16x16x32_bf16 v[148:151], v[204:207], a[0:3], v[148:151]
ds_read_b64_tr_b16 v[194:195], v237 offset:12800
buffer_load_dwordx4 v227, s[32:35], s52 offen offset:1152 lds
v_mfma_f32_16x16x32_bf16 v[156:159], v[204:207], a[4:7], v[156:159]
ds_read_b64_tr_b16 v[196:197], v237 offset:12288
s_waitcnt lgkmcnt(9)
v_mfma_f32_16x16x32_bf16 v[160:163], v[176:179], a[0:3], v[160:163]
ds_read_b64_tr_b16 v[198:199], v236 offset:12800
s_add_u32 m0, s48, 81664
v_mfma_f32_16x16x32_bf16 v[168:171], v[176:179], a[4:7], v[168:171]
ds_read_b64_tr_b16 v[200:201], v236 offset:20480
buffer_load_dwordx4 v226, s[32:35], s52 offen offset:256 lds
v_mfma_f32_16x16x32_bf16 v[164:167], v[180:183], a[0:3], v[164:167]
ds_read_b64_tr_b16 v[202:203], v237 offset:20992
v_mfma_f32_16x16x32_bf16 v[172:175], v[180:183], a[4:7], v[172:175]
ds_read_b64_tr_b16 v[204:205], v237 offset:20480
s_waitcnt lgkmcnt(7)
v_mfma_f32_16x16x32_bf16 v[128:131], v[184:187], a[8:11], v[128:131]
ds_read_b64_tr_b16 v[206:207], v236 offset:20992
buffer_load_dwordx4 v227, s[32:35], s52 offen offset:1280 lds
v_mfma_f32_16x16x32_bf16 v[136:139], v[184:187], a[12:15], v[136:139]
v_mfma_f32_16x16x32_bf16 v[132:135], v[188:191], a[8:11], v[132:135]
v_mfma_f32_16x16x32_bf16 v[140:143], v[188:191], a[12:15], v[140:143]
s_add_u32 s53, s50, 16384
v_add_u32 v232, s53, v231
s_waitcnt lgkmcnt(4)
v_mfma_f32_16x16x32_bf16 v[144:147], v[192:195], a[8:11], v[144:147]
v_xor_b32 v233, 64, v232
v_add_u32 v236, 114688, v230
v_mfma_f32_16x16x32_bf16 v[152:155], v[192:195], a[12:15], v[152:155]
v_xor_b32 v237, 32, v236
s_waitcnt vmcnt(16) lgkmcnt(0)
s_barrier
ds_read_b128 a[16:19], v232 offset:0
ds_read_b128 a[20:23], v232 offset:2048
ds_read_b64_tr_b16 v[176:177], v236 offset:0
ds_read_b64_tr_b16 v[178:179], v237 offset:512
ds_read_b64_tr_b16 v[180:181], v237 offset:0
ds_read_b64_tr_b16 v[182:183], v236 offset:512
ds_read_b64_tr_b16 v[184:185], v236 offset:8192
ds_read_b64_tr_b16 v[186:187], v237 offset:8704
v_mfma_f32_16x16x32_bf16 v[148:151], v[196:199], a[8:11], v[148:151]
s_add_u32 m0, s48, 8192
s_nop 0
buffer_load_dwordx4 v228, s[40:43], s69 offen lds
v_mfma_f32_16x16x32_bf16 v[156:159], v[196:199], a[12:15], v[156:159]
ds_read_b64_tr_b16 v[188:189], v237 offset:8192
v_mfma_f32_16x16x32_bf16 v[160:163], v[200:203], a[8:11], v[160:163]
ds_read_b64_tr_b16 v[190:191], v236 offset:8704
buffer_load_dwordx4 v229, s[40:43], s69 offen offset:1024 lds
v_mfma_f32_16x16x32_bf16 v[168:171], v[200:203], a[12:15], v[168:171]
ds_read_b64_tr_b16 v[192:193], v236 offset:16384
v_mfma_f32_16x16x32_bf16 v[164:167], v[204:207], a[8:11], v[164:167]
ds_read_b64_tr_b16 v[194:195], v237 offset:16896
s_mul_i32 s52, s69, 6144
s_add_u32 m0, s48, 90112
v_mfma_f32_16x16x32_bf16 v[172:175], v[204:207], a[12:15], v[172:175]
ds_read_b64_tr_b16 v[196:197], v237 offset:16384
buffer_load_dwordx4 v226, s[32:35], s52 offen lds
s_waitcnt lgkmcnt(7)
v_mfma_f32_16x16x32_bf16 v[128:131], v[176:179], a[16:19], v[128:131]
ds_read_b64_tr_b16 v[198:199], v236 offset:16896
v_mfma_f32_16x16x32_bf16 v[136:139], v[176:179], a[20:23], v[136:139]
ds_read_b128 a[24:27], v233 offset:0
ds_read_b128 a[28:31], v233 offset:2048
buffer_load_dwordx4 v227, s[32:35], s52 offen offset:1024 lds
v_mfma_f32_16x16x32_bf16 v[132:135], v[180:183], a[16:19], v[132:135]
ds_read_b64_tr_b16 v[200:201], v236 offset:4096
ds_read_b64_tr_b16 v[202:203], v237 offset:4608
v_mfma_f32_16x16x32_bf16 v[140:143], v[180:183], a[20:23], v[140:143]
ds_read_b64_tr_b16 v[204:205], v237 offset:4096
s_add_u32 m0, s48, 98176
s_waitcnt lgkmcnt(9)
v_mfma_f32_16x16x32_bf16 v[144:147], v[184:187], a[16:19], v[144:147]
ds_read_b64_tr_b16 v[206:207], v236 offset:4608
buffer_load_dwordx4 v226, s[32:35], s52 offen offset:128 lds
v_mfma_f32_16x16x32_bf16 v[152:155], v[184:187], a[20:23], v[152:155]
ds_read_b64_tr_b16 v[176:177], v236 offset:12288
v_mfma_f32_16x16x32_bf16 v[148:151], v[188:191], a[16:19], v[148:151]
ds_read_b64_tr_b16 v[178:179], v237 offset:12800
buffer_load_dwordx4 v227, s[32:35], s52 offen offset:1152 lds
v_mfma_f32_16x16x32_bf16 v[156:159], v[188:191], a[20:23], v[156:159]
ds_read_b64_tr_b16 v[180:181], v237 offset:12288
s_waitcnt lgkmcnt(9)
v_mfma_f32_16x16x32_bf16 v[160:163], v[192:195], a[16:19], v[160:163]
ds_read_b64_tr_b16 v[182:183], v236 offset:12800
s_add_u32 m0, s48, 106240
v_mfma_f32_16x16x32_bf16 v[168:171], v[192:195], a[20:23], v[168:171]
ds_read_b64_tr_b16 v[184:185], v236 offset:20480
buffer_load_dwordx4 v226, s[32:35], s52 offen offset:256 lds
v_mfma_f32_16x16x32_bf16 v[164:167], v[196:199], a[16:19], v[164:167]
ds_read_b64_tr_b16 v[186:187], v237 offset:20992
v_mfma_f32_16x16x32_bf16 v[172:175], v[196:199], a[20:23], v[172:175]
ds_read_b64_tr_b16 v[188:189], v237 offset:20480
s_waitcnt lgkmcnt(7)
v_mfma_f32_16x16x32_bf16 v[128:131], v[200:203], a[24:27], v[128:131]
ds_read_b64_tr_b16 v[190:191], v236 offset:20992
buffer_load_dwordx4 v227, s[32:35], s52 offen offset:1280 lds
v_mfma_f32_16x16x32_bf16 v[136:139], v[200:203], a[28:31], v[136:139]
v_mfma_f32_16x16x32_bf16 v[132:135], v[204:207], a[24:27], v[132:135]
v_mfma_f32_16x16x32_bf16 v[140:143], v[204:207], a[28:31], v[140:143]
s_add_u32 s53, s50, 24576
v_add_u32 v232, s53, v231
s_waitcnt lgkmcnt(4)
v_mfma_f32_16x16x32_bf16 v[144:147], v[176:179], a[24:27], v[144:147]
v_xor_b32 v233, 64, v232
v_add_u32 v236, 139264, v230
v_mfma_f32_16x16x32_bf16 v[152:155], v[176:179], a[28:31], v[152:155]
v_xor_b32 v237, 32, v236
s_waitcnt vmcnt(16) lgkmcnt(0)
s_barrier
s_bitcmp1_b32 s90, 0
s_cbranch_scc0 L_noswap1
s_mov_b32 s20, s60
s_mov_b32 s60, s65
s_mov_b32 s65, s20
s_mov_b32 s20, s61
s_mov_b32 s61, s66
s_mov_b32 s66, s20
s_mov_b32 s20, s62
s_mov_b32 s62, s67
s_mov_b32 s67, s20
s_mov_b32 s20, s63
s_mov_b32 s63, s68
s_mov_b32 s68, s20
s_mov_b32 s20, s64
s_mov_b32 s64, s69
s_mov_b32 s69, s20
L_noswap1:
ds_read_b128 a[32:35], v232 offset:0
ds_read_b128 a[36:39], v232 offset:2048
ds_read_b64_tr_b16 v[192:193], v236 offset:0
ds_read_b64_tr_b16 v[194:195], v237 offset:512
ds_read_b64_tr_b16 v[196:197], v237 offset:0
ds_read_b64_tr_b16 v[198:199], v236 offset:512
ds_read_b64_tr_b16 v[200:201], v236 offset:8192
ds_read_b64_tr_b16 v[202:203], v237 offset:8704
v_mfma_f32_16x16x32_bf16 v[148:151], v[180:183], a[24:27], v[148:151]
s_mov_b32 s52, 0
s_add_u32 m0, s48, 114688
s_nop 0
buffer_load_dwordx4 v224, s[24:27], s52 offen nt lds
v_mfma_f32_16x16x32_bf16 v[156:159], v[180:183], a[28:31], v[156:159]
ds_read_b64_tr_b16 v[204:205], v237 offset:8192
v_mfma_f32_16x16x32_bf16 v[160:163], v[184:187], a[24:27], v[160:163]
ds_read_b64_tr_b16 v[206:207], v236 offset:8704
buffer_load_dwordx4 v225, s[24:27], s52 offen offset:1024 nt lds
v_mfma_f32_16x16x32_bf16 v[168:171], v[184:187], a[28:31], v[168:171]
ds_read_b64_tr_b16 v[176:177], v236 offset:16384
s_add_u32 m0, s48, 122752
v_mfma_f32_16x16x32_bf16 v[164:167], v[188:191], a[24:27], v[164:167]
ds_read_b64_tr_b16 v[178:179], v237 offset:16896
buffer_load_dwordx4 v224, s[24:27], s52 offen offset:128 nt lds
v_mfma_f32_16x16x32_bf16 v[172:175], v[188:191], a[28:31], v[172:175]
ds_read_b64_tr_b16 v[180:181], v237 offset:16384
s_waitcnt lgkmcnt(7)
v_mfma_f32_16x16x32_bf16 v[128:131], v[192:195], a[32:35], v[128:131]
ds_read_b64_tr_b16 v[182:183], v236 offset:16896
buffer_load_dwordx4 v225, s[24:27], s52 offen offset:1152 nt lds
v_mfma_f32_16x16x32_bf16 v[136:139], v[192:195], a[36:39], v[136:139]
ds_read_b128 a[40:43], v233 offset:0
ds_read_b128 a[44:47], v233 offset:2048
s_add_u32 m0, s48, 130816
v_mfma_f32_16x16x32_bf16 v[132:135], v[196:199], a[32:35], v[132:135]
ds_read_b64_tr_b16 v[184:185], v236 offset:4096
ds_read_b64_tr_b16 v[186:187], v237 offset:4608
buffer_load_dwordx4 v224, s[24:27], s52 offen offset:256 nt lds
v_mfma_f32_16x16x32_bf16 v[140:143], v[196:199], a[36:39], v[140:143]
ds_read_b64_tr_b16 v[188:189], v237 offset:4096
s_waitcnt lgkmcnt(9)
v_mfma_f32_16x16x32_bf16 v[144:147], v[200:203], a[32:35], v[144:147]
ds_read_b64_tr_b16 v[190:191], v236 offset:4608
v_mfma_f32_16x16x32_bf16 v[152:155], v[200:203], a[36:39], v[152:155]
ds_read_b64_tr_b16 v[192:193], v236 offset:12288
buffer_load_dwordx4 v225, s[24:27], s52 offen offset:1280 nt lds
v_mfma_f32_16x16x32_bf16 v[148:151], v[204:207], a[32:35], v[148:151]
ds_read_b64_tr_b16 v[194:195], v237 offset:12800
v_mfma_f32_16x16x32_bf16 v[156:159], v[204:207], a[36:39], v[156:159]
ds_read_b64_tr_b16 v[196:197], v237 offset:12288
s_waitcnt lgkmcnt(9)
v_mfma_f32_16x16x32_bf16 v[160:163], v[176:179], a[32:35], v[160:163]
ds_read_b64_tr_b16 v[198:199], v236 offset:12800
v_mfma_f32_16x16x32_bf16 v[168:171], v[176:179], a[36:39], v[168:171]
ds_read_b64_tr_b16 v[200:201], v236 offset:20480
v_mfma_f32_16x16x32_bf16 v[164:167], v[180:183], a[32:35], v[164:167]
ds_read_b64_tr_b16 v[202:203], v237 offset:20992
v_mfma_f32_16x16x32_bf16 v[172:175], v[180:183], a[36:39], v[172:175]
ds_read_b64_tr_b16 v[204:205], v237 offset:20480
s_waitcnt lgkmcnt(7)
v_mfma_f32_16x16x32_bf16 v[128:131], v[184:187], a[40:43], v[128:131]
ds_read_b64_tr_b16 v[206:207], v236 offset:20992
v_mfma_f32_16x16x32_bf16 v[136:139], v[184:187], a[44:47], v[136:139]
v_mfma_f32_16x16x32_bf16 v[132:135], v[188:191], a[40:43], v[132:135]
v_mfma_f32_16x16x32_bf16 v[140:143], v[188:191], a[44:47], v[140:143]
s_add_u32 s53, s50, 0
v_add_u32 v232, s53, v231
s_waitcnt lgkmcnt(4)
v_mfma_f32_16x16x32_bf16 v[144:147], v[192:195], a[40:43], v[144:147]
v_xor_b32 v233, 64, v232
v_add_u32 v236, 65536, v230
v_mfma_f32_16x16x32_bf16 v[152:155], v[192:195], a[44:47], v[152:155]
v_xor_b32 v237, 32, v236
s_waitcnt vmcnt(14) lgkmcnt(0)
s_barrier
ds_read_b128 a[48:51], v232 offset:0
ds_read_b128 a[52:55], v232 offset:2048
ds_read_b64_tr_b16 v[176:177], v236 offset:0
ds_read_b64_tr_b16 v[178:179], v237 offset:512
ds_read_b64_tr_b16 v[180:181], v237 offset:0
ds_read_b64_tr_b16 v[182:183], v236 offset:512
ds_read_b64_tr_b16 v[184:185], v236 offset:8192
ds_read_b64_tr_b16 v[186:187], v237 offset:8704
v_mfma_f32_16x16x32_bf16 v[148:151], v[196:199], a[40:43], v[148:151]
s_mov_b32 s52, 24576
s_add_u32 m0, s48, 139264
s_nop 0
buffer_load_dwordx4 v224, s[24:27], s52 offen nt lds
v_mfma_f32_16x16x32_bf16 v[156:159], v[196:199], a[44:47], v[156:159]
ds_read_b64_tr_b16 v[188:189], v237 offset:8192
v_mfma_f32_16x16x32_bf16 v[160:163], v[200:203], a[40:43], v[160:163]
ds_read_b64_tr_b16 v[190:191], v236 offset:8704
buffer_load_dwordx4 v225, s[24:27], s52 offen offset:1024 nt lds
v_mfma_f32_16x16x32_bf16 v[168:171], v[200:203], a[44:47], v[168:171]
ds_read_b64_tr_b16 v[192:193], v236 offset:16384
s_add_u32 m0, s48, 147328
v_mfma_f32_16x16x32_bf16 v[164:167], v[204:207], a[40:43], v[164:167]
ds_read_b64_tr_b16 v[194:195], v237 offset:16896
buffer_load_dwordx4 v224, s[24:27], s52 offen offset:128 nt lds
v_mfma_f32_16x16x32_bf16 v[172:175], v[204:207], a[44:47], v[172:175]
ds_read_b64_tr_b16 v[196:197], v237 offset:16384
s_waitcnt lgkmcnt(7)
v_mfma_f32_16x16x32_bf16 v[128:131], v[176:179], a[48:51], v[128:131]
ds_read_b64_tr_b16 v[198:199], v236 offset:16896
buffer_load_dwordx4 v225, s[24:27], s52 offen offset:1152 nt lds
v_mfma_f32_16x16x32_bf16 v[136:139], v[176:179], a[52:55], v[136:139]
ds_read_b128 a[56:59], v233 offset:0
ds_read_b128 a[60:63], v233 offset:2048
s_add_u32 m0, s48, 155392
v_mfma_f32_16x16x32_bf16 v[132:135], v[180:183], a[48:51], v[132:135]
ds_read_b64_tr_b16 v[200:201], v236 offset:4096
ds_read_b64_tr_b16 v[202:203], v237 offset:4608
buffer_load_dwordx4 v224, s[24:27], s52 offen offset:256 nt lds
v_mfma_f32_16x16x32_bf16 v[140:143], v[180:183], a[52:55], v[140:143]
ds_read_b64_tr_b16 v[204:205], v237 offset:4096
s_waitcnt lgkmcnt(9)
v_mfma_f32_16x16x32_bf16 v[144:147], v[184:187], a[48:51], v[144:147]
ds_read_b64_tr_b16 v[206:207], v236 offset:4608
v_mfma_f32_16x16x32_bf16 v[152:155], v[184:187], a[52:55], v[152:155]
ds_read_b64_tr_b16 v[176:177], v236 offset:12288
buffer_load_dwordx4 v225, s[24:27], s52 offen offset:1280 nt lds
v_mfma_f32_16x16x32_bf16 v[148:151], v[188:191], a[48:51], v[148:151]
ds_read_b64_tr_b16 v[178:179], v237 offset:12800
v_mfma_f32_16x16x32_bf16 v[156:159], v[188:191], a[52:55], v[156:159]
ds_read_b64_tr_b16 v[180:181], v237 offset:12288
s_waitcnt lgkmcnt(9)
v_mfma_f32_16x16x32_bf16 v[160:163], v[192:195], a[48:51], v[160:163]
ds_read_b64_tr_b16 v[182:183], v236 offset:12800
v_mfma_f32_16x16x32_bf16 v[168:171], v[192:195], a[52:55], v[168:171]
ds_read_b64_tr_b16 v[184:185], v236 offset:20480
v_mfma_f32_16x16x32_bf16 v[164:167], v[196:199], a[48:51], v[164:167]
ds_read_b64_tr_b16 v[186:187], v237 offset:20992
v_mfma_f32_16x16x32_bf16 v[172:175], v[196:199], a[52:55], v[172:175]
ds_read_b64_tr_b16 v[188:189], v237 offset:20480
s_waitcnt lgkmcnt(7)
v_mfma_f32_16x16x32_bf16 v[128:131], v[200:203], a[56:59], v[128:131]
ds_read_b64_tr_b16 v[190:191], v236 offset:20992
v_mfma_f32_16x16x32_bf16 v[136:139], v[200:203], a[60:63], v[136:139]
v_mfma_f32_16x16x32_bf16 v[132:135], v[204:207], a[56:59], v[132:135]
v_mfma_f32_16x16x32_bf16 v[140:143], v[204:207], a[60:63], v[140:143]
s_add_u32 s53, s50, 8192
v_add_u32 v232, s53, v231
s_waitcnt lgkmcnt(4)
v_mfma_f32_16x16x32_bf16 v[144:147], v[176:179], a[56:59], v[144:147]
v_xor_b32 v233, 64, v232
v_add_u32 v236, 90112, v230
v_mfma_f32_16x16x32_bf16 v[152:155], v[176:179], a[60:63], v[152:155]
v_xor_b32 v237, 32, v236
s_waitcnt vmcnt(12) lgkmcnt(0)
s_barrier
ds_read_b128 a[64:67], v232 offset:0
ds_read_b128 a[68:71], v232 offset:2048
ds_read_b64_tr_b16 v[192:193], v236 offset:0
ds_read_b64_tr_b16 v[194:195], v237 offset:512
ds_read_b64_tr_b16 v[196:197], v237 offset:0
ds_read_b64_tr_b16 v[198:199], v236 offset:512
ds_read_b64_tr_b16 v[200:201], v236 offset:8192
ds_read_b64_tr_b16 v[202:203], v237 offset:8704
v_mfma_f32_16x16x32_bf16 v[148:151], v[180:183], a[56:59], v[148:151]
v_mfma_f32_16x16x32_bf16 v[156:159], v[180:183], a[60:63], v[156:159]
ds_read_b64_tr_b16 v[204:205], v237 offset:8192
v_mfma_f32_16x16x32_bf16 v[160:163], v[184:187], a[56:59], v[160:163]
ds_read_b64_tr_b16 v[206:207], v236 offset:8704
v_mfma_f32_16x16x32_bf16 v[168:171], v[184:187], a[60:63], v[168:171]
ds_read_b64_tr_b16 v[176:177], v236 offset:16384
v_mfma_f32_16x16x32_bf16 v[164:167], v[188:191], a[56:59], v[164:167]
ds_read_b64_tr_b16 v[178:179], v237 offset:16896
v_mfma_f32_16x16x32_bf16 v[172:175], v[188:191], a[60:63], v[172:175]
ds_read_b64_tr_b16 v[180:181], v237 offset:16384
s_waitcnt lgkmcnt(7)
v_mfma_f32_16x16x32_bf16 v[128:131], v[192:195], a[64:67], v[128:131]
ds_read_b64_tr_b16 v[182:183], v236 offset:16896
v_mfma_f32_16x16x32_bf16 v[136:139], v[192:195], a[68:71], v[136:139]
ds_read_b128 a[72:75], v233 offset:0
ds_read_b128 a[76:79], v233 offset:2048
v_mfma_f32_16x16x32_bf16 v[132:135], v[196:199], a[64:67], v[132:135]
ds_read_b64_tr_b16 v[184:185], v236 offset:4096
ds_read_b64_tr_b16 v[186:187], v237 offset:4608
s_mul_i32 s52, s60, 6144
s_add_u32 s52, s52, 3072
s_add_u32 m0, s48, 65536
v_mfma_f32_16x16x32_bf16 v[140:143], v[196:199], a[68:71], v[140:143]
ds_read_b64_tr_b16 v[188:189], v237 offset:4096
buffer_load_dwordx4 v226, s[32:35], s52 offen lds
s_waitcnt lgkmcnt(9)
v_mfma_f32_16x16x32_bf16 v[144:147], v[200:203], a[64:67], v[144:147]
ds_read_b64_tr_b16 v[190:191], v236 offset:4608
v_mfma_f32_16x16x32_bf16 v[152:155], v[200:203], a[68:71], v[152:155]
ds_read_b64_tr_b16 v[192:193], v236 offset:12288
buffer_load_dwordx4 v227, s[32:35], s52 offen offset:1024 lds
v_mfma_f32_16x16x32_bf16 v[148:151], v[204:207], a[64:67], v[148:151]
ds_read_b64_tr_b16 v[194:195], v237 offset:12800
v_mfma_f32_16x16x32_bf16 v[156:159], v[204:207], a[68:71], v[156:159]
ds_read_b64_tr_b16 v[196:197], v237 offset:12288
s_add_u32 m0, s48, 73600
s_waitcnt lgkmcnt(9)
v_mfma_f32_16x16x32_bf16 v[160:163], v[176:179], a[64:67], v[160:163]
ds_read_b64_tr_b16 v[198:199], v236 offset:12800
buffer_load_dwordx4 v226, s[32:35], s52 offen offset:128 lds
v_mfma_f32_16x16x32_bf16 v[168:171], v[176:179], a[68:71], v[168:171]
ds_read_b64_tr_b16 v[200:201], v236 offset:20480
v_mfma_f32_16x16x32_bf16 v[164:167], v[180:183], a[64:67], v[164:167]
ds_read_b64_tr_b16 v[202:203], v237 offset:20992
v_mfma_f32_16x16x32_bf16 v[172:175], v[180:183], a[68:71], v[172:175]
ds_read_b64_tr_b16 v[204:205], v237 offset:20480
buffer_load_dwordx4 v227, s[32:35], s52 offen offset:1152 lds
s_waitcnt lgkmcnt(7)
v_mfma_f32_16x16x32_bf16 v[128:131], v[184:187], a[72:75], v[128:131]
ds_read_b64_tr_b16 v[206:207], v236 offset:20992
v_mfma_f32_16x16x32_bf16 v[136:139], v[184:187], a[76:79], v[136:139]
s_add_u32 m0, s48, 81664
v_mfma_f32_16x16x32_bf16 v[132:135], v[188:191], a[72:75], v[132:135]
buffer_load_dwordx4 v226, s[32:35], s52 offen offset:256 lds
v_mfma_f32_16x16x32_bf16 v[140:143], v[188:191], a[76:79], v[140:143]
s_waitcnt lgkmcnt(4)
v_mfma_f32_16x16x32_bf16 v[144:147], v[192:195], a[72:75], v[144:147]
v_mfma_f32_16x16x32_bf16 v[152:155], v[192:195], a[76:79], v[152:155]
buffer_load_dwordx4 v227, s[32:35], s52 offen offset:1280 lds
s_waitcnt lgkmcnt(0)
s_barrier
s_mov_b32 s52, 49152
s_add_u32 m0, s48, 90112
s_nop 0
buffer_load_dwordx4 v224, s[24:27], s52 offen nt lds
buffer_load_dwordx4 v225, s[24:27], s52 offen offset:1024 nt lds
v_mfma_f32_16x16x32_bf16 v[148:151], v[196:199], a[72:75], v[148:151]
s_add_u32 m0, s48, 98176
s_nop 0
buffer_load_dwordx4 v224, s[24:27], s52 offen offset:128 nt lds
buffer_load_dwordx4 v225, s[24:27], s52 offen offset:1152 nt lds
v_mfma_f32_16x16x32_bf16 v[156:159], v[196:199], a[76:79], v[156:159]
s_add_u32 m0, s48, 106240
s_nop 0
buffer_load_dwordx4 v224, s[24:27], s52 offen offset:256 nt lds
v_mfma_f32_16x16x32_bf16 v[160:163], v[200:203], a[72:75], v[160:163]
buffer_load_dwordx4 v225, s[24:27], s52 offen offset:1280 nt lds
v_mfma_f32_16x16x32_bf16 v[168:171], v[200:203], a[76:79], v[168:171]
s_add_u32 s53, s49, 114688
v_add_u32 v232, s53, v231
v_mfma_f32_16x16x32_bf16 v[164:167], v[204:207], a[72:75], v[164:167]
v_xor_b32 v233, 64, v232
v_mfma_f32_16x16x32_bf16 v[172:175], v[204:207], a[76:79], v[172:175]
v_cvt_pk_bf16_f32 v128, v128, v129
v_cvt_pk_bf16_f32 v129, v130, v131
v_cvt_pk_bf16_f32 v130, v132, v133
v_cvt_pk_bf16_f32 v131, v134, v135
v_cvt_pk_bf16_f32 v136, v136, v137
v_cvt_pk_bf16_f32 v137, v138, v139
v_cvt_pk_bf16_f32 v138, v140, v141
v_cvt_pk_bf16_f32 v139, v142, v143
v_cvt_pk_bf16_f32 v144, v144, v145
v_cvt_pk_bf16_f32 v145, v146, v147
v_cvt_pk_bf16_f32 v146, v148, v149
v_cvt_pk_bf16_f32 v147, v150, v151
v_cvt_pk_bf16_f32 v152, v152, v153
v_cvt_pk_bf16_f32 v153, v154, v155
v_cvt_pk_bf16_f32 v154, v156, v157
v_cvt_pk_bf16_f32 v155, v158, v159
v_cvt_pk_bf16_f32 v160, v160, v161
v_cvt_pk_bf16_f32 v161, v162, v163
v_cvt_pk_bf16_f32 v162, v164, v165
v_cvt_pk_bf16_f32 v163, v166, v167
v_cvt_pk_bf16_f32 v168, v168, v169
v_cvt_pk_bf16_f32 v169, v170, v171
v_cvt_pk_bf16_f32 v170, v172, v173
v_cvt_pk_bf16_f32 v171, v174, v175
ds_write_b64 v251, v[128:129] offset:32768
ds_write_b64 v251, v[130:131] offset:33280
ds_write_b64 v251, v[136:137] offset:33792
ds_write_b64 v251, v[138:139] offset:34304
ds_write_b64 v251, v[144:145] offset:40960
ds_write_b64 v251, v[146:147] offset:41472
ds_write_b64 v251, v[152:153] offset:41984
ds_write_b64 v251, v[154:155] offset:42496
ds_write_b64 v251, v[160:161] offset:49152
ds_write_b64 v251, v[162:163] offset:49664
ds_write_b64 v251, v[168:169] offset:50176
ds_write_b64 v251, v[170:171] offset:50688
L_head_done:
s_waitcnt vmcnt(18) lgkmcnt(0)
s_barrier
ds_read_b128 a[208:211], v238 offset:32768
ds_read_b128 a[212:215], v238 offset:33792
ds_read_b128 v[176:179], v232 offset:0
ds_read_b128 v[180:183], v232 offset:2048
ds_read_b128 a[216:219], v238 offset:34816
ds_read_b128 a[220:223], v238 offset:35840
ds_read_b128 v[184:187], v233 offset:0
ds_read_b128 v[188:191], v233 offset:2048
ds_read_b128 a[224:227], v238 offset:40960
ds_read_b128 a[228:231], v238 offset:41984
ds_read_b128 v[192:195], v232 offset:8192
ds_read_b128 v[196:199], v232 offset:10240
s_waitcnt lgkmcnt(8)
v_mfma_f32_16x16x32_bf16 v[0:3], v[176:179], a[208:211], 0
v_mfma_f32_16x16x32_bf16 v[8:11], v[176:179], a[212:215], 0
ds_read_b128 a[232:235], v238 offset:43008
ds_read_b128 a[236:239], v238 offset:44032
v_mfma_f32_16x16x32_bf16 v[4:7], v[180:183], a[208:211], 0
ds_read_b128 v[200:203], v233 offset:8192
v_mfma_f32_16x16x32_bf16 v[12:15], v[180:183], a[212:215], 0
ds_read_b128 v[204:207], v233 offset:10240
s_waitcnt lgkmcnt(8)
v_mfma_f32_16x16x32_bf16 v[0:3], v[184:187], a[216:219], v[0:3]
v_mfma_f32_16x16x32_bf16 v[8:11], v[184:187], a[220:223], v[8:11]
ds_read_b128 a[240:243], v238 offset:49152
ds_read_b128 a[244:247], v238 offset:50176
v_mfma_f32_16x16x32_bf16 v[4:7], v[188:191], a[216:219], v[4:7]
ds_read_b128 v[176:179], v232 offset:16384
v_mfma_f32_16x16x32_bf16 v[12:15], v[188:191], a[220:223], v[12:15]
ds_read_b128 v[180:183], v232 offset:18432
s_waitcnt lgkmcnt(8)
v_mfma_f32_16x16x32_bf16 v[0:3], v[192:195], a[224:227], v[0:3]
v_mfma_f32_16x16x32_bf16 v[8:11], v[192:195], a[228:231], v[8:11]
ds_read_b128 a[248:251], v238 offset:51200
ds_read_b128 a[252:255], v238 offset:52224
v_mfma_f32_16x16x32_bf16 v[4:7], v[196:199], a[224:227], v[4:7]
ds_read_b128 v[184:187], v233 offset:16384
v_mfma_f32_16x16x32_bf16 v[12:15], v[196:199], a[228:231], v[12:15]
ds_read_b128 v[188:191], v233 offset:18432
s_waitcnt lgkmcnt(8)
v_mfma_f32_16x16x32_bf16 v[0:3], v[200:203], a[232:235], v[0:3]
v_mfma_f32_16x16x32_bf16 v[8:11], v[200:203], a[236:239], v[8:11]
v_mfma_f32_16x16x32_bf16 v[4:7], v[204:207], a[232:235], v[4:7]
v_mfma_f32_16x16x32_bf16 v[12:15], v[204:207], a[236:239], v[12:15]
s_add_u32 s53, s49, 139264
v_add_u32 v232, s53, v231
s_waitcnt lgkmcnt(4)
v_mfma_f32_16x16x32_bf16 v[0:3], v[176:179], a[240:243], v[0:3]
v_xor_b32 v233, 64, v232
v_mfma_f32_16x16x32_bf16 v[8:11], v[176:179], a[244:247], v[8:11]
s_waitcnt vmcnt(12) lgkmcnt(0)
s_barrier
ds_read_b128 v[192:195], v232 offset:0
ds_read_b128 v[196:199], v232 offset:2048
ds_read_b128 v[200:203], v233 offset:0
v_mfma_f32_16x16x32_bf16 v[4:7], v[180:183], a[240:243], v[4:7]
v_mfma_f32_16x16x32_bf16 v[12:15], v[180:183], a[244:247], v[12:15]
ds_read_b128 v[204:207], v233 offset:2048
v_mfma_f32_16x16x32_bf16 v[0:3], v[184:187], a[248:251], v[0:3]
v_mfma_f32_16x16x32_bf16 v[8:11], v[184:187], a[252:255], v[8:11]
ds_read_b128 v[176:179], v232 offset:8192
v_mfma_f32_16x16x32_bf16 v[4:7], v[188:191], a[248:251], v[4:7]
v_mfma_f32_16x16x32_bf16 v[12:15], v[188:191], a[252:255], v[12:15]
ds_read_b128 v[180:183], v232 offset:10240
s_waitcnt lgkmcnt(4)
v_mfma_f32_16x16x32_bf16 v[16:19], v[192:195], a[208:211], 0
v_mfma_f32_16x16x32_bf16 v[24:27], v[192:195], a[212:215], 0
ds_read_b128 v[184:187], v233 offset:8192
v_mfma_f32_16x16x32_bf16 v[20:23], v[196:199], a[208:211], 0
s_mul_i32 s52, s61, 6144
s_add_u32 s52, s52, 3072
s_add_u32 m0, s48, 114688
v_max3_f32 v240, v0, v1, v2
v_mfma_f32_16x16x32_bf16 v[28:31], v[196:199], a[212:215], 0
ds_read_b128 v[188:191], v233 offset:10240
buffer_load_dwordx4 v226, s[32:35], s52 offen lds
s_waitcnt lgkmcnt(4)
v_mfma_f32_16x16x32_bf16 v[16:19], v[200:203], a[216:219], v[16:19]
v_max3_f32 v241, v8, v9, v10
v_max3_f32 v240, v240, v3, v4
v_mfma_f32_16x16x32_bf16 v[24:27], v[200:203], a[220:223], v[24:27]
ds_read_b128 v[192:195], v232 offset:16384
buffer_load_dwordx4 v227, s[32:35], s52 offen offset:1024 lds
v_mfma_f32_16x16x32_bf16 v[20:23], v[204:207], a[216:219], v[20:23]
v_max3_f32 v241, v241, v11, v12
v_max3_f32 v240, v240, v5, v6
v_mfma_f32_16x16x32_bf16 v[28:31], v[204:207], a[220:223], v[28:31]
ds_read_b128 v[196:199], v232 offset:18432
s_add_u32 m0, s48, 122752
v_max3_f32 v241, v241, v13, v14
s_waitcnt lgkmcnt(4)
v_mfma_f32_16x16x32_bf16 v[16:19], v[176:179], a[224:227], v[16:19]
buffer_load_dwordx4 v226, s[32:35], s52 offen offset:128 lds
v_mfma_f32_16x16x32_bf16 v[24:27], v[176:179], a[228:231], v[24:27]
ds_read_b128 v[200:203], v233 offset:16384
v_max_f32 v240, v240, v7
v_mfma_f32_16x16x32_bf16 v[20:23], v[180:183], a[224:227], v[20:23]
v_max_f32 v241, v241, v15
v_mfma_f32_16x16x32_bf16 v[28:31], v[180:183], a[228:231], v[28:31]
ds_read_b128 v[204:207], v233 offset:18432
buffer_load_dwordx4 v227, s[32:35], s52 offen offset:1152 lds
s_waitcnt lgkmcnt(4)
v_mfma_f32_16x16x32_bf16 v[16:19], v[184:187], a[232:235], v[16:19]
v_mfma_f32_16x16x32_bf16 v[24:27], v[184:187], a[236:239], v[24:27]
s_add_u32 m0, s48, 130816
v_mfma_f32_16x16x32_bf16 v[20:23], v[188:191], a[232:235], v[20:23]
buffer_load_dwordx4 v226, s[32:35], s52 offen offset:256 lds
v_mfma_f32_16x16x32_bf16 v[28:31], v[188:191], a[236:239], v[28:31]
v_add_u32 v236, 65536, v230
v_xor_b32 v237, 32, v236
s_waitcnt lgkmcnt(2)
v_mfma_f32_16x16x32_bf16 v[16:19], v[192:195], a[240:243], v[16:19]
v_mfma_f32_16x16x32_bf16 v[24:27], v[192:195], a[244:247], v[24:27]
buffer_load_dwordx4 v227, s[32:35], s52 offen offset:1280 lds
s_waitcnt vmcnt(12) lgkmcnt(0)
s_barrier
ds_read_b64_tr_b16 v[176:177], v236 offset:0
ds_read_b64_tr_b16 v[178:179], v237 offset:512
ds_read_b64_tr_b16 v[180:181], v237 offset:0
ds_read_b64_tr_b16 v[182:183], v236 offset:512
ds_read_b64_tr_b16 v[184:185], v236 offset:8192
ds_read_b64_tr_b16 v[186:187], v237 offset:8704
v_mfma_f32_16x16x32_bf16 v[20:23], v[196:199], a[240:243], v[20:23]
s_mov_b32 s52, 73728
s_add_u32 m0, s48, 139264
s_nop 0
buffer_load_dwordx4 v224, s[24:27], s52 offen nt lds
v_mfma_f32_16x16x32_bf16 v[28:31], v[196:199], a[244:247], v[28:31]
ds_read_b64_tr_b16 v[188:189], v237 offset:8192
v_mfma_f32_16x16x32_bf16 v[16:19], v[200:203], a[248:251], v[16:19]
ds_read_b64_tr_b16 v[190:191], v236 offset:8704
buffer_load_dwordx4 v225, s[24:27], s52 offen offset:1024 nt lds
v_mfma_f32_16x16x32_bf16 v[24:27], v[200:203], a[252:255], v[24:27]
ds_read_b64_tr_b16 v[192:193], v236 offset:16384
s_add_u32 m0, s48, 147328
v_mfma_f32_16x16x32_bf16 v[20:23], v[204:207], a[248:251], v[20:23]
ds_read_b64_tr_b16 v[194:195], v237 offset:16896
buffer_load_dwordx4 v224, s[24:27], s52 offen offset:128 nt lds
v_mfma_f32_16x16x32_bf16 v[28:31], v[204:207], a[252:255], v[28:31]
ds_read_b64_tr_b16 v[196:197], v237 offset:16384
s_waitcnt lgkmcnt(7)
v_mfma_f32_16x16x32_bf16 v[128:131], v[176:179], a[0:3], 0
ds_read_b64_tr_b16 v[198:199], v236 offset:16896
buffer_load_dwordx4 v225, s[24:27], s52 offen offset:1152 nt lds
v_mfma_f32_16x16x32_bf16 v[136:139], v[176:179], a[4:7], 0
ds_read_b64_tr_b16 v[200:201], v236 offset:4096
s_add_u32 m0, s48, 155392
v_mfma_f32_16x16x32_bf16 v[132:135], v[180:183], a[0:3], 0
ds_read_b64_tr_b16 v[202:203], v237 offset:4608
buffer_load_dwordx4 v224, s[24:27], s52 offen offset:256 nt lds
v_mfma_f32_16x16x32_bf16 v[140:143], v[180:183], a[4:7], 0
ds_read_b64_tr_b16 v[204:205], v237 offset:4096
v_max3_f32 v240, v240, v16, v17
s_waitcnt lgkmcnt(7)
v_mfma_f32_16x16x32_bf16 v[144:147], v[184:187], a[0:3], 0
ds_read_b64_tr_b16 v[206:207], v236 offset:4608
v_max3_f32 v241, v241, v24, v25
v_mfma_f32_16x16x32_bf16 v[152:155], v[184:187], a[4:7], 0
ds_read_b64_tr_b16 v[176:177], v236 offset:12288
buffer_load_dwordx4 v225, s[24:27], s52 offen offset:1280 nt lds
v_mfma_f32_16x16x32_bf16 v[148:151], v[188:191], a[0:3], 0
ds_read_b64_tr_b16 v[178:179], v237 offset:12800
v_max3_f32 v240, v240, v18, v19
v_mfma_f32_16x16x32_bf16 v[156:159], v[188:191], a[4:7], 0
ds_read_b64_tr_b16 v[180:181], v237 offset:12288
v_max3_f32 v241, v241, v26, v27
s_waitcnt lgkmcnt(7)
v_mfma_f32_16x16x32_bf16 v[160:163], v[192:195], a[0:3], 0
ds_read_b64_tr_b16 v[182:183], v236 offset:12800
v_max3_f32 v240, v240, v20, v21
v_mfma_f32_16x16x32_bf16 v[168:171], v[192:195], a[4:7], 0
ds_read_b64_tr_b16 v[184:185], v236 offset:20480
v_max3_f32 v241, v241, v28, v29
v_mfma_f32_16x16x32_bf16 v[164:167], v[196:199], a[0:3], 0
ds_read_b64_tr_b16 v[186:187], v237 offset:20992
v_max3_f32 v240, v240, v22, v23
v_mfma_f32_16x16x32_bf16 v[172:175], v[196:199], a[4:7], 0
ds_read_b64_tr_b16 v[188:189], v237 offset:20480
v_max3_f32 v241, v241, v30, v31
s_waitcnt lgkmcnt(7)
v_mfma_f32_16x16x32_bf16 v[128:131], v[200:203], a[8:11], v[128:131]
ds_read_b64_tr_b16 v[190:191], v236 offset:20992
v_mfma_f32_16x16x32_bf16 v[136:139], v[200:203], a[12:15], v[136:139]
v_mfma_f32_16x16x32_bf16 v[132:135], v[204:207], a[8:11], v[132:135]
v_mfma_f32_16x16x32_bf16 v[140:143], v[204:207], a[12:15], v[140:143]
s_add_u32 s53, s49, 90112
v_add_u32 v232, s53, v231
s_waitcnt lgkmcnt(4)
v_mfma_f32_16x16x32_bf16 v[144:147], v[176:179], a[8:11], v[144:147]
v_xor_b32 v233, 64, v232
v_mfma_f32_16x16x32_bf16 v[152:155], v[176:179], a[12:15], v[152:155]
s_waitcnt vmcnt(12) lgkmcnt(0)
s_barrier
ds_read_b128 v[192:195], v232 offset:0
ds_read_b128 v[196:199], v232 offset:2048
ds_read_b128 v[200:203], v233 offset:0
v_mfma_f32_16x16x32_bf16 v[148:151], v[180:183], a[8:11], v[148:151]
v_mfma_f32_16x16x32_bf16 v[156:159], v[180:183], a[12:15], v[156:159]
ds_read_b128 v[204:207], v233 offset:2048
v_mfma_f32_16x16x32_bf16 v[160:163], v[184:187], a[8:11], v[160:163]
v_mfma_f32_16x16x32_bf16 v[168:171], v[184:187], a[12:15], v[168:171]
ds_read_b128 v[176:179], v232 offset:8192
v_mfma_f32_16x16x32_bf16 v[164:167], v[188:191], a[8:11], v[164:167]
v_mfma_f32_16x16x32_bf16 v[172:175], v[188:191], a[12:15], v[172:175]
ds_read_b128 v[180:183], v232 offset:10240
s_waitcnt lgkmcnt(4)
v_mfma_f32_16x16x32_bf16 v[32:35], v[192:195], a[208:211], 0
v_mfma_f32_16x16x32_bf16 v[40:43], v[192:195], a[212:215], 0
ds_read_b128 v[184:187], v233 offset:8192
v_mfma_f32_16x16x32_bf16 v[36:39], v[196:199], a[208:211], 0
s_mul_i32 s52, s62, 6144
s_add_u32 s52, s52, 3072
s_add_u32 m0, s48, 65536
v_mfma_f32_16x16x32_bf16 v[44:47], v[196:199], a[212:215], 0
ds_read_b128 v[188:191], v233 offset:10240
buffer_load_dwordx4 v226, s[32:35], s52 offen lds
s_waitcnt lgkmcnt(4)
v_mfma_f32_16x16x32_bf16 v[32:35], v[200:203], a[216:219], v[32:35]
v_mfma_f32_16x16x32_bf16 v[40:43], v[200:203], a[220:223], v[40:43]
ds_read_b128 v[192:195], v232 offset:16384
buffer_load_dwordx4 v227, s[32:35], s52 offen offset:1024 lds
v_mfma_f32_16x16x32_bf16 v[36:39], v[204:207], a[216:219], v[36:39]
v_mfma_f32_16x16x32_bf16 v[44:47], v[204:207], a[220:223], v[44:47]
ds_read_b128 v[196:199], v232 offset:18432
s_add_u32 m0, s48, 73600
s_waitcnt lgkmcnt(4)
v_mfma_f32_16x16x32_bf16 v[32:35], v[176:179], a[224:227], v[32:35]
buffer_load_dwordx4 v226, s[32:35], s52 offen offset:128 lds
v_mfma_f32_16x16x32_bf16 v[40:43], v[176:179], a[228:231], v[40:43]
ds_read_b128 v[200:203], v233 offset:16384
v_mfma_f32_16x16x32_bf16 v[36:39], v[180:183], a[224:227], v[36:39]
v_mfma_f32_16x16x32_bf16 v[44:47], v[180:183], a[228:231], v[44:47]
ds_read_b128 v[204:207], v233 offset:18432
buffer_load_dwordx4 v227, s[32:35], s52 offen offset:1152 lds
s_waitcnt lgkmcnt(4)
v_mfma_f32_16x16x32_bf16 v[32:35], v[184:187], a[232:235], v[32:35]
v_mfma_f32_16x16x32_bf16 v[40:43], v[184:187], a[236:239], v[40:43]
s_add_u32 m0, s48, 81664
v_mfma_f32_16x16x32_bf16 v[36:39], v[188:191], a[232:235], v[36:39]
buffer_load_dwordx4 v226, s[32:35], s52 offen offset:256 lds
v_mfma_f32_16x16x32_bf16 v[44:47], v[188:191], a[236:239], v[44:47]
v_add_u32 v236, 114688, v230
v_xor_b32 v237, 32, v236
s_waitcnt lgkmcnt(2)
v_mfma_f32_16x16x32_bf16 v[32:35], v[192:195], a[240:243], v[32:35]
v_mfma_f32_16x16x32_bf16 v[40:43], v[192:195], a[244:247], v[40:43]
buffer_load_dwordx4 v227, s[32:35], s52 offen offset:1280 lds
s_waitcnt vmcnt(12) lgkmcnt(0)
s_barrier
ds_read_b64_tr_b16 v[176:177], v236 offset:0
ds_read_b64_tr_b16 v[178:179], v237 offset:512
ds_read_b64_tr_b16 v[180:181], v237 offset:0
ds_read_b64_tr_b16 v[182:183], v236 offset:512
ds_read_b64_tr_b16 v[184:185], v236 offset:8192
ds_read_b64_tr_b16 v[186:187], v237 offset:8704
v_mfma_f32_16x16x32_bf16 v[36:39], v[196:199], a[240:243], v[36:39]
s_mov_b32 s52, 98304
s_add_u32 m0, s48, 90112
s_nop 0
buffer_load_dwordx4 v224, s[24:27], s52 offen nt lds
v_mfma_f32_16x16x32_bf16 v[44:47], v[196:199], a[244:247], v[44:47]
ds_read_b64_tr_b16 v[188:189], v237 offset:8192
v_mfma_f32_16x16x32_bf16 v[32:35], v[200:203], a[248:251], v[32:35]
ds_read_b64_tr_b16 v[190:191], v236 offset:8704
buffer_load_dwordx4 v225, s[24:27], s52 offen offset:1024 nt lds
v_mfma_f32_16x16x32_bf16 v[40:43], v[200:203], a[252:255], v[40:43]
ds_read_b64_tr_b16 v[192:193], v236 offset:16384
s_add_u32 m0, s48, 98176
v_mfma_f32_16x16x32_bf16 v[36:39], v[204:207], a[248:251], v[36:39]
ds_read_b64_tr_b16 v[194:195], v237 offset:16896
buffer_load_dwordx4 v224, s[24:27], s52 offen offset:128 nt lds
v_mfma_f32_16x16x32_bf16 v[44:47], v[204:207], a[252:255], v[44:47]
ds_read_b64_tr_b16 v[196:197], v237 offset:16384
s_waitcnt lgkmcnt(7)
v_mfma_f32_16x16x32_bf16 v[128:131], v[176:179], a[16:19], v[128:131]
ds_read_b64_tr_b16 v[198:199], v236 offset:16896
buffer_load_dwordx4 v225, s[24:27], s52 offen offset:1152 nt lds
v_mfma_f32_16x16x32_bf16 v[136:139], v[176:179], a[20:23], v[136:139]
ds_read_b64_tr_b16 v[200:201], v236 offset:4096
s_add_u32 m0, s48, 106240
v_mfma_f32_16x16x32_bf16 v[132:135], v[180:183], a[16:19], v[132:135]
ds_read_b64_tr_b16 v[202:203], v237 offset:4608
buffer_load_dwordx4 v224, s[24:27], s52 offen offset:256 nt lds
v_mfma_f32_16x16x32_bf16 v[140:143], v[180:183], a[20:23], v[140:143]
ds_read_b64_tr_b16 v[204:205], v237 offset:4096
v_max3_f32 v240, v240, v32, v33
s_waitcnt lgkmcnt(7)
v_mfma_f32_16x16x32_bf16 v[144:147], v[184:187], a[16:19], v[144:147]
ds_read_b64_tr_b16 v[206:207], v236 offset:4608
v_max3_f32 v241, v241, v40, v41
v_mfma_f32_16x16x32_bf16 v[152:155], v[184:187], a[20:23], v[152:155]
ds_read_b64_tr_b16 v[176:177], v236 offset:12288
buffer_load_dwordx4 v225, s[24:27], s52 offen offset:1280 nt lds
v_mfma_f32_16x16x32_bf16 v[148:151], v[188:191], a[16:19], v[148:151]
ds_read_b64_tr_b16 v[178:179], v237 offset:12800
v_max3_f32 v240, v240, v34, v35
v_mfma_f32_16x16x32_bf16 v[156:159], v[188:191], a[20:23], v[156:159]
ds_read_b64_tr_b16 v[180:181], v237 offset:12288
v_max3_f32 v241, v241, v42, v43
s_waitcnt lgkmcnt(7)
v_mfma_f32_16x16x32_bf16 v[160:163], v[192:195], a[16:19], v[160:163]
ds_read_b64_tr_b16 v[182:183], v236 offset:12800
v_max3_f32 v240, v240, v36, v37
v_mfma_f32_16x16x32_bf16 v[168:171], v[192:195], a[20:23], v[168:171]
ds_read_b64_tr_b16 v[184:185], v236 offset:20480
v_max3_f32 v241, v241, v44, v45
v_mfma_f32_16x16x32_bf16 v[164:167], v[196:199], a[16:19], v[164:167]
ds_read_b64_tr_b16 v[186:187], v237 offset:20992
v_max3_f32 v240, v240, v38, v39
v_mfma_f32_16x16x32_bf16 v[172:175], v[196:199], a[20:23], v[172:175]
ds_read_b64_tr_b16 v[188:189], v237 offset:20480
v_max3_f32 v241, v241, v46, v47
s_waitcnt lgkmcnt(7)
v_mfma_f32_16x16x32_bf16 v[128:131], v[200:203], a[24:27], v[128:131]
ds_read_b64_tr_b16 v[190:191], v236 offset:20992
v_mfma_f32_16x16x32_bf16 v[136:139], v[200:203], a[28:31], v[136:139]
v_mfma_f32_16x16x32_bf16 v[132:135], v[204:207], a[24:27], v[132:135]
v_mfma_f32_16x16x32_bf16 v[140:143], v[204:207], a[28:31], v[140:143]
s_add_u32 s53, s49, 139264
v_add_u32 v232, s53, v231
s_waitcnt lgkmcnt(4)
v_mfma_f32_16x16x32_bf16 v[144:147], v[176:179], a[24:27], v[144:147]
v_xor_b32 v233, 64, v232
v_mfma_f32_16x16x32_bf16 v[152:155], v[176:179], a[28:31], v[152:155]
s_waitcnt vmcnt(12) lgkmcnt(0)
s_barrier
ds_read_b128 v[192:195], v232 offset:0
ds_read_b128 v[196:199], v232 offset:2048
ds_read_b128 v[200:203], v233 offset:0
v_mfma_f32_16x16x32_bf16 v[148:151], v[180:183], a[24:27], v[148:151]
v_mfma_f32_16x16x32_bf16 v[156:159], v[180:183], a[28:31], v[156:159]
ds_read_b128 v[204:207], v233 offset:2048
v_mfma_f32_16x16x32_bf16 v[160:163], v[184:187], a[24:27], v[160:163]
v_mfma_f32_16x16x32_bf16 v[168:171], v[184:187], a[28:31], v[168:171]
ds_read_b128 v[176:179], v232 offset:8192
v_mfma_f32_16x16x32_bf16 v[164:167], v[188:191], a[24:27], v[164:167]
v_mfma_f32_16x16x32_bf16 v[172:175], v[188:191], a[28:31], v[172:175]
ds_read_b128 v[180:183], v232 offset:10240
s_waitcnt lgkmcnt(4)
v_mfma_f32_16x16x32_bf16 v[48:51], v[192:195], a[208:211], 0
v_mfma_f32_16x16x32_bf16 v[56:59], v[192:195], a[212:215], 0
ds_read_b128 v[184:187], v233 offset:8192
v_mfma_f32_16x16x32_bf16 v[52:55], v[196:199], a[208:211], 0
s_mul_i32 s52, s63, 6144
s_add_u32 s52, s52, 3072
s_add_u32 m0, s48, 114688
v_mfma_f32_16x16x32_bf16 v[60:63], v[196:199], a[212:215], 0
ds_read_b128 v[188:191], v233 offset:10240
buffer_load_dwordx4 v226, s[32:35], s52 offen lds
s_waitcnt lgkmcnt(4)
v_mfma_f32_16x16x32_bf16 v[48:51], v[200:203], a[216:219], v[48:51]
v_mfma_f32_16x16x32_bf16 v[56:59], v[200:203], a[220:223], v[56:59]
ds_read_b128 v[192:195], v232 offset:16384
buffer_load_dwordx4 v227, s[32:35], s52 offen offset:1024 lds
v_mfma_f32_16x16x32_bf16 v[52:55], v[204:207], a[216:219], v[52:55]
v_mfma_f32_16x16x32_bf16 v[60:63], v[204:207], a[220:223], v[60:63]
ds_read_b128 v[196:199], v232 offset:18432
s_add_u32 m0, s48, 122752
s_waitcnt lgkmcnt(4)
v_mfma_f32_16x16x32_bf16 v[48:51], v[176:179], a[224:227], v[48:51]
buffer_load_dwordx4 v226, s[32:35], s52 offen offset:128 lds
v_mfma_f32_16x16x32_bf16 v[56:59], v[176:179], a[228:231], v[56:59]
ds_read_b128 v[200:203], v233 offset:16384
v_mfma_f32_16x16x32_bf16 v[52:55], v[180:183], a[224:227], v[52:55]
v_mfma_f32_16x16x32_bf16 v[60:63], v[180:183], a[228:231], v[60:63]
ds_read_b128 v[204:207], v233 offset:18432
buffer_load_dwordx4 v227, s[32:35], s52 offen offset:1152 lds
s_waitcnt lgkmcnt(4)
v_mfma_f32_16x16x32_bf16 v[48:51], v[184:187], a[232:235], v[48:51]
v_mfma_f32_16x16x32_bf16 v[56:59], v[184:187], a[236:239], v[56:59]
s_add_u32 m0, s48, 130816
v_mfma_f32_16x16x32_bf16 v[52:55], v[188:191], a[232:235], v[52:55]
buffer_load_dwordx4 v226, s[32:35], s52 offen offset:256 lds
v_mfma_f32_16x16x32_bf16 v[60:63], v[188:191], a[236:239], v[60:63]
v_add_u32 v236, 65536, v230
v_xor_b32 v237, 32, v236
s_waitcnt lgkmcnt(2)
v_mfma_f32_16x16x32_bf16 v[48:51], v[192:195], a[240:243], v[48:51]
v_mfma_f32_16x16x32_bf16 v[56:59], v[192:195], a[244:247], v[56:59]
buffer_load_dwordx4 v227, s[32:35], s52 offen offset:1280 lds
s_waitcnt vmcnt(12) lgkmcnt(0)
s_barrier
ds_read_b64_tr_b16 v[176:177], v236 offset:0
ds_read_b64_tr_b16 v[178:179], v237 offset:512
ds_read_b64_tr_b16 v[180:181], v237 offset:0
ds_read_b64_tr_b16 v[182:183], v236 offset:512
ds_read_b64_tr_b16 v[184:185], v236 offset:8192
ds_read_b64_tr_b16 v[186:187], v237 offset:8704
v_mfma_f32_16x16x32_bf16 v[52:55], v[196:199], a[240:243], v[52:55]
s_mov_b32 s52, 122880
s_add_u32 m0, s48, 139264
s_nop 0
buffer_load_dwordx4 v224, s[24:27], s52 offen nt lds
v_mfma_f32_16x16x32_bf16 v[60:63], v[196:199], a[244:247], v[60:63]
ds_read_b64_tr_b16 v[188:189], v237 offset:8192
v_mfma_f32_16x16x32_bf16 v[48:51], v[200:203], a[248:251], v[48:51]
ds_read_b64_tr_b16 v[190:191], v236 offset:8704
buffer_load_dwordx4 v225, s[24:27], s52 offen offset:1024 nt lds
v_mfma_f32_16x16x32_bf16 v[56:59], v[200:203], a[252:255], v[56:59]
ds_read_b64_tr_b16 v[192:193], v236 offset:16384
s_add_u32 m0, s48, 147328
v_mfma_f32_16x16x32_bf16 v[52:55], v[204:207], a[248:251], v[52:55]
ds_read_b64_tr_b16 v[194:195], v237 offset:16896
buffer_load_dwordx4 v224, s[24:27], s52 offen offset:128 nt lds
v_mfma_f32_16x16x32_bf16 v[60:63], v[204:207], a[252:255], v[60:63]
ds_read_b64_tr_b16 v[196:197], v237 offset:16384
s_waitcnt lgkmcnt(7)
v_mfma_f32_16x16x32_bf16 v[128:131], v[176:179], a[32:35], v[128:131]
ds_read_b64_tr_b16 v[198:199], v236 offset:16896
buffer_load_dwordx4 v225, s[24:27], s52 offen offset:1152 nt lds
v_mfma_f32_16x16x32_bf16 v[136:139], v[176:179], a[36:39], v[136:139]
ds_read_b64_tr_b16 v[200:201], v236 offset:4096
s_add_u32 m0, s48, 155392
v_mfma_f32_16x16x32_bf16 v[132:135], v[180:183], a[32:35], v[132:135]
ds_read_b64_tr_b16 v[202:203], v237 offset:4608
buffer_load_dwordx4 v224, s[24:27], s52 offen offset:256 nt lds
v_mfma_f32_16x16x32_bf16 v[140:143], v[180:183], a[36:39], v[140:143]
ds_read_b64_tr_b16 v[204:205], v237 offset:4096
v_max3_f32 v240, v240, v48, v49
s_waitcnt lgkmcnt(7)
v_mfma_f32_16x16x32_bf16 v[144:147], v[184:187], a[32:35], v[144:147]
ds_read_b64_tr_b16 v[206:207], v236 offset:4608
v_max3_f32 v241, v241, v56, v57
v_mfma_f32_16x16x32_bf16 v[152:155], v[184:187], a[36:39], v[152:155]
ds_read_b64_tr_b16 v[176:177], v236 offset:12288
buffer_load_dwordx4 v225, s[24:27], s52 offen offset:1280 nt lds
v_mfma_f32_16x16x32_bf16 v[148:151], v[188:191], a[32:35], v[148:151]
ds_read_b64_tr_b16 v[178:179], v237 offset:12800
v_max3_f32 v240, v240, v50, v51
v_mfma_f32_16x16x32_bf16 v[156:159], v[188:191], a[36:39], v[156:159]
ds_read_b64_tr_b16 v[180:181], v237 offset:12288
v_max3_f32 v241, v241, v58, v59
s_waitcnt lgkmcnt(7)
v_mfma_f32_16x16x32_bf16 v[160:163], v[192:195], a[32:35], v[160:163]
ds_read_b64_tr_b16 v[182:183], v236 offset:12800
v_max3_f32 v240, v240, v52, v53
v_mfma_f32_16x16x32_bf16 v[168:171], v[192:195], a[36:39], v[168:171]
ds_read_b64_tr_b16 v[184:185], v236 offset:20480
v_max3_f32 v241, v241, v60, v61
v_mfma_f32_16x16x32_bf16 v[164:167], v[196:199], a[32:35], v[164:167]
ds_read_b64_tr_b16 v[186:187], v237 offset:20992
v_max3_f32 v240, v240, v54, v55
v_mfma_f32_16x16x32_bf16 v[172:175], v[196:199], a[36:39], v[172:175]
ds_read_b64_tr_b16 v[188:189], v237 offset:20480
v_max3_f32 v241, v241, v62, v63
s_waitcnt lgkmcnt(7)
v_mfma_f32_16x16x32_bf16 v[128:131], v[200:203], a[40:43], v[128:131]
ds_read_b64_tr_b16 v[190:191], v236 offset:20992
v_mfma_f32_16x16x32_bf16 v[136:139], v[200:203], a[44:47], v[136:139]
v_mfma_f32_16x16x32_bf16 v[132:135], v[204:207], a[40:43], v[132:135]
v_mfma_f32_16x16x32_bf16 v[140:143], v[204:207], a[44:47], v[140:143]
s_add_u32 s53, s49, 90112
v_add_u32 v232, s53, v231
s_waitcnt lgkmcnt(4)
v_mfma_f32_16x16x32_bf16 v[144:147], v[176:179], a[40:43], v[144:147]
v_xor_b32 v233, 64, v232
v_mfma_f32_16x16x32_bf16 v[152:155], v[176:179], a[44:47], v[152:155]
s_waitcnt vmcnt(12) lgkmcnt(0)
s_barrier
ds_read_b128 v[192:195], v232 offset:0
ds_read_b128 v[196:199], v232 offset:2048
ds_read_b128 v[200:203], v233 offset:0
v_mfma_f32_16x16x32_bf16 v[148:151], v[180:183], a[40:43], v[148:151]
v_mfma_f32_16x16x32_bf16 v[156:159], v[180:183], a[44:47], v[156:159]
ds_read_b128 v[204:207], v233 offset:2048
v_mfma_f32_16x16x32_bf16 v[160:163], v[184:187], a[40:43], v[160:163]
v_mfma_f32_16x16x32_bf16 v[168:171], v[184:187], a[44:47], v[168:171]
ds_read_b128 v[176:179], v232 offset:8192
v_mfma_f32_16x16x32_bf16 v[164:167], v[188:191], a[40:43], v[164:167]
v_mfma_f32_16x16x32_bf16 v[172:175], v[188:191], a[44:47], v[172:175]
ds_read_b128 v[180:183], v232 offset:10240
s_waitcnt lgkmcnt(4)
v_mfma_f32_16x16x32_bf16 v[64:67], v[192:195], a[208:211], 0
v_mfma_f32_16x16x32_bf16 v[72:75], v[192:195], a[212:215], 0
ds_read_b128 v[184:187], v233 offset:8192
v_mfma_f32_16x16x32_bf16 v[68:71], v[196:199], a[208:211], 0
s_mul_i32 s52, s64, 6144
s_add_u32 s52, s52, 3072
s_add_u32 m0, s48, 65536
v_mfma_f32_16x16x32_bf16 v[76:79], v[196:199], a[212:215], 0
ds_read_b128 v[188:191], v233 offset:10240
buffer_load_dwordx4 v226, s[32:35], s52 offen lds
s_waitcnt lgkmcnt(4)
v_mfma_f32_16x16x32_bf16 v[64:67], v[200:203], a[216:219], v[64:67]
v_mfma_f32_16x16x32_bf16 v[72:75], v[200:203], a[220:223], v[72:75]
ds_read_b128 v[192:195], v232 offset:16384
buffer_load_dwordx4 v227, s[32:35], s52 offen offset:1024 lds
v_mfma_f32_16x16x32_bf16 v[68:71], v[204:207], a[216:219], v[68:71]
v_mfma_f32_16x16x32_bf16 v[76:79], v[204:207], a[220:223], v[76:79]
ds_read_b128 v[196:199], v232 offset:18432
s_add_u32 m0, s48, 73600
s_waitcnt lgkmcnt(4)
v_mfma_f32_16x16x32_bf16 v[64:67], v[176:179], a[224:227], v[64:67]
buffer_load_dwordx4 v226, s[32:35], s52 offen offset:128 lds
v_mfma_f32_16x16x32_bf16 v[72:75], v[176:179], a[228:231], v[72:75]
ds_read_b128 v[200:203], v233 offset:16384
v_mfma_f32_16x16x32_bf16 v[68:71], v[180:183], a[224:227], v[68:71]
v_mfma_f32_16x16x32_bf16 v[76:79], v[180:183], a[228:231], v[76:79]
ds_read_b128 v[204:207], v233 offset:18432
buffer_load_dwordx4 v227, s[32:35], s52 offen offset:1152 lds
s_waitcnt lgkmcnt(4)
v_mfma_f32_16x16x32_bf16 v[64:67], v[184:187], a[232:235], v[64:67]
v_mfma_f32_16x16x32_bf16 v[72:75], v[184:187], a[236:239], v[72:75]
s_add_u32 m0, s48, 81664
v_mfma_f32_16x16x32_bf16 v[68:71], v[188:191], a[232:235], v[68:71]
buffer_load_dwordx4 v226, s[32:35], s52 offen offset:256 lds
v_mfma_f32_16x16x32_bf16 v[76:79], v[188:191], a[236:239], v[76:79]
v_add_u32 v236, 114688, v230
v_xor_b32 v237, 32, v236
s_waitcnt lgkmcnt(2)
v_mfma_f32_16x16x32_bf16 v[64:67], v[192:195], a[240:243], v[64:67]
v_mfma_f32_16x16x32_bf16 v[72:75], v[192:195], a[244:247], v[72:75]
buffer_load_dwordx4 v227, s[32:35], s52 offen offset:1280 lds
s_waitcnt vmcnt(12) lgkmcnt(0)
s_barrier
ds_read_b64_tr_b16 v[176:177], v236 offset:0
ds_read_b64_tr_b16 v[178:179], v237 offset:512
ds_read_b64_tr_b16 v[180:181], v237 offset:0
ds_read_b64_tr_b16 v[182:183], v236 offset:512
ds_read_b64_tr_b16 v[184:185], v236 offset:8192
ds_read_b64_tr_b16 v[186:187], v237 offset:8704
v_mfma_f32_16x16x32_bf16 v[68:71], v[196:199], a[240:243], v[68:71]
s_mov_b32 s52, 147456
s_add_u32 m0, s48, 90112
s_nop 0
buffer_load_dwordx4 v224, s[24:27], s52 offen nt lds
v_mfma_f32_16x16x32_bf16 v[76:79], v[196:199], a[244:247], v[76:79]
ds_read_b64_tr_b16 v[188:189], v237 offset:8192
v_mfma_f32_16x16x32_bf16 v[64:67], v[200:203], a[248:251], v[64:67]
ds_read_b64_tr_b16 v[190:191], v236 offset:8704
buffer_load_dwordx4 v225, s[24:27], s52 offen offset:1024 nt lds
v_mfma_f32_16x16x32_bf16 v[72:75], v[200:203], a[252:255], v[72:75]
ds_read_b64_tr_b16 v[192:193], v236 offset:16384
s_add_u32 m0, s48, 98176
v_mfma_f32_16x16x32_bf16 v[68:71], v[204:207], a[248:251], v[68:71]
ds_read_b64_tr_b16 v[194:195], v237 offset:16896
buffer_load_dwordx4 v224, s[24:27], s52 offen offset:128 nt lds
v_mfma_f32_16x16x32_bf16 v[76:79], v[204:207], a[252:255], v[76:79]
ds_read_b64_tr_b16 v[196:197], v237 offset:16384
s_waitcnt lgkmcnt(7)
v_mfma_f32_16x16x32_bf16 v[128:131], v[176:179], a[48:51], v[128:131]
ds_read_b64_tr_b16 v[198:199], v236 offset:16896
buffer_load_dwordx4 v225, s[24:27], s52 offen offset:1152 nt lds
v_mfma_f32_16x16x32_bf16 v[136:139], v[176:179], a[52:55], v[136:139]
ds_read_b64_tr_b16 v[200:201], v236 offset:4096
s_add_u32 m0, s48, 106240
v_mfma_f32_16x16x32_bf16 v[132:135], v[180:183], a[48:51], v[132:135]
ds_read_b64_tr_b16 v[202:203], v237 offset:4608
buffer_load_dwordx4 v224, s[24:27], s52 offen offset:256 nt lds
v_mfma_f32_16x16x32_bf16 v[140:143], v[180:183], a[52:55], v[140:143]
ds_read_b64_tr_b16 v[204:205], v237 offset:4096
v_max3_f32 v240, v240, v64, v65
s_waitcnt lgkmcnt(7)
v_mfma_f32_16x16x32_bf16 v[144:147], v[184:187], a[48:51], v[144:147]
ds_read_b64_tr_b16 v[206:207], v236 offset:4608
v_max3_f32 v241, v241, v72, v73
v_mfma_f32_16x16x32_bf16 v[152:155], v[184:187], a[52:55], v[152:155]
ds_read_b64_tr_b16 v[176:177], v236 offset:12288
buffer_load_dwordx4 v225, s[24:27], s52 offen offset:1280 nt lds
v_mfma_f32_16x16x32_bf16 v[148:151], v[188:191], a[48:51], v[148:151]
ds_read_b64_tr_b16 v[178:179], v237 offset:12800
v_max3_f32 v240, v240, v66, v67
v_mfma_f32_16x16x32_bf16 v[156:159], v[188:191], a[52:55], v[156:159]
ds_read_b64_tr_b16 v[180:181], v237 offset:12288
v_max3_f32 v241, v241, v74, v75
s_waitcnt lgkmcnt(7)
v_mfma_f32_16x16x32_bf16 v[160:163], v[192:195], a[48:51], v[160:163]
ds_read_b64_tr_b16 v[182:183], v236 offset:12800
v_max3_f32 v240, v240, v68, v69
v_mfma_f32_16x16x32_bf16 v[168:171], v[192:195], a[52:55], v[168:171]
ds_read_b64_tr_b16 v[184:185], v236 offset:20480
v_max3_f32 v241, v241, v76, v77
v_mfma_f32_16x16x32_bf16 v[164:167], v[196:199], a[48:51], v[164:167]
ds_read_b64_tr_b16 v[186:187], v237 offset:20992
v_max3_f32 v240, v240, v70, v71
v_mfma_f32_16x16x32_bf16 v[172:175], v[196:199], a[52:55], v[172:175]
ds_read_b64_tr_b16 v[188:189], v237 offset:20480
v_max3_f32 v241, v241, v78, v79
s_waitcnt lgkmcnt(7)
v_mfma_f32_16x16x32_bf16 v[128:131], v[200:203], a[56:59], v[128:131]
ds_read_b64_tr_b16 v[190:191], v236 offset:20992
v_mfma_f32_16x16x32_bf16 v[136:139], v[200:203], a[60:63], v[136:139]
v_mfma_f32_16x16x32_bf16 v[132:135], v[204:207], a[56:59], v[132:135]
v_mfma_f32_16x16x32_bf16 v[140:143], v[204:207], a[60:63], v[140:143]
s_add_u32 s53, s49, 139264
v_add_u32 v232, s53, v231
s_waitcnt lgkmcnt(4)
v_mfma_f32_16x16x32_bf16 v[144:147], v[176:179], a[56:59], v[144:147]
v_xor_b32 v233, 64, v232
v_mfma_f32_16x16x32_bf16 v[152:155], v[176:179], a[60:63], v[152:155]
s_waitcnt vmcnt(12) lgkmcnt(0)
s_barrier
ds_read_b128 v[192:195], v232 offset:0
ds_read_b128 v[196:199], v232 offset:2048
ds_read_b128 v[200:203], v233 offset:0
v_mfma_f32_16x16x32_bf16 v[148:151], v[180:183], a[56:59], v[148:151]
v_mfma_f32_16x16x32_bf16 v[156:159], v[180:183], a[60:63], v[156:159]
ds_read_b128 v[204:207], v233 offset:2048
v_mfma_f32_16x16x32_bf16 v[160:163], v[184:187], a[56:59], v[160:163]
v_mfma_f32_16x16x32_bf16 v[168:171], v[184:187], a[60:63], v[168:171]
ds_read_b128 v[176:179], v232 offset:8192
v_mfma_f32_16x16x32_bf16 v[164:167], v[188:191], a[56:59], v[164:167]
v_mfma_f32_16x16x32_bf16 v[172:175], v[188:191], a[60:63], v[172:175]
ds_read_b128 v[180:183], v232 offset:10240
s_waitcnt lgkmcnt(4)
v_mfma_f32_16x16x32_bf16 v[80:83], v[192:195], a[208:211], 0
v_mfma_f32_16x16x32_bf16 v[88:91], v[192:195], a[212:215], 0
ds_read_b128 v[184:187], v233 offset:8192
v_mfma_f32_16x16x32_bf16 v[84:87], v[196:199], a[208:211], 0
s_mul_i32 s52, s65, 6144
s_add_u32 s52, s52, 3072
s_add_u32 m0, s48, 114688
v_mfma_f32_16x16x32_bf16 v[92:95], v[196:199], a[212:215], 0
ds_read_b128 v[188:191], v233 offset:10240
buffer_load_dwordx4 v226, s[32:35], s52 offen lds
s_waitcnt lgkmcnt(4)
v_mfma_f32_16x16x32_bf16 v[80:83], v[200:203], a[216:219], v[80:83]
v_mfma_f32_16x16x32_bf16 v[88:91], v[200:203], a[220:223], v[88:91]
ds_read_b128 v[192:195], v232 offset:16384
buffer_load_dwordx4 v227, s[32:35], s52 offen offset:1024 lds
v_mfma_f32_16x16x32_bf16 v[84:87], v[204:207], a[216:219], v[84:87]
v_mfma_f32_16x16x32_bf16 v[92:95], v[204:207], a[220:223], v[92:95]
ds_read_b128 v[196:199], v232 offset:18432
s_add_u32 m0, s48, 122752
s_waitcnt lgkmcnt(4)
v_mfma_f32_16x16x32_bf16 v[80:83], v[176:179], a[224:227], v[80:83]
buffer_load_dwordx4 v226, s[32:35], s52 offen offset:128 lds
v_mfma_f32_16x16x32_bf16 v[88:91], v[176:179], a[228:231], v[88:91]
ds_read_b128 v[200:203], v233 offset:16384
v_mfma_f32_16x16x32_bf16 v[84:87], v[180:183], a[224:227], v[84:87]
v_mfma_f32_16x16x32_bf16 v[92:95], v[180:183], a[228:231], v[92:95]
ds_read_b128 v[204:207], v233 offset:18432
buffer_load_dwordx4 v227, s[32:35], s52 offen offset:1152 lds
s_waitcnt lgkmcnt(4)
v_mfma_f32_16x16x32_bf16 v[80:83], v[184:187], a[232:235], v[80:83]
v_mfma_f32_16x16x32_bf16 v[88:91], v[184:187], a[236:239], v[88:91]
s_add_u32 m0, s48, 130816
v_mfma_f32_16x16x32_bf16 v[84:87], v[188:191], a[232:235], v[84:87]
buffer_load_dwordx4 v226, s[32:35], s52 offen offset:256 lds
v_mfma_f32_16x16x32_bf16 v[92:95], v[188:191], a[236:239], v[92:95]
v_add_u32 v236, 65536, v230
v_xor_b32 v237, 32, v236
s_waitcnt lgkmcnt(2)
v_mfma_f32_16x16x32_bf16 v[80:83], v[192:195], a[240:243], v[80:83]
v_mfma_f32_16x16x32_bf16 v[88:91], v[192:195], a[244:247], v[88:91]
buffer_load_dwordx4 v227, s[32:35], s52 offen offset:1280 lds
s_waitcnt vmcnt(12) lgkmcnt(0)
s_barrier
ds_read_b64_tr_b16 v[176:177], v236 offset:0
ds_read_b64_tr_b16 v[178:179], v237 offset:512
ds_read_b64_tr_b16 v[180:181], v237 offset:0
ds_read_b64_tr_b16 v[182:183], v236 offset:512
ds_read_b64_tr_b16 v[184:185], v236 offset:8192
ds_read_b64_tr_b16 v[186:187], v237 offset:8704
v_mfma_f32_16x16x32_bf16 v[84:87], v[196:199], a[240:243], v[84:87]
s_mov_b32 s52, 172032
s_add_u32 m0, s48, 139264
s_nop 0
buffer_load_dwordx4 v224, s[24:27], s52 offen nt lds
v_mfma_f32_16x16x32_bf16 v[92:95], v[196:199], a[244:247], v[92:95]
ds_read_b64_tr_b16 v[188:189], v237 offset:8192
v_mfma_f32_16x16x32_bf16 v[80:83], v[200:203], a[248:251], v[80:83]
ds_read_b64_tr_b16 v[190:191], v236 offset:8704
buffer_load_dwordx4 v225, s[24:27], s52 offen offset:1024 nt lds
v_mfma_f32_16x16x32_bf16 v[88:91], v[200:203], a[252:255], v[88:91]
ds_read_b64_tr_b16 v[192:193], v236 offset:16384
s_add_u32 m0, s48, 147328
v_mfma_f32_16x16x32_bf16 v[84:87], v[204:207], a[248:251], v[84:87]
ds_read_b64_tr_b16 v[194:195], v237 offset:16896
buffer_load_dwordx4 v224, s[24:27], s52 offen offset:128 nt lds
v_mfma_f32_16x16x32_bf16 v[92:95], v[204:207], a[252:255], v[92:95]
ds_read_b64_tr_b16 v[196:197], v237 offset:16384
s_waitcnt lgkmcnt(7)
v_mfma_f32_16x16x32_bf16 v[128:131], v[176:179], a[64:67], v[128:131]
ds_read_b64_tr_b16 v[198:199], v236 offset:16896
buffer_load_dwordx4 v225, s[24:27], s52 offen offset:1152 nt lds
v_mfma_f32_16x16x32_bf16 v[136:139], v[176:179], a[68:71], v[136:139]
ds_read_b64_tr_b16 v[200:201], v236 offset:4096
s_add_u32 m0, s48, 155392
v_mfma_f32_16x16x32_bf16 v[132:135], v[180:183], a[64:67], v[132:135]
ds_read_b64_tr_b16 v[202:203], v237 offset:4608
buffer_load_dwordx4 v224, s[24:27], s52 offen offset:256 nt lds
v_mfma_f32_16x16x32_bf16 v[140:143], v[180:183], a[68:71], v[140:143]
ds_read_b64_tr_b16 v[204:205], v237 offset:4096
v_max3_f32 v240, v240, v80, v81
s_waitcnt lgkmcnt(7)
v_mfma_f32_16x16x32_bf16 v[144:147], v[184:187], a[64:67], v[144:147]
ds_read_b64_tr_b16 v[206:207], v236 offset:4608
v_max3_f32 v241, v241, v88, v89
v_mfma_f32_16x16x32_bf16 v[152:155], v[184:187], a[68:71], v[152:155]
ds_read_b64_tr_b16 v[176:177], v236 offset:12288
buffer_load_dwordx4 v225, s[24:27], s52 offen offset:1280 nt lds
v_mfma_f32_16x16x32_bf16 v[148:151], v[188:191], a[64:67], v[148:151]
ds_read_b64_tr_b16 v[178:179], v237 offset:12800
v_max3_f32 v240, v240, v82, v83
v_mfma_f32_16x16x32_bf16 v[156:159], v[188:191], a[68:71], v[156:159]
ds_read_b64_tr_b16 v[180:181], v237 offset:12288
v_max3_f32 v241, v241, v90, v91
s_waitcnt lgkmcnt(7)
v_mfma_f32_16x16x32_bf16 v[160:163], v[192:195], a[64:67], v[160:163]
ds_read_b64_tr_b16 v[182:183], v236 offset:12800
v_max3_f32 v240, v240, v84, v85
v_mfma_f32_16x16x32_bf16 v[168:171], v[192:195], a[68:71], v[168:171]
ds_read_b64_tr_b16 v[184:185], v236 offset:20480
v_max3_f32 v241, v241, v92, v93
v_mfma_f32_16x16x32_bf16 v[164:167], v[196:199], a[64:67], v[164:167]
ds_read_b64_tr_b16 v[186:187], v237 offset:20992
v_max3_f32 v240, v240, v86, v87
v_mfma_f32_16x16x32_bf16 v[172:175], v[196:199], a[68:71], v[172:175]
ds_read_b64_tr_b16 v[188:189], v237 offset:20480
v_max3_f32 v241, v241, v94, v95
s_waitcnt lgkmcnt(7)
v_mfma_f32_16x16x32_bf16 v[128:131], v[200:203], a[72:75], v[128:131]
ds_read_b64_tr_b16 v[190:191], v236 offset:20992
v_mfma_f32_16x16x32_bf16 v[136:139], v[200:203], a[76:79], v[136:139]
v_mfma_f32_16x16x32_bf16 v[132:135], v[204:207], a[72:75], v[132:135]
v_mfma_f32_16x16x32_bf16 v[140:143], v[204:207], a[76:79], v[140:143]
s_add_u32 s53, s49, 90112
v_add_u32 v232, s53, v231
s_waitcnt lgkmcnt(4)
v_mfma_f32_16x16x32_bf16 v[144:147], v[176:179], a[72:75], v[144:147]
v_xor_b32 v233, 64, v232
v_mfma_f32_16x16x32_bf16 v[152:155], v[176:179], a[76:79], v[152:155]
s_waitcnt vmcnt(12) lgkmcnt(0)
s_barrier
ds_read_b128 v[192:195], v232 offset:0
ds_read_b128 v[196:199], v232 offset:2048
ds_read_b128 v[200:203], v233 offset:0
v_mfma_f32_16x16x32_bf16 v[148:151], v[180:183], a[72:75], v[148:151]
v_mfma_f32_16x16x32_bf16 v[156:159], v[180:183], a[76:79], v[156:159]
ds_read_b128 v[204:207], v233 offset:2048
v_mfma_f32_16x16x32_bf16 v[160:163], v[184:187], a[72:75], v[160:163]
v_mfma_f32_16x16x32_bf16 v[168:171], v[184:187], a[76:79], v[168:171]
ds_read_b128 v[176:179], v232 offset:8192
v_mfma_f32_16x16x32_bf16 v[164:167], v[188:191], a[72:75], v[164:167]
v_mfma_f32_16x16x32_bf16 v[172:175], v[188:191], a[76:79], v[172:175]
ds_read_b128 v[180:183], v232 offset:10240
s_waitcnt lgkmcnt(4)
v_mfma_f32_16x16x32_bf16 v[96:99], v[192:195], a[208:211], 0
v_mfma_f32_16x16x32_bf16 v[104:107], v[192:195], a[212:215], 0
ds_read_b128 v[184:187], v233 offset:8192
v_mfma_f32_16x16x32_bf16 v[100:103], v[196:199], a[208:211], 0
s_mul_i32 s52, s66, 6144
s_add_u32 s52, s52, 3072
s_add_u32 m0, s48, 65536
v_mfma_f32_16x16x32_bf16 v[108:111], v[196:199], a[212:215], 0
ds_read_b128 v[188:191], v233 offset:10240
buffer_load_dwordx4 v226, s[32:35], s52 offen lds
s_waitcnt lgkmcnt(4)
v_mfma_f32_16x16x32_bf16 v[96:99], v[200:203], a[216:219], v[96:99]
v_mfma_f32_16x16x32_bf16 v[104:107], v[200:203], a[220:223], v[104:107]
ds_read_b128 v[192:195], v232 offset:16384
buffer_load_dwordx4 v227, s[32:35], s52 offen offset:1024 lds
v_mfma_f32_16x16x32_bf16 v[100:103], v[204:207], a[216:219], v[100:103]
v_mfma_f32_16x16x32_bf16 v[108:111], v[204:207], a[220:223], v[108:111]
ds_read_b128 v[196:199], v232 offset:18432
s_add_u32 m0, s48, 73600
s_waitcnt lgkmcnt(4)
v_mfma_f32_16x16x32_bf16 v[96:99], v[176:179], a[224:227], v[96:99]
buffer_load_dwordx4 v226, s[32:35], s52 offen offset:128 lds
v_mfma_f32_16x16x32_bf16 v[104:107], v[176:179], a[228:231], v[104:107]
ds_read_b128 v[200:203], v233 offset:16384
v_mfma_f32_16x16x32_bf16 v[100:103], v[180:183], a[224:227], v[100:103]
v_mfma_f32_16x16x32_bf16 v[108:111], v[180:183], a[228:231], v[108:111]
ds_read_b128 v[204:207], v233 offset:18432
buffer_load_dwordx4 v227, s[32:35], s52 offen offset:1152 lds
s_waitcnt lgkmcnt(4)
v_mfma_f32_16x16x32_bf16 v[96:99], v[184:187], a[232:235], v[96:99]
v_mfma_f32_16x16x32_bf16 v[104:107], v[184:187], a[236:239], v[104:107]
s_add_u32 m0, s48, 81664
v_mfma_f32_16x16x32_bf16 v[100:103], v[188:191], a[232:235], v[100:103]
buffer_load_dwordx4 v226, s[32:35], s52 offen offset:256 lds
v_mfma_f32_16x16x32_bf16 v[108:111], v[188:191], a[236:239], v[108:111]
v_add_u32 v236, 114688, v230
v_xor_b32 v237, 32, v236
s_waitcnt lgkmcnt(2)
v_mfma_f32_16x16x32_bf16 v[96:99], v[192:195], a[240:243], v[96:99]
v_mfma_f32_16x16x32_bf16 v[104:107], v[192:195], a[244:247], v[104:107]
buffer_load_dwordx4 v227, s[32:35], s52 offen offset:1280 lds
s_waitcnt vmcnt(12) lgkmcnt(0)
s_barrier
ds_read_b64_tr_b16 v[176:177], v236 offset:0
ds_read_b64_tr_b16 v[178:179], v237 offset:512
ds_read_b64_tr_b16 v[180:181], v237 offset:0
ds_read_b64_tr_b16 v[182:183], v236 offset:512
ds_read_b64_tr_b16 v[184:185], v236 offset:8192
ds_read_b64_tr_b16 v[186:187], v237 offset:8704
v_mfma_f32_16x16x32_bf16 v[100:103], v[196:199], a[240:243], v[100:103]
s_mul_i32 s52, s67, 6144
s_add_u32 s52, s52, 3072
s_add_u32 m0, s48, 90112
s_nop 0
buffer_load_dwordx4 v226, s[32:35], s52 offen lds
v_mfma_f32_16x16x32_bf16 v[108:111], v[196:199], a[244:247], v[108:111]
ds_read_b64_tr_b16 v[188:189], v237 offset:8192
v_mfma_f32_16x16x32_bf16 v[96:99], v[200:203], a[248:251], v[96:99]
ds_read_b64_tr_b16 v[190:191], v236 offset:8704
v_mfma_f32_16x16x32_bf16 v[104:107], v[200:203], a[252:255], v[104:107]
ds_read_b64_tr_b16 v[192:193], v236 offset:16384
buffer_load_dwordx4 v227, s[32:35], s52 offen offset:1024 lds
v_mfma_f32_16x16x32_bf16 v[100:103], v[204:207], a[248:251], v[100:103]
ds_read_b64_tr_b16 v[194:195], v237 offset:16896
v_mfma_f32_16x16x32_bf16 v[108:111], v[204:207], a[252:255], v[108:111]
ds_read_b64_tr_b16 v[196:197], v237 offset:16384
s_waitcnt lgkmcnt(7)
v_mfma_f32_16x16x32_bf16 v[128:131], v[176:179], a[80:83], v[128:131]
ds_read_b64_tr_b16 v[198:199], v236 offset:16896
s_add_u32 m0, s48, 98176
v_mfma_f32_16x16x32_bf16 v[136:139], v[176:179], a[84:87], v[136:139]
ds_read_b64_tr_b16 v[200:201], v236 offset:4096
buffer_load_dwordx4 v226, s[32:35], s52 offen offset:128 lds
v_mfma_f32_16x16x32_bf16 v[132:135], v[180:183], a[80:83], v[132:135]
ds_read_b64_tr_b16 v[202:203], v237 offset:4608
v_max3_f32 v240, v240, v96, v97
v_mfma_f32_16x16x32_bf16 v[140:143], v[180:183], a[84:87], v[140:143]
ds_read_b64_tr_b16 v[204:205], v237 offset:4096
v_max3_f32 v241, v241, v104, v105
s_waitcnt lgkmcnt(7)
v_mfma_f32_16x16x32_bf16 v[144:147], v[184:187], a[80:83], v[144:147]
ds_read_b64_tr_b16 v[206:207], v236 offset:4608
buffer_load_dwordx4 v227, s[32:35], s52 offen offset:1152 lds
v_mfma_f32_16x16x32_bf16 v[152:155], v[184:187], a[84:87], v[152:155]
ds_read_b64_tr_b16 v[176:177], v236 offset:12288
v_max3_f32 v240, v240, v98, v99
v_mfma_f32_16x16x32_bf16 v[148:151], v[188:191], a[80:83], v[148:151]
ds_read_b64_tr_b16 v[178:179], v237 offset:12800
v_max3_f32 v241, v241, v106, v107
v_mfma_f32_16x16x32_bf16 v[156:159], v[188:191], a[84:87], v[156:159]
ds_read_b64_tr_b16 v[180:181], v237 offset:12288
s_add_u32 m0, s48, 106240
v_max3_f32 v240, v240, v100, v101
s_waitcnt lgkmcnt(7)
v_mfma_f32_16x16x32_bf16 v[160:163], v[192:195], a[80:83], v[160:163]
ds_read_b64_tr_b16 v[182:183], v236 offset:12800
buffer_load_dwordx4 v226, s[32:35], s52 offen offset:256 lds
v_mfma_f32_16x16x32_bf16 v[168:171], v[192:195], a[84:87], v[168:171]
ds_read_b64_tr_b16 v[184:185], v236 offset:20480
v_max3_f32 v241, v241, v108, v109
v_mfma_f32_16x16x32_bf16 v[164:167], v[196:199], a[80:83], v[164:167]
ds_read_b64_tr_b16 v[186:187], v237 offset:20992
v_max3_f32 v240, v240, v102, v103
v_mfma_f32_16x16x32_bf16 v[172:175], v[196:199], a[84:87], v[172:175]
ds_read_b64_tr_b16 v[188:189], v237 offset:20480
v_max3_f32 v241, v241, v110, v111
s_waitcnt lgkmcnt(7)
v_mfma_f32_16x16x32_bf16 v[128:131], v[200:203], a[88:91], v[128:131]
ds_read_b64_tr_b16 v[190:191], v236 offset:20992
buffer_load_dwordx4 v227, s[32:35], s52 offen offset:1280 lds
v_mfma_f32_16x16x32_bf16 v[136:139], v[200:203], a[92:95], v[136:139]
v_mfma_f32_16x16x32_bf16 v[132:135], v[204:207], a[88:91], v[132:135]
v_mfma_f32_16x16x32_bf16 v[140:143], v[204:207], a[92:95], v[140:143]
s_add_u32 s53, s49, 139264
v_add_u32 v232, s53, v231
s_waitcnt lgkmcnt(4)
v_mfma_f32_16x16x32_bf16 v[144:147], v[176:179], a[88:91], v[144:147]
v_xor_b32 v233, 64, v232
v_mfma_f32_16x16x32_bf16 v[152:155], v[176:179], a[92:95], v[152:155]
s_waitcnt vmcnt(12) lgkmcnt(0)
s_barrier
ds_read_b128 v[192:195], v232 offset:0
ds_read_b128 v[196:199], v232 offset:2048
ds_read_b128 v[200:203], v233 offset:0
v_mfma_f32_16x16x32_bf16 v[148:151], v[180:183], a[88:91], v[148:151]
s_mov_b32 s52, 0
s_add_u32 m0, s48, 114688
s_nop 0
buffer_load_dwordx4 v224, s[28:31], s52 offen nt lds
v_mfma_f32_16x16x32_bf16 v[156:159], v[180:183], a[92:95], v[156:159]
ds_read_b128 v[204:207], v233 offset:2048
v_mfma_f32_16x16x32_bf16 v[160:163], v[184:187], a[88:91], v[160:163]
buffer_load_dwordx4 v225, s[28:31], s52 offen offset:1024 nt lds
v_mfma_f32_16x16x32_bf16 v[168:171], v[184:187], a[92:95], v[168:171]
ds_read_b128 v[176:179], v232 offset:8192
s_add_u32 m0, s48, 122752
v_mfma_f32_16x16x32_bf16 v[164:167], v[188:191], a[88:91], v[164:167]
buffer_load_dwordx4 v224, s[28:31], s52 offen offset:128 nt lds
v_mfma_f32_16x16x32_bf16 v[172:175], v[188:191], a[92:95], v[172:175]
ds_read_b128 v[180:183], v232 offset:10240
s_waitcnt lgkmcnt(4)
v_mfma_f32_16x16x32_bf16 v[112:115], v[192:195], a[208:211], 0
buffer_load_dwordx4 v225, s[28:31], s52 offen offset:1152 nt lds
v_mfma_f32_16x16x32_bf16 v[120:123], v[192:195], a[212:215], 0
ds_read_b128 v[184:187], v233 offset:8192
s_add_u32 m0, s48, 130816
v_mfma_f32_16x16x32_bf16 v[116:119], v[196:199], a[208:211], 0
buffer_load_dwordx4 v224, s[28:31], s52 offen offset:256 nt lds
v_mfma_f32_16x16x32_bf16 v[124:127], v[196:199], a[212:215], 0
ds_read_b128 v[188:191], v233 offset:10240
s_waitcnt lgkmcnt(4)
v_mfma_f32_16x16x32_bf16 v[112:115], v[200:203], a[216:219], v[112:115]
v_mfma_f32_16x16x32_bf16 v[120:123], v[200:203], a[220:223], v[120:123]
ds_read_b128 v[192:195], v232 offset:16384
buffer_load_dwordx4 v225, s[28:31], s52 offen offset:1280 nt lds
v_mfma_f32_16x16x32_bf16 v[116:119], v[204:207], a[216:219], v[116:119]
v_mfma_f32_16x16x32_bf16 v[124:127], v[204:207], a[220:223], v[124:127]
ds_read_b128 v[196:199], v232 offset:18432
s_waitcnt lgkmcnt(4)
v_mfma_f32_16x16x32_bf16 v[112:115], v[176:179], a[224:227], v[112:115]
v_mfma_f32_16x16x32_bf16 v[120:123], v[176:179], a[228:231], v[120:123]
ds_read_b128 v[200:203], v233 offset:16384
v_mfma_f32_16x16x32_bf16 v[116:119], v[180:183], a[224:227], v[116:119]
v_mfma_f32_16x16x32_bf16 v[124:127], v[180:183], a[228:231], v[124:127]
ds_read_b128 v[204:207], v233 offset:18432
s_waitcnt lgkmcnt(4)
v_mfma_f32_16x16x32_bf16 v[112:115], v[184:187], a[232:235], v[112:115]
v_mfma_f32_16x16x32_bf16 v[120:123], v[184:187], a[236:239], v[120:123]
v_mfma_f32_16x16x32_bf16 v[116:119], v[188:191], a[232:235], v[116:119]
v_mfma_f32_16x16x32_bf16 v[124:127], v[188:191], a[236:239], v[124:127]
v_add_u32 v236, 65536, v230
v_xor_b32 v237, 32, v236
s_waitcnt lgkmcnt(2)
v_mfma_f32_16x16x32_bf16 v[112:115], v[192:195], a[240:243], v[112:115]
v_mfma_f32_16x16x32_bf16 v[120:123], v[192:195], a[244:247], v[120:123]
s_waitcnt vmcnt(12) lgkmcnt(0)
s_barrier
ds_read_b64_tr_b16 v[176:177], v236 offset:0
ds_read_b64_tr_b16 v[178:179], v237 offset:512
ds_read_b64_tr_b16 v[180:181], v237 offset:0
ds_read_b64_tr_b16 v[182:183], v236 offset:512
ds_read_b64_tr_b16 v[184:185], v236 offset:8192
ds_read_b64_tr_b16 v[186:187], v237 offset:8704
v_mfma_f32_16x16x32_bf16 v[116:119], v[196:199], a[240:243], v[116:119]
v_mfma_f32_16x16x32_bf16 v[124:127], v[196:199], a[244:247], v[124:127]
ds_read_b64_tr_b16 v[188:189], v237 offset:8192
v_mfma_f32_16x16x32_bf16 v[112:115], v[200:203], a[248:251], v[112:115]
ds_read_b64_tr_b16 v[190:191], v236 offset:8704
v_mfma_f32_16x16x32_bf16 v[120:123], v[200:203], a[252:255], v[120:123]
ds_read_b64_tr_b16 v[192:193], v236 offset:16384
v_mfma_f32_16x16x32_bf16 v[116:119], v[204:207], a[248:251], v[116:119]
ds_read_b64_tr_b16 v[194:195], v237 offset:16896
v_mfma_f32_16x16x32_bf16 v[124:127], v[204:207], a[252:255], v[124:127]
ds_read_b64_tr_b16 v[196:197], v237 offset:16384
s_waitcnt lgkmcnt(7)
v_mfma_f32_16x16x32_bf16 v[128:131], v[176:179], a[96:99], v[128:131]
ds_read_b64_tr_b16 v[198:199], v236 offset:16896
v_mfma_f32_16x16x32_bf16 v[136:139], v[176:179], a[100:103], v[136:139]
ds_read_b64_tr_b16 v[200:201], v236 offset:4096
v_mfma_f32_16x16x32_bf16 v[132:135], v[180:183], a[96:99], v[132:135]
ds_read_b64_tr_b16 v[202:203], v237 offset:4608
s_mul_i32 s52, s68, 6144
s_add_u32 s52, s52, 3072
s_add_u32 m0, s48, 139264
v_max3_f32 v240, v240, v112, v113
v_max3_f32 v241, v241, v120, v121
v_mfma_f32_16x16x32_bf16 v[140:143], v[180:183], a[100:103], v[140:143]
ds_read_b64_tr_b16 v[204:205], v237 offset:4096
buffer_load_dwordx4 v226, s[32:35], s52 offen lds
v_max3_f32 v240, v240, v114, v115
s_waitcnt lgkmcnt(7)
v_mfma_f32_16x16x32_bf16 v[144:147], v[184:187], a[96:99], v[144:147]
ds_read_b64_tr_b16 v[206:207], v236 offset:4608
v_max3_f32 v241, v241, v122, v123
v_max3_f32 v240, v240, v116, v117
v_max3_f32 v241, v241, v124, v125
v_mfma_f32_16x16x32_bf16 v[152:155], v[184:187], a[100:103], v[152:155]
ds_read_b64_tr_b16 v[176:177], v236 offset:12288
buffer_load_dwordx4 v227, s[32:35], s52 offen offset:1024 lds
v_max3_f32 v240, v240, v118, v119
v_mfma_f32_16x16x32_bf16 v[148:151], v[188:191], a[96:99], v[148:151]
ds_read_b64_tr_b16 v[178:179], v237 offset:12800
v_max3_f32 v241, v241, v126, v127
v_mov_b32 v246, v240
v_mov_b32 v247, v241
v_mfma_f32_16x16x32_bf16 v[156:159], v[188:191], a[100:103], v[156:159]
ds_read_b64_tr_b16 v[180:181], v237 offset:12288
s_add_u32 m0, s48, 147328
v_permlane16_swap_b32 v246, v240
v_permlane16_swap_b32 v247, v241
s_waitcnt lgkmcnt(7)
v_mfma_f32_16x16x32_bf16 v[160:163], v[192:195], a[96:99], v[160:163]
ds_read_b64_tr_b16 v[182:183], v236 offset:12800
buffer_load_dwordx4 v226, s[32:35], s52 offen offset:128 lds
v_max_f32 v240, v240, v246
v_mfma_f32_16x16x32_bf16 v[168:171], v[192:195], a[100:103], v[168:171]
ds_read_b64_tr_b16 v[184:185], v236 offset:20480
v_max_f32 v241, v241, v247
v_mov_b32 v246, v240
v_mov_b32 v247, v241
v_mfma_f32_16x16x32_bf16 v[164:167], v[196:199], a[96:99], v[164:167]
ds_read_b64_tr_b16 v[186:187], v237 offset:20992
v_permlane32_swap_b32 v246, v240
v_permlane32_swap_b32 v247, v241
v_max_f32 v240, v240, v246
v_mfma_f32_16x16x32_bf16 v[172:175], v[196:199], a[100:103], v[172:175]
ds_read_b64_tr_b16 v[188:189], v237 offset:20480
buffer_load_dwordx4 v227, s[32:35], s52 offen offset:1152 lds
v_max_f32 v241, v241, v247
ds_write_b64 v239, v[240:241] offset:57344
s_waitcnt lgkmcnt(8)
v_mfma_f32_16x16x32_bf16 v[128:131], v[200:203], a[104:107], v[128:131]
ds_read_b64_tr_b16 v[190:191], v236 offset:20992
v_mfma_f32_16x16x32_bf16 v[136:139], v[200:203], a[108:111], v[136:139]
s_add_u32 m0, s48, 155392
v_mfma_f32_16x16x32_bf16 v[132:135], v[204:207], a[104:107], v[132:135]
buffer_load_dwordx4 v226, s[32:35], s52 offen offset:256 lds
v_mfma_f32_16x16x32_bf16 v[140:143], v[204:207], a[108:111], v[140:143]
v_add_u32 v236, 90112, v230
v_xor_b32 v237, 32, v236
s_waitcnt lgkmcnt(5)
v_mfma_f32_16x16x32_bf16 v[144:147], v[176:179], a[104:107], v[144:147]
v_mfma_f32_16x16x32_bf16 v[152:155], v[176:179], a[108:111], v[152:155]
buffer_load_dwordx4 v227, s[32:35], s52 offen offset:1280 lds
s_waitcnt vmcnt(12) lgkmcnt(0)
s_barrier
ds_read_b64_tr_b16 v[192:193], v236 offset:0
ds_read_b64_tr_b16 v[194:195], v237 offset:512
ds_read_b64_tr_b16 v[196:197], v237 offset:0
ds_read_b64_tr_b16 v[198:199], v236 offset:512
ds_read_b64_tr_b16 v[200:201], v236 offset:8192
ds_read_b64_tr_b16 v[202:203], v237 offset:8704
v_mfma_f32_16x16x32_bf16 v[148:151], v[180:183], a[104:107], v[148:151]
s_mov_b32 s52, 24576
s_add_u32 m0, s48, 65536
s_nop 0
buffer_load_dwordx4 v224, s[28:31], s52 offen nt lds
ds_read_b64 v[246:247], v238 offset:57344
ds_read_b64 v[248:249], v238 offset:59392
s_waitcnt lgkmcnt(0)
v_max_f32 v246, v246, v248
v_mfma_f32_16x16x32_bf16 v[156:159], v[180:183], a[108:111], v[156:159]
ds_read_b64_tr_b16 v[204:205], v237 offset:8192
v_max_f32 v247, v247, v249
v_mul_f32 v242, s51, v246
v_mul_f32 v243, s51, v247
v_fma_f32 v0, v0, s51, -v242
v_fma_f32 v1, v1, s51, -v242
v_mfma_f32_16x16x32_bf16 v[160:163], v[184:187], a[104:107], v[160:163]
ds_read_b64_tr_b16 v[206:207], v236 offset:8704
buffer_load_dwordx4 v225, s[28:31], s52 offen offset:1024 nt lds
v_exp_f32 v0, v0
v_mfma_f32_16x16x32_bf16 v[168:171], v[184:187], a[108:111], v[168:171]
ds_read_b64_tr_b16 v[176:177], v236 offset:16384
s_add_u32 m0, s48, 73600
v_exp_f32 v1, v1
v_fma_f32 v2, v2, s51, -v242
v_fma_f32 v3, v3, s51, -v242
v_add_f32 v244, v0, v1
v_mfma_f32_16x16x32_bf16 v[164:167], v[188:191], a[104:107], v[164:167]
ds_read_b64_tr_b16 v[178:179], v237 offset:16896
buffer_load_dwordx4 v224, s[28:31], s52 offen offset:128 nt lds
v_cvt_pk_bf16_f32 v0, v0, v1
v_exp_f32 v2, v2
v_mfma_f32_16x16x32_bf16 v[172:175], v[188:191], a[108:111], v[172:175]
ds_read_b64_tr_b16 v[180:181], v237 offset:16384
v_exp_f32 v3, v3
v_fma_f32 v4, v4, s51, -v242
v_fma_f32 v5, v5, s51, -v242
v_add_f32 v244, v244, v2
v_mfma_f32_16x16x32_bf16 v[128:131], v[192:195], a[112:115], v[128:131]
ds_read_b64_tr_b16 v[182:183], v236 offset:16896
buffer_load_dwordx4 v225, s[28:31], s52 offen offset:1152 nt lds
v_add_f32 v244, v244, v3
v_cvt_pk_bf16_f32 v1, v2, v3
v_mfma_f32_16x16x32_bf16 v[136:139], v[192:195], a[116:119], v[136:139]
ds_read_b64_tr_b16 v[184:185], v236 offset:4096
s_add_u32 m0, s48, 81664
v_exp_f32 v4, v4
v_exp_f32 v5, v5
v_fma_f32 v6, v6, s51, -v242
v_mfma_f32_16x16x32_bf16 v[132:135], v[196:199], a[112:115], v[132:135]
ds_read_b64_tr_b16 v[186:187], v237 offset:4608
buffer_load_dwordx4 v224, s[28:31], s52 offen offset:256 nt lds
v_fma_f32 v7, v7, s51, -v242
v_add_f32 v244, v244, v4
v_add_f32 v244, v244, v5
v_mfma_f32_16x16x32_bf16 v[140:143], v[196:199], a[116:119], v[140:143]
ds_read_b64_tr_b16 v[188:189], v237 offset:4096
v_cvt_pk_bf16_f32 v2, v4, v5
v_exp_f32 v6, v6
v_exp_f32 v7, v7
s_waitcnt lgkmcnt(7)
v_mfma_f32_16x16x32_bf16 v[144:147], v[200:203], a[112:115], v[144:147]
ds_read_b64_tr_b16 v[190:191], v236 offset:4608
v_fma_f32 v8, v8, s51, -v243
v_fma_f32 v9, v9, s51, -v243
v_add_f32 v244, v244, v6
v_add_f32 v244, v244, v7
v_cvt_pk_bf16_f32 v3, v6, v7
v_mfma_f32_16x16x32_bf16 v[152:155], v[200:203], a[116:119], v[152:155]
ds_read_b64_tr_b16 v[192:193], v236 offset:12288
buffer_load_dwordx4 v225, s[28:31], s52 offen offset:1280 nt lds
v_exp_f32 v8, v8
v_exp_f32 v9, v9
v_mfma_f32_16x16x32_bf16 v[148:151], v[204:207], a[112:115], v[148:151]
ds_read_b64_tr_b16 v[194:195], v237 offset:12800
v_fma_f32 v10, v10, s51, -v243
v_fma_f32 v11, v11, s51, -v243
v_add_f32 v245, v8, v9
v_cvt_pk_bf16_f32 v4, v8, v9
v_mfma_f32_16x16x32_bf16 v[156:159], v[204:207], a[116:119], v[156:159]
ds_read_b64_tr_b16 v[196:197], v237 offset:12288
v_exp_f32 v10, v10
v_exp_f32 v11, v11
v_fma_f32 v12, v12, s51, -v243
s_waitcnt lgkmcnt(7)
v_mfma_f32_16x16x32_bf16 v[160:163], v[176:179], a[112:115], v[160:163]
ds_read_b64_tr_b16 v[198:199], v236 offset:12800
v_fma_f32 v13, v13, s51, -v243
v_add_f32 v245, v245, v10
v_add_f32 v245, v245, v11
v_cvt_pk_bf16_f32 v5, v10, v11
v_exp_f32 v12, v12
v_mfma_f32_16x16x32_bf16 v[168:171], v[176:179], a[116:119], v[168:171]
ds_read_b64_tr_b16 v[200:201], v236 offset:20480
v_exp_f32 v13, v13
v_fma_f32 v14, v14, s51, -v243
v_fma_f32 v15, v15, s51, -v243
v_add_f32 v245, v245, v12
v_mfma_f32_16x16x32_bf16 v[164:167], v[180:183], a[112:115], v[164:167]
ds_read_b64_tr_b16 v[202:203], v237 offset:20992
v_add_f32 v245, v245, v13
v_cvt_pk_bf16_f32 v6, v12, v13
v_exp_f32 v14, v14
v_mfma_f32_16x16x32_bf16 v[172:175], v[180:183], a[116:119], v[172:175]
ds_read_b64_tr_b16 v[204:205], v237 offset:20480
v_exp_f32 v15, v15
v_add_f32 v245, v245, v14
v_add_f32 v245, v245, v15
v_cvt_pk_bf16_f32 v7, v14, v15
ds_write_b128 v239, v[0:3] offset:16384
ds_write_b128 v239, v[4:7] offset:17408
s_waitcnt lgkmcnt(9)
v_mfma_f32_16x16x32_bf16 v[128:131], v[184:187], a[120:123], v[128:131]
ds_read_b64_tr_b16 v[206:207], v236 offset:20992
v_mfma_f32_16x16x32_bf16 v[136:139], v[184:187], a[124:127], v[136:139]
v_mfma_f32_16x16x32_bf16 v[132:135], v[188:191], a[120:123], v[132:135]
v_mfma_f32_16x16x32_bf16 v[140:143], v[188:191], a[124:127], v[140:143]
v_add_u32 v236, 114688, v250
v_xor_b32 v237, 32, v236
s_waitcnt lgkmcnt(6)
v_mfma_f32_16x16x32_bf16 v[144:147], v[192:195], a[120:123], v[144:147]
v_xor_b32 v232, 0x1000, v236
v_xor_b32 v233, 0x1000, v237
v_mfma_f32_16x16x32_bf16 v[152:155], v[192:195], a[124:127], v[152:155]
s_waitcnt vmcnt(12) lgkmcnt(0)
s_barrier
ds_read_b64_tr_b16 v[176:177], v236 offset:0
ds_read_b64_tr_b16 v[178:179], v236 offset:2048
ds_read_b64_tr_b16 v[180:181], v237 offset:0
ds_read_b64_tr_b16 v[182:183], v237 offset:2048
ds_read_b64_tr_b16 v[184:185], v236 offset:8192
ds_read_b64_tr_b16 v[186:187], v236 offset:10240
v_mfma_f32_16x16x32_bf16 v[148:151], v[196:199], a[120:123], v[148:151]
v_fma_f32 v16, v16, s51, -v242
v_fma_f32 v17, v17, s51, -v242
v_exp_f32 v16, v16
v_mfma_f32_16x16x32_bf16 v[156:159], v[196:199], a[124:127], v[156:159]
ds_read_b64_tr_b16 v[188:189], v237 offset:8192
v_exp_f32 v17, v17
v_mfma_f32_16x16x32_bf16 v[160:163], v[200:203], a[120:123], v[160:163]
ds_read_b64_tr_b16 v[190:191], v237 offset:10240
v_fma_f32 v18, v18, s51, -v242
v_fma_f32 v19, v19, s51, -v242
v_mfma_f32_16x16x32_bf16 v[168:171], v[200:203], a[124:127], v[168:171]
ds_read_b64_tr_b16 v[192:193], v236 offset:16384
v_add_f32 v244, v244, v16
v_add_f32 v244, v244, v17
v_mfma_f32_16x16x32_bf16 v[164:167], v[204:207], a[120:123], v[164:167]
ds_read_b64_tr_b16 v[194:195], v236 offset:18432
v_cvt_pk_bf16_f32 v16, v16, v17
v_exp_f32 v18, v18
v_mfma_f32_16x16x32_bf16 v[172:175], v[204:207], a[124:127], v[172:175]
ds_read_b64_tr_b16 v[196:197], v237 offset:16384
v_exp_f32 v19, v19
s_waitcnt lgkmcnt(7)
v_mfma_f32_16x16x32_bf16 a[160:163], v[176:179], v[0:3], 0
ds_read_b64_tr_b16 v[198:199], v237 offset:18432
v_fma_f32 v20, v20, s51, -v242
v_fma_f32 v21, v21, s51, -v242
v_mfma_f32_16x16x32_bf16 a[168:171], v[176:179], v[4:7], 0
ds_read_b128 v[8:11], v234 offset:16384
ds_read_b128 v[12:15], v234 offset:17408
v_add_f32 v244, v244, v18
v_mfma_f32_16x16x32_bf16 a[164:167], v[180:183], v[0:3], 0
ds_read_b64_tr_b16 v[200:201], v232 offset:0
ds_read_b64_tr_b16 v[202:203], v232 offset:2048
s_mul_i32 s52, s69, 6144
s_add_u32 s52, s52, 3072
s_add_u32 m0, s48, 90112
v_mfma_f32_16x16x32_bf16 a[172:175], v[180:183], v[4:7], 0
ds_read_b64_tr_b16 v[204:205], v233 offset:0
buffer_load_dwordx4 v226, s[32:35], s52 offen lds
s_waitcnt lgkmcnt(9)
v_mfma_f32_16x16x32_bf16 a[176:179], v[184:187], v[0:3], 0
ds_read_b64_tr_b16 v[206:207], v233 offset:2048
v_add_f32 v244, v244, v19
v_cvt_pk_bf16_f32 v17, v18, v19
v_mfma_f32_16x16x32_bf16 a[184:187], v[184:187], v[4:7], 0
ds_read_b64_tr_b16 v[176:177], v232 offset:8192
buffer_load_dwordx4 v227, s[32:35], s52 offen offset:1024 lds
v_mfma_f32_16x16x32_bf16 a[180:183], v[188:191], v[0:3], 0
ds_read_b64_tr_b16 v[178:179], v232 offset:10240
v_exp_f32 v20, v20
v_mfma_f32_16x16x32_bf16 a[188:191], v[188:191], v[4:7], 0
ds_read_b64_tr_b16 v[180:181], v233 offset:8192
s_add_u32 m0, s48, 98176
v_exp_f32 v21, v21
s_waitcnt lgkmcnt(9)
v_mfma_f32_16x16x32_bf16 a[192:195], v[192:195], v[0:3], 0
ds_read_b64_tr_b16 v[182:183], v233 offset:10240
buffer_load_dwordx4 v226, s[32:35], s52 offen offset:128 lds
v_mfma_f32_16x16x32_bf16 a[200:203], v[192:195], v[4:7], 0
ds_read_b64_tr_b16 v[184:185], v232 offset:16384
v_fma_f32 v22, v22, s51, -v242
v_fma_f32 v23, v23, s51, -v242
v_mfma_f32_16x16x32_bf16 a[196:199], v[196:199], v[0:3], 0
ds_read_b64_tr_b16 v[186:187], v232 offset:18432
v_add_f32 v244, v244, v20
v_add_f32 v244, v244, v21
v_mfma_f32_16x16x32_bf16 a[204:207], v[196:199], v[4:7], 0
ds_read_b64_tr_b16 v[188:189], v233 offset:16384
buffer_load_dwordx4 v227, s[32:35], s52 offen offset:1152 lds
s_waitcnt lgkmcnt(7)
v_mfma_f32_16x16x32_bf16 a[160:163], v[200:203], v[8:11], a[160:163]
ds_read_b64_tr_b16 v[190:191], v233 offset:18432
v_cvt_pk_bf16_f32 v18, v20, v21
v_exp_f32 v22, v22
v_mfma_f32_16x16x32_bf16 a[168:171], v[200:203], v[12:15], a[168:171]
s_add_u32 m0, s48, 106240
v_exp_f32 v23, v23
v_fma_f32 v24, v24, s51, -v243
v_mfma_f32_16x16x32_bf16 a[164:167], v[204:207], v[8:11], a[164:167]
buffer_load_dwordx4 v226, s[32:35], s52 offen offset:256 lds
v_fma_f32 v25, v25, s51, -v243
v_mfma_f32_16x16x32_bf16 a[172:175], v[204:207], v[12:15], a[172:175]
v_add_u32 v236, 139264, v230
v_xor_b32 v237, 32, v236
v_add_f32 v244, v244, v22
s_waitcnt lgkmcnt(4)
v_mfma_f32_16x16x32_bf16 a[176:179], v[176:179], v[8:11], a[176:179]
v_add_f32 v244, v244, v23
v_cvt_pk_bf16_f32 v19, v22, v23
v_exp_f32 v24, v24
v_mfma_f32_16x16x32_bf16 a[184:187], v[176:179], v[12:15], a[184:187]
buffer_load_dwordx4 v227, s[32:35], s52 offen offset:1280 lds
s_waitcnt vmcnt(12) lgkmcnt(0)
s_barrier
ds_read_b64_tr_b16 v[192:193], v236 offset:0
ds_read_b64_tr_b16 v[194:195], v237 offset:512
ds_read_b64_tr_b16 v[196:197], v237 offset:0
ds_read_b64_tr_b16 v[198:199], v236 offset:512
ds_read_b64_tr_b16 v[200:201], v236 offset:8192
ds_read_b64_tr_b16 v[202:203], v237 offset:8704
v_mfma_f32_16x16x32_bf16 a[180:183], v[180:183], v[8:11], a[180:183]
s_mov_b32 s52, 49152
s_add_u32 m0, s48, 114688
s_nop 0
buffer_load_dwordx4 v224, s[28:31], s52 offen nt lds
v_mfma_f32_16x16x32_bf16 a[188:191], v[180:183], v[12:15], a[188:191]
ds_read_b64_tr_b16 v[204:205], v237 offset:8192
v_exp_f32 v25, v25
v_fma_f32 v26, v26, s51, -v243
v_mfma_f32_16x16x32_bf16 a[192:195], v[184:187], v[8:11], a[192:195]
ds_read_b64_tr_b16 v[206:207], v236 offset:8704
buffer_load_dwordx4 v225, s[28:31], s52 offen offset:1024 nt lds
v_fma_f32 v27, v27, s51, -v243
v_mfma_f32_16x16x32_bf16 a[200:203], v[184:187], v[12:15], a[200:203]
ds_read_b64_tr_b16 v[176:177], v236 offset:16384
s_add_u32 m0, s48, 122752
v_add_f32 v245, v245, v24
v_add_f32 v245, v245, v25
v_mfma_f32_16x16x32_bf16 a[196:199], v[188:191], v[8:11], a[196:199]
ds_read_b64_tr_b16 v[178:179], v237 offset:16896
buffer_load_dwordx4 v224, s[28:31], s52 offen offset:128 nt lds
v_mfma_f32_16x16x32_bf16 a[204:207], v[188:191], v[12:15], a[204:207]
ds_read_b64_tr_b16 v[180:181], v237 offset:16384
v_cvt_pk_bf16_f32 v20, v24, v25
v_exp_f32 v26, v26
s_waitcnt lgkmcnt(7)
v_mfma_f32_16x16x32_bf16 v[128:131], v[192:195], a[128:131], v[128:131]
ds_read_b64_tr_b16 v[182:183], v236 offset:16896
buffer_load_dwordx4 v225, s[28:31], s52 offen offset:1152 nt lds
v_mfma_f32_16x16x32_bf16 v[136:139], v[192:195], a[132:135], v[136:139]
ds_read_b64_tr_b16 v[184:185], v236 offset:4096
s_add_u32 m0, s48, 130816
v_exp_f32 v27, v27
v_mfma_f32_16x16x32_bf16 v[132:135], v[196:199], a[128:131], v[132:135]
ds_read_b64_tr_b16 v[186:187], v237 offset:4608
buffer_load_dwordx4 v224, s[28:31], s52 offen offset:256 nt lds
v_fma_f32 v28, v28, s51, -v243
v_mfma_f32_16x16x32_bf16 v[140:143], v[196:199], a[132:135], v[140:143]
ds_read_b64_tr_b16 v[188:189], v237 offset:4096
v_fma_f32 v29, v29, s51, -v243
v_add_f32 v245, v245, v26
s_waitcnt lgkmcnt(7)
v_mfma_f32_16x16x32_bf16 v[144:147], v[200:203], a[128:131], v[144:147]
ds_read_b64_tr_b16 v[190:191], v236 offset:4608
v_add_f32 v245, v245, v27
v_cvt_pk_bf16_f32 v21, v26, v27
v_mfma_f32_16x16x32_bf16 v[152:155], v[200:203], a[132:135], v[152:155]
ds_read_b64_tr_b16 v[192:193], v236 offset:12288
buffer_load_dwordx4 v225, s[28:31], s52 offen offset:1280 nt lds
v_mfma_f32_16x16x32_bf16 v[148:151], v[204:207], a[128:131], v[148:151]
ds_read_b64_tr_b16 v[194:195], v237 offset:12800
v_exp_f32 v28, v28
v_mfma_f32_16x16x32_bf16 v[156:159], v[204:207], a[132:135], v[156:159]
ds_read_b64_tr_b16 v[196:197], v237 offset:12288
v_exp_f32 v29, v29
v_fma_f32 v30, v30, s51, -v243
s_waitcnt lgkmcnt(7)
v_mfma_f32_16x16x32_bf16 v[160:163], v[176:179], a[128:131], v[160:163]
ds_read_b64_tr_b16 v[198:199], v236 offset:12800
v_fma_f32 v31, v31, s51, -v243
v_add_f32 v245, v245, v28
v_add_f32 v245, v245, v29
v_mfma_f32_16x16x32_bf16 v[168:171], v[176:179], a[132:135], v[168:171]
ds_read_b64_tr_b16 v[200:201], v236 offset:20480
v_cvt_pk_bf16_f32 v22, v28, v29
v_exp_f32 v30, v30
v_mfma_f32_16x16x32_bf16 v[164:167], v[180:183], a[128:131], v[164:167]
ds_read_b64_tr_b16 v[202:203], v237 offset:20992
v_exp_f32 v31, v31
v_add_f32 v245, v245, v30
v_mfma_f32_16x16x32_bf16 v[172:175], v[180:183], a[132:135], v[172:175]
ds_read_b64_tr_b16 v[204:205], v237 offset:20480
v_add_f32 v245, v245, v31
v_cvt_pk_bf16_f32 v23, v30, v31
ds_write_b128 v239, v[16:19] offset:0
ds_write_b128 v239, v[20:23] offset:1024
s_waitcnt lgkmcnt(9)
v_mfma_f32_16x16x32_bf16 v[128:131], v[184:187], a[136:139], v[128:131]
ds_read_b64_tr_b16 v[206:207], v236 offset:20992
v_mfma_f32_16x16x32_bf16 v[136:139], v[184:187], a[140:143], v[136:139]
v_mfma_f32_16x16x32_bf16 v[132:135], v[188:191], a[136:139], v[132:135]
v_mfma_f32_16x16x32_bf16 v[140:143], v[188:191], a[140:143], v[140:143]
v_add_u32 v236, 65536, v250
v_xor_b32 v237, 32, v236
s_waitcnt lgkmcnt(6)
v_mfma_f32_16x16x32_bf16 v[144:147], v[192:195], a[136:139], v[144:147]
v_xor_b32 v232, 0x1000, v236
v_xor_b32 v233, 0x1000, v237
v_mfma_f32_16x16x32_bf16 v[152:155], v[192:195], a[140:143], v[152:155]
s_waitcnt vmcnt(12) lgkmcnt(0)
s_barrier
ds_read_b64_tr_b16 v[176:177], v236 offset:0
ds_read_b64_tr_b16 v[178:179], v236 offset:2048
ds_read_b64_tr_b16 v[180:181], v237 offset:0
ds_read_b64_tr_b16 v[182:183], v237 offset:2048
ds_read_b64_tr_b16 v[184:185], v236 offset:8192
ds_read_b64_tr_b16 v[186:187], v236 offset:10240
v_mfma_f32_16x16x32_bf16 v[148:151], v[196:199], a[136:139], v[148:151]
v_fma_f32 v32, v32, s51, -v242
v_fma_f32 v33, v33, s51, -v242
v_exp_f32 v32, v32
v_mfma_f32_16x16x32_bf16 v[156:159], v[196:199], a[140:143], v[156:159]
ds_read_b64_tr_b16 v[188:189], v237 offset:8192
v_exp_f32 v33, v33
v_mfma_f32_16x16x32_bf16 v[160:163], v[200:203], a[136:139], v[160:163]
ds_read_b64_tr_b16 v[190:191], v237 offset:10240
v_fma_f32 v34, v34, s51, -v242
v_fma_f32 v35, v35, s51, -v242
v_mfma_f32_16x16x32_bf16 v[168:171], v[200:203], a[140:143], v[168:171]
ds_read_b64_tr_b16 v[192:193], v236 offset:16384
v_add_f32 v244, v244, v32
v_add_f32 v244, v244, v33
v_mfma_f32_16x16x32_bf16 v[164:167], v[204:207], a[136:139], v[164:167]
ds_read_b64_tr_b16 v[194:195], v236 offset:18432
v_cvt_pk_bf16_f32 v32, v32, v33
v_exp_f32 v34, v34
v_mfma_f32_16x16x32_bf16 v[172:175], v[204:207], a[140:143], v[172:175]
ds_read_b64_tr_b16 v[196:197], v237 offset:16384
v_exp_f32 v35, v35
s_waitcnt lgkmcnt(7)
v_mfma_f32_16x16x32_bf16 a[160:163], v[176:179], v[16:19], a[160:163]
ds_read_b64_tr_b16 v[198:199], v237 offset:18432
v_fma_f32 v36, v36, s51, -v242
v_fma_f32 v37, v37, s51, -v242
v_mfma_f32_16x16x32_bf16 a[168:171], v[176:179], v[20:23], a[168:171]
ds_read_b128 v[24:27], v234 offset:0
ds_read_b128 v[28:31], v234 offset:1024
v_add_f32 v244, v244, v34
v_mfma_f32_16x16x32_bf16 a[164:167], v[180:183], v[16:19], a[164:167]
ds_read_b64_tr_b16 v[200:201], v232 offset:0
ds_read_b64_tr_b16 v[202:203], v232 offset:2048
s_mul_i32 s52, s60, 6144
s_add_u32 s52, s52, 6144
s_add_u32 m0, s48, 139264
v_mfma_f32_16x16x32_bf16 a[172:175], v[180:183], v[20:23], a[172:175]
ds_read_b64_tr_b16 v[204:205], v233 offset:0
buffer_load_dwordx4 v226, s[32:35], s52 offen lds
s_waitcnt lgkmcnt(9)
v_mfma_f32_16x16x32_bf16 a[176:179], v[184:187], v[16:19], a[176:179]
ds_read_b64_tr_b16 v[206:207], v233 offset:2048
v_add_f32 v244, v244, v35
v_cvt_pk_bf16_f32 v33, v34, v35
v_mfma_f32_16x16x32_bf16 a[184:187], v[184:187], v[20:23], a[184:187]
ds_read_b64_tr_b16 v[176:177], v232 offset:8192
buffer_load_dwordx4 v227, s[32:35], s52 offen offset:1024 lds
v_mfma_f32_16x16x32_bf16 a[180:183], v[188:191], v[16:19], a[180:183]
ds_read_b64_tr_b16 v[178:179], v232 offset:10240
v_exp_f32 v36, v36
v_mfma_f32_16x16x32_bf16 a[188:191], v[188:191], v[20:23], a[188:191]
ds_read_b64_tr_b16 v[180:181], v233 offset:8192
s_add_u32 m0, s48, 147328
v_exp_f32 v37, v37
s_waitcnt lgkmcnt(9)
v_mfma_f32_16x16x32_bf16 a[192:195], v[192:195], v[16:19], a[192:195]
ds_read_b64_tr_b16 v[182:183], v233 offset:10240
buffer_load_dwordx4 v226, s[32:35], s52 offen offset:128 lds
v_mfma_f32_16x16x32_bf16 a[200:203], v[192:195], v[20:23], a[200:203]
ds_read_b64_tr_b16 v[184:185], v232 offset:16384
v_fma_f32 v38, v38, s51, -v242
v_fma_f32 v39, v39, s51, -v242
v_mfma_f32_16x16x32_bf16 a[196:199], v[196:199], v[16:19], a[196:199]
ds_read_b64_tr_b16 v[186:187], v232 offset:18432
v_add_f32 v244, v244, v36
v_add_f32 v244, v244, v37
v_mfma_f32_16x16x32_bf16 a[204:207], v[196:199], v[20:23], a[204:207]
ds_read_b64_tr_b16 v[188:189], v233 offset:16384
buffer_load_dwordx4 v227, s[32:35], s52 offen offset:1152 lds
s_waitcnt lgkmcnt(7)
v_mfma_f32_16x16x32_bf16 a[160:163], v[200:203], v[24:27], a[160:163]
ds_read_b64_tr_b16 v[190:191], v233 offset:18432
v_cvt_pk_bf16_f32 v34, v36, v37
v_exp_f32 v38, v38
v_mfma_f32_16x16x32_bf16 a[168:171], v[200:203], v[28:31], a[168:171]
s_add_u32 m0, s48, 155392
v_exp_f32 v39, v39
v_fma_f32 v40, v40, s51, -v243
v_mfma_f32_16x16x32_bf16 a[164:167], v[204:207], v[24:27], a[164:167]
buffer_load_dwordx4 v226, s[32:35], s52 offen offset:256 lds
v_fma_f32 v41, v41, s51, -v243
v_mfma_f32_16x16x32_bf16 a[172:175], v[204:207], v[28:31], a[172:175]
v_add_u32 v236, 90112, v230
v_xor_b32 v237, 32, v236
v_add_f32 v244, v244, v38
s_waitcnt lgkmcnt(4)
v_mfma_f32_16x16x32_bf16 a[176:179], v[176:179], v[24:27], a[176:179]
v_add_f32 v244, v244, v39
v_cvt_pk_bf16_f32 v35, v38, v39
v_exp_f32 v40, v40
v_mfma_f32_16x16x32_bf16 a[184:187], v[176:179], v[28:31], a[184:187]
buffer_load_dwordx4 v227, s[32:35], s52 offen offset:1280 lds
s_waitcnt vmcnt(12) lgkmcnt(0)
s_barrier
s_cmp_eq_u32 s58, 0
s_cbranch_scc0 L_rdy_skip
s_mov_b64 exec, 1
v_mov_b32 v253, 1
buffer_atomic_add v253, v252, s[12:15], 0 offen sc1
s_mov_b64 exec, -1
L_rdy_skip:
ds_read_b64_tr_b16 v[192:193], v236 offset:0
ds_read_b64_tr_b16 v[194:195], v237 offset:512
ds_read_b64_tr_b16 v[196:197], v237 offset:0
ds_read_b64_tr_b16 v[198:199], v236 offset:512
ds_read_b64_tr_b16 v[200:201], v236 offset:8192
ds_read_b64_tr_b16 v[202:203], v237 offset:8704
v_mfma_f32_16x16x32_bf16 a[180:183], v[180:183], v[24:27], a[180:183]
s_mov_b32 s52, 73728
s_add_u32 m0, s48, 65536
s_nop 0
buffer_load_dwordx4 v224, s[28:31], s52 offen nt lds
v_mfma_f32_16x16x32_bf16 a[188:191], v[180:183], v[28:31], a[188:191]
ds_read_b64_tr_b16 v[204:205], v237 offset:8192
v_exp_f32 v41, v41
v_fma_f32 v42, v42, s51, -v243
v_mfma_f32_16x16x32_bf16 a[192:195], v[184:187], v[24:27], a[192:195]
ds_read_b64_tr_b16 v[206:207], v236 offset:8704
buffer_load_dwordx4 v225, s[28:31], s52 offen offset:1024 nt lds
v_fma_f32 v43, v43, s51, -v243
v_mfma_f32_16x16x32_bf16 a[200:203], v[184:187], v[28:31], a[200:203]
ds_read_b64_tr_b16 v[176:177], v236 offset:16384
s_add_u32 m0, s48, 73600
v_add_f32 v245, v245, v40
v_add_f32 v245, v245, v41
v_mfma_f32_16x16x32_bf16 a[196:199], v[188:191], v[24:27], a[196:199]
ds_read_b64_tr_b16 v[178:179], v237 offset:16896
buffer_load_dwordx4 v224, s[28:31], s52 offen offset:128 nt lds
v_mfma_f32_16x16x32_bf16 a[204:207], v[188:191], v[28:31], a[204:207]
ds_read_b64_tr_b16 v[180:181], v237 offset:16384
v_cvt_pk_bf16_f32 v36, v40, v41
v_exp_f32 v42, v42
s_waitcnt lgkmcnt(7)
v_mfma_f32_16x16x32_bf16 v[128:131], v[192:195], a[144:147], v[128:131]
ds_read_b64_tr_b16 v[182:183], v236 offset:16896
buffer_load_dwordx4 v225, s[28:31], s52 offen offset:1152 nt lds
v_mfma_f32_16x16x32_bf16 v[136:139], v[192:195], a[148:151], v[136:139]
ds_read_b64_tr_b16 v[184:185], v236 offset:4096
s_add_u32 m0, s48, 81664
v_exp_f32 v43, v43
v_mfma_f32_16x16x32_bf16 v[132:135], v[196:199], a[144:147], v[132:135]
ds_read_b64_tr_b16 v[186:187], v237 offset:4608
buffer_load_dwordx4 v224, s[28:31], s52 offen offset:256 nt lds
v_fma_f32 v44, v44, s51, -v243
v_mfma_f32_16x16x32_bf16 v[140:143], v[196:199], a[148:151], v[140:143]
ds_read_b64_tr_b16 v[188:189], v237 offset:4096
v_fma_f32 v45, v45, s51, -v243
v_add_f32 v245, v245, v42
s_waitcnt lgkmcnt(7)
v_mfma_f32_16x16x32_bf16 v[144:147], v[200:203], a[144:147], v[144:147]
ds_read_b64_tr_b16 v[190:191], v236 offset:4608
v_add_f32 v245, v245, v43
v_cvt_pk_bf16_f32 v37, v42, v43
v_mfma_f32_16x16x32_bf16 v[152:155], v[200:203], a[148:151], v[152:155]
ds_read_b64_tr_b16 v[192:193], v236 offset:12288
buffer_load_dwordx4 v225, s[28:31], s52 offen offset:1280 nt lds
v_mfma_f32_16x16x32_bf16 v[148:151], v[204:207], a[144:147], v[148:151]
ds_read_b64_tr_b16 v[194:195], v237 offset:12800
v_exp_f32 v44, v44
v_mfma_f32_16x16x32_bf16 v[156:159], v[204:207], a[148:151], v[156:159]
ds_read_b64_tr_b16 v[196:197], v237 offset:12288
v_exp_f32 v45, v45
v_fma_f32 v46, v46, s51, -v243
s_waitcnt lgkmcnt(7)
v_mfma_f32_16x16x32_bf16 v[160:163], v[176:179], a[144:147], v[160:163]
ds_read_b64_tr_b16 v[198:199], v236 offset:12800
v_fma_f32 v47, v47, s51, -v243
v_add_f32 v245, v245, v44
v_add_f32 v245, v245, v45
v_mfma_f32_16x16x32_bf16 v[168:171], v[176:179], a[148:151], v[168:171]
ds_read_b64_tr_b16 v[200:201], v236 offset:20480
v_cvt_pk_bf16_f32 v38, v44, v45
v_exp_f32 v46, v46
v_mfma_f32_16x16x32_bf16 v[164:167], v[180:183], a[144:147], v[164:167]
ds_read_b64_tr_b16 v[202:203], v237 offset:20992
v_exp_f32 v47, v47
v_add_f32 v245, v245, v46
v_mfma_f32_16x16x32_bf16 v[172:175], v[180:183], a[148:151], v[172:175]
ds_read_b64_tr_b16 v[204:205], v237 offset:20480
v_add_f32 v245, v245, v47
v_cvt_pk_bf16_f32 v39, v46, v47
ds_write_b128 v239, v[32:35] offset:16384
ds_write_b128 v239, v[36:39] offset:17408
s_waitcnt lgkmcnt(9)
v_mfma_f32_16x16x32_bf16 v[128:131], v[184:187], a[152:155], v[128:131]
ds_read_b64_tr_b16 v[206:207], v236 offset:20992
v_mfma_f32_16x16x32_bf16 v[136:139], v[184:187], a[156:159], v[136:139]
v_mfma_f32_16x16x32_bf16 v[132:135], v[188:191], a[152:155], v[132:135]
v_mfma_f32_16x16x32_bf16 v[140:143], v[188:191], a[156:159], v[140:143]
v_add_u32 v236, 114688, v250
v_xor_b32 v237, 32, v236
s_waitcnt lgkmcnt(6)
v_mfma_f32_16x16x32_bf16 v[144:147], v[192:195], a[152:155], v[144:147]
v_xor_b32 v232, 0x1000, v236
v_xor_b32 v233, 0x1000, v237
v_mfma_f32_16x16x32_bf16 v[152:155], v[192:195], a[156:159], v[152:155]
s_waitcnt vmcnt(12) lgkmcnt(0)
s_barrier
ds_read_b64_tr_b16 v[176:177], v236 offset:0
ds_read_b64_tr_b16 v[178:179], v236 offset:2048
ds_read_b64_tr_b16 v[180:181], v237 offset:0
ds_read_b64_tr_b16 v[182:183], v237 offset:2048
ds_read_b64_tr_b16 v[184:185], v236 offset:8192
ds_read_b64_tr_b16 v[186:187], v236 offset:10240
v_mfma_f32_16x16x32_bf16 v[148:151], v[196:199], a[152:155], v[148:151]
v_fma_f32 v48, v48, s51, -v242
v_fma_f32 v49, v49, s51, -v242
v_exp_f32 v48, v48
v_mfma_f32_16x16x32_bf16 v[156:159], v[196:199], a[156:159], v[156:159]
ds_read_b64_tr_b16 v[188:189], v237 offset:8192
v_exp_f32 v49, v49
v_fma_f32 v50, v50, s51, -v242
v_mfma_f32_16x16x32_bf16 v[160:163], v[200:203], a[152:155], v[160:163]
ds_read_b64_tr_b16 v[190:191], v237 offset:10240
v_fma_f32 v51, v51, s51, -v242
v_add_f32 v244, v244, v48
v_add_f32 v244, v244, v49
v_mfma_f32_16x16x32_bf16 v[168:171], v[200:203], a[156:159], v[168:171]
ds_read_b64_tr_b16 v[192:193], v236 offset:16384
v_cvt_pk_bf16_f32 v48, v48, v49
v_exp_f32 v50, v50
v_mfma_f32_16x16x32_bf16 v[164:167], v[204:207], a[152:155], v[164:167]
ds_read_b64_tr_b16 v[194:195], v236 offset:18432
v_exp_f32 v51, v51
v_fma_f32 v52, v52, s51, -v242
v_mfma_f32_16x16x32_bf16 v[172:175], v[204:207], a[156:159], v[172:175]
ds_read_b64_tr_b16 v[196:197], v237 offset:16384
v_fma_f32 v53, v53, s51, -v242
v_add_f32 v244, v244, v50
v_add_f32 v244, v244, v51
s_waitcnt lgkmcnt(7)
v_mfma_f32_16x16x32_bf16 a[160:163], v[176:179], v[32:35], a[160:163]
ds_read_b64_tr_b16 v[198:199], v237 offset:18432
v_cvt_pk_bf16_f32 v49, v50, v51
v_exp_f32 v52, v52
v_mfma_f32_16x16x32_bf16 a[168:171], v[176:179], v[36:39], a[168:171]
ds_read_b128 v[40:43], v234 offset:16384
ds_read_b128 v[44:47], v234 offset:17408
v_mfma_f32_16x16x32_bf16 a[164:167], v[180:183], v[32:35], a[164:167]
ds_read_b64_tr_b16 v[200:201], v232 offset:0
ds_read_b64_tr_b16 v[202:203], v232 offset:2048
s_mul_i32 s52, s61, 6144
s_add_u32 s52, s52, 6144
s_add_u32 m0, s48, 90112
v_cvt_pk_bf16_f32 v128, v128, v129
v_mfma_f32_16x16x32_bf16 a[172:175], v[180:183], v[36:39], a[172:175]
ds_read_b64_tr_b16 v[204:205], v233 offset:0
buffer_load_dwordx4 v226, s[32:35], s52 offen lds
v_cvt_pk_bf16_f32 v129, v130, v131
v_cvt_pk_bf16_f32 v130, v132, v133
s_waitcnt lgkmcnt(9)
v_mfma_f32_16x16x32_bf16 a[176:179], v[184:187], v[32:35], a[176:179]
ds_read_b64_tr_b16 v[206:207], v233 offset:2048
v_cvt_pk_bf16_f32 v131, v134, v135
v_cvt_pk_bf16_f32 v136, v136, v137
v_cvt_pk_bf16_f32 v137, v138, v139
v_mfma_f32_16x16x32_bf16 a[184:187], v[184:187], v[36:39], a[184:187]
ds_read_b64_tr_b16 v[176:177], v232 offset:8192
buffer_load_dwordx4 v227, s[32:35], s52 offen offset:1024 lds
v_cvt_pk_bf16_f32 v138, v140, v141
v_cvt_pk_bf16_f32 v139, v142, v143
v_mfma_f32_16x16x32_bf16 a[180:183], v[188:191], v[32:35], a[180:183]
ds_read_b64_tr_b16 v[178:179], v232 offset:10240
v_cvt_pk_bf16_f32 v144, v144, v145
v_cvt_pk_bf16_f32 v145, v146, v147
v_cvt_pk_bf16_f32 v146, v148, v149
v_mfma_f32_16x16x32_bf16 a[188:191], v[188:191], v[36:39], a[188:191]
ds_read_b64_tr_b16 v[180:181], v233 offset:8192
s_add_u32 m0, s48, 98176
v_cvt_pk_bf16_f32 v147, v150, v151
v_cvt_pk_bf16_f32 v152, v152, v153
v_cvt_pk_bf16_f32 v153, v154, v155
s_waitcnt lgkmcnt(9)
v_mfma_f32_16x16x32_bf16 a[192:195], v[192:195], v[32:35], a[192:195]
ds_read_b64_tr_b16 v[182:183], v233 offset:10240
buffer_load_dwordx4 v226, s[32:35], s52 offen offset:128 lds
v_cvt_pk_bf16_f32 v154, v156, v157
v_cvt_pk_bf16_f32 v155, v158, v159
v_mfma_f32_16x16x32_bf16 a[200:203], v[192:195], v[36:39], a[200:203]
ds_read_b64_tr_b16 v[184:185], v232 offset:16384
v_cvt_pk_bf16_f32 v160, v160, v161
v_cvt_pk_bf16_f32 v161, v162, v163
v_cvt_pk_bf16_f32 v162, v164, v165
v_mfma_f32_16x16x32_bf16 a[196:199], v[196:199], v[32:35], a[196:199]
ds_read_b64_tr_b16 v[186:187], v232 offset:18432
v_cvt_pk_bf16_f32 v163, v166, v167
v_cvt_pk_bf16_f32 v168, v168, v169
v_cvt_pk_bf16_f32 v169, v170, v171
v_cvt_pk_bf16_f32 v170, v172, v173
v_mfma_f32_16x16x32_bf16 a[204:207], v[196:199], v[36:39], a[204:207]
ds_read_b64_tr_b16 v[188:189], v233 offset:16384
buffer_load_dwordx4 v227, s[32:35], s52 offen offset:1152 lds
v_cvt_pk_bf16_f32 v171, v174, v175
ds_write_b64 v251, v[128:129] offset:32768
ds_write_b64 v251, v[130:131] offset:33280
ds_write_b64 v251, v[136:137] offset:33792
ds_write_b64 v251, v[138:139] offset:34304
ds_write_b64 v251, v[144:145] offset:40960
ds_write_b64 v251, v[146:147] offset:41472
ds_write_b64 v251, v[152:153] offset:41984
ds_write_b64 v251, v[154:155] offset:42496
ds_write_b64 v251, v[160:161] offset:49152
ds_write_b64 v251, v[162:163] offset:49664
ds_write_b64 v251, v[168:169] offset:50176
ds_write_b64 v251, v[170:171] offset:50688
s_waitcnt lgkmcnt(15)
v_mfma_f32_16x16x32_bf16 a[160:163], v[200:203], v[40:43], a[160:163]
ds_read_b64_tr_b16 v[190:191], v233 offset:18432
v_mfma_f32_16x16x32_bf16 a[168:171], v[200:203], v[44:47], a[168:171]
s_add_u32 m0, s48, 106240
v_mfma_f32_16x16x32_bf16 a[164:167], v[204:207], v[40:43], a[164:167]
buffer_load_dwordx4 v226, s[32:35], s52 offen offset:256 lds
v_mfma_f32_16x16x32_bf16 a[172:175], v[204:207], v[44:47], a[172:175]
v_add_u32 v236, 139264, v230
v_xor_b32 v237, 32, v236
v_mfma_f32_16x16x32_bf16 a[176:179], v[176:179], v[40:43], a[176:179]
v_mfma_f32_16x16x32_bf16 a[184:187], v[176:179], v[44:47], a[184:187]
buffer_load_dwordx4 v227, s[32:35], s52 offen offset:1280 lds
s_waitcnt vmcnt(12) lgkmcnt(0)
s_barrier
ds_read_b64_tr_b16 v[192:193], v236 offset:0
ds_read_b64_tr_b16 v[194:195], v237 offset:512
ds_read_b64_tr_b16 v[196:197], v237 offset:0
ds_read_b64_tr_b16 v[198:199], v236 offset:512
ds_read_b64_tr_b16 v[200:201], v236 offset:8192
ds_read_b64_tr_b16 v[202:203], v237 offset:8704
v_mfma_f32_16x16x32_bf16 a[180:183], v[180:183], v[40:43], a[180:183]
s_mov_b32 s52, 98304
s_add_u32 m0, s48, 114688
s_nop 0
buffer_load_dwordx4 v224, s[28:31], s52 offen nt lds
v_exp_f32 v53, v53
v_mfma_f32_16x16x32_bf16 a[188:191], v[180:183], v[44:47], a[188:191]
ds_read_b64_tr_b16 v[204:205], v237 offset:8192
v_fma_f32 v54, v54, s51, -v242
v_fma_f32 v55, v55, s51, -v242
v_add_f32 v244, v244, v52
v_mfma_f32_16x16x32_bf16 a[192:195], v[184:187], v[40:43], a[192:195]
ds_read_b64_tr_b16 v[206:207], v236 offset:8704
buffer_load_dwordx4 v225, s[28:31], s52 offen offset:1024 nt lds
v_add_f32 v244, v244, v53
v_cvt_pk_bf16_f32 v50, v52, v53
v_mfma_f32_16x16x32_bf16 a[200:203], v[184:187], v[44:47], a[200:203]
ds_read_b64_tr_b16 v[176:177], v236 offset:16384
s_add_u32 m0, s48, 122752
v_exp_f32 v54, v54
v_mfma_f32_16x16x32_bf16 a[196:199], v[188:191], v[40:43], a[196:199]
ds_read_b64_tr_b16 v[178:179], v237 offset:16896
buffer_load_dwordx4 v224, s[28:31], s52 offen offset:128 nt lds
v_exp_f32 v55, v55
v_mfma_f32_16x16x32_bf16 a[204:207], v[188:191], v[44:47], a[204:207]
ds_read_b64_tr_b16 v[180:181], v237 offset:16384
v_fma_f32 v56, v56, s51, -v243
v_fma_f32 v57, v57, s51, -v243
v_add_f32 v244, v244, v54
v_add_f32 v244, v244, v55
s_waitcnt lgkmcnt(7)
v_mfma_f32_16x16x32_bf16 v[128:131], v[192:195], a[0:3], 0
ds_read_b64_tr_b16 v[182:183], v236 offset:16896
buffer_load_dwordx4 v225, s[28:31], s52 offen offset:1152 nt lds
v_cvt_pk_bf16_f32 v51, v54, v55
v_mfma_f32_16x16x32_bf16 v[136:139], v[192:195], a[4:7], 0
ds_read_b64_tr_b16 v[184:185], v236 offset:4096
s_add_u32 m0, s48, 130816
v_exp_f32 v56, v56
v_exp_f32 v57, v57
v_mfma_f32_16x16x32_bf16 v[132:135], v[196:199], a[0:3], 0
ds_read_b64_tr_b16 v[186:187], v237 offset:4608
buffer_load_dwordx4 v224, s[28:31], s52 offen offset:256 nt lds
v_fma_f32 v58, v58, s51, -v243
v_mfma_f32_16x16x32_bf16 v[140:143], v[196:199], a[4:7], 0
ds_read_b64_tr_b16 v[188:189], v237 offset:4096
v_fma_f32 v59, v59, s51, -v243
v_add_f32 v245, v245, v56
v_add_f32 v245, v245, v57
s_waitcnt lgkmcnt(7)
v_mfma_f32_16x16x32_bf16 v[144:147], v[200:203], a[0:3], 0
ds_read_b64_tr_b16 v[190:191], v236 offset:4608
v_cvt_pk_bf16_f32 v52, v56, v57
v_exp_f32 v58, v58
v_mfma_f32_16x16x32_bf16 v[152:155], v[200:203], a[4:7], 0
ds_read_b64_tr_b16 v[192:193], v236 offset:12288
buffer_load_dwordx4 v225, s[28:31], s52 offen offset:1280 nt lds
v_exp_f32 v59, v59
v_mfma_f32_16x16x32_bf16 v[148:151], v[204:207], a[0:3], 0
ds_read_b64_tr_b16 v[194:195], v237 offset:12800
v_fma_f32 v60, v60, s51, -v243
v_fma_f32 v61, v61, s51, -v243
v_add_f32 v245, v245, v58
v_add_f32 v245, v245, v59
v_mfma_f32_16x16x32_bf16 v[156:159], v[204:207], a[4:7], 0
ds_read_b64_tr_b16 v[196:197], v237 offset:12288
v_cvt_pk_bf16_f32 v53, v58, v59
v_exp_f32 v60, v60
s_waitcnt lgkmcnt(7)
v_mfma_f32_16x16x32_bf16 v[160:163], v[176:179], a[0:3], 0
ds_read_b64_tr_b16 v[198:199], v236 offset:12800
v_exp_f32 v61, v61
v_fma_f32 v62, v62, s51, -v243
v_fma_f32 v63, v63, s51, -v243
v_mfma_f32_16x16x32_bf16 v[168:171], v[176:179], a[4:7], 0
ds_read_b64_tr_b16 v[200:201], v236 offset:20480
v_add_f32 v245, v245, v60
v_add_f32 v245, v245, v61
v_cvt_pk_bf16_f32 v54, v60, v61
v_mfma_f32_16x16x32_bf16 v[164:167], v[180:183], a[0:3], 0
ds_read_b64_tr_b16 v[202:203], v237 offset:20992
v_exp_f32 v62, v62
v_exp_f32 v63, v63
v_mfma_f32_16x16x32_bf16 v[172:175], v[180:183], a[4:7], 0
ds_read_b64_tr_b16 v[204:205], v237 offset:20480
v_add_f32 v245, v245, v62
v_add_f32 v245, v245, v63
v_cvt_pk_bf16_f32 v55, v62, v63
ds_write_b128 v239, v[48:51] offset:0
ds_write_b128 v239, v[52:55] offset:1024
s_waitcnt lgkmcnt(9)
v_mfma_f32_16x16x32_bf16 v[128:131], v[184:187], a[8:11], v[128:131]
ds_read_b64_tr_b16 v[206:207], v236 offset:20992
v_mfma_f32_16x16x32_bf16 v[136:139], v[184:187], a[12:15], v[136:139]
v_mfma_f32_16x16x32_bf16 v[132:135], v[188:191], a[8:11], v[132:135]
v_mfma_f32_16x16x32_bf16 v[140:143], v[188:191], a[12:15], v[140:143]
v_add_u32 v236, 65536, v250
v_xor_b32 v237, 32, v236
s_waitcnt lgkmcnt(6)
v_mfma_f32_16x16x32_bf16 v[144:147], v[192:195], a[8:11], v[144:147]
v_xor_b32 v232, 0x1000, v236
v_xor_b32 v233, 0x1000, v237
v_mfma_f32_16x16x32_bf16 v[152:155], v[192:195], a[12:15], v[152:155]
s_waitcnt vmcnt(12) lgkmcnt(0)
s_barrier
ds_read_b64_tr_b16 v[176:177], v236 offset:0
ds_read_b64_tr_b16 v[178:179], v236 offset:2048
ds_read_b64_tr_b16 v[180:181], v237 offset:0
ds_read_b64_tr_b16 v[182:183], v237 offset:2048
ds_read_b64_tr_b16 v[184:185], v236 offset:8192
ds_read_b64_tr_b16 v[186:187], v236 offset:10240
v_mfma_f32_16x16x32_bf16 v[148:151], v[196:199], a[8:11], v[148:151]
v_fma_f32 v64, v64, s51, -v242
v_fma_f32 v65, v65, s51, -v242
v_exp_f32 v64, v64
v_mfma_f32_16x16x32_bf16 v[156:159], v[196:199], a[12:15], v[156:159]
ds_read_b64_tr_b16 v[188:189], v237 offset:8192
v_exp_f32 v65, v65
v_mfma_f32_16x16x32_bf16 v[160:163], v[200:203], a[8:11], v[160:163]
ds_read_b64_tr_b16 v[190:191], v237 offset:10240
v_fma_f32 v66, v66, s51, -v242
v_fma_f32 v67, v67, s51, -v242
v_mfma_f32_16x16x32_bf16 v[168:171], v[200:203], a[12:15], v[168:171]
ds_read_b64_tr_b16 v[192:193], v236 offset:16384
v_add_f32 v244, v244, v64
v_add_f32 v244, v244, v65
v_mfma_f32_16x16x32_bf16 v[164:167], v[204:207], a[8:11], v[164:167]
ds_read_b64_tr_b16 v[194:195], v236 offset:18432
v_cvt_pk_bf16_f32 v64, v64, v65
v_exp_f32 v66, v66
v_mfma_f32_16x16x32_bf16 v[172:175], v[204:207], a[12:15], v[172:175]
ds_read_b64_tr_b16 v[196:197], v237 offset:16384
v_exp_f32 v67, v67
s_waitcnt lgkmcnt(7)
v_mfma_f32_16x16x32_bf16 a[160:163], v[176:179], v[48:51], a[160:163]
ds_read_b64_tr_b16 v[198:199], v237 offset:18432
v_fma_f32 v68, v68, s51, -v242
v_fma_f32 v69, v69, s51, -v242
v_mfma_f32_16x16x32_bf16 a[168:171], v[176:179], v[52:55], a[168:171]
ds_read_b128 v[56:59], v234 offset:0
ds_read_b128 v[60:63], v234 offset:1024
v_add_f32 v244, v244, v66
v_mfma_f32_16x16x32_bf16 a[164:167], v[180:183], v[48:51], a[164:167]
ds_read_b64_tr_b16 v[200:201], v232 offset:0
ds_read_b64_tr_b16 v[202:203], v232 offset:2048
s_mul_i32 s52, s62, 6144
s_add_u32 s52, s52, 6144
s_add_u32 m0, s48, 139264
v_mfma_f32_16x16x32_bf16 a[172:175], v[180:183], v[52:55], a[172:175]
ds_read_b64_tr_b16 v[204:205], v233 offset:0
buffer_load_dwordx4 v226, s[32:35], s52 offen lds
s_waitcnt lgkmcnt(9)
v_mfma_f32_16x16x32_bf16 a[176:179], v[184:187], v[48:51], a[176:179]
ds_read_b64_tr_b16 v[206:207], v233 offset:2048
v_add_f32 v244, v244, v67
v_cvt_pk_bf16_f32 v65, v66, v67
v_mfma_f32_16x16x32_bf16 a[184:187], v[184:187], v[52:55], a[184:187]
ds_read_b64_tr_b16 v[176:177], v232 offset:8192
buffer_load_dwordx4 v227, s[32:35], s52 offen offset:1024 lds
v_mfma_f32_16x16x32_bf16 a[180:183], v[188:191], v[48:51], a[180:183]
ds_read_b64_tr_b16 v[178:179], v232 offset:10240
v_exp_f32 v68, v68
v_mfma_f32_16x16x32_bf16 a[188:191], v[188:191], v[52:55], a[188:191]
ds_read_b64_tr_b16 v[180:181], v233 offset:8192
s_add_u32 m0, s48, 147328
v_exp_f32 v69, v69
s_waitcnt lgkmcnt(9)
v_mfma_f32_16x16x32_bf16 a[192:195], v[192:195], v[48:51], a[192:195]
ds_read_b64_tr_b16 v[182:183], v233 offset:10240
buffer_load_dwordx4 v226, s[32:35], s52 offen offset:128 lds
v_mfma_f32_16x16x32_bf16 a[200:203], v[192:195], v[52:55], a[200:203]
ds_read_b64_tr_b16 v[184:185], v232 offset:16384
v_fma_f32 v70, v70, s51, -v242
v_fma_f32 v71, v71, s51, -v242
v_mfma_f32_16x16x32_bf16 a[196:199], v[196:199], v[48:51], a[196:199]
ds_read_b64_tr_b16 v[186:187], v232 offset:18432
v_add_f32 v244, v244, v68
v_add_f32 v244, v244, v69
v_mfma_f32_16x16x32_bf16 a[204:207], v[196:199], v[52:55], a[204:207]
ds_read_b64_tr_b16 v[188:189], v233 offset:16384
buffer_load_dwordx4 v227, s[32:35], s52 offen offset:1152 lds
s_waitcnt lgkmcnt(7)
v_mfma_f32_16x16x32_bf16 a[160:163], v[200:203], v[56:59], a[160:163]
ds_read_b64_tr_b16 v[190:191], v233 offset:18432
v_cvt_pk_bf16_f32 v66, v68, v69
v_exp_f32 v70, v70
v_mfma_f32_16x16x32_bf16 a[168:171], v[200:203], v[60:63], a[168:171]
s_add_u32 m0, s48, 155392
v_exp_f32 v71, v71
v_fma_f32 v72, v72, s51, -v243
v_mfma_f32_16x16x32_bf16 a[164:167], v[204:207], v[56:59], a[164:167]
buffer_load_dwordx4 v226, s[32:35], s52 offen offset:256 lds
v_fma_f32 v73, v73, s51, -v243
v_mfma_f32_16x16x32_bf16 a[172:175], v[204:207], v[60:63], a[172:175]
v_add_u32 v236, 90112, v230
v_xor_b32 v237, 32, v236
v_add_f32 v244, v244, v70
s_waitcnt lgkmcnt(4)
v_mfma_f32_16x16x32_bf16 a[176:179], v[176:179], v[56:59], a[176:179]
v_add_f32 v244, v244, v71
v_cvt_pk_bf16_f32 v67, v70, v71
v_exp_f32 v72, v72
v_mfma_f32_16x16x32_bf16 a[184:187], v[176:179], v[60:63], a[184:187]
buffer_load_dwordx4 v227, s[32:35], s52 offen offset:1280 lds
s_waitcnt vmcnt(12) lgkmcnt(0)
s_barrier
ds_read_b64_tr_b16 v[192:193], v236 offset:0
ds_read_b64_tr_b16 v[194:195], v237 offset:512
ds_read_b64_tr_b16 v[196:197], v237 offset:0
ds_read_b64_tr_b16 v[198:199], v236 offset:512
ds_read_b64_tr_b16 v[200:201], v236 offset:8192
ds_read_b64_tr_b16 v[202:203], v237 offset:8704
v_mfma_f32_16x16x32_bf16 a[180:183], v[180:183], v[56:59], a[180:183]
s_mov_b32 s52, 122880
s_add_u32 m0, s48, 65536
s_nop 0
buffer_load_dwordx4 v224, s[28:31], s52 offen nt lds
v_mfma_f32_16x16x32_bf16 a[188:191], v[180:183], v[60:63], a[188:191]
ds_read_b64_tr_b16 v[204:205], v237 offset:8192
v_exp_f32 v73, v73
v_fma_f32 v74, v74, s51, -v243
v_mfma_f32_16x16x32_bf16 a[192:195], v[184:187], v[56:59], a[192:195]
ds_read_b64_tr_b16 v[206:207], v236 offset:8704
buffer_load_dwordx4 v225, s[28:31], s52 offen offset:1024 nt lds
v_fma_f32 v75, v75, s51, -v243
v_mfma_f32_16x16x32_bf16 a[200:203], v[184:187], v[60:63], a[200:203]
ds_read_b64_tr_b16 v[176:177], v236 offset:16384
s_add_u32 m0, s48, 73600
v_add_f32 v245, v245, v72
v_add_f32 v245, v245, v73
v_mfma_f32_16x16x32_bf16 a[196:199], v[188:191], v[56:59], a[196:199]
ds_read_b64_tr_b16 v[178:179], v237 offset:16896
buffer_load_dwordx4 v224, s[28:31], s52 offen offset:128 nt lds
v_mfma_f32_16x16x32_bf16 a[204:207], v[188:191], v[60:63], a[204:207]
ds_read_b64_tr_b16 v[180:181], v237 offset:16384
v_cvt_pk_bf16_f32 v68, v72, v73
v_exp_f32 v74, v74
s_waitcnt lgkmcnt(7)
v_mfma_f32_16x16x32_bf16 v[128:131], v[192:195], a[16:19], v[128:131]
ds_read_b64_tr_b16 v[182:183], v236 offset:16896
buffer_load_dwordx4 v225, s[28:31], s52 offen offset:1152 nt lds
v_mfma_f32_16x16x32_bf16 v[136:139], v[192:195], a[20:23], v[136:139]
ds_read_b64_tr_b16 v[184:185], v236 offset:4096
s_add_u32 m0, s48, 81664
v_exp_f32 v75, v75
v_mfma_f32_16x16x32_bf16 v[132:135], v[196:199], a[16:19], v[132:135]
ds_read_b64_tr_b16 v[186:187], v237 offset:4608
buffer_load_dwordx4 v224, s[28:31], s52 offen offset:256 nt lds
v_fma_f32 v76, v76, s51, -v243
v_mfma_f32_16x16x32_bf16 v[140:143], v[196:199], a[20:23], v[140:143]
ds_read_b64_tr_b16 v[188:189], v237 offset:4096
v_fma_f32 v77, v77, s51, -v243
v_add_f32 v245, v245, v74
s_waitcnt lgkmcnt(7)
v_mfma_f32_16x16x32_bf16 v[144:147], v[200:203], a[16:19], v[144:147]
ds_read_b64_tr_b16 v[190:191], v236 offset:4608
v_add_f32 v245, v245, v75
v_cvt_pk_bf16_f32 v69, v74, v75
v_mfma_f32_16x16x32_bf16 v[152:155], v[200:203], a[20:23], v[152:155]
ds_read_b64_tr_b16 v[192:193], v236 offset:12288
buffer_load_dwordx4 v225, s[28:31], s52 offen offset:1280 nt lds
v_mfma_f32_16x16x32_bf16 v[148:151], v[204:207], a[16:19], v[148:151]
ds_read_b64_tr_b16 v[194:195], v237 offset:12800
v_exp_f32 v76, v76
v_mfma_f32_16x16x32_bf16 v[156:159], v[204:207], a[20:23], v[156:159]
ds_read_b64_tr_b16 v[196:197], v237 offset:12288
v_exp_f32 v77, v77
v_fma_f32 v78, v78, s51, -v243
s_waitcnt lgkmcnt(7)
v_mfma_f32_16x16x32_bf16 v[160:163], v[176:179], a[16:19], v[160:163]
ds_read_b64_tr_b16 v[198:199], v236 offset:12800
v_fma_f32 v79, v79, s51, -v243
v_add_f32 v245, v245, v76
v_add_f32 v245, v245, v77
v_mfma_f32_16x16x32_bf16 v[168:171], v[176:179], a[20:23], v[168:171]
ds_read_b64_tr_b16 v[200:201], v236 offset:20480
v_cvt_pk_bf16_f32 v70, v76, v77
v_exp_f32 v78, v78
v_mfma_f32_16x16x32_bf16 v[164:167], v[180:183], a[16:19], v[164:167]
ds_read_b64_tr_b16 v[202:203], v237 offset:20992
v_exp_f32 v79, v79
v_add_f32 v245, v245, v78
v_mfma_f32_16x16x32_bf16 v[172:175], v[180:183], a[20:23], v[172:175]
ds_read_b64_tr_b16 v[204:205], v237 offset:20480
v_add_f32 v245, v245, v79
v_cvt_pk_bf16_f32 v71, v78, v79
ds_write_b128 v239, v[64:67] offset:16384
ds_write_b128 v239, v[68:71] offset:17408
s_waitcnt lgkmcnt(9)
v_mfma_f32_16x16x32_bf16 v[128:131], v[184:187], a[24:27], v[128:131]
ds_read_b64_tr_b16 v[206:207], v236 offset:20992
v_mfma_f32_16x16x32_bf16 v[136:139], v[184:187], a[28:31], v[136:139]
v_mfma_f32_16x16x32_bf16 v[132:135], v[188:191], a[24:27], v[132:135]
v_mfma_f32_16x16x32_bf16 v[140:143], v[188:191], a[28:31], v[140:143]
v_add_u32 v236, 114688, v250
v_xor_b32 v237, 32, v236
s_waitcnt lgkmcnt(6)
v_mfma_f32_16x16x32_bf16 v[144:147], v[192:195], a[24:27], v[144:147]
v_xor_b32 v232, 0x1000, v236
v_xor_b32 v233, 0x1000, v237
v_mfma_f32_16x16x32_bf16 v[152:155], v[192:195], a[28:31], v[152:155]
s_waitcnt vmcnt(12) lgkmcnt(0)
s_barrier
ds_read_b64_tr_b16 v[176:177], v236 offset:0
ds_read_b64_tr_b16 v[178:179], v236 offset:2048
ds_read_b64_tr_b16 v[180:181], v237 offset:0
ds_read_b64_tr_b16 v[182:183], v237 offset:2048
ds_read_b64_tr_b16 v[184:185], v236 offset:8192
ds_read_b64_tr_b16 v[186:187], v236 offset:10240
v_mfma_f32_16x16x32_bf16 v[148:151], v[196:199], a[24:27], v[148:151]
v_fma_f32 v80, v80, s51, -v242
v_fma_f32 v81, v81, s51, -v242
v_exp_f32 v80, v80
v_mfma_f32_16x16x32_bf16 v[156:159], v[196:199], a[28:31], v[156:159]
ds_read_b64_tr_b16 v[188:189], v237 offset:8192
v_exp_f32 v81, v81
v_mfma_f32_16x16x32_bf16 v[160:163], v[200:203], a[24:27], v[160:163]
ds_read_b64_tr_b16 v[190:191], v237 offset:10240
v_fma_f32 v82, v82, s51, -v242
v_fma_f32 v83, v83, s51, -v242
v_mfma_f32_16x16x32_bf16 v[168:171], v[200:203], a[28:31], v[168:171]
ds_read_b64_tr_b16 v[192:193], v236 offset:16384
v_add_f32 v244, v244, v80
v_add_f32 v244, v244, v81
v_mfma_f32_16x16x32_bf16 v[164:167], v[204:207], a[24:27], v[164:167]
ds_read_b64_tr_b16 v[194:195], v236 offset:18432
v_cvt_pk_bf16_f32 v80, v80, v81
v_exp_f32 v82, v82
v_mfma_f32_16x16x32_bf16 v[172:175], v[204:207], a[28:31], v[172:175]
ds_read_b64_tr_b16 v[196:197], v237 offset:16384
v_exp_f32 v83, v83
s_waitcnt lgkmcnt(7)
v_mfma_f32_16x16x32_bf16 a[160:163], v[176:179], v[64:67], a[160:163]
ds_read_b64_tr_b16 v[198:199], v237 offset:18432
v_fma_f32 v84, v84, s51, -v242
v_fma_f32 v85, v85, s51, -v242
v_mfma_f32_16x16x32_bf16 a[168:171], v[176:179], v[68:71], a[168:171]
ds_read_b128 v[72:75], v234 offset:16384
ds_read_b128 v[76:79], v234 offset:17408
v_add_f32 v244, v244, v82
v_mfma_f32_16x16x32_bf16 a[164:167], v[180:183], v[64:67], a[164:167]
ds_read_b64_tr_b16 v[200:201], v232 offset:0
ds_read_b64_tr_b16 v[202:203], v232 offset:2048
s_mul_i32 s52, s63, 6144
s_add_u32 s52, s52, 6144
s_add_u32 m0, s48, 90112
v_mfma_f32_16x16x32_bf16 a[172:175], v[180:183], v[68:71], a[172:175]
ds_read_b64_tr_b16 v[204:205], v233 offset:0
buffer_load_dwordx4 v226, s[32:35], s52 offen lds
s_waitcnt lgkmcnt(9)
v_mfma_f32_16x16x32_bf16 a[176:179], v[184:187], v[64:67], a[176:179]
ds_read_b64_tr_b16 v[206:207], v233 offset:2048
v_add_f32 v244, v244, v83
v_cvt_pk_bf16_f32 v81, v82, v83
v_mfma_f32_16x16x32_bf16 a[184:187], v[184:187], v[68:71], a[184:187]
ds_read_b64_tr_b16 v[176:177], v232 offset:8192
buffer_load_dwordx4 v227, s[32:35], s52 offen offset:1024 lds
v_mfma_f32_16x16x32_bf16 a[180:183], v[188:191], v[64:67], a[180:183]
ds_read_b64_tr_b16 v[178:179], v232 offset:10240
v_exp_f32 v84, v84
v_mfma_f32_16x16x32_bf16 a[188:191], v[188:191], v[68:71], a[188:191]
ds_read_b64_tr_b16 v[180:181], v233 offset:8192
s_add_u32 m0, s48, 98176
v_exp_f32 v85, v85
s_waitcnt lgkmcnt(9)
v_mfma_f32_16x16x32_bf16 a[192:195], v[192:195], v[64:67], a[192:195]
ds_read_b64_tr_b16 v[182:183], v233 offset:10240
buffer_load_dwordx4 v226, s[32:35], s52 offen offset:128 lds
v_mfma_f32_16x16x32_bf16 a[200:203], v[192:195], v[68:71], a[200:203]
ds_read_b64_tr_b16 v[184:185], v232 offset:16384
v_fma_f32 v86, v86, s51, -v242
v_fma_f32 v87, v87, s51, -v242
v_mfma_f32_16x16x32_bf16 a[196:199], v[196:199], v[64:67], a[196:199]
ds_read_b64_tr_b16 v[186:187], v232 offset:18432
v_add_f32 v244, v244, v84
v_add_f32 v244, v244, v85
v_mfma_f32_16x16x32_bf16 a[204:207], v[196:199], v[68:71], a[204:207]
ds_read_b64_tr_b16 v[188:189], v233 offset:16384
buffer_load_dwordx4 v227, s[32:35], s52 offen offset:1152 lds
s_waitcnt lgkmcnt(7)
v_mfma_f32_16x16x32_bf16 a[160:163], v[200:203], v[72:75], a[160:163]
ds_read_b64_tr_b16 v[190:191], v233 offset:18432
v_cvt_pk_bf16_f32 v82, v84, v85
v_exp_f32 v86, v86
v_mfma_f32_16x16x32_bf16 a[168:171], v[200:203], v[76:79], a[168:171]
s_add_u32 m0, s48, 106240
v_exp_f32 v87, v87
v_fma_f32 v88, v88, s51, -v243
v_mfma_f32_16x16x32_bf16 a[164:167], v[204:207], v[72:75], a[164:167]
buffer_load_dwordx4 v226, s[32:35], s52 offen offset:256 lds
v_fma_f32 v89, v89, s51, -v243
v_mfma_f32_16x16x32_bf16 a[172:175], v[204:207], v[76:79], a[172:175]
v_add_u32 v236, 139264, v230
v_xor_b32 v237, 32, v236
v_add_f32 v244, v244, v86
s_waitcnt lgkmcnt(4)
v_mfma_f32_16x16x32_bf16 a[176:179], v[176:179], v[72:75], a[176:179]
v_add_f32 v244, v244, v87
v_cvt_pk_bf16_f32 v83, v86, v87
v_exp_f32 v88, v88
v_mfma_f32_16x16x32_bf16 a[184:187], v[176:179], v[76:79], a[184:187]
buffer_load_dwordx4 v227, s[32:35], s52 offen offset:1280 lds
s_waitcnt vmcnt(12) lgkmcnt(0)
s_barrier
ds_read_b64_tr_b16 v[192:193], v236 offset:0
ds_read_b64_tr_b16 v[194:195], v237 offset:512
ds_read_b64_tr_b16 v[196:197], v237 offset:0
ds_read_b64_tr_b16 v[198:199], v236 offset:512
ds_read_b64_tr_b16 v[200:201], v236 offset:8192
ds_read_b64_tr_b16 v[202:203], v237 offset:8704
v_mfma_f32_16x16x32_bf16 a[180:183], v[180:183], v[72:75], a[180:183]
s_mov_b32 s52, 147456
s_add_u32 m0, s48, 114688
s_nop 0
buffer_load_dwordx4 v224, s[28:31], s52 offen nt lds
v_mfma_f32_16x16x32_bf16 a[188:191], v[180:183], v[76:79], a[188:191]
ds_read_b64_tr_b16 v[204:205], v237 offset:8192
v_exp_f32 v89, v89
v_fma_f32 v90, v90, s51, -v243
v_mfma_f32_16x16x32_bf16 a[192:195], v[184:187], v[72:75], a[192:195]
ds_read_b64_tr_b16 v[206:207], v236 offset:8704
buffer_load_dwordx4 v225, s[28:31], s52 offen offset:1024 nt lds
v_fma_f32 v91, v91, s51, -v243
v_mfma_f32_16x16x32_bf16 a[200:203], v[184:187], v[76:79], a[200:203]
ds_read_b64_tr_b16 v[176:177], v236 offset:16384
s_add_u32 m0, s48, 122752
v_add_f32 v245, v245, v88
v_add_f32 v245, v245, v89
v_mfma_f32_16x16x32_bf16 a[196:199], v[188:191], v[72:75], a[196:199]
ds_read_b64_tr_b16 v[178:179], v237 offset:16896
buffer_load_dwordx4 v224, s[28:31], s52 offen offset:128 nt lds
v_mfma_f32_16x16x32_bf16 a[204:207], v[188:191], v[76:79], a[204:207]
ds_read_b64_tr_b16 v[180:181], v237 offset:16384
v_cvt_pk_bf16_f32 v84, v88, v89
v_exp_f32 v90, v90
s_waitcnt lgkmcnt(7)
v_mfma_f32_16x16x32_bf16 v[128:131], v[192:195], a[32:35], v[128:131]
ds_read_b64_tr_b16 v[182:183], v236 offset:16896
buffer_load_dwordx4 v225, s[28:31], s52 offen offset:1152 nt lds
v_mfma_f32_16x16x32_bf16 v[136:139], v[192:195], a[36:39], v[136:139]
ds_read_b64_tr_b16 v[184:185], v236 offset:4096
s_add_u32 m0, s48, 130816
v_exp_f32 v91, v91
v_mfma_f32_16x16x32_bf16 v[132:135], v[196:199], a[32:35], v[132:135]
ds_read_b64_tr_b16 v[186:187], v237 offset:4608
buffer_load_dwordx4 v224, s[28:31], s52 offen offset:256 nt lds
v_fma_f32 v92, v92, s51, -v243
v_mfma_f32_16x16x32_bf16 v[140:143], v[196:199], a[36:39], v[140:143]
ds_read_b64_tr_b16 v[188:189], v237 offset:4096
v_fma_f32 v93, v93, s51, -v243
v_add_f32 v245, v245, v90
s_waitcnt lgkmcnt(7)
v_mfma_f32_16x16x32_bf16 v[144:147], v[200:203], a[32:35], v[144:147]
ds_read_b64_tr_b16 v[190:191], v236 offset:4608
v_add_f32 v245, v245, v91
v_cvt_pk_bf16_f32 v85, v90, v91
v_mfma_f32_16x16x32_bf16 v[152:155], v[200:203], a[36:39], v[152:155]
ds_read_b64_tr_b16 v[192:193], v236 offset:12288
buffer_load_dwordx4 v225, s[28:31], s52 offen offset:1280 nt lds
v_mfma_f32_16x16x32_bf16 v[148:151], v[204:207], a[32:35], v[148:151]
ds_read_b64_tr_b16 v[194:195], v237 offset:12800
v_exp_f32 v92, v92
v_mfma_f32_16x16x32_bf16 v[156:159], v[204:207], a[36:39], v[156:159]
ds_read_b64_tr_b16 v[196:197], v237 offset:12288
v_exp_f32 v93, v93
v_fma_f32 v94, v94, s51, -v243
s_waitcnt lgkmcnt(7)
v_mfma_f32_16x16x32_bf16 v[160:163], v[176:179], a[32:35], v[160:163]
ds_read_b64_tr_b16 v[198:199], v236 offset:12800
v_fma_f32 v95, v95, s51, -v243
v_add_f32 v245, v245, v92
v_add_f32 v245, v245, v93
v_mfma_f32_16x16x32_bf16 v[168:171], v[176:179], a[36:39], v[168:171]
ds_read_b64_tr_b16 v[200:201], v236 offset:20480
v_cvt_pk_bf16_f32 v86, v92, v93
v_exp_f32 v94, v94
v_mfma_f32_16x16x32_bf16 v[164:167], v[180:183], a[32:35], v[164:167]
ds_read_b64_tr_b16 v[202:203], v237 offset:20992
v_exp_f32 v95, v95
v_add_f32 v245, v245, v94
v_mfma_f32_16x16x32_bf16 v[172:175], v[180:183], a[36:39], v[172:175]
ds_read_b64_tr_b16 v[204:205], v237 offset:20480
v_add_f32 v245, v245, v95
v_cvt_pk_bf16_f32 v87, v94, v95
ds_write_b128 v239, v[80:83] offset:0
ds_write_b128 v239, v[84:87] offset:1024
s_waitcnt lgkmcnt(9)
v_mfma_f32_16x16x32_bf16 v[128:131], v[184:187], a[40:43], v[128:131]
ds_read_b64_tr_b16 v[206:207], v236 offset:20992
v_mfma_f32_16x16x32_bf16 v[136:139], v[184:187], a[44:47], v[136:139]
v_mfma_f32_16x16x32_bf16 v[132:135], v[188:191], a[40:43], v[132:135]
v_mfma_f32_16x16x32_bf16 v[140:143], v[188:191], a[44:47], v[140:143]
v_add_u32 v236, 65536, v250
v_xor_b32 v237, 32, v236
s_waitcnt lgkmcnt(6)
v_mfma_f32_16x16x32_bf16 v[144:147], v[192:195], a[40:43], v[144:147]
v_xor_b32 v232, 0x1000, v236
v_xor_b32 v233, 0x1000, v237
v_mfma_f32_16x16x32_bf16 v[152:155], v[192:195], a[44:47], v[152:155]
s_waitcnt vmcnt(12) lgkmcnt(0)
s_barrier
ds_read_b64_tr_b16 v[176:177], v236 offset:0
ds_read_b64_tr_b16 v[178:179], v236 offset:2048
ds_read_b64_tr_b16 v[180:181], v237 offset:0
ds_read_b64_tr_b16 v[182:183], v237 offset:2048
ds_read_b64_tr_b16 v[184:185], v236 offset:8192
ds_read_b64_tr_b16 v[186:187], v236 offset:10240
v_mfma_f32_16x16x32_bf16 v[148:151], v[196:199], a[40:43], v[148:151]
v_fma_f32 v96, v96, s51, -v242
v_fma_f32 v97, v97, s51, -v242
v_exp_f32 v96, v96
v_mfma_f32_16x16x32_bf16 v[156:159], v[196:199], a[44:47], v[156:159]
ds_read_b64_tr_b16 v[188:189], v237 offset:8192
v_exp_f32 v97, v97
v_mfma_f32_16x16x32_bf16 v[160:163], v[200:203], a[40:43], v[160:163]
ds_read_b64_tr_b16 v[190:191], v237 offset:10240
v_fma_f32 v98, v98, s51, -v242
v_fma_f32 v99, v99, s51, -v242
v_mfma_f32_16x16x32_bf16 v[168:171], v[200:203], a[44:47], v[168:171]
ds_read_b64_tr_b16 v[192:193], v236 offset:16384
v_add_f32 v244, v244, v96
v_add_f32 v244, v244, v97
v_mfma_f32_16x16x32_bf16 v[164:167], v[204:207], a[40:43], v[164:167]
ds_read_b64_tr_b16 v[194:195], v236 offset:18432
v_cvt_pk_bf16_f32 v96, v96, v97
v_exp_f32 v98, v98
v_mfma_f32_16x16x32_bf16 v[172:175], v[204:207], a[44:47], v[172:175]
ds_read_b64_tr_b16 v[196:197], v237 offset:16384
v_exp_f32 v99, v99
s_waitcnt lgkmcnt(7)
v_mfma_f32_16x16x32_bf16 a[160:163], v[176:179], v[80:83], a[160:163]
ds_read_b64_tr_b16 v[198:199], v237 offset:18432
v_fma_f32 v100, v100, s51, -v242
v_fma_f32 v101, v101, s51, -v242
v_mfma_f32_16x16x32_bf16 a[168:171], v[176:179], v[84:87], a[168:171]
ds_read_b128 v[88:91], v234 offset:0
ds_read_b128 v[92:95], v234 offset:1024
v_add_f32 v244, v244, v98
v_mfma_f32_16x16x32_bf16 a[164:167], v[180:183], v[80:83], a[164:167]
ds_read_b64_tr_b16 v[200:201], v232 offset:0
ds_read_b64_tr_b16 v[202:203], v232 offset:2048
s_mul_i32 s52, s64, 6144
s_add_u32 s52, s52, 6144
s_add_u32 m0, s48, 139264
v_mfma_f32_16x16x32_bf16 a[172:175], v[180:183], v[84:87], a[172:175]
ds_read_b64_tr_b16 v[204:205], v233 offset:0
buffer_load_dwordx4 v226, s[32:35], s52 offen lds
s_waitcnt lgkmcnt(9)
v_mfma_f32_16x16x32_bf16 a[176:179], v[184:187], v[80:83], a[176:179]
ds_read_b64_tr_b16 v[206:207], v233 offset:2048
v_add_f32 v244, v244, v99
v_cvt_pk_bf16_f32 v97, v98, v99
v_mfma_f32_16x16x32_bf16 a[184:187], v[184:187], v[84:87], a[184:187]
ds_read_b64_tr_b16 v[176:177], v232 offset:8192
buffer_load_dwordx4 v227, s[32:35], s52 offen offset:1024 lds
v_mfma_f32_16x16x32_bf16 a[180:183], v[188:191], v[80:83], a[180:183]
ds_read_b64_tr_b16 v[178:179], v232 offset:10240
v_exp_f32 v100, v100
v_mfma_f32_16x16x32_bf16 a[188:191], v[188:191], v[84:87], a[188:191]
ds_read_b64_tr_b16 v[180:181], v233 offset:8192
s_add_u32 m0, s48, 147328
v_exp_f32 v101, v101
s_waitcnt lgkmcnt(9)
v_mfma_f32_16x16x32_bf16 a[192:195], v[192:195], v[80:83], a[192:195]
ds_read_b64_tr_b16 v[182:183], v233 offset:10240
buffer_load_dwordx4 v226, s[32:35], s52 offen offset:128 lds
v_mfma_f32_16x16x32_bf16 a[200:203], v[192:195], v[84:87], a[200:203]
ds_read_b64_tr_b16 v[184:185], v232 offset:16384
v_fma_f32 v102, v102, s51, -v242
v_fma_f32 v103, v103, s51, -v242
v_mfma_f32_16x16x32_bf16 a[196:199], v[196:199], v[80:83], a[196:199]
ds_read_b64_tr_b16 v[186:187], v232 offset:18432
v_add_f32 v244, v244, v100
v_add_f32 v244, v244, v101
v_mfma_f32_16x16x32_bf16 a[204:207], v[196:199], v[84:87], a[204:207]
ds_read_b64_tr_b16 v[188:189], v233 offset:16384
buffer_load_dwordx4 v227, s[32:35], s52 offen offset:1152 lds
s_waitcnt lgkmcnt(7)
v_mfma_f32_16x16x32_bf16 a[160:163], v[200:203], v[88:91], a[160:163]
ds_read_b64_tr_b16 v[190:191], v233 offset:18432
v_cvt_pk_bf16_f32 v98, v100, v101
v_exp_f32 v102, v102
v_mfma_f32_16x16x32_bf16 a[168:171], v[200:203], v[92:95], a[168:171]
s_add_u32 m0, s48, 155392
v_exp_f32 v103, v103
v_fma_f32 v104, v104, s51, -v243
v_mfma_f32_16x16x32_bf16 a[164:167], v[204:207], v[88:91], a[164:167]
buffer_load_dwordx4 v226, s[32:35], s52 offen offset:256 lds
v_fma_f32 v105, v105, s51, -v243
v_mfma_f32_16x16x32_bf16 a[172:175], v[204:207], v[92:95], a[172:175]
v_add_u32 v236, 90112, v230
v_xor_b32 v237, 32, v236
v_add_f32 v244, v244, v102
s_waitcnt lgkmcnt(4)
v_mfma_f32_16x16x32_bf16 a[176:179], v[176:179], v[88:91], a[176:179]
v_add_f32 v244, v244, v103
v_cvt_pk_bf16_f32 v99, v102, v103
v_exp_f32 v104, v104
v_mfma_f32_16x16x32_bf16 a[184:187], v[176:179], v[92:95], a[184:187]
buffer_load_dwordx4 v227, s[32:35], s52 offen offset:1280 lds
s_waitcnt vmcnt(12) lgkmcnt(0)
s_barrier
ds_read_b64_tr_b16 v[192:193], v236 offset:0
ds_read_b64_tr_b16 v[194:195], v237 offset:512
ds_read_b64_tr_b16 v[196:197], v237 offset:0
ds_read_b64_tr_b16 v[198:199], v236 offset:512
ds_read_b64_tr_b16 v[200:201], v236 offset:8192
ds_read_b64_tr_b16 v[202:203], v237 offset:8704
v_mfma_f32_16x16x32_bf16 a[180:183], v[180:183], v[88:91], a[180:183]
s_mov_b32 s52, 172032
s_add_u32 m0, s48, 65536
s_nop 0
buffer_load_dwordx4 v224, s[28:31], s52 offen nt lds
v_mfma_f32_16x16x32_bf16 a[188:191], v[180:183], v[92:95], a[188:191]
ds_read_b64_tr_b16 v[204:205], v237 offset:8192
v_exp_f32 v105, v105
v_fma_f32 v106, v106, s51, -v243
v_mfma_f32_16x16x32_bf16 a[192:195], v[184:187], v[88:91], a[192:195]
ds_read_b64_tr_b16 v[206:207], v236 offset:8704
buffer_load_dwordx4 v225, s[28:31], s52 offen offset:1024 nt lds
v_fma_f32 v107, v107, s51, -v243
v_mfma_f32_16x16x32_bf16 a[200:203], v[184:187], v[92:95], a[200:203]
ds_read_b64_tr_b16 v[176:177], v236 offset:16384
s_add_u32 m0, s48, 73600
v_add_f32 v245, v245, v104
v_add_f32 v245, v245, v105
v_mfma_f32_16x16x32_bf16 a[196:199], v[188:191], v[88:91], a[196:199]
ds_read_b64_tr_b16 v[178:179], v237 offset:16896
buffer_load_dwordx4 v224, s[28:31], s52 offen offset:128 nt lds
v_mfma_f32_16x16x32_bf16 a[204:207], v[188:191], v[92:95], a[204:207]
ds_read_b64_tr_b16 v[180:181], v237 offset:16384
v_cvt_pk_bf16_f32 v100, v104, v105
v_exp_f32 v106, v106
s_waitcnt lgkmcnt(7)
v_mfma_f32_16x16x32_bf16 v[128:131], v[192:195], a[48:51], v[128:131]
ds_read_b64_tr_b16 v[182:183], v236 offset:16896
buffer_load_dwordx4 v225, s[28:31], s52 offen offset:1152 nt lds
v_mfma_f32_16x16x32_bf16 v[136:139], v[192:195], a[52:55], v[136:139]
ds_read_b64_tr_b16 v[184:185], v236 offset:4096
s_add_u32 m0, s48, 81664
v_exp_f32 v107, v107
v_mfma_f32_16x16x32_bf16 v[132:135], v[196:199], a[48:51], v[132:135]
ds_read_b64_tr_b16 v[186:187], v237 offset:4608
buffer_load_dwordx4 v224, s[28:31], s52 offen offset:256 nt lds
v_fma_f32 v108, v108, s51, -v243
v_mfma_f32_16x16x32_bf16 v[140:143], v[196:199], a[52:55], v[140:143]
ds_read_b64_tr_b16 v[188:189], v237 offset:4096
v_fma_f32 v109, v109, s51, -v243
v_add_f32 v245, v245, v106
s_waitcnt lgkmcnt(7)
v_mfma_f32_16x16x32_bf16 v[144:147], v[200:203], a[48:51], v[144:147]
ds_read_b64_tr_b16 v[190:191], v236 offset:4608
v_add_f32 v245, v245, v107
v_cvt_pk_bf16_f32 v101, v106, v107
v_mfma_f32_16x16x32_bf16 v[152:155], v[200:203], a[52:55], v[152:155]
ds_read_b64_tr_b16 v[192:193], v236 offset:12288
buffer_load_dwordx4 v225, s[28:31], s52 offen offset:1280 nt lds
v_mfma_f32_16x16x32_bf16 v[148:151], v[204:207], a[48:51], v[148:151]
ds_read_b64_tr_b16 v[194:195], v237 offset:12800
v_exp_f32 v108, v108
v_mfma_f32_16x16x32_bf16 v[156:159], v[204:207], a[52:55], v[156:159]
ds_read_b64_tr_b16 v[196:197], v237 offset:12288
v_exp_f32 v109, v109
v_fma_f32 v110, v110, s51, -v243
s_waitcnt lgkmcnt(7)
v_mfma_f32_16x16x32_bf16 v[160:163], v[176:179], a[48:51], v[160:163]
ds_read_b64_tr_b16 v[198:199], v236 offset:12800
v_fma_f32 v111, v111, s51, -v243
v_add_f32 v245, v245, v108
v_add_f32 v245, v245, v109
v_mfma_f32_16x16x32_bf16 v[168:171], v[176:179], a[52:55], v[168:171]
ds_read_b64_tr_b16 v[200:201], v236 offset:20480
v_cvt_pk_bf16_f32 v102, v108, v109
v_exp_f32 v110, v110
v_mfma_f32_16x16x32_bf16 v[164:167], v[180:183], a[48:51], v[164:167]
ds_read_b64_tr_b16 v[202:203], v237 offset:20992
v_exp_f32 v111, v111
v_add_f32 v245, v245, v110
v_mfma_f32_16x16x32_bf16 v[172:175], v[180:183], a[52:55], v[172:175]
ds_read_b64_tr_b16 v[204:205], v237 offset:20480
v_add_f32 v245, v245, v111
v_cvt_pk_bf16_f32 v103, v110, v111
ds_write_b128 v239, v[96:99] offset:16384
ds_write_b128 v239, v[100:103] offset:17408
s_waitcnt lgkmcnt(9)
v_mfma_f32_16x16x32_bf16 v[128:131], v[184:187], a[56:59], v[128:131]
ds_read_b64_tr_b16 v[206:207], v236 offset:20992
v_mfma_f32_16x16x32_bf16 v[136:139], v[184:187], a[60:63], v[136:139]
v_mfma_f32_16x16x32_bf16 v[132:135], v[188:191], a[56:59], v[132:135]
v_mfma_f32_16x16x32_bf16 v[140:143], v[188:191], a[60:63], v[140:143]
v_add_u32 v236, 114688, v250
v_xor_b32 v237, 32, v236
s_waitcnt lgkmcnt(6)
v_mfma_f32_16x16x32_bf16 v[144:147], v[192:195], a[56:59], v[144:147]
v_xor_b32 v232, 0x1000, v236
v_xor_b32 v233, 0x1000, v237
v_mfma_f32_16x16x32_bf16 v[152:155], v[192:195], a[60:63], v[152:155]
s_waitcnt vmcnt(12) lgkmcnt(0)
s_barrier
ds_read_b64_tr_b16 v[176:177], v236 offset:0
ds_read_b64_tr_b16 v[178:179], v236 offset:2048
ds_read_b64_tr_b16 v[180:181], v237 offset:0
ds_read_b64_tr_b16 v[182:183], v237 offset:2048
ds_read_b64_tr_b16 v[184:185], v236 offset:8192
ds_read_b64_tr_b16 v[186:187], v236 offset:10240
v_mfma_f32_16x16x32_bf16 v[148:151], v[196:199], a[56:59], v[148:151]
v_fma_f32 v112, v112, s51, -v242
v_fma_f32 v113, v113, s51, -v242
v_exp_f32 v112, v112
v_mfma_f32_16x16x32_bf16 v[156:159], v[196:199], a[60:63], v[156:159]
ds_read_b64_tr_b16 v[188:189], v237 offset:8192
v_exp_f32 v113, v113
v_mfma_f32_16x16x32_bf16 v[160:163], v[200:203], a[56:59], v[160:163]
ds_read_b64_tr_b16 v[190:191], v237 offset:10240
v_fma_f32 v114, v114, s51, -v242
v_fma_f32 v115, v115, s51, -v242
v_mfma_f32_16x16x32_bf16 v[168:171], v[200:203], a[60:63], v[168:171]
ds_read_b64_tr_b16 v[192:193], v236 offset:16384
v_add_f32 v244, v244, v112
v_add_f32 v244, v244, v113
v_mfma_f32_16x16x32_bf16 v[164:167], v[204:207], a[56:59], v[164:167]
ds_read_b64_tr_b16 v[194:195], v236 offset:18432
v_cvt_pk_bf16_f32 v112, v112, v113
v_exp_f32 v114, v114
v_mfma_f32_16x16x32_bf16 v[172:175], v[204:207], a[60:63], v[172:175]
ds_read_b64_tr_b16 v[196:197], v237 offset:16384
v_exp_f32 v115, v115
s_waitcnt lgkmcnt(7)
v_mfma_f32_16x16x32_bf16 a[160:163], v[176:179], v[96:99], a[160:163]
ds_read_b64_tr_b16 v[198:199], v237 offset:18432
v_fma_f32 v116, v116, s51, -v242
v_fma_f32 v117, v117, s51, -v242
v_mfma_f32_16x16x32_bf16 a[168:171], v[176:179], v[100:103], a[168:171]
ds_read_b128 v[104:107], v234 offset:16384
ds_read_b128 v[108:111], v234 offset:17408
v_add_f32 v244, v244, v114
v_add_f32 v244, v244, v115
v_mfma_f32_16x16x32_bf16 a[164:167], v[180:183], v[96:99], a[164:167]
ds_read_b64_tr_b16 v[200:201], v232 offset:0
ds_read_b64_tr_b16 v[202:203], v232 offset:2048
s_mul_i32 s52, s65, 6144
s_add_u32 s52, s52, 6144
s_add_u32 m0, s48, 90112
v_mfma_f32_16x16x32_bf16 a[172:175], v[180:183], v[100:103], a[172:175]
ds_read_b64_tr_b16 v[204:205], v233 offset:0
buffer_load_dwordx4 v226, s[32:35], s52 offen lds
s_waitcnt lgkmcnt(9)
v_mfma_f32_16x16x32_bf16 a[176:179], v[184:187], v[96:99], a[176:179]
ds_read_b64_tr_b16 v[206:207], v233 offset:2048
v_cvt_pk_bf16_f32 v113, v114, v115
v_exp_f32 v116, v116
v_mfma_f32_16x16x32_bf16 a[184:187], v[184:187], v[100:103], a[184:187]
ds_read_b64_tr_b16 v[176:177], v232 offset:8192
buffer_load_dwordx4 v227, s[32:35], s52 offen offset:1024 lds
v_mfma_f32_16x16x32_bf16 a[180:183], v[188:191], v[96:99], a[180:183]
ds_read_b64_tr_b16 v[178:179], v232 offset:10240
v_exp_f32 v117, v117
v_fma_f32 v118, v118, s51, -v242
v_mfma_f32_16x16x32_bf16 a[188:191], v[188:191], v[100:103], a[188:191]
ds_read_b64_tr_b16 v[180:181], v233 offset:8192
s_add_u32 m0, s48, 98176
v_fma_f32 v119, v119, s51, -v242
v_add_f32 v244, v244, v116
s_waitcnt lgkmcnt(9)
v_mfma_f32_16x16x32_bf16 a[192:195], v[192:195], v[96:99], a[192:195]
ds_read_b64_tr_b16 v[182:183], v233 offset:10240
buffer_load_dwordx4 v226, s[32:35], s52 offen offset:128 lds
v_mfma_f32_16x16x32_bf16 a[200:203], v[192:195], v[100:103], a[200:203]
ds_read_b64_tr_b16 v[184:185], v232 offset:16384
v_add_f32 v244, v244, v117
v_cvt_pk_bf16_f32 v114, v116, v117
v_mfma_f32_16x16x32_bf16 a[196:199], v[196:199], v[96:99], a[196:199]
ds_read_b64_tr_b16 v[186:187], v232 offset:18432
v_exp_f32 v118, v118
v_mfma_f32_16x16x32_bf16 a[204:207], v[196:199], v[100:103], a[204:207]
ds_read_b64_tr_b16 v[188:189], v233 offset:16384
buffer_load_dwordx4 v227, s[32:35], s52 offen offset:1152 lds
s_waitcnt lgkmcnt(7)
v_mfma_f32_16x16x32_bf16 a[160:163], v[200:203], v[104:107], a[160:163]
ds_read_b64_tr_b16 v[190:191], v233 offset:18432
v_exp_f32 v119, v119
v_fma_f32 v120, v120, s51, -v243
v_mfma_f32_16x16x32_bf16 a[168:171], v[200:203], v[108:111], a[168:171]
s_add_u32 m0, s48, 106240
v_fma_f32 v121, v121, s51, -v243
v_add_f32 v244, v244, v118
v_add_f32 v244, v244, v119
v_mfma_f32_16x16x32_bf16 a[164:167], v[204:207], v[104:107], a[164:167]
buffer_load_dwordx4 v226, s[32:35], s52 offen offset:256 lds
v_cvt_pk_bf16_f32 v115, v118, v119
v_mfma_f32_16x16x32_bf16 a[172:175], v[204:207], v[108:111], a[172:175]
v_add_u32 v236, 139264, v230
v_xor_b32 v237, 32, v236
v_exp_f32 v120, v120
s_waitcnt lgkmcnt(4)
v_mfma_f32_16x16x32_bf16 a[176:179], v[176:179], v[104:107], a[176:179]
v_exp_f32 v121, v121
v_fma_f32 v122, v122, s51, -v243
v_fma_f32 v123, v123, s51, -v243
v_mfma_f32_16x16x32_bf16 a[184:187], v[176:179], v[108:111], a[184:187]
buffer_load_dwordx4 v227, s[32:35], s52 offen offset:1280 lds
v_add_f32 v245, v245, v120
v_add_f32 v245, v245, v121
s_waitcnt vmcnt(12) lgkmcnt(0)
s_barrier
ds_read_b64_tr_b16 v[192:193], v236 offset:0
ds_read_b64_tr_b16 v[194:195], v237 offset:512
ds_read_b64_tr_b16 v[196:197], v237 offset:0
ds_read_b64_tr_b16 v[198:199], v236 offset:512
ds_read_b64_tr_b16 v[200:201], v236 offset:8192
ds_read_b64_tr_b16 v[202:203], v237 offset:8704
v_mfma_f32_16x16x32_bf16 a[180:183], v[180:183], v[104:107], a[180:183]
s_mov_b32 s52, 1572864
s_add_u32 m0, s48, 114688
s_nop 0
buffer_load_dwordx4 v224, s[24:27], s52 offen nt lds
v_cvt_pk_bf16_f32 v116, v120, v121
v_mfma_f32_16x16x32_bf16 a[188:191], v[180:183], v[108:111], a[188:191]
ds_read_b64_tr_b16 v[204:205], v237 offset:8192
v_exp_f32 v122, v122
v_mfma_f32_16x16x32_bf16 a[192:195], v[184:187], v[104:107], a[192:195]
ds_read_b64_tr_b16 v[206:207], v236 offset:8704
buffer_load_dwordx4 v225, s[24:27], s52 offen offset:1024 nt lds
v_mfma_f32_16x16x32_bf16 a[200:203], v[184:187], v[108:111], a[200:203]
ds_read_b64_tr_b16 v[176:177], v236 offset:16384
s_add_u32 m0, s48, 122752
v_exp_f32 v123, v123
v_mfma_f32_16x16x32_bf16 a[196:199], v[188:191], v[104:107], a[196:199]
ds_read_b64_tr_b16 v[178:179], v237 offset:16896
buffer_load_dwordx4 v224, s[24:27], s52 offen offset:128 nt lds
v_fma_f32 v124, v124, s51, -v243
v_mfma_f32_16x16x32_bf16 a[204:207], v[188:191], v[108:111], a[204:207]
ds_read_b64_tr_b16 v[180:181], v237 offset:16384
v_fma_f32 v125, v125, s51, -v243
v_add_f32 v245, v245, v122
v_add_f32 v245, v245, v123
s_waitcnt lgkmcnt(7)
v_mfma_f32_16x16x32_bf16 v[128:131], v[192:195], a[64:67], v[128:131]
ds_read_b64_tr_b16 v[182:183], v236 offset:16896
buffer_load_dwordx4 v225, s[24:27], s52 offen offset:1152 nt lds
v_cvt_pk_bf16_f32 v117, v122, v123
v_mfma_f32_16x16x32_bf16 v[136:139], v[192:195], a[68:71], v[136:139]
ds_read_b64_tr_b16 v[184:185], v236 offset:4096
s_add_u32 m0, s48, 130816
v_exp_f32 v124, v124
v_mfma_f32_16x16x32_bf16 v[132:135], v[196:199], a[64:67], v[132:135]
ds_read_b64_tr_b16 v[186:187], v237 offset:4608
buffer_load_dwordx4 v224, s[24:27], s52 offen offset:256 nt lds
v_exp_f32 v125, v125
v_mfma_f32_16x16x32_bf16 v[140:143], v[196:199], a[68:71], v[140:143]
ds_read_b64_tr_b16 v[188:189], v237 offset:4096
v_fma_f32 v126, v126, s51, -v243
v_fma_f32 v127, v127, s51, -v243
v_add_f32 v245, v245, v124
s_waitcnt lgkmcnt(7)
v_mfma_f32_16x16x32_bf16 v[144:147], v[200:203], a[64:67], v[144:147]
ds_read_b64_tr_b16 v[190:191], v236 offset:4608
v_add_f32 v245, v245, v125
v_cvt_pk_bf16_f32 v118, v124, v125
v_mfma_f32_16x16x32_bf16 v[152:155], v[200:203], a[68:71], v[152:155]
ds_read_b64_tr_b16 v[192:193], v236 offset:12288
buffer_load_dwordx4 v225, s[24:27], s52 offen offset:1280 nt lds
v_exp_f32 v126, v126
v_mfma_f32_16x16x32_bf16 v[148:151], v[204:207], a[64:67], v[148:151]
ds_read_b64_tr_b16 v[194:195], v237 offset:12800
v_exp_f32 v127, v127
v_add_f32 v245, v245, v126
v_mfma_f32_16x16x32_bf16 v[156:159], v[204:207], a[68:71], v[156:159]
ds_read_b64_tr_b16 v[196:197], v237 offset:12288
v_add_f32 v245, v245, v127
v_cvt_pk_bf16_f32 v119, v126, v127
v_mov_b32 v246, v244
s_waitcnt lgkmcnt(7)
v_mfma_f32_16x16x32_bf16 v[160:163], v[176:179], a[64:67], v[160:163]
ds_read_b64_tr_b16 v[198:199], v236 offset:12800
v_mov_b32 v247, v245
v_permlane16_swap_b32 v246, v244
s_nop 0
v_permlane16_swap_b32 v247, v245
v_mfma_f32_16x16x32_bf16 v[168:171], v[176:179], a[68:71], v[168:171]
ds_read_b64_tr_b16 v[200:201], v236 offset:20480
v_add_f32 v244, v244, v246
v_add_f32 v245, v245, v247
v_mov_b32 v246, v244
v_mfma_f32_16x16x32_bf16 v[164:167], v[180:183], a[64:67], v[164:167]
ds_read_b64_tr_b16 v[202:203], v237 offset:20992
v_mov_b32 v247, v245
v_permlane32_swap_b32 v246, v244
s_nop 0
v_permlane32_swap_b32 v247, v245
v_mfma_f32_16x16x32_bf16 v[172:175], v[180:183], a[68:71], v[172:175]
ds_read_b64_tr_b16 v[204:205], v237 offset:20480
v_add_f32 v244, v244, v246
v_add_f32 v245, v245, v247
ds_write_b128 v239, v[112:115] offset:0
ds_write_b128 v239, v[116:119] offset:1024
ds_write_b64 v239, v[244:245] offset:58368
s_waitcnt lgkmcnt(10)
v_mfma_f32_16x16x32_bf16 v[128:131], v[184:187], a[72:75], v[128:131]
ds_read_b64_tr_b16 v[206:207], v236 offset:20992
v_mfma_f32_16x16x32_bf16 v[136:139], v[184:187], a[76:79], v[136:139]
v_mfma_f32_16x16x32_bf16 v[132:135], v[188:191], a[72:75], v[132:135]
v_mfma_f32_16x16x32_bf16 v[140:143], v[188:191], a[76:79], v[140:143]
v_add_u32 v236, 65536, v250
v_xor_b32 v237, 32, v236
s_waitcnt lgkmcnt(7)
v_mfma_f32_16x16x32_bf16 v[144:147], v[192:195], a[72:75], v[144:147]
v_xor_b32 v232, 0x1000, v236
v_xor_b32 v233, 0x1000, v237
v_mfma_f32_16x16x32_bf16 v[152:155], v[192:195], a[76:79], v[152:155]
s_waitcnt vmcnt(12) lgkmcnt(0)
s_barrier
ds_read_b64_tr_b16 v[176:177], v236 offset:0
ds_read_b64_tr_b16 v[178:179], v236 offset:2048
ds_read_b64_tr_b16 v[180:181], v237 offset:0
ds_read_b64_tr_b16 v[182:183], v237 offset:2048
ds_read_b64_tr_b16 v[184:185], v236 offset:8192
ds_read_b64_tr_b16 v[186:187], v236 offset:10240
v_mfma_f32_16x16x32_bf16 v[148:151], v[196:199], a[72:75], v[148:151]
s_mov_b32 s52, 1597440
s_add_u32 m0, s48, 139264
s_nop 0
buffer_load_dwordx4 v224, s[24:27], s52 offen nt lds
v_mfma_f32_16x16x32_bf16 v[156:159], v[196:199], a[76:79], v[156:159]
ds_read_b64_tr_b16 v[188:189], v237 offset:8192
v_mfma_f32_16x16x32_bf16 v[160:163], v[200:203], a[72:75], v[160:163]
ds_read_b64_tr_b16 v[190:191], v237 offset:10240
buffer_load_dwordx4 v225, s[24:27], s52 offen offset:1024 nt lds
v_mfma_f32_16x16x32_bf16 v[168:171], v[200:203], a[76:79], v[168:171]
ds_read_b64_tr_b16 v[192:193], v236 offset:16384
s_add_u32 m0, s48, 147328
v_mfma_f32_16x16x32_bf16 v[164:167], v[204:207], a[72:75], v[164:167]
ds_read_b64_tr_b16 v[194:195], v236 offset:18432
buffer_load_dwordx4 v224, s[24:27], s52 offen offset:128 nt lds
v_mfma_f32_16x16x32_bf16 v[172:175], v[204:207], a[76:79], v[172:175]
ds_read_b64_tr_b16 v[196:197], v237 offset:16384
s_waitcnt lgkmcnt(7)
v_mfma_f32_16x16x32_bf16 a[160:163], v[176:179], v[112:115], a[160:163]
ds_read_b64_tr_b16 v[198:199], v237 offset:18432
buffer_load_dwordx4 v225, s[24:27], s52 offen offset:1152 nt lds
v_mfma_f32_16x16x32_bf16 a[168:171], v[176:179], v[116:119], a[168:171]
ds_read_b128 v[120:123], v234 offset:0
ds_read_b128 v[124:127], v234 offset:1024
s_add_u32 m0, s48, 155392
v_mfma_f32_16x16x32_bf16 a[164:167], v[180:183], v[112:115], a[164:167]
ds_read_b64_tr_b16 v[200:201], v232 offset:0
ds_read_b64_tr_b16 v[202:203], v232 offset:2048
buffer_load_dwordx4 v224, s[24:27], s52 offen offset:256 nt lds
v_mfma_f32_16x16x32_bf16 a[172:175], v[180:183], v[116:119], a[172:175]
ds_read_b64_tr_b16 v[204:205], v233 offset:0
s_waitcnt lgkmcnt(9)
v_mfma_f32_16x16x32_bf16 a[176:179], v[184:187], v[112:115], a[176:179]
ds_read_b64_tr_b16 v[206:207], v233 offset:2048
v_mfma_f32_16x16x32_bf16 a[184:187], v[184:187], v[116:119], a[184:187]
ds_read_b64_tr_b16 v[176:177], v232 offset:8192
buffer_load_dwordx4 v225, s[24:27], s52 offen offset:1280 nt lds
v_mfma_f32_16x16x32_bf16 a[180:183], v[188:191], v[112:115], a[180:183]
ds_read_b64_tr_b16 v[178:179], v232 offset:10240
v_mfma_f32_16x16x32_bf16 a[188:191], v[188:191], v[116:119], a[188:191]
ds_read_b64_tr_b16 v[180:181], v233 offset:8192
s_waitcnt lgkmcnt(9)
v_mfma_f32_16x16x32_bf16 a[192:195], v[192:195], v[112:115], a[192:195]
ds_read_b64_tr_b16 v[182:183], v233 offset:10240
v_mfma_f32_16x16x32_bf16 a[200:203], v[192:195], v[116:119], a[200:203]
ds_read_b64_tr_b16 v[184:185], v232 offset:16384
v_mfma_f32_16x16x32_bf16 a[196:199], v[196:199], v[112:115], a[196:199]
ds_read_b64_tr_b16 v[186:187], v232 offset:18432
v_mfma_f32_16x16x32_bf16 a[204:207], v[196:199], v[116:119], a[204:207]
ds_read_b64_tr_b16 v[188:189], v233 offset:16384
s_waitcnt lgkmcnt(7)
v_mfma_f32_16x16x32_bf16 a[160:163], v[200:203], v[120:123], a[160:163]
ds_read_b64_tr_b16 v[190:191], v233 offset:18432
v_mfma_f32_16x16x32_bf16 a[168:171], v[200:203], v[124:127], a[168:171]
v_mfma_f32_16x16x32_bf16 a[164:167], v[204:207], v[120:123], a[164:167]
v_mfma_f32_16x16x32_bf16 a[172:175], v[204:207], v[124:127], a[172:175]
v_add_u32 v236, 90112, v230
v_xor_b32 v237, 32, v236
s_waitcnt lgkmcnt(4)
v_mfma_f32_16x16x32_bf16 a[176:179], v[176:179], v[120:123], a[176:179]
v_mfma_f32_16x16x32_bf16 a[184:187], v[176:179], v[124:127], a[184:187]
s_waitcnt vmcnt(12) lgkmcnt(0)
s_barrier
ds_read_b64_tr_b16 v[192:193], v236 offset:0
ds_read_b64_tr_b16 v[194:195], v237 offset:512
ds_read_b64_tr_b16 v[196:197], v237 offset:0
ds_read_b64_tr_b16 v[198:199], v236 offset:512
ds_read_b64_tr_b16 v[200:201], v236 offset:8192
ds_read_b64_tr_b16 v[202:203], v237 offset:8704
v_mfma_f32_16x16x32_bf16 a[180:183], v[180:183], v[120:123], a[180:183]
ds_read_b64 v[246:247], v238 offset:58368
ds_read_b64 v[248:249], v238 offset:60416
s_waitcnt lgkmcnt(0)
v_add_f32 v246, v246, v248
v_mfma_f32_16x16x32_bf16 a[188:191], v[180:183], v[124:127], a[188:191]
ds_read_b64_tr_b16 v[204:205], v237 offset:8192
v_add_f32 v247, v247, v249
v_rcp_f32 v248, v246
v_mfma_f32_16x16x32_bf16 a[192:195], v[184:187], v[120:123], a[192:195]
ds_read_b64_tr_b16 v[206:207], v236 offset:8704
v_rcp_f32 v249, v247
v_mfma_f32_16x16x32_bf16 a[200:203], v[184:187], v[124:127], a[200:203]
ds_read_b64_tr_b16 v[176:177], v236 offset:16384
v_mfma_f32_16x16x32_bf16 a[196:199], v[188:191], v[120:123], a[196:199]
ds_read_b64_tr_b16 v[178:179], v237 offset:16896
v_mfma_f32_16x16x32_bf16 a[204:207], v[188:191], v[124:127], a[204:207]
ds_read_b64_tr_b16 v[180:181], v237 offset:16384
v_mfma_f32_16x16x32_bf16 v[128:131], v[192:195], a[80:83], v[128:131]
ds_read_b64_tr_b16 v[182:183], v236 offset:16896
v_mfma_f32_16x16x32_bf16 v[136:139], v[192:195], a[84:87], v[136:139]
ds_read_b64_tr_b16 v[184:185], v236 offset:4096
v_mfma_f32_16x16x32_bf16 v[132:135], v[196:199], a[80:83], v[132:135]
ds_read_b64_tr_b16 v[186:187], v237 offset:4608
s_add_u32 s52, s70, 0
s_add_u32 m0, s48, 65536
v_accvgpr_read_b32 v64, a160
v_accvgpr_read_b32 v65, a161
v_mfma_f32_16x16x32_bf16 v[140:143], v[196:199], a[84:87], v[140:143]
ds_read_b64_tr_b16 v[188:189], v237 offset:4096
buffer_load_dwordx4 v228, s[36:39], s52 offen lds
v_accvgpr_read_b32 v66, a162
s_waitcnt lgkmcnt(7)
v_mfma_f32_16x16x32_bf16 v[144:147], v[200:203], a[80:83], v[144:147]
ds_read_b64_tr_b16 v[190:191], v236 offset:4608
v_accvgpr_read_b32 v67, a163
v_accvgpr_read_b32 v68, a164
v_accvgpr_read_b32 v69, a165
v_mfma_f32_16x16x32_bf16 v[152:155], v[200:203], a[84:87], v[152:155]
ds_read_b64_tr_b16 v[192:193], v236 offset:12288
buffer_load_dwordx4 v229, s[36:39], s52 offen offset:1024 lds
v_accvgpr_read_b32 v70, a166
v_mfma_f32_16x16x32_bf16 v[148:151], v[204:207], a[80:83], v[148:151]
ds_read_b64_tr_b16 v[194:195], v237 offset:12800
v_accvgpr_read_b32 v71, a167
v_mul_f32 v64, v64, v248
v_mul_f32 v65, v65, v248
v_mfma_f32_16x16x32_bf16 v[156:159], v[204:207], a[84:87], v[156:159]
ds_read_b64_tr_b16 v[196:197], v237 offset:12288
s_add_u32 s52, s70, 81920
s_add_u32 m0, s48, 73728
v_mul_f32 v66, v66, v248
v_mul_f32 v67, v67, v248
s_waitcnt lgkmcnt(7)
v_mfma_f32_16x16x32_bf16 v[160:163], v[176:179], a[80:83], v[160:163]
ds_read_b64_tr_b16 v[198:199], v236 offset:12800
buffer_load_dwordx4 v228, s[36:39], s52 offen lds
v_mul_f32 v68, v68, v248
v_mfma_f32_16x16x32_bf16 v[168:171], v[176:179], a[84:87], v[168:171]
ds_read_b64_tr_b16 v[200:201], v236 offset:20480
v_mul_f32 v69, v69, v248
v_mul_f32 v70, v70, v248
v_mul_f32 v71, v71, v248
v_mfma_f32_16x16x32_bf16 v[164:167], v[180:183], a[80:83], v[164:167]
ds_read_b64_tr_b16 v[202:203], v237 offset:20992
v_cvt_pk_bf16_f32 v64, v64, v65
v_cvt_pk_bf16_f32 v65, v66, v67
v_mfma_f32_16x16x32_bf16 v[172:175], v[180:183], a[84:87], v[172:175]
ds_read_b64_tr_b16 v[204:205], v237 offset:20480
buffer_load_dwordx4 v229, s[36:39], s52 offen offset:1024 lds
v_cvt_pk_bf16_f32 v66, v68, v69
s_waitcnt lgkmcnt(7)
v_mfma_f32_16x16x32_bf16 v[128:131], v[184:187], a[88:91], v[128:131]
ds_read_b64_tr_b16 v[206:207], v236 offset:20992
v_cvt_pk_bf16_f32 v67, v70, v71
v_accvgpr_read_b32 v72, a168
v_mfma_f32_16x16x32_bf16 v[136:139], v[184:187], a[92:95], v[136:139]
s_add_u32 s52, s70, 163840
s_add_u32 m0, s48, 81920
v_accvgpr_read_b32 v73, a169
v_accvgpr_read_b32 v74, a170
v_accvgpr_read_b32 v75, a171
v_mfma_f32_16x16x32_bf16 v[132:135], v[188:191], a[88:91], v[132:135]
buffer_load_dwordx4 v228, s[36:39], s52 offen lds
v_accvgpr_read_b32 v76, a172
v_mfma_f32_16x16x32_bf16 v[140:143], v[188:191], a[92:95], v[140:143]
s_add_u32 s53, s49, 114688
v_add_u32 v232, s53, v231
v_accvgpr_read_b32 v77, a173
v_accvgpr_read_b32 v78, a174
s_waitcnt lgkmcnt(4)
v_mfma_f32_16x16x32_bf16 v[144:147], v[192:195], a[88:91], v[144:147]
v_xor_b32 v233, 64, v232
v_accvgpr_read_b32 v79, a175
v_mul_f32 v72, v72, v249
v_mul_f32 v73, v73, v249
v_mfma_f32_16x16x32_bf16 v[152:155], v[192:195], a[92:95], v[152:155]
buffer_load_dwordx4 v229, s[36:39], s52 offen offset:1024 lds
v_mul_f32 v74, v74, v249
s_waitcnt vmcnt(12) lgkmcnt(0)
s_barrier
ds_read_b128 a[208:211], v238 offset:32768
ds_read_b128 a[212:215], v238 offset:33792
ds_read_b128 v[176:179], v232 offset:0
ds_read_b128 v[180:183], v232 offset:2048
ds_read_b128 a[216:219], v238 offset:34816
ds_read_b128 a[220:223], v238 offset:35840
ds_read_b128 v[184:187], v233 offset:0
v_mfma_f32_16x16x32_bf16 v[148:151], v[196:199], a[88:91], v[148:151]
s_mov_b32 s52, 1622016
s_add_u32 m0, s48, 90112
s_nop 0
buffer_load_dwordx4 v224, s[24:27], s52 offen nt lds
v_mul_f32 v75, v75, v249
v_mfma_f32_16x16x32_bf16 v[156:159], v[196:199], a[92:95], v[156:159]
ds_read_b128 v[188:191], v233 offset:2048
v_mul_f32 v76, v76, v249
v_mul_f32 v77, v77, v249
v_mul_f32 v78, v78, v249
v_mfma_f32_16x16x32_bf16 v[160:163], v[200:203], a[88:91], v[160:163]
buffer_load_dwordx4 v225, s[24:27], s52 offen offset:1024 nt lds
v_mul_f32 v79, v79, v249
v_cvt_pk_bf16_f32 v72, v72, v73
v_mfma_f32_16x16x32_bf16 v[168:171], v[200:203], a[92:95], v[168:171]
ds_read_b128 a[224:227], v238 offset:40960
ds_read_b128 a[228:231], v238 offset:41984
s_add_u32 m0, s48, 98176
v_cvt_pk_bf16_f32 v73, v74, v75
v_mfma_f32_16x16x32_bf16 v[164:167], v[204:207], a[88:91], v[164:167]
ds_read_b128 v[192:195], v232 offset:8192
buffer_load_dwordx4 v224, s[24:27], s52 offen offset:128 nt lds
v_cvt_pk_bf16_f32 v74, v76, v77
v_mfma_f32_16x16x32_bf16 v[172:175], v[204:207], a[92:95], v[172:175]
ds_read_b128 v[196:199], v232 offset:10240
v_cvt_pk_bf16_f32 v75, v78, v79
v_accvgpr_read_b32 v80, a176
v_accvgpr_read_b32 v81, a177
s_waitcnt lgkmcnt(8)
v_mfma_f32_16x16x32_bf16 v[0:3], v[176:179], a[208:211], 0
buffer_load_dwordx4 v225, s[24:27], s52 offen offset:1152 nt lds
v_accvgpr_read_b32 v82, a178
v_accvgpr_read_b32 v83, a179
v_mfma_f32_16x16x32_bf16 v[8:11], v[176:179], a[212:215], 0
ds_read_b128 a[232:235], v238 offset:43008
ds_read_b128 a[236:239], v238 offset:44032
s_add_u32 m0, s48, 106240
v_accvgpr_read_b32 v84, a180
v_mfma_f32_16x16x32_bf16 v[4:7], v[180:183], a[208:211], 0
ds_read_b128 v[200:203], v233 offset:8192
buffer_load_dwordx4 v224, s[24:27], s52 offen offset:256 nt lds
v_accvgpr_read_b32 v85, a181
v_mfma_f32_16x16x32_bf16 v[12:15], v[180:183], a[212:215], 0
ds_read_b128 v[204:207], v233 offset:10240
v_accvgpr_read_b32 v86, a182
v_accvgpr_read_b32 v87, a183
v_mul_f32 v80, v80, v248
s_waitcnt lgkmcnt(8)
v_mfma_f32_16x16x32_bf16 v[0:3], v[184:187], a[216:219], v[0:3]
v_mul_f32 v81, v81, v248
v_mul_f32 v82, v82, v248
v_mul_f32 v83, v83, v248
v_mul_f32 v84, v84, v248
v_mfma_f32_16x16x32_bf16 v[8:11], v[184:187], a[220:223], v[8:11]
ds_read_b128 a[240:243], v238 offset:49152
ds_read_b128 a[244:247], v238 offset:50176
buffer_load_dwordx4 v225, s[24:27], s52 offen offset:1280 nt lds
v_mfma_f32_16x16x32_bf16 v[4:7], v[188:191], a[216:219], v[4:7]
ds_read_b128 v[176:179], v232 offset:16384
v_mul_f32 v85, v85, v248
v_mul_f32 v86, v86, v248
v_mul_f32 v87, v87, v248
v_mfma_f32_16x16x32_bf16 v[12:15], v[188:191], a[220:223], v[12:15]
ds_read_b128 v[180:183], v232 offset:18432
v_cvt_pk_bf16_f32 v80, v80, v81
v_cvt_pk_bf16_f32 v81, v82, v83
v_cvt_pk_bf16_f32 v82, v84, v85
s_waitcnt lgkmcnt(8)
v_mfma_f32_16x16x32_bf16 v[0:3], v[192:195], a[224:227], v[0:3]
v_cvt_pk_bf16_f32 v83, v86, v87
v_accvgpr_read_b32 v88, a184
v_accvgpr_read_b32 v89, a185
v_mfma_f32_16x16x32_bf16 v[8:11], v[192:195], a[228:231], v[8:11]
ds_read_b128 a[248:251], v238 offset:51200
ds_read_b128 a[252:255], v238 offset:52224
v_accvgpr_read_b32 v90, a186
v_accvgpr_read_b32 v91, a187
v_mfma_f32_16x16x32_bf16 v[4:7], v[196:199], a[224:227], v[4:7]
ds_read_b128 v[184:187], v233 offset:16384
v_accvgpr_read_b32 v92, a188
v_accvgpr_read_b32 v93, a189
v_mfma_f32_16x16x32_bf16 v[12:15], v[196:199], a[228:231], v[12:15]
ds_read_b128 v[188:191], v233 offset:18432
v_accvgpr_read_b32 v94, a190
v_accvgpr_read_b32 v95, a191
v_mul_f32 v88, v88, v249
s_waitcnt lgkmcnt(8)
v_mfma_f32_16x16x32_bf16 v[0:3], v[200:203], a[232:235], v[0:3]
v_mul_f32 v89, v89, v249
v_mul_f32 v90, v90, v249
v_mul_f32 v91, v91, v249
v_mfma_f32_16x16x32_bf16 v[8:11], v[200:203], a[236:239], v[8:11]
v_mul_f32 v92, v92, v249
v_mul_f32 v93, v93, v249
v_mul_f32 v94, v94, v249
v_mul_f32 v95, v95, v249
v_mfma_f32_16x16x32_bf16 v[4:7], v[204:207], a[232:235], v[4:7]
v_cvt_pk_bf16_f32 v88, v88, v89
v_cvt_pk_bf16_f32 v89, v90, v91
v_cvt_pk_bf16_f32 v90, v92, v93
v_mfma_f32_16x16x32_bf16 v[12:15], v[204:207], a[236:239], v[12:15]
s_add_u32 s53, s49, 139264
v_add_u32 v232, s53, v231
v_cvt_pk_bf16_f32 v91, v94, v95
v_accvgpr_read_b32 v96, a192
s_waitcnt lgkmcnt(4)
v_mfma_f32_16x16x32_bf16 v[0:3], v[176:179], a[240:243], v[0:3]
v_xor_b32 v233, 64, v232
v_accvgpr_read_b32 v97, a193
v_accvgpr_read_b32 v98, a194
v_accvgpr_read_b32 v99, a195
v_mfma_f32_16x16x32_bf16 v[8:11], v[176:179], a[244:247], v[8:11]
v_accvgpr_read_b32 v100, a196
v_accvgpr_read_b32 v101, a197
v_accvgpr_read_b32 v102, a198
s_waitcnt vmcnt(12) lgkmcnt(0)
s_barrier
ds_read_b128 v[192:195], v232 offset:0
ds_read_b128 v[196:199], v232 offset:2048
ds_read_b128 v[200:203], v233 offset:0
v_mfma_f32_16x16x32_bf16 v[4:7], v[180:183], a[240:243], v[4:7]
v_accvgpr_read_b32 v103, a199
v_mul_f32 v96, v96, v248
v_mul_f32 v97, v97, v248
v_mfma_f32_16x16x32_bf16 v[12:15], v[180:183], a[244:247], v[12:15]
ds_read_b128 v[204:207], v233 offset:2048
v_mul_f32 v98, v98, v248
v_mul_f32 v99, v99, v248
v_mfma_f32_16x16x32_bf16 v[0:3], v[184:187], a[248:251], v[0:3]
v_mul_f32 v100, v100, v248
v_mul_f32 v101, v101, v248
v_mul_f32 v102, v102, v248
v_mfma_f32_16x16x32_bf16 v[8:11], v[184:187], a[252:255], v[8:11]
ds_read_b128 v[176:179], v232 offset:8192
v_mul_f32 v103, v103, v248
v_cvt_pk_bf16_f32 v96, v96, v97
v_mfma_f32_16x16x32_bf16 v[4:7], v[188:191], a[248:251], v[4:7]
v_cvt_pk_bf16_f32 v97, v98, v99
v_cvt_pk_bf16_f32 v98, v100, v101
v_cvt_pk_bf16_f32 v99, v102, v103
v_mfma_f32_16x16x32_bf16 v[12:15], v[188:191], a[252:255], v[12:15]
ds_read_b128 v[180:183], v232 offset:10240
v_accvgpr_read_b32 v104, a200
v_accvgpr_read_b32 v105, a201
s_waitcnt lgkmcnt(4)
v_mfma_f32_16x16x32_bf16 v[16:19], v[192:195], a[208:211], 0
v_accvgpr_read_b32 v106, a202
v_accvgpr_read_b32 v107, a203
v_accvgpr_read_b32 v108, a204
v_accvgpr_read_b32 v109, a205
v_mfma_f32_16x16x32_bf16 v[24:27], v[192:195], a[212:215], 0
ds_read_b128 v[184:187], v233 offset:8192
v_accvgpr_read_b32 v110, a206
v_accvgpr_read_b32 v111, a207
v_mfma_f32_16x16x32_bf16 v[20:23], v[196:199], a[208:211], 0
s_add_u32 s52, s71, 0
s_add_u32 m0, s48, 114688
v_mul_f32 v104, v104, v249
v_mul_f32 v105, v105, v249
v_mul_f32 v106, v106, v249
v_mfma_f32_16x16x32_bf16 v[28:31], v[196:199], a[212:215], 0
ds_read_b128 v[188:191], v233 offset:10240
buffer_load_dwordx4 v228, s[36:39], s52 offen lds
s_waitcnt lgkmcnt(4)
v_mfma_f32_16x16x32_bf16 v[16:19], v[200:203], a[216:219], v[16:19]
v_mul_f32 v107, v107, v249
v_mul_f32 v108, v108, v249
v_mul_f32 v109, v109, v249
v_mul_f32 v110, v110, v249
v_mfma_f32_16x16x32_bf16 v[24:27], v[200:203], a[220:223], v[24:27]
ds_read_b128 v[192:195], v232 offset:16384
buffer_load_dwordx4 v229, s[36:39], s52 offen offset:1024 lds
v_mfma_f32_16x16x32_bf16 v[20:23], v[204:207], a[216:219], v[20:23]
v_mul_f32 v111, v111, v249
v_cvt_pk_bf16_f32 v104, v104, v105
v_cvt_pk_bf16_f32 v105, v106, v107
v_cvt_pk_bf16_f32 v106, v108, v109
v_mfma_f32_16x16x32_bf16 v[28:31], v[204:207], a[220:223], v[28:31]
ds_read_b128 v[196:199], v232 offset:18432
s_add_u32 s52, s71, 81920
s_add_u32 m0, s48, 122880
v_cvt_pk_bf16_f32 v107, v110, v111
s_waitcnt lgkmcnt(4)
v_mfma_f32_16x16x32_bf16 v[16:19], v[176:179], a[224:227], v[16:19]
buffer_load_dwordx4 v228, s[36:39], s52 offen lds
v_max3_f32 v240, v0, v1, v2
v_max3_f32 v241, v8, v9, v10
v_mfma_f32_16x16x32_bf16 v[24:27], v[176:179], a[228:231], v[24:27]
ds_read_b128 v[200:203], v233 offset:16384
v_max3_f32 v240, v240, v3, v4
v_max3_f32 v241, v241, v11, v12
v_mfma_f32_16x16x32_bf16 v[20:23], v[180:183], a[224:227], v[20:23]
v_max3_f32 v240, v240, v5, v6
v_max3_f32 v241, v241, v13, v14
v_max_f32 v240, v240, v7
v_max_f32 v241, v241, v15
v_mfma_f32_16x16x32_bf16 v[28:31], v[180:183], a[228:231], v[28:31]
ds_read_b128 v[204:207], v233 offset:18432
buffer_load_dwordx4 v229, s[36:39], s52 offen offset:1024 lds
ds_write_b64 v251, v[64:65] offset:0
ds_write_b64 v251, v[66:67] offset:512
ds_write_b64 v251, v[72:73] offset:1024
ds_write_b64 v251, v[74:75] offset:1536
ds_write_b64 v251, v[80:81] offset:8192
ds_write_b64 v251, v[82:83] offset:8704
ds_write_b64 v251, v[88:89] offset:9216
ds_write_b64 v251, v[90:91] offset:9728
ds_write_b64 v251, v[96:97] offset:16384
ds_write_b64 v251, v[98:99] offset:16896
ds_write_b64 v251, v[104:105] offset:17408
ds_write_b64 v251, v[106:107] offset:17920
s_waitcnt lgkmcnt(15)
v_mfma_f32_16x16x32_bf16 v[16:19], v[184:187], a[232:235], v[16:19]
v_mfma_f32_16x16x32_bf16 v[24:27], v[184:187], a[236:239], v[24:27]
s_add_u32 s52, s71, 163840
s_add_u32 m0, s48, 131072
v_mfma_f32_16x16x32_bf16 v[20:23], v[188:191], a[232:235], v[20:23]
buffer_load_dwordx4 v228, s[36:39], s52 offen lds
v_mfma_f32_16x16x32_bf16 v[28:31], v[188:191], a[236:239], v[28:31]
v_add_u32 v236, 65536, v230
v_xor_b32 v237, 32, v236
s_waitcnt lgkmcnt(14)
v_mfma_f32_16x16x32_bf16 v[16:19], v[192:195], a[240:243], v[16:19]
v_mfma_f32_16x16x32_bf16 v[24:27], v[192:195], a[244:247], v[24:27]
buffer_load_dwordx4 v229, s[36:39], s52 offen offset:1024 lds
s_waitcnt vmcnt(12) lgkmcnt(0)
s_barrier
ds_read_b128 a[160:163], v238 offset:0
ds_read_b128 a[164:167], v238 offset:1024
ds_read_b64_tr_b16 v[176:177], v236 offset:0
ds_read_b64_tr_b16 v[178:179], v237 offset:512
ds_read_b64_tr_b16 v[180:181], v237 offset:0
ds_read_b64_tr_b16 v[182:183], v236 offset:512
ds_read_b128 a[168:171], v238 offset:2048
ds_read_b128 a[172:175], v238 offset:3072
ds_read_b64_tr_b16 v[184:185], v236 offset:4096
ds_read_b64_tr_b16 v[186:187], v237 offset:4608
v_mfma_f32_16x16x32_bf16 v[20:23], v[196:199], a[240:243], v[20:23]
s_mov_b32 s52, 1646592
s_add_u32 m0, s48, 139264
s_nop 0
buffer_load_dwordx4 v224, s[24:27], s52 offen nt lds
v_mfma_f32_16x16x32_bf16 v[28:31], v[196:199], a[244:247], v[28:31]
ds_read_b64_tr_b16 v[188:189], v237 offset:4096
v_mfma_f32_16x16x32_bf16 v[16:19], v[200:203], a[248:251], v[16:19]
ds_read_b64_tr_b16 v[190:191], v236 offset:4608
buffer_load_dwordx4 v225, s[24:27], s52 offen offset:1024 nt lds
v_mfma_f32_16x16x32_bf16 v[24:27], v[200:203], a[252:255], v[24:27]
ds_read_b128 a[176:179], v238 offset:8192
ds_read_b128 a[180:183], v238 offset:9216
s_add_u32 m0, s48, 147328
v_mfma_f32_16x16x32_bf16 v[20:23], v[204:207], a[248:251], v[20:23]
ds_read_b64_tr_b16 v[192:193], v236 offset:8192
ds_read_b64_tr_b16 v[194:195], v237 offset:8704
buffer_load_dwordx4 v224, s[24:27], s52 offen offset:128 nt lds
v_mfma_f32_16x16x32_bf16 v[28:31], v[204:207], a[252:255], v[28:31]
ds_read_b64_tr_b16 v[196:197], v237 offset:8192
s_waitcnt lgkmcnt(11)
v_mfma_f32_16x16x32_bf16 a[0:3], v[176:179], a[160:163], 0
ds_read_b64_tr_b16 v[198:199], v236 offset:8704
buffer_load_dwordx4 v225, s[24:27], s52 offen offset:1152 nt lds
v_mfma_f32_16x16x32_bf16 a[8:11], v[176:179], a[164:167], 0
ds_read_b128 a[184:187], v238 offset:10240
ds_read_b128 a[188:191], v238 offset:11264
s_add_u32 m0, s48, 155392
v_mfma_f32_16x16x32_bf16 a[4:7], v[180:183], a[160:163], 0
ds_read_b64_tr_b16 v[200:201], v236 offset:12288
ds_read_b64_tr_b16 v[202:203], v237 offset:12800
buffer_load_dwordx4 v224, s[24:27], s52 offen offset:256 nt lds
v_mfma_f32_16x16x32_bf16 a[12:15], v[180:183], a[164:167], 0
ds_read_b64_tr_b16 v[204:205], v237 offset:12288
v_max3_f32 v240, v240, v16, v17
s_waitcnt lgkmcnt(11)
v_mfma_f32_16x16x32_bf16 a[0:3], v[184:187], a[168:171], a[0:3]
ds_read_b64_tr_b16 v[206:207], v236 offset:12800
v_max3_f32 v241, v241, v24, v25
v_mfma_f32_16x16x32_bf16 a[8:11], v[184:187], a[172:175], a[8:11]
ds_read_b128 a[192:195], v238 offset:16384
ds_read_b128 a[196:199], v238 offset:17408
buffer_load_dwordx4 v225, s[24:27], s52 offen offset:1280 nt lds
v_mfma_f32_16x16x32_bf16 a[4:7], v[188:191], a[168:171], a[4:7]
ds_read_b64_tr_b16 v[176:177], v236 offset:16384
ds_read_b64_tr_b16 v[178:179], v237 offset:16896
v_mfma_f32_16x16x32_bf16 a[12:15], v[188:191], a[172:175], a[12:15]
ds_read_b64_tr_b16 v[180:181], v237 offset:16384
v_max3_f32 v240, v240, v18, v19
s_waitcnt lgkmcnt(11)
v_mfma_f32_16x16x32_bf16 a[0:3], v[192:195], a[176:179], a[0:3]
ds_read_b64_tr_b16 v[182:183], v236 offset:16896
v_max3_f32 v241, v241, v26, v27
v_mfma_f32_16x16x32_bf16 a[8:11], v[192:195], a[180:183], a[8:11]
ds_read_b128 a[200:203], v238 offset:18432
ds_read_b128 a[204:207], v238 offset:19456
v_mfma_f32_16x16x32_bf16 a[4:7], v[196:199], a[176:179], a[4:7]
ds_read_b64_tr_b16 v[184:185], v236 offset:20480
ds_read_b64_tr_b16 v[186:187], v237 offset:20992
v_mfma_f32_16x16x32_bf16 a[12:15], v[196:199], a[180:183], a[12:15]
ds_read_b64_tr_b16 v[188:189], v237 offset:20480
v_max3_f32 v240, v240, v20, v21
s_waitcnt lgkmcnt(11)
v_mfma_f32_16x16x32_bf16 a[0:3], v[200:203], a[184:187], a[0:3]
ds_read_b64_tr_b16 v[190:191], v236 offset:20992
v_max3_f32 v241, v241, v28, v29
v_mfma_f32_16x16x32_bf16 a[8:11], v[200:203], a[188:191], a[8:11]
v_max3_f32 v240, v240, v22, v23
v_max3_f32 v241, v241, v30, v31
v_mfma_f32_16x16x32_bf16 a[4:7], v[204:207], a[184:187], a[4:7]
v_mfma_f32_16x16x32_bf16 a[12:15], v[204:207], a[188:191], a[12:15]
s_add_u32 s53, s49, 90112
v_add_u32 v232, s53, v231
s_waitcnt lgkmcnt(6)
v_mfma_f32_16x16x32_bf16 a[0:3], v[176:179], a[192:195], a[0:3]
v_xor_b32 v233, 64, v232
v_mfma_f32_16x16x32_bf16 a[8:11], v[176:179], a[196:199], a[8:11]
s_waitcnt vmcnt(12) lgkmcnt(0)
s_barrier
ds_read_b128 v[192:195], v232 offset:0
ds_read_b128 v[196:199], v232 offset:2048
ds_read_b128 v[200:203], v233 offset:0
v_mfma_f32_16x16x32_bf16 a[4:7], v[180:183], a[192:195], a[4:7]
v_mfma_f32_16x16x32_bf16 a[12:15], v[180:183], a[196:199], a[12:15]
ds_read_b128 v[204:207], v233 offset:2048
v_mfma_f32_16x16x32_bf16 a[0:3], v[184:187], a[200:203], a[0:3]
v_mfma_f32_16x16x32_bf16 a[8:11], v[184:187], a[204:207], a[8:11]
ds_read_b128 v[176:179], v232 offset:8192
v_mfma_f32_16x16x32_bf16 a[4:7], v[188:191], a[200:203], a[4:7]
v_mfma_f32_16x16x32_bf16 a[12:15], v[188:191], a[204:207], a[12:15]
ds_read_b128 v[180:183], v232 offset:10240
s_waitcnt lgkmcnt(4)
v_mfma_f32_16x16x32_bf16 v[32:35], v[192:195], a[208:211], 0
v_mfma_f32_16x16x32_bf16 v[40:43], v[192:195], a[212:215], 0
ds_read_b128 v[184:187], v233 offset:8192
v_mfma_f32_16x16x32_bf16 v[36:39], v[196:199], a[208:211], 0
s_add_u32 s52, s72, 0
s_add_u32 m0, s48, 65536
v_mfma_f32_16x16x32_bf16 v[44:47], v[196:199], a[212:215], 0
ds_read_b128 v[188:191], v233 offset:10240
buffer_load_dwordx4 v228, s[36:39], s52 offen lds
s_waitcnt lgkmcnt(4)
v_mfma_f32_16x16x32_bf16 v[32:35], v[200:203], a[216:219], v[32:35]
v_mfma_f32_16x16x32_bf16 v[40:43], v[200:203], a[220:223], v[40:43]
ds_read_b128 v[192:195], v232 offset:16384
buffer_load_dwordx4 v229, s[36:39], s52 offen offset:1024 lds
v_mfma_f32_16x16x32_bf16 v[36:39], v[204:207], a[216:219], v[36:39]
v_mfma_f32_16x16x32_bf16 v[44:47], v[204:207], a[220:223], v[44:47]
ds_read_b128 v[196:199], v232 offset:18432
s_add_u32 s52, s72, 81920
s_add_u32 m0, s48, 73728
s_waitcnt lgkmcnt(4)
v_mfma_f32_16x16x32_bf16 v[32:35], v[176:179], a[224:227], v[32:35]
buffer_load_dwordx4 v228, s[36:39], s52 offen lds
v_mfma_f32_16x16x32_bf16 v[40:43], v[176:179], a[228:231], v[40:43]
ds_read_b128 v[200:203], v233 offset:16384
v_mfma_f32_16x16x32_bf16 v[36:39], v[180:183], a[224:227], v[36:39]
v_mfma_f32_16x16x32_bf16 v[44:47], v[180:183], a[228:231], v[44:47]
ds_read_b128 v[204:207], v233 offset:18432
buffer_load_dwordx4 v229, s[36:39], s52 offen offset:1024 lds
s_waitcnt lgkmcnt(4)
v_mfma_f32_16x16x32_bf16 v[32:35], v[184:187], a[232:235], v[32:35]
v_mfma_f32_16x16x32_bf16 v[40:43], v[184:187], a[236:239], v[40:43]
s_add_u32 s52, s72, 163840
s_add_u32 m0, s48, 81920
v_mfma_f32_16x16x32_bf16 v[36:39], v[188:191], a[232:235], v[36:39]
buffer_load_dwordx4 v228, s[36:39], s52 offen lds
v_mfma_f32_16x16x32_bf16 v[44:47], v[188:191], a[236:239], v[44:47]
v_add_u32 v236, 114688, v230
v_xor_b32 v237, 32, v236
s_waitcnt lgkmcnt(2)
v_mfma_f32_16x16x32_bf16 v[32:35], v[192:195], a[240:243], v[32:35]
v_mfma_f32_16x16x32_bf16 v[40:43], v[192:195], a[244:247], v[40:43]
buffer_load_dwordx4 v229, s[36:39], s52 offen offset:1024 lds
s_waitcnt vmcnt(12) lgkmcnt(0)
s_barrier
ds_read_b64_tr_b16 v[176:177], v236 offset:0
ds_read_b64_tr_b16 v[178:179], v237 offset:512
ds_read_b64_tr_b16 v[180:181], v237 offset:0
ds_read_b64_tr_b16 v[182:183], v236 offset:512
ds_read_b64_tr_b16 v[184:185], v236 offset:4096
ds_read_b64_tr_b16 v[186:187], v237 offset:4608
v_mfma_f32_16x16x32_bf16 v[36:39], v[196:199], a[240:243], v[36:39]
s_mov_b32 s52, 1671168
s_add_u32 m0, s48, 90112
s_nop 0
buffer_load_dwordx4 v224, s[24:27], s52 offen nt lds
v_mfma_f32_16x16x32_bf16 v[44:47], v[196:199], a[244:247], v[44:47]
ds_read_b64_tr_b16 v[188:189], v237 offset:4096
v_mfma_f32_16x16x32_bf16 v[32:35], v[200:203], a[248:251], v[32:35]
ds_read_b64_tr_b16 v[190:191], v236 offset:4608
buffer_load_dwordx4 v225, s[24:27], s52 offen offset:1024 nt lds
v_mfma_f32_16x16x32_bf16 v[40:43], v[200:203], a[252:255], v[40:43]
ds_read_b64_tr_b16 v[192:193], v236 offset:8192
s_add_u32 m0, s48, 98176
v_mfma_f32_16x16x32_bf16 v[36:39], v[204:207], a[248:251], v[36:39]
ds_read_b64_tr_b16 v[194:195], v237 offset:8704
buffer_load_dwordx4 v224, s[24:27], s52 offen offset:128 nt lds
v_mfma_f32_16x16x32_bf16 v[44:47], v[204:207], a[252:255], v[44:47]
ds_read_b64_tr_b16 v[196:197], v237 offset:8192
s_waitcnt lgkmcnt(7)
v_mfma_f32_16x16x32_bf16 a[16:19], v[176:179], a[160:163], 0
ds_read_b64_tr_b16 v[198:199], v236 offset:8704
buffer_load_dwordx4 v225, s[24:27], s52 offen offset:1152 nt lds
v_mfma_f32_16x16x32_bf16 a[24:27], v[176:179], a[164:167], 0
ds_read_b64_tr_b16 v[200:201], v236 offset:12288
s_add_u32 m0, s48, 106240
v_mfma_f32_16x16x32_bf16 a[20:23], v[180:183], a[160:163], 0
ds_read_b64_tr_b16 v[202:203], v237 offset:12800
buffer_load_dwordx4 v224, s[24:27], s52 offen offset:256 nt lds
v_mfma_f32_16x16x32_bf16 a[28:31], v[180:183], a[164:167], 0
ds_read_b64_tr_b16 v[204:205], v237 offset:12288
v_max3_f32 v240, v240, v32, v33
s_waitcnt lgkmcnt(7)
v_mfma_f32_16x16x32_bf16 a[16:19], v[184:187], a[168:171], a[16:19]
ds_read_b64_tr_b16 v[206:207], v236 offset:12800
v_max3_f32 v241, v241, v40, v41
v_mfma_f32_16x16x32_bf16 a[24:27], v[184:187], a[172:175], a[24:27]
ds_read_b64_tr_b16 v[176:177], v236 offset:16384
buffer_load_dwordx4 v225, s[24:27], s52 offen offset:1280 nt lds
v_mfma_f32_16x16x32_bf16 a[20:23], v[188:191], a[168:171], a[20:23]
ds_read_b64_tr_b16 v[178:179], v237 offset:16896
v_max3_f32 v240, v240, v34, v35
v_mfma_f32_16x16x32_bf16 a[28:31], v[188:191], a[172:175], a[28:31]
ds_read_b64_tr_b16 v[180:181], v237 offset:16384
v_max3_f32 v241, v241, v42, v43
s_waitcnt lgkmcnt(7)
v_mfma_f32_16x16x32_bf16 a[16:19], v[192:195], a[176:179], a[16:19]
ds_read_b64_tr_b16 v[182:183], v236 offset:16896
v_max3_f32 v240, v240, v36, v37
v_mfma_f32_16x16x32_bf16 a[24:27], v[192:195], a[180:183], a[24:27]
ds_read_b64_tr_b16 v[184:185], v236 offset:20480
v_max3_f32 v241, v241, v44, v45
v_mfma_f32_16x16x32_bf16 a[20:23], v[196:199], a[176:179], a[20:23]
ds_read_b64_tr_b16 v[186:187], v237 offset:20992
v_max3_f32 v240, v240, v38, v39
v_mfma_f32_16x16x32_bf16 a[28:31], v[196:199], a[180:183], a[28:31]
ds_read_b64_tr_b16 v[188:189], v237 offset:20480
v_max3_f32 v241, v241, v46, v47
s_waitcnt lgkmcnt(7)
v_mfma_f32_16x16x32_bf16 a[16:19], v[200:203], a[184:187], a[16:19]
ds_read_b64_tr_b16 v[190:191], v236 offset:20992
v_mfma_f32_16x16x32_bf16 a[24:27], v[200:203], a[188:191], a[24:27]
v_mfma_f32_16x16x32_bf16 a[20:23], v[204:207], a[184:187], a[20:23]
v_mfma_f32_16x16x32_bf16 a[28:31], v[204:207], a[188:191], a[28:31]
s_add_u32 s53, s49, 139264
v_add_u32 v232, s53, v231
s_waitcnt lgkmcnt(4)
v_mfma_f32_16x16x32_bf16 a[16:19], v[176:179], a[192:195], a[16:19]
v_xor_b32 v233, 64, v232
v_mfma_f32_16x16x32_bf16 a[24:27], v[176:179], a[196:199], a[24:27]
s_waitcnt vmcnt(12) lgkmcnt(0)
s_barrier
ds_read_b128 v[192:195], v232 offset:0
ds_read_b128 v[196:199], v232 offset:2048
ds_read_b128 v[200:203], v233 offset:0
v_mfma_f32_16x16x32_bf16 a[20:23], v[180:183], a[192:195], a[20:23]
v_mfma_f32_16x16x32_bf16 a[28:31], v[180:183], a[196:199], a[28:31]
ds_read_b128 v[204:207], v233 offset:2048
v_mfma_f32_16x16x32_bf16 a[16:19], v[184:187], a[200:203], a[16:19]
v_mfma_f32_16x16x32_bf16 a[24:27], v[184:187], a[204:207], a[24:27]
ds_read_b128 v[176:179], v232 offset:8192
v_mfma_f32_16x16x32_bf16 a[20:23], v[188:191], a[200:203], a[20:23]
v_mfma_f32_16x16x32_bf16 a[28:31], v[188:191], a[204:207], a[28:31]
ds_read_b128 v[180:183], v232 offset:10240
s_waitcnt lgkmcnt(4)
v_mfma_f32_16x16x32_bf16 v[48:51], v[192:195], a[208:211], 0
v_mfma_f32_16x16x32_bf16 v[56:59], v[192:195], a[212:215], 0
ds_read_b128 v[184:187], v233 offset:8192
v_mfma_f32_16x16x32_bf16 v[52:55], v[196:199], a[208:211], 0
s_add_u32 s52, s73, 0
s_add_u32 m0, s48, 114688
v_mfma_f32_16x16x32_bf16 v[60:63], v[196:199], a[212:215], 0
ds_read_b128 v[188:191], v233 offset:10240
buffer_load_dwordx4 v228, s[36:39], s52 offen lds
s_waitcnt lgkmcnt(4)
v_mfma_f32_16x16x32_bf16 v[48:51], v[200:203], a[216:219], v[48:51]
v_mfma_f32_16x16x32_bf16 v[56:59], v[200:203], a[220:223], v[56:59]
ds_read_b128 v[192:195], v232 offset:16384
buffer_load_dwordx4 v229, s[36:39], s52 offen offset:1024 lds
v_mfma_f32_16x16x32_bf16 v[52:55], v[204:207], a[216:219], v[52:55]
v_mfma_f32_16x16x32_bf16 v[60:63], v[204:207], a[220:223], v[60:63]
ds_read_b128 v[196:199], v232 offset:18432
s_add_u32 s52, s73, 81920
s_add_u32 m0, s48, 122880
s_waitcnt lgkmcnt(4)
v_mfma_f32_16x16x32_bf16 v[48:51], v[176:179], a[224:227], v[48:51]
buffer_load_dwordx4 v228, s[36:39], s52 offen lds
v_mfma_f32_16x16x32_bf16 v[56:59], v[176:179], a[228:231], v[56:59]
ds_read_b128 v[200:203], v233 offset:16384
v_mfma_f32_16x16x32_bf16 v[52:55], v[180:183], a[224:227], v[52:55]
v_mfma_f32_16x16x32_bf16 v[60:63], v[180:183], a[228:231], v[60:63]
ds_read_b128 v[204:207], v233 offset:18432
buffer_load_dwordx4 v229, s[36:39], s52 offen offset:1024 lds
s_waitcnt lgkmcnt(4)
v_mfma_f32_16x16x32_bf16 v[48:51], v[184:187], a[232:235], v[48:51]
v_mfma_f32_16x16x32_bf16 v[56:59], v[184:187], a[236:239], v[56:59]
s_add_u32 s52, s73, 163840
s_add_u32 m0, s48, 131072
v_mfma_f32_16x16x32_bf16 v[52:55], v[188:191], a[232:235], v[52:55]
buffer_load_dwordx4 v228, s[36:39], s52 offen lds
v_mfma_f32_16x16x32_bf16 v[60:63], v[188:191], a[236:239], v[60:63]
v_add_u32 v236, 65536, v230
v_xor_b32 v237, 32, v236
s_waitcnt lgkmcnt(2)
v_mfma_f32_16x16x32_bf16 v[48:51], v[192:195], a[240:243], v[48:51]
v_mfma_f32_16x16x32_bf16 v[56:59], v[192:195], a[244:247], v[56:59]
buffer_load_dwordx4 v229, s[36:39], s52 offen offset:1024 lds
s_waitcnt vmcnt(12) lgkmcnt(0)
s_barrier
ds_read_b64_tr_b16 v[176:177], v236 offset:0
ds_read_b64_tr_b16 v[178:179], v237 offset:512
ds_read_b64_tr_b16 v[180:181], v237 offset:0
ds_read_b64_tr_b16 v[182:183], v236 offset:512
ds_read_b64_tr_b16 v[184:185], v236 offset:4096
ds_read_b64_tr_b16 v[186:187], v237 offset:4608
v_mfma_f32_16x16x32_bf16 v[52:55], v[196:199], a[240:243], v[52:55]
s_mov_b32 s52, 1695744
s_add_u32 m0, s48, 139264
s_nop 0
buffer_load_dwordx4 v224, s[24:27], s52 offen nt lds
v_mfma_f32_16x16x32_bf16 v[60:63], v[196:199], a[244:247], v[60:63]
ds_read_b64_tr_b16 v[188:189], v237 offset:4096
v_mfma_f32_16x16x32_bf16 v[48:51], v[200:203], a[248:251], v[48:51]
ds_read_b64_tr_b16 v[190:191], v236 offset:4608
buffer_load_dwordx4 v225, s[24:27], s52 offen offset:1024 nt lds
v_mfma_f32_16x16x32_bf16 v[56:59], v[200:203], a[252:255], v[56:59]
ds_read_b64_tr_b16 v[192:193], v236 offset:8192
s_add_u32 m0, s48, 147328
v_mfma_f32_16x16x32_bf16 v[52:55], v[204:207], a[248:251], v[52:55]
ds_read_b64_tr_b16 v[194:195], v237 offset:8704
buffer_load_dwordx4 v224, s[24:27], s52 offen offset:128 nt lds
v_mfma_f32_16x16x32_bf16 v[60:63], v[204:207], a[252:255], v[60:63]
ds_read_b64_tr_b16 v[196:197], v237 offset:8192
s_waitcnt lgkmcnt(7)
v_mfma_f32_16x16x32_bf16 a[32:35], v[176:179], a[160:163], 0
ds_read_b64_tr_b16 v[198:199], v236 offset:8704
buffer_load_dwordx4 v225, s[24:27], s52 offen offset:1152 nt lds
v_mfma_f32_16x16x32_bf16 a[40:43], v[176:179], a[164:167], 0
ds_read_b64_tr_b16 v[200:201], v236 offset:12288
s_add_u32 m0, s48, 155392
v_mfma_f32_16x16x32_bf16 a[36:39], v[180:183], a[160:163], 0
ds_read_b64_tr_b16 v[202:203], v237 offset:12800
buffer_load_dwordx4 v224, s[24:27], s52 offen offset:256 nt lds
v_mfma_f32_16x16x32_bf16 a[44:47], v[180:183], a[164:167], 0
ds_read_b64_tr_b16 v[204:205], v237 offset:12288
v_max3_f32 v240, v240, v48, v49
s_waitcnt lgkmcnt(7)
v_mfma_f32_16x16x32_bf16 a[32:35], v[184:187], a[168:171], a[32:35]
ds_read_b64_tr_b16 v[206:207], v236 offset:12800
v_max3_f32 v241, v241, v56, v57
v_mfma_f32_16x16x32_bf16 a[40:43], v[184:187], a[172:175], a[40:43]
ds_read_b64_tr_b16 v[176:177], v236 offset:16384
buffer_load_dwordx4 v225, s[24:27], s52 offen offset:1280 nt lds
v_mfma_f32_16x16x32_bf16 a[36:39], v[188:191], a[168:171], a[36:39]
ds_read_b64_tr_b16 v[178:179], v237 offset:16896
v_max3_f32 v240, v240, v50, v51
v_mfma_f32_16x16x32_bf16 a[44:47], v[188:191], a[172:175], a[44:47]
ds_read_b64_tr_b16 v[180:181], v237 offset:16384
v_max3_f32 v241, v241, v58, v59
s_waitcnt lgkmcnt(7)
v_mfma_f32_16x16x32_bf16 a[32:35], v[192:195], a[176:179], a[32:35]
ds_read_b64_tr_b16 v[182:183], v236 offset:16896
v_max3_f32 v240, v240, v52, v53
v_mfma_f32_16x16x32_bf16 a[40:43], v[192:195], a[180:183], a[40:43]
ds_read_b64_tr_b16 v[184:185], v236 offset:20480
v_max3_f32 v241, v241, v60, v61
v_mfma_f32_16x16x32_bf16 a[36:39], v[196:199], a[176:179], a[36:39]
ds_read_b64_tr_b16 v[186:187], v237 offset:20992
v_max3_f32 v240, v240, v54, v55
v_mfma_f32_16x16x32_bf16 a[44:47], v[196:199], a[180:183], a[44:47]
ds_read_b64_tr_b16 v[188:189], v237 offset:20480
v_max3_f32 v241, v241, v62, v63
s_waitcnt lgkmcnt(7)
v_mfma_f32_16x16x32_bf16 a[32:35], v[200:203], a[184:187], a[32:35]
ds_read_b64_tr_b16 v[190:191], v236 offset:20992
v_mfma_f32_16x16x32_bf16 a[40:43], v[200:203], a[188:191], a[40:43]
v_mfma_f32_16x16x32_bf16 a[36:39], v[204:207], a[184:187], a[36:39]
v_mfma_f32_16x16x32_bf16 a[44:47], v[204:207], a[188:191], a[44:47]
s_add_u32 s53, s49, 90112
v_add_u32 v232, s53, v231
s_waitcnt lgkmcnt(4)
v_mfma_f32_16x16x32_bf16 a[32:35], v[176:179], a[192:195], a[32:35]
v_xor_b32 v233, 64, v232
v_mfma_f32_16x16x32_bf16 a[40:43], v[176:179], a[196:199], a[40:43]
s_waitcnt vmcnt(12) lgkmcnt(0)
s_barrier
ds_read_b128 v[192:195], v232 offset:0
ds_read_b128 v[196:199], v232 offset:2048
ds_read_b128 v[200:203], v233 offset:0
v_mfma_f32_16x16x32_bf16 a[36:39], v[180:183], a[192:195], a[36:39]
v_mfma_f32_16x16x32_bf16 a[44:47], v[180:183], a[196:199], a[44:47]
ds_read_b128 v[204:207], v233 offset:2048
v_mfma_f32_16x16x32_bf16 a[32:35], v[184:187], a[200:203], a[32:35]
v_mfma_f32_16x16x32_bf16 a[40:43], v[184:187], a[204:207], a[40:43]
ds_read_b128 v[176:179], v232 offset:8192
v_mfma_f32_16x16x32_bf16 a[36:39], v[188:191], a[200:203], a[36:39]
v_mfma_f32_16x16x32_bf16 a[44:47], v[188:191], a[204:207], a[44:47]
ds_read_b128 v[180:183], v232 offset:10240
s_waitcnt lgkmcnt(4)
v_mfma_f32_16x16x32_bf16 v[64:67], v[192:195], a[208:211], 0
v_mfma_f32_16x16x32_bf16 v[72:75], v[192:195], a[212:215], 0
ds_read_b128 v[184:187], v233 offset:8192
v_mfma_f32_16x16x32_bf16 v[68:71], v[196:199], a[208:211], 0
s_add_u32 s52, s74, 0
s_add_u32 m0, s48, 65536
v_mfma_f32_16x16x32_bf16 v[76:79], v[196:199], a[212:215], 0
ds_read_b128 v[188:191], v233 offset:10240
buffer_load_dwordx4 v228, s[36:39], s52 offen lds
s_waitcnt lgkmcnt(4)
v_mfma_f32_16x16x32_bf16 v[64:67], v[200:203], a[216:219], v[64:67]
v_mfma_f32_16x16x32_bf16 v[72:75], v[200:203], a[220:223], v[72:75]
ds_read_b128 v[192:195], v232 offset:16384
buffer_load_dwordx4 v229, s[36:39], s52 offen offset:1024 lds
v_mfma_f32_16x16x32_bf16 v[68:71], v[204:207], a[216:219], v[68:71]
v_mfma_f32_16x16x32_bf16 v[76:79], v[204:207], a[220:223], v[76:79]
ds_read_b128 v[196:199], v232 offset:18432
s_add_u32 s52, s74, 81920
s_add_u32 m0, s48, 73728
s_waitcnt lgkmcnt(4)
v_mfma_f32_16x16x32_bf16 v[64:67], v[176:179], a[224:227], v[64:67]
buffer_load_dwordx4 v228, s[36:39], s52 offen lds
v_mfma_f32_16x16x32_bf16 v[72:75], v[176:179], a[228:231], v[72:75]
ds_read_b128 v[200:203], v233 offset:16384
v_mfma_f32_16x16x32_bf16 v[68:71], v[180:183], a[224:227], v[68:71]
v_mfma_f32_16x16x32_bf16 v[76:79], v[180:183], a[228:231], v[76:79]
ds_read_b128 v[204:207], v233 offset:18432
buffer_load_dwordx4 v229, s[36:39], s52 offen offset:1024 lds
s_waitcnt lgkmcnt(4)
v_mfma_f32_16x16x32_bf16 v[64:67], v[184:187], a[232:235], v[64:67]
v_mfma_f32_16x16x32_bf16 v[72:75], v[184:187], a[236:239], v[72:75]
s_add_u32 s52, s74, 163840
s_add_u32 m0, s48, 81920
v_mfma_f32_16x16x32_bf16 v[68:71], v[188:191], a[232:235], v[68:71]
buffer_load_dwordx4 v228, s[36:39], s52 offen lds
v_mfma_f32_16x16x32_bf16 v[76:79], v[188:191], a[236:239], v[76:79]
v_add_u32 v236, 114688, v230
v_xor_b32 v237, 32, v236
s_waitcnt lgkmcnt(2)
v_mfma_f32_16x16x32_bf16 v[64:67], v[192:195], a[240:243], v[64:67]
v_mfma_f32_16x16x32_bf16 v[72:75], v[192:195], a[244:247], v[72:75]
buffer_load_dwordx4 v229, s[36:39], s52 offen offset:1024 lds
s_waitcnt vmcnt(12) lgkmcnt(0)
s_barrier
ds_read_b64_tr_b16 v[176:177], v236 offset:0
ds_read_b64_tr_b16 v[178:179], v237 offset:512
ds_read_b64_tr_b16 v[180:181], v237 offset:0
ds_read_b64_tr_b16 v[182:183], v236 offset:512
ds_read_b64_tr_b16 v[184:185], v236 offset:4096
ds_read_b64_tr_b16 v[186:187], v237 offset:4608
v_mfma_f32_16x16x32_bf16 v[68:71], v[196:199], a[240:243], v[68:71]
s_mov_b32 s52, 1720320
s_add_u32 m0, s48, 90112
s_nop 0
buffer_load_dwordx4 v224, s[24:27], s52 offen nt lds
v_mfma_f32_16x16x32_bf16 v[76:79], v[196:199], a[244:247], v[76:79]
ds_read_b64_tr_b16 v[188:189], v237 offset:4096
v_mfma_f32_16x16x32_bf16 v[64:67], v[200:203], a[248:251], v[64:67]
ds_read_b64_tr_b16 v[190:191], v236 offset:4608
buffer_load_dwordx4 v225, s[24:27], s52 offen offset:1024 nt lds
v_mfma_f32_16x16x32_bf16 v[72:75], v[200:203], a[252:255], v[72:75]
ds_read_b64_tr_b16 v[192:193], v236 offset:8192
s_add_u32 m0, s48, 98176
v_mfma_f32_16x16x32_bf16 v[68:71], v[204:207], a[248:251], v[68:71]
ds_read_b64_tr_b16 v[194:195], v237 offset:8704
buffer_load_dwordx4 v224, s[24:27], s52 offen offset:128 nt lds
v_mfma_f32_16x16x32_bf16 v[76:79], v[204:207], a[252:255], v[76:79]
ds_read_b64_tr_b16 v[196:197], v237 offset:8192
s_waitcnt lgkmcnt(7)
v_mfma_f32_16x16x32_bf16 a[48:51], v[176:179], a[160:163], 0
ds_read_b64_tr_b16 v[198:199], v236 offset:8704
buffer_load_dwordx4 v225, s[24:27], s52 offen offset:1152 nt lds
v_mfma_f32_16x16x32_bf16 a[56:59], v[176:179], a[164:167], 0
ds_read_b64_tr_b16 v[200:201], v236 offset:12288
s_add_u32 m0, s48, 106240
v_mfma_f32_16x16x32_bf16 a[52:55], v[180:183], a[160:163], 0
ds_read_b64_tr_b16 v[202:203], v237 offset:12800
buffer_load_dwordx4 v224, s[24:27], s52 offen offset:256 nt lds
v_mfma_f32_16x16x32_bf16 a[60:63], v[180:183], a[164:167], 0
ds_read_b64_tr_b16 v[204:205], v237 offset:12288
v_max3_f32 v240, v240, v64, v65
s_waitcnt lgkmcnt(7)
v_mfma_f32_16x16x32_bf16 a[48:51], v[184:187], a[168:171], a[48:51]
ds_read_b64_tr_b16 v[206:207], v236 offset:12800
v_max3_f32 v241, v241, v72, v73
v_mfma_f32_16x16x32_bf16 a[56:59], v[184:187], a[172:175], a[56:59]
ds_read_b64_tr_b16 v[176:177], v236 offset:16384
buffer_load_dwordx4 v225, s[24:27], s52 offen offset:1280 nt lds
v_mfma_f32_16x16x32_bf16 a[52:55], v[188:191], a[168:171], a[52:55]
ds_read_b64_tr_b16 v[178:179], v237 offset:16896
v_max3_f32 v240, v240, v66, v67
v_mfma_f32_16x16x32_bf16 a[60:63], v[188:191], a[172:175], a[60:63]
ds_read_b64_tr_b16 v[180:181], v237 offset:16384
v_max3_f32 v241, v241, v74, v75
s_waitcnt lgkmcnt(7)
v_mfma_f32_16x16x32_bf16 a[48:51], v[192:195], a[176:179], a[48:51]
ds_read_b64_tr_b16 v[182:183], v236 offset:16896
v_max3_f32 v240, v240, v68, v69
v_mfma_f32_16x16x32_bf16 a[56:59], v[192:195], a[180:183], a[56:59]
ds_read_b64_tr_b16 v[184:185], v236 offset:20480
v_max3_f32 v241, v241, v76, v77
v_mfma_f32_16x16x32_bf16 a[52:55], v[196:199], a[176:179], a[52:55]
ds_read_b64_tr_b16 v[186:187], v237 offset:20992
v_max3_f32 v240, v240, v70, v71
v_mfma_f32_16x16x32_bf16 a[60:63], v[196:199], a[180:183], a[60:63]
ds_read_b64_tr_b16 v[188:189], v237 offset:20480
v_max3_f32 v241, v241, v78, v79
s_waitcnt lgkmcnt(7)
v_mfma_f32_16x16x32_bf16 a[48:51], v[200:203], a[184:187], a[48:51]
ds_read_b64_tr_b16 v[190:191], v236 offset:20992
v_mfma_f32_16x16x32_bf16 a[56:59], v[200:203], a[188:191], a[56:59]
v_mfma_f32_16x16x32_bf16 a[52:55], v[204:207], a[184:187], a[52:55]
v_mfma_f32_16x16x32_bf16 a[60:63], v[204:207], a[188:191], a[60:63]
s_add_u32 s53, s49, 139264
v_add_u32 v232, s53, v231
s_waitcnt lgkmcnt(4)
v_mfma_f32_16x16x32_bf16 a[48:51], v[176:179], a[192:195], a[48:51]
v_xor_b32 v233, 64, v232
v_mfma_f32_16x16x32_bf16 a[56:59], v[176:179], a[196:199], a[56:59]
s_waitcnt vmcnt(12) lgkmcnt(0)
s_barrier
ds_read_b128 v[192:195], v232 offset:0
ds_read_b128 v[196:199], v232 offset:2048
ds_read_b128 v[200:203], v233 offset:0
v_mfma_f32_16x16x32_bf16 a[52:55], v[180:183], a[192:195], a[52:55]
v_mfma_f32_16x16x32_bf16 a[60:63], v[180:183], a[196:199], a[60:63]
ds_read_b128 v[204:207], v233 offset:2048
v_mfma_f32_16x16x32_bf16 a[48:51], v[184:187], a[200:203], a[48:51]
v_mfma_f32_16x16x32_bf16 a[56:59], v[184:187], a[204:207], a[56:59]
ds_read_b128 v[176:179], v232 offset:8192
v_mfma_f32_16x16x32_bf16 a[52:55], v[188:191], a[200:203], a[52:55]
v_mfma_f32_16x16x32_bf16 a[60:63], v[188:191], a[204:207], a[60:63]
ds_read_b128 v[180:183], v232 offset:10240
s_waitcnt lgkmcnt(4)
v_mfma_f32_16x16x32_bf16 v[80:83], v[192:195], a[208:211], 0
v_mfma_f32_16x16x32_bf16 v[88:91], v[192:195], a[212:215], 0
ds_read_b128 v[184:187], v233 offset:8192
v_mfma_f32_16x16x32_bf16 v[84:87], v[196:199], a[208:211], 0
s_add_u32 s52, s75, 0
s_add_u32 m0, s48, 114688
v_mfma_f32_16x16x32_bf16 v[92:95], v[196:199], a[212:215], 0
ds_read_b128 v[188:191], v233 offset:10240
buffer_load_dwordx4 v228, s[36:39], s52 offen lds
s_waitcnt lgkmcnt(4)
v_mfma_f32_16x16x32_bf16 v[80:83], v[200:203], a[216:219], v[80:83]
v_mfma_f32_16x16x32_bf16 v[88:91], v[200:203], a[220:223], v[88:91]
ds_read_b128 v[192:195], v232 offset:16384
buffer_load_dwordx4 v229, s[36:39], s52 offen offset:1024 lds
v_mfma_f32_16x16x32_bf16 v[84:87], v[204:207], a[216:219], v[84:87]
v_mfma_f32_16x16x32_bf16 v[92:95], v[204:207], a[220:223], v[92:95]
ds_read_b128 v[196:199], v232 offset:18432
s_add_u32 s52, s75, 81920
s_add_u32 m0, s48, 122880
s_waitcnt lgkmcnt(4)
v_mfma_f32_16x16x32_bf16 v[80:83], v[176:179], a[224:227], v[80:83]
buffer_load_dwordx4 v228, s[36:39], s52 offen lds
v_mfma_f32_16x16x32_bf16 v[88:91], v[176:179], a[228:231], v[88:91]
ds_read_b128 v[200:203], v233 offset:16384
v_mfma_f32_16x16x32_bf16 v[84:87], v[180:183], a[224:227], v[84:87]
v_mfma_f32_16x16x32_bf16 v[92:95], v[180:183], a[228:231], v[92:95]
ds_read_b128 v[204:207], v233 offset:18432
buffer_load_dwordx4 v229, s[36:39], s52 offen offset:1024 lds
s_waitcnt lgkmcnt(4)
v_mfma_f32_16x16x32_bf16 v[80:83], v[184:187], a[232:235], v[80:83]
v_mfma_f32_16x16x32_bf16 v[88:91], v[184:187], a[236:239], v[88:91]
s_add_u32 s52, s75, 163840
s_add_u32 m0, s48, 131072
v_mfma_f32_16x16x32_bf16 v[84:87], v[188:191], a[232:235], v[84:87]
buffer_load_dwordx4 v228, s[36:39], s52 offen lds
v_mfma_f32_16x16x32_bf16 v[92:95], v[188:191], a[236:239], v[92:95]
v_add_u32 v236, 65536, v230
v_xor_b32 v237, 32, v236
s_waitcnt lgkmcnt(2)
v_mfma_f32_16x16x32_bf16 v[80:83], v[192:195], a[240:243], v[80:83]
v_mfma_f32_16x16x32_bf16 v[88:91], v[192:195], a[244:247], v[88:91]
buffer_load_dwordx4 v229, s[36:39], s52 offen offset:1024 lds
s_waitcnt vmcnt(12) lgkmcnt(0)
s_barrier
ds_read_b64_tr_b16 v[176:177], v236 offset:0
ds_read_b64_tr_b16 v[178:179], v237 offset:512
ds_read_b64_tr_b16 v[180:181], v237 offset:0
ds_read_b64_tr_b16 v[182:183], v236 offset:512
ds_read_b64_tr_b16 v[184:185], v236 offset:4096
ds_read_b64_tr_b16 v[186:187], v237 offset:4608
v_mfma_f32_16x16x32_bf16 v[84:87], v[196:199], a[240:243], v[84:87]
s_mov_b32 s52, 1744896
s_add_u32 m0, s48, 139264
s_nop 0
buffer_load_dwordx4 v224, s[24:27], s52 offen nt lds
v_mfma_f32_16x16x32_bf16 v[92:95], v[196:199], a[244:247], v[92:95]
ds_read_b64_tr_b16 v[188:189], v237 offset:4096
v_mfma_f32_16x16x32_bf16 v[80:83], v[200:203], a[248:251], v[80:83]
ds_read_b64_tr_b16 v[190:191], v236 offset:4608
buffer_load_dwordx4 v225, s[24:27], s52 offen offset:1024 nt lds
v_mfma_f32_16x16x32_bf16 v[88:91], v[200:203], a[252:255], v[88:91]
ds_read_b64_tr_b16 v[192:193], v236 offset:8192
s_add_u32 m0, s48, 147328
v_mfma_f32_16x16x32_bf16 v[84:87], v[204:207], a[248:251], v[84:87]
ds_read_b64_tr_b16 v[194:195], v237 offset:8704
buffer_load_dwordx4 v224, s[24:27], s52 offen offset:128 nt lds
v_mfma_f32_16x16x32_bf16 v[92:95], v[204:207], a[252:255], v[92:95]
ds_read_b64_tr_b16 v[196:197], v237 offset:8192
s_waitcnt lgkmcnt(7)
v_mfma_f32_16x16x32_bf16 a[64:67], v[176:179], a[160:163], 0
ds_read_b64_tr_b16 v[198:199], v236 offset:8704
buffer_load_dwordx4 v225, s[24:27], s52 offen offset:1152 nt lds
v_mfma_f32_16x16x32_bf16 a[72:75], v[176:179], a[164:167], 0
ds_read_b64_tr_b16 v[200:201], v236 offset:12288
s_add_u32 m0, s48, 155392
v_mfma_f32_16x16x32_bf16 a[68:71], v[180:183], a[160:163], 0
ds_read_b64_tr_b16 v[202:203], v237 offset:12800
buffer_load_dwordx4 v224, s[24:27], s52 offen offset:256 nt lds
v_mfma_f32_16x16x32_bf16 a[76:79], v[180:183], a[164:167], 0
ds_read_b64_tr_b16 v[204:205], v237 offset:12288
v_max3_f32 v240, v240, v80, v81
s_waitcnt lgkmcnt(7)
v_mfma_f32_16x16x32_bf16 a[64:67], v[184:187], a[168:171], a[64:67]
ds_read_b64_tr_b16 v[206:207], v236 offset:12800
v_max3_f32 v241, v241, v88, v89
v_mfma_f32_16x16x32_bf16 a[72:75], v[184:187], a[172:175], a[72:75]
ds_read_b64_tr_b16 v[176:177], v236 offset:16384
buffer_load_dwordx4 v225, s[24:27], s52 offen offset:1280 nt lds
v_mfma_f32_16x16x32_bf16 a[68:71], v[188:191], a[168:171], a[68:71]
ds_read_b64_tr_b16 v[178:179], v237 offset:16896
v_max3_f32 v240, v240, v82, v83
v_mfma_f32_16x16x32_bf16 a[76:79], v[188:191], a[172:175], a[76:79]
ds_read_b64_tr_b16 v[180:181], v237 offset:16384
v_max3_f32 v241, v241, v90, v91
s_waitcnt lgkmcnt(7)
v_mfma_f32_16x16x32_bf16 a[64:67], v[192:195], a[176:179], a[64:67]
ds_read_b64_tr_b16 v[182:183], v236 offset:16896
v_max3_f32 v240, v240, v84, v85
v_mfma_f32_16x16x32_bf16 a[72:75], v[192:195], a[180:183], a[72:75]
ds_read_b64_tr_b16 v[184:185], v236 offset:20480
v_max3_f32 v241, v241, v92, v93
v_mfma_f32_16x16x32_bf16 a[68:71], v[196:199], a[176:179], a[68:71]
ds_read_b64_tr_b16 v[186:187], v237 offset:20992
v_max3_f32 v240, v240, v86, v87
v_mfma_f32_16x16x32_bf16 a[76:79], v[196:199], a[180:183], a[76:79]
ds_read_b64_tr_b16 v[188:189], v237 offset:20480
v_max3_f32 v241, v241, v94, v95
s_waitcnt lgkmcnt(7)
v_mfma_f32_16x16x32_bf16 a[64:67], v[200:203], a[184:187], a[64:67]
ds_read_b64_tr_b16 v[190:191], v236 offset:20992
v_mfma_f32_16x16x32_bf16 a[72:75], v[200:203], a[188:191], a[72:75]
v_mfma_f32_16x16x32_bf16 a[68:71], v[204:207], a[184:187], a[68:71]
v_mfma_f32_16x16x32_bf16 a[76:79], v[204:207], a[188:191], a[76:79]
s_add_u32 s53, s49, 90112
v_add_u32 v232, s53, v231
s_waitcnt lgkmcnt(4)
v_mfma_f32_16x16x32_bf16 a[64:67], v[176:179], a[192:195], a[64:67]
v_xor_b32 v233, 64, v232
v_mfma_f32_16x16x32_bf16 a[72:75], v[176:179], a[196:199], a[72:75]
s_waitcnt vmcnt(12) lgkmcnt(0)
s_barrier
ds_read_b128 v[192:195], v232 offset:0
ds_read_b128 v[196:199], v232 offset:2048
ds_read_b128 v[200:203], v233 offset:0
v_mfma_f32_16x16x32_bf16 a[68:71], v[180:183], a[192:195], a[68:71]
v_mfma_f32_16x16x32_bf16 a[76:79], v[180:183], a[196:199], a[76:79]
ds_read_b128 v[204:207], v233 offset:2048
v_mfma_f32_16x16x32_bf16 a[64:67], v[184:187], a[200:203], a[64:67]
v_mfma_f32_16x16x32_bf16 a[72:75], v[184:187], a[204:207], a[72:75]
ds_read_b128 v[176:179], v232 offset:8192
v_mfma_f32_16x16x32_bf16 a[68:71], v[188:191], a[200:203], a[68:71]
v_mfma_f32_16x16x32_bf16 a[76:79], v[188:191], a[204:207], a[76:79]
ds_read_b128 v[180:183], v232 offset:10240
s_waitcnt lgkmcnt(4)
v_mfma_f32_16x16x32_bf16 v[96:99], v[192:195], a[208:211], 0
v_mfma_f32_16x16x32_bf16 v[104:107], v[192:195], a[212:215], 0
ds_read_b128 v[184:187], v233 offset:8192
v_mfma_f32_16x16x32_bf16 v[100:103], v[196:199], a[208:211], 0
s_add_u32 s52, s76, 0
s_add_u32 m0, s48, 65536
v_mfma_f32_16x16x32_bf16 v[108:111], v[196:199], a[212:215], 0
ds_read_b128 v[188:191], v233 offset:10240
buffer_load_dwordx4 v228, s[36:39], s52 offen lds
s_waitcnt lgkmcnt(4)
v_mfma_f32_16x16x32_bf16 v[96:99], v[200:203], a[216:219], v[96:99]
v_mfma_f32_16x16x32_bf16 v[104:107], v[200:203], a[220:223], v[104:107]
ds_read_b128 v[192:195], v232 offset:16384
buffer_load_dwordx4 v229, s[36:39], s52 offen offset:1024 lds
v_mfma_f32_16x16x32_bf16 v[100:103], v[204:207], a[216:219], v[100:103]
v_mfma_f32_16x16x32_bf16 v[108:111], v[204:207], a[220:223], v[108:111]
ds_read_b128 v[196:199], v232 offset:18432
s_add_u32 s52, s76, 81920
s_add_u32 m0, s48, 73728
s_waitcnt lgkmcnt(4)
v_mfma_f32_16x16x32_bf16 v[96:99], v[176:179], a[224:227], v[96:99]
buffer_load_dwordx4 v228, s[36:39], s52 offen lds
v_mfma_f32_16x16x32_bf16 v[104:107], v[176:179], a[228:231], v[104:107]
ds_read_b128 v[200:203], v233 offset:16384
v_mfma_f32_16x16x32_bf16 v[100:103], v[180:183], a[224:227], v[100:103]
v_mfma_f32_16x16x32_bf16 v[108:111], v[180:183], a[228:231], v[108:111]
ds_read_b128 v[204:207], v233 offset:18432
buffer_load_dwordx4 v229, s[36:39], s52 offen offset:1024 lds
s_waitcnt lgkmcnt(4)
v_mfma_f32_16x16x32_bf16 v[96:99], v[184:187], a[232:235], v[96:99]
v_mfma_f32_16x16x32_bf16 v[104:107], v[184:187], a[236:239], v[104:107]
s_add_u32 s52, s76, 163840
s_add_u32 m0, s48, 81920
v_mfma_f32_16x16x32_bf16 v[100:103], v[188:191], a[232:235], v[100:103]
buffer_load_dwordx4 v228, s[36:39], s52 offen lds
v_mfma_f32_16x16x32_bf16 v[108:111], v[188:191], a[236:239], v[108:111]
v_add_u32 v236, 114688, v230
v_xor_b32 v237, 32, v236
s_waitcnt lgkmcnt(2)
v_mfma_f32_16x16x32_bf16 v[96:99], v[192:195], a[240:243], v[96:99]
v_mfma_f32_16x16x32_bf16 v[104:107], v[192:195], a[244:247], v[104:107]
buffer_load_dwordx4 v229, s[36:39], s52 offen offset:1024 lds
s_waitcnt vmcnt(12) lgkmcnt(0)
s_barrier
ds_read_b64_tr_b16 v[176:177], v236 offset:0
ds_read_b64_tr_b16 v[178:179], v237 offset:512
ds_read_b64_tr_b16 v[180:181], v237 offset:0
ds_read_b64_tr_b16 v[182:183], v236 offset:512
ds_read_b64_tr_b16 v[184:185], v236 offset:4096
ds_read_b64_tr_b16 v[186:187], v237 offset:4608
v_mfma_f32_16x16x32_bf16 v[100:103], v[196:199], a[240:243], v[100:103]
s_add_u32 s52, s77, 0
s_add_u32 m0, s48, 90112
s_nop 0
buffer_load_dwordx4 v228, s[36:39], s52 offen lds
v_mfma_f32_16x16x32_bf16 v[108:111], v[196:199], a[244:247], v[108:111]
ds_read_b64_tr_b16 v[188:189], v237 offset:4096
v_mfma_f32_16x16x32_bf16 v[96:99], v[200:203], a[248:251], v[96:99]
ds_read_b64_tr_b16 v[190:191], v236 offset:4608
v_mfma_f32_16x16x32_bf16 v[104:107], v[200:203], a[252:255], v[104:107]
ds_read_b64_tr_b16 v[192:193], v236 offset:8192
buffer_load_dwordx4 v229, s[36:39], s52 offen offset:1024 lds
v_mfma_f32_16x16x32_bf16 v[100:103], v[204:207], a[248:251], v[100:103]
ds_read_b64_tr_b16 v[194:195], v237 offset:8704
v_mfma_f32_16x16x32_bf16 v[108:111], v[204:207], a[252:255], v[108:111]
ds_read_b64_tr_b16 v[196:197], v237 offset:8192
s_waitcnt lgkmcnt(7)
v_mfma_f32_16x16x32_bf16 a[80:83], v[176:179], a[160:163], 0
ds_read_b64_tr_b16 v[198:199], v236 offset:8704
s_add_u32 s52, s77, 81920
s_add_u32 m0, s48, 98304
v_mfma_f32_16x16x32_bf16 a[88:91], v[176:179], a[164:167], 0
ds_read_b64_tr_b16 v[200:201], v236 offset:12288
buffer_load_dwordx4 v228, s[36:39], s52 offen lds
v_mfma_f32_16x16x32_bf16 a[84:87], v[180:183], a[160:163], 0
ds_read_b64_tr_b16 v[202:203], v237 offset:12800
v_max3_f32 v240, v240, v96, v97
v_mfma_f32_16x16x32_bf16 a[92:95], v[180:183], a[164:167], 0
ds_read_b64_tr_b16 v[204:205], v237 offset:12288
v_max3_f32 v241, v241, v104, v105
s_waitcnt lgkmcnt(7)
v_mfma_f32_16x16x32_bf16 a[80:83], v[184:187], a[168:171], a[80:83]
ds_read_b64_tr_b16 v[206:207], v236 offset:12800
buffer_load_dwordx4 v229, s[36:39], s52 offen offset:1024 lds
v_mfma_f32_16x16x32_bf16 a[88:91], v[184:187], a[172:175], a[88:91]
ds_read_b64_tr_b16 v[176:177], v236 offset:16384
v_max3_f32 v240, v240, v98, v99
v_mfma_f32_16x16x32_bf16 a[84:87], v[188:191], a[168:171], a[84:87]
ds_read_b64_tr_b16 v[178:179], v237 offset:16896
v_max3_f32 v241, v241, v106, v107
v_mfma_f32_16x16x32_bf16 a[92:95], v[188:191], a[172:175], a[92:95]
ds_read_b64_tr_b16 v[180:181], v237 offset:16384
s_add_u32 s52, s77, 163840
s_add_u32 m0, s48, 106496
s_waitcnt lgkmcnt(7)
v_mfma_f32_16x16x32_bf16 a[80:83], v[192:195], a[176:179], a[80:83]
ds_read_b64_tr_b16 v[182:183], v236 offset:16896
buffer_load_dwordx4 v228, s[36:39], s52 offen lds
v_mfma_f32_16x16x32_bf16 a[88:91], v[192:195], a[180:183], a[88:91]
ds_read_b64_tr_b16 v[184:185], v236 offset:20480
v_max3_f32 v240, v240, v100, v101
v_mfma_f32_16x16x32_bf16 a[84:87], v[196:199], a[176:179], a[84:87]
ds_read_b64_tr_b16 v[186:187], v237 offset:20992
v_max3_f32 v241, v241, v108, v109
v_mfma_f32_16x16x32_bf16 a[92:95], v[196:199], a[180:183], a[92:95]
ds_read_b64_tr_b16 v[188:189], v237 offset:20480
v_max3_f32 v240, v240, v102, v103
s_waitcnt lgkmcnt(7)
v_mfma_f32_16x16x32_bf16 a[80:83], v[200:203], a[184:187], a[80:83]
ds_read_b64_tr_b16 v[190:191], v236 offset:20992
buffer_load_dwordx4 v229, s[36:39], s52 offen offset:1024 lds
v_mfma_f32_16x16x32_bf16 a[88:91], v[200:203], a[188:191], a[88:91]
v_max3_f32 v241, v241, v110, v111
v_mfma_f32_16x16x32_bf16 a[84:87], v[204:207], a[184:187], a[84:87]
v_mfma_f32_16x16x32_bf16 a[92:95], v[204:207], a[188:191], a[92:95]
s_add_u32 s53, s49, 139264
v_add_u32 v232, s53, v231
s_waitcnt lgkmcnt(4)
v_mfma_f32_16x16x32_bf16 a[80:83], v[176:179], a[192:195], a[80:83]
v_xor_b32 v233, 64, v232
v_mfma_f32_16x16x32_bf16 a[88:91], v[176:179], a[196:199], a[88:91]
s_waitcnt vmcnt(12) lgkmcnt(0)
s_barrier
ds_read_b128 v[192:195], v232 offset:0
ds_read_b128 v[196:199], v232 offset:2048
ds_read_b128 v[200:203], v233 offset:0
v_mfma_f32_16x16x32_bf16 a[84:87], v[180:183], a[192:195], a[84:87]
s_mov_b32 s52, 1572864
s_add_u32 m0, s48, 114688
s_nop 0
buffer_load_dwordx4 v224, s[28:31], s52 offen nt lds
v_mfma_f32_16x16x32_bf16 a[92:95], v[180:183], a[196:199], a[92:95]
ds_read_b128 v[204:207], v233 offset:2048
v_mfma_f32_16x16x32_bf16 a[80:83], v[184:187], a[200:203], a[80:83]
buffer_load_dwordx4 v225, s[28:31], s52 offen offset:1024 nt lds
v_mfma_f32_16x16x32_bf16 a[88:91], v[184:187], a[204:207], a[88:91]
ds_read_b128 v[176:179], v232 offset:8192
s_add_u32 m0, s48, 122752
v_mfma_f32_16x16x32_bf16 a[84:87], v[188:191], a[200:203], a[84:87]
buffer_load_dwordx4 v224, s[28:31], s52 offen offset:128 nt lds
v_mfma_f32_16x16x32_bf16 a[92:95], v[188:191], a[204:207], a[92:95]
ds_read_b128 v[180:183], v232 offset:10240
s_waitcnt lgkmcnt(4)
v_mfma_f32_16x16x32_bf16 v[112:115], v[192:195], a[208:211], 0
buffer_load_dwordx4 v225, s[28:31], s52 offen offset:1152 nt lds
v_mfma_f32_16x16x32_bf16 v[120:123], v[192:195], a[212:215], 0
ds_read_b128 v[184:187], v233 offset:8192
s_add_u32 m0, s48, 130816
v_mfma_f32_16x16x32_bf16 v[116:119], v[196:199], a[208:211], 0
buffer_load_dwordx4 v224, s[28:31], s52 offen offset:256 nt lds
v_mfma_f32_16x16x32_bf16 v[124:127], v[196:199], a[212:215], 0
ds_read_b128 v[188:191], v233 offset:10240
s_waitcnt lgkmcnt(4)
v_mfma_f32_16x16x32_bf16 v[112:115], v[200:203], a[216:219], v[112:115]
v_mfma_f32_16x16x32_bf16 v[120:123], v[200:203], a[220:223], v[120:123]
ds_read_b128 v[192:195], v232 offset:16384
buffer_load_dwordx4 v225, s[28:31], s52 offen offset:1280 nt lds
v_mfma_f32_16x16x32_bf16 v[116:119], v[204:207], a[216:219], v[116:119]
v_mfma_f32_16x16x32_bf16 v[124:127], v[204:207], a[220:223], v[124:127]
ds_read_b128 v[196:199], v232 offset:18432
s_waitcnt lgkmcnt(4)
v_mfma_f32_16x16x32_bf16 v[112:115], v[176:179], a[224:227], v[112:115]
v_mfma_f32_16x16x32_bf16 v[120:123], v[176:179], a[228:231], v[120:123]
ds_read_b128 v[200:203], v233 offset:16384
v_mfma_f32_16x16x32_bf16 v[116:119], v[180:183], a[224:227], v[116:119]
v_mfma_f32_16x16x32_bf16 v[124:127], v[180:183], a[228:231], v[124:127]
ds_read_b128 v[204:207], v233 offset:18432
s_waitcnt lgkmcnt(4)
v_mfma_f32_16x16x32_bf16 v[112:115], v[184:187], a[232:235], v[112:115]
v_mfma_f32_16x16x32_bf16 v[120:123], v[184:187], a[236:239], v[120:123]
v_mfma_f32_16x16x32_bf16 v[116:119], v[188:191], a[232:235], v[116:119]
v_mfma_f32_16x16x32_bf16 v[124:127], v[188:191], a[236:239], v[124:127]
v_add_u32 v236, 65536, v230
v_xor_b32 v237, 32, v236
s_waitcnt lgkmcnt(2)
v_mfma_f32_16x16x32_bf16 v[112:115], v[192:195], a[240:243], v[112:115]
v_mfma_f32_16x16x32_bf16 v[120:123], v[192:195], a[244:247], v[120:123]
s_waitcnt vmcnt(12) lgkmcnt(0)
s_barrier
ds_read_b64_tr_b16 v[176:177], v236 offset:0
ds_read_b64_tr_b16 v[178:179], v237 offset:512
ds_read_b64_tr_b16 v[180:181], v237 offset:0
ds_read_b64_tr_b16 v[182:183], v236 offset:512
ds_read_b64_tr_b16 v[184:185], v236 offset:4096
ds_read_b64_tr_b16 v[186:187], v237 offset:4608
v_mfma_f32_16x16x32_bf16 v[116:119], v[196:199], a[240:243], v[116:119]
s_mov_b32 s52, 1597440
s_add_u32 m0, s48, 139264
s_nop 0
buffer_load_dwordx4 v224, s[28:31], s52 offen nt lds
v_mfma_f32_16x16x32_bf16 v[124:127], v[196:199], a[244:247], v[124:127]
ds_read_b64_tr_b16 v[188:189], v237 offset:4096
v_mfma_f32_16x16x32_bf16 v[112:115], v[200:203], a[248:251], v[112:115]
ds_read_b64_tr_b16 v[190:191], v236 offset:4608
buffer_load_dwordx4 v225, s[28:31], s52 offen offset:1024 nt lds
v_mfma_f32_16x16x32_bf16 v[120:123], v[200:203], a[252:255], v[120:123]
ds_read_b64_tr_b16 v[192:193], v236 offset:8192
s_add_u32 m0, s48, 147328
v_mfma_f32_16x16x32_bf16 v[116:119], v[204:207], a[248:251], v[116:119]
ds_read_b64_tr_b16 v[194:195], v237 offset:8704
buffer_load_dwordx4 v224, s[28:31], s52 offen offset:128 nt lds
v_mfma_f32_16x16x32_bf16 v[124:127], v[204:207], a[252:255], v[124:127]
ds_read_b64_tr_b16 v[196:197], v237 offset:8192
s_waitcnt lgkmcnt(7)
v_mfma_f32_16x16x32_bf16 a[96:99], v[176:179], a[160:163], 0
ds_read_b64_tr_b16 v[198:199], v236 offset:8704
buffer_load_dwordx4 v225, s[28:31], s52 offen offset:1152 nt lds
v_mfma_f32_16x16x32_bf16 a[104:107], v[176:179], a[164:167], 0
ds_read_b64_tr_b16 v[200:201], v236 offset:12288
s_add_u32 m0, s48, 155392
v_mfma_f32_16x16x32_bf16 a[100:103], v[180:183], a[160:163], 0
ds_read_b64_tr_b16 v[202:203], v237 offset:12800
buffer_load_dwordx4 v224, s[28:31], s52 offen offset:256 nt lds
v_max3_f32 v240, v240, v112, v113
v_max3_f32 v241, v241, v120, v121
v_max3_f32 v240, v240, v114, v115
v_max3_f32 v241, v241, v122, v123
v_max3_f32 v240, v240, v116, v117
v_mfma_f32_16x16x32_bf16 a[108:111], v[180:183], a[164:167], 0
ds_read_b64_tr_b16 v[204:205], v237 offset:12288
v_max3_f32 v241, v241, v124, v125
v_max3_f32 v240, v240, v118, v119
v_max3_f32 v241, v241, v126, v127
v_mov_b32 v246, v240
v_mov_b32 v247, v241
s_nop 0
v_permlane16_swap_b32 v246, v240
v_permlane16_swap_b32 v247, v241
s_waitcnt lgkmcnt(7)
v_mfma_f32_16x16x32_bf16 a[96:99], v[184:187], a[168:171], a[96:99]
ds_read_b64_tr_b16 v[206:207], v236 offset:12800
v_max_f32 v240, v240, v246
v_max_f32 v241, v241, v247
v_mov_b32 v246, v240
v_mov_b32 v247, v241
s_nop 0
v_permlane32_swap_b32 v246, v240
v_permlane32_swap_b32 v247, v241
v_max_f32 v240, v240, v246
v_mfma_f32_16x16x32_bf16 a[104:107], v[184:187], a[172:175], a[104:107]
ds_read_b64_tr_b16 v[176:177], v236 offset:16384
buffer_load_dwordx4 v225, s[28:31], s52 offen offset:1280 nt lds
v_max_f32 v241, v241, v247
v_accvgpr_mov_b32 a208, a160
v_accvgpr_mov_b32 a209, a161
v_accvgpr_mov_b32 a210, a162
v_accvgpr_mov_b32 a211, a163
v_mfma_f32_16x16x32_bf16 a[100:103], v[188:191], a[168:171], a[100:103]
ds_read_b64_tr_b16 v[178:179], v237 offset:16896
v_accvgpr_mov_b32 a212, a164
v_accvgpr_mov_b32 a213, a165
v_accvgpr_mov_b32 a214, a166
v_accvgpr_mov_b32 a215, a167
v_accvgpr_mov_b32 a216, a168
v_accvgpr_mov_b32 a217, a169
v_accvgpr_mov_b32 a218, a170
v_mfma_f32_16x16x32_bf16 a[108:111], v[188:191], a[172:175], a[108:111]
ds_read_b64_tr_b16 v[180:181], v237 offset:16384
v_accvgpr_mov_b32 a219, a171
v_accvgpr_mov_b32 a220, a172
v_accvgpr_mov_b32 a221, a173
v_accvgpr_mov_b32 a222, a174
v_accvgpr_mov_b32 a223, a175
v_accvgpr_mov_b32 a224, a176
v_accvgpr_mov_b32 a225, a177
s_waitcnt lgkmcnt(7)
v_mfma_f32_16x16x32_bf16 a[96:99], v[192:195], a[176:179], a[96:99]
ds_read_b64_tr_b16 v[182:183], v236 offset:16896
v_accvgpr_mov_b32 a226, a178
v_accvgpr_mov_b32 a227, a179
v_accvgpr_mov_b32 a228, a180
v_accvgpr_mov_b32 a229, a181
v_accvgpr_mov_b32 a230, a182
v_accvgpr_mov_b32 a231, a183
v_accvgpr_mov_b32 a232, a184
v_accvgpr_mov_b32 a233, a185
v_mfma_f32_16x16x32_bf16 a[104:107], v[192:195], a[180:183], a[104:107]
ds_read_b64_tr_b16 v[184:185], v236 offset:20480
v_accvgpr_mov_b32 a234, a186
v_accvgpr_mov_b32 a235, a187
v_accvgpr_mov_b32 a236, a188
v_accvgpr_mov_b32 a237, a189
v_accvgpr_mov_b32 a238, a190
v_accvgpr_mov_b32 a239, a191
v_accvgpr_mov_b32 a240, a192
v_mfma_f32_16x16x32_bf16 a[100:103], v[196:199], a[176:179], a[100:103]
ds_read_b64_tr_b16 v[186:187], v237 offset:20992
v_accvgpr_mov_b32 a241, a193
v_accvgpr_mov_b32 a242, a194
v_accvgpr_mov_b32 a243, a195
v_accvgpr_mov_b32 a244, a196
v_accvgpr_mov_b32 a245, a197
v_accvgpr_mov_b32 a246, a198
v_accvgpr_mov_b32 a247, a199
v_accvgpr_mov_b32 a248, a200
v_mfma_f32_16x16x32_bf16 a[108:111], v[196:199], a[180:183], a[108:111]
ds_read_b64_tr_b16 v[188:189], v237 offset:20480
v_accvgpr_mov_b32 a249, a201
v_accvgpr_mov_b32 a250, a202
v_accvgpr_mov_b32 a251, a203
v_accvgpr_mov_b32 a252, a204
v_accvgpr_mov_b32 a253, a205
v_accvgpr_mov_b32 a254, a206
v_accvgpr_mov_b32 a255, a207
ds_write_b64 v239, v[240:241] offset:57344
s_waitcnt lgkmcnt(8)
v_mfma_f32_16x16x32_bf16 a[96:99], v[200:203], a[184:187], a[96:99]
ds_read_b64_tr_b16 v[190:191], v236 offset:20992
v_mfma_f32_16x16x32_bf16 a[104:107], v[200:203], a[188:191], a[104:107]
v_mfma_f32_16x16x32_bf16 a[100:103], v[204:207], a[184:187], a[100:103]
v_mfma_f32_16x16x32_bf16 a[108:111], v[204:207], a[188:191], a[108:111]
v_add_u32 v236, 90112, v230
v_xor_b32 v237, 32, v236
s_waitcnt lgkmcnt(5)
v_mfma_f32_16x16x32_bf16 a[96:99], v[176:179], a[192:195], a[96:99]
v_mfma_f32_16x16x32_bf16 a[104:107], v[176:179], a[196:199], a[104:107]
s_waitcnt vmcnt(12) lgkmcnt(0)
s_barrier
ds_read_b64_tr_b16 v[192:193], v236 offset:0
ds_read_b64_tr_b16 v[194:195], v237 offset:512
ds_read_b64_tr_b16 v[196:197], v237 offset:0
ds_read_b64_tr_b16 v[198:199], v236 offset:512
ds_read_b64_tr_b16 v[200:201], v236 offset:4096
ds_read_b64_tr_b16 v[202:203], v237 offset:4608
v_mfma_f32_16x16x32_bf16 a[100:103], v[180:183], a[192:195], a[100:103]
ds_read_b64 v[246:247], v238 offset:57344
ds_read_b64 v[248:249], v238 offset:59392
s_waitcnt lgkmcnt(0)
v_max_f32 v246, v246, v248
v_max_f32 v247, v247, v249
v_mul_f32 v242, s51, v246
v_mul_f32 v243, s51, v247
v_mfma_f32_16x16x32_bf16 a[108:111], v[180:183], a[196:199], a[108:111]
ds_read_b64_tr_b16 v[204:205], v237 offset:4096
v_fma_f32 v0, v0, s51, -v242
v_fma_f32 v1, v1, s51, -v242
v_exp_f32 v0, v0
v_mfma_f32_16x16x32_bf16 a[96:99], v[184:187], a[200:203], a[96:99]
ds_read_b64_tr_b16 v[206:207], v236 offset:4608
v_exp_f32 v1, v1
v_fma_f32 v2, v2, s51, -v242
v_fma_f32 v3, v3, s51, -v242
v_add_f32 v244, v0, v1
v_mfma_f32_16x16x32_bf16 a[104:107], v[184:187], a[204:207], a[104:107]
ds_read_b64_tr_b16 v[176:177], v236 offset:8192
v_cvt_pk_bf16_f32 v0, v0, v1
v_exp_f32 v2, v2
v_exp_f32 v3, v3
v_mfma_f32_16x16x32_bf16 a[100:103], v[188:191], a[200:203], a[100:103]
ds_read_b64_tr_b16 v[178:179], v237 offset:8704
v_fma_f32 v4, v4, s51, -v242
v_fma_f32 v5, v5, s51, -v242
v_add_f32 v244, v244, v2
v_add_f32 v244, v244, v3
v_cvt_pk_bf16_f32 v1, v2, v3
v_mfma_f32_16x16x32_bf16 a[108:111], v[188:191], a[204:207], a[108:111]
ds_read_b64_tr_b16 v[180:181], v237 offset:8192
v_exp_f32 v4, v4
v_exp_f32 v5, v5
v_fma_f32 v6, v6, s51, -v242
v_mfma_f32_16x16x32_bf16 a[112:115], v[192:195], a[160:163], 0
ds_read_b64_tr_b16 v[182:183], v236 offset:8704
v_fma_f32 v7, v7, s51, -v242
v_add_f32 v244, v244, v4
v_add_f32 v244, v244, v5
v_cvt_pk_bf16_f32 v2, v4, v5
v_mfma_f32_16x16x32_bf16 a[120:123], v[192:195], a[164:167], 0
ds_read_b64_tr_b16 v[184:185], v236 offset:12288
v_exp_f32 v6, v6
v_exp_f32 v7, v7
v_fma_f32 v8, v8, s51, -v243
v_mfma_f32_16x16x32_bf16 a[116:119], v[196:199], a[160:163], 0
ds_read_b64_tr_b16 v[186:187], v237 offset:12800
s_add_u32 s52, s78, 0
s_add_u32 m0, s48, 65536
v_fma_f32 v9, v9, s51, -v243
v_add_f32 v244, v244, v6
v_add_f32 v244, v244, v7
v_cvt_pk_bf16_f32 v3, v6, v7
v_mfma_f32_16x16x32_bf16 a[124:127], v[196:199], a[164:167], 0
ds_read_b64_tr_b16 v[188:189], v237 offset:12288
buffer_load_dwordx4 v228, s[36:39], s52 offen lds
v_exp_f32 v8, v8
s_waitcnt lgkmcnt(7)
v_mfma_f32_16x16x32_bf16 a[112:115], v[200:203], a[168:171], a[112:115]
ds_read_b64_tr_b16 v[190:191], v236 offset:12800
v_exp_f32 v9, v9
v_fma_f32 v10, v10, s51, -v243
v_fma_f32 v11, v11, s51, -v243
v_add_f32 v245, v8, v9
v_mfma_f32_16x16x32_bf16 a[120:123], v[200:203], a[172:175], a[120:123]
ds_read_b64_tr_b16 v[192:193], v236 offset:16384
buffer_load_dwordx4 v229, s[36:39], s52 offen offset:1024 lds
v_cvt_pk_bf16_f32 v4, v8, v9
v_exp_f32 v10, v10
v_mfma_f32_16x16x32_bf16 a[116:119], v[204:207], a[168:171], a[116:119]
ds_read_b64_tr_b16 v[194:195], v237 offset:16896
v_exp_f32 v11, v11
v_fma_f32 v12, v12, s51, -v243
v_fma_f32 v13, v13, s51, -v243
v_add_f32 v245, v245, v10
v_mfma_f32_16x16x32_bf16 a[124:127], v[204:207], a[172:175], a[124:127]
ds_read_b64_tr_b16 v[196:197], v237 offset:16384
s_add_u32 s52, s78, 81920
s_add_u32 m0, s48, 73728
v_add_f32 v245, v245, v11
v_cvt_pk_bf16_f32 v5, v10, v11
v_exp_f32 v12, v12
s_waitcnt lgkmcnt(7)
v_mfma_f32_16x16x32_bf16 a[112:115], v[176:179], a[176:179], a[112:115]
ds_read_b64_tr_b16 v[198:199], v236 offset:16896
buffer_load_dwordx4 v228, s[36:39], s52 offen lds
v_exp_f32 v13, v13
v_fma_f32 v14, v14, s51, -v243
v_mfma_f32_16x16x32_bf16 a[120:123], v[176:179], a[180:183], a[120:123]
ds_read_b64_tr_b16 v[200:201], v236 offset:20480
v_fma_f32 v15, v15, s51, -v243
v_add_f32 v245, v245, v12
v_add_f32 v245, v245, v13
v_cvt_pk_bf16_f32 v6, v12, v13
v_mfma_f32_16x16x32_bf16 a[116:119], v[180:183], a[176:179], a[116:119]
ds_read_b64_tr_b16 v[202:203], v237 offset:20992
v_exp_f32 v14, v14
v_exp_f32 v15, v15
v_add_f32 v245, v245, v14
v_mfma_f32_16x16x32_bf16 a[124:127], v[180:183], a[180:183], a[124:127]
ds_read_b64_tr_b16 v[204:205], v237 offset:20480
buffer_load_dwordx4 v229, s[36:39], s52 offen offset:1024 lds
v_add_f32 v245, v245, v15
v_cvt_pk_bf16_f32 v7, v14, v15
ds_write_b128 v239, v[0:3] offset:16384
ds_write_b128 v239, v[4:7] offset:17408
s_waitcnt lgkmcnt(9)
v_mfma_f32_16x16x32_bf16 a[112:115], v[184:187], a[184:187], a[112:115]
ds_read_b64_tr_b16 v[206:207], v236 offset:20992
v_mfma_f32_16x16x32_bf16 a[120:123], v[184:187], a[188:191], a[120:123]
s_add_u32 s52, s78, 163840
s_add_u32 m0, s48, 81920
v_mfma_f32_16x16x32_bf16 a[116:119], v[188:191], a[184:187], a[116:119]
buffer_load_dwordx4 v228, s[36:39], s52 offen lds
v_mfma_f32_16x16x32_bf16 a[124:127], v[188:191], a[188:191], a[124:127]
v_add_u32 v236, 114688, v250
v_xor_b32 v237, 32, v236
s_waitcnt lgkmcnt(6)
v_mfma_f32_16x16x32_bf16 a[112:115], v[192:195], a[192:195], a[112:115]
v_xor_b32 v232, 0x1000, v236
v_xor_b32 v233, 0x1000, v237
v_mfma_f32_16x16x32_bf16 a[120:123], v[192:195], a[196:199], a[120:123]
buffer_load_dwordx4 v229, s[36:39], s52 offen offset:1024 lds
s_waitcnt vmcnt(12) lgkmcnt(0)
s_barrier
ds_read_b64_tr_b16 v[176:177], v236 offset:0
ds_read_b64_tr_b16 v[178:179], v236 offset:2048
ds_read_b64_tr_b16 v[180:181], v237 offset:0
ds_read_b64_tr_b16 v[182:183], v237 offset:2048
ds_read_b64_tr_b16 v[184:185], v236 offset:8192
ds_read_b64_tr_b16 v[186:187], v236 offset:10240
v_mfma_f32_16x16x32_bf16 a[116:119], v[196:199], a[192:195], a[116:119]
s_mov_b32 s52, 1622016
s_add_u32 m0, s48, 90112
s_nop 0
buffer_load_dwordx4 v224, s[28:31], s52 offen nt lds
v_fma_f32 v16, v16, s51, -v242
v_fma_f32 v17, v17, s51, -v242
v_mfma_f32_16x16x32_bf16 a[124:127], v[196:199], a[196:199], a[124:127]
ds_read_b64_tr_b16 v[188:189], v237 offset:8192
v_exp_f32 v16, v16
v_exp_f32 v17, v17
v_fma_f32 v18, v18, s51, -v242
v_mfma_f32_16x16x32_bf16 a[112:115], v[200:203], a[200:203], a[112:115]
ds_read_b64_tr_b16 v[190:191], v237 offset:10240
buffer_load_dwordx4 v225, s[28:31], s52 offen offset:1024 nt lds
v_fma_f32 v19, v19, s51, -v242
v_add_f32 v244, v244, v16
v_add_f32 v244, v244, v17
v_mfma_f32_16x16x32_bf16 a[120:123], v[200:203], a[204:207], a[120:123]
ds_read_b64_tr_b16 v[192:193], v236 offset:16384
s_add_u32 m0, s48, 98176
v_cvt_pk_bf16_f32 v16, v16, v17
v_exp_f32 v18, v18
v_exp_f32 v19, v19
v_mfma_f32_16x16x32_bf16 a[116:119], v[204:207], a[200:203], a[116:119]
ds_read_b64_tr_b16 v[194:195], v236 offset:18432
buffer_load_dwordx4 v224, s[28:31], s52 offen offset:128 nt lds
v_fma_f32 v20, v20, s51, -v242
v_fma_f32 v21, v21, s51, -v242
v_add_f32 v244, v244, v18
v_mfma_f32_16x16x32_bf16 a[124:127], v[204:207], a[204:207], a[124:127]
ds_read_b64_tr_b16 v[196:197], v237 offset:16384
v_add_f32 v244, v244, v19
v_cvt_pk_bf16_f32 v17, v18, v19
v_exp_f32 v20, v20
s_waitcnt lgkmcnt(7)
v_mfma_f32_16x16x32_bf16 a[160:163], v[176:179], v[0:3], 0
ds_read_b64_tr_b16 v[198:199], v237 offset:18432
buffer_load_dwordx4 v225, s[28:31], s52 offen offset:1152 nt lds
v_exp_f32 v21, v21
v_fma_f32 v22, v22, s51, -v242
v_mfma_f32_16x16x32_bf16 a[168:171], v[176:179], v[4:7], 0
ds_read_b128 v[8:11], v234 offset:16384
ds_read_b128 v[12:15], v234 offset:17408
s_add_u32 m0, s48, 106240
v_fma_f32 v23, v23, s51, -v242
v_add_f32 v244, v244, v20
v_add_f32 v244, v244, v21
v_mfma_f32_16x16x32_bf16 a[164:167], v[180:183], v[0:3], 0
ds_read_b64_tr_b16 v[200:201], v232 offset:0
ds_read_b64_tr_b16 v[202:203], v232 offset:2048
buffer_load_dwordx4 v224, s[28:31], s52 offen offset:256 nt lds
v_cvt_pk_bf16_f32 v18, v20, v21
v_mfma_f32_16x16x32_bf16 a[172:175], v[180:183], v[4:7], 0
ds_read_b64_tr_b16 v[204:205], v233 offset:0
v_exp_f32 v22, v22
v_exp_f32 v23, v23
v_fma_f32 v24, v24, s51, -v243
s_waitcnt lgkmcnt(9)
v_mfma_f32_16x16x32_bf16 a[176:179], v[184:187], v[0:3], 0
ds_read_b64_tr_b16 v[206:207], v233 offset:2048
v_fma_f32 v25, v25, s51, -v243
v_add_f32 v244, v244, v22
v_add_f32 v244, v244, v23
v_cvt_pk_bf16_f32 v19, v22, v23
v_exp_f32 v24, v24
v_mfma_f32_16x16x32_bf16 a[184:187], v[184:187], v[4:7], 0
ds_read_b64_tr_b16 v[176:177], v232 offset:8192
buffer_load_dwordx4 v225, s[28:31], s52 offen offset:1280 nt lds
v_exp_f32 v25, v25
v_fma_f32 v26, v26, s51, -v243
v_mfma_f32_16x16x32_bf16 a[180:183], v[188:191], v[0:3], 0
ds_read_b64_tr_b16 v[178:179], v232 offset:10240
v_fma_f32 v27, v27, s51, -v243
v_add_f32 v245, v245, v24
v_add_f32 v245, v245, v25
v_cvt_pk_bf16_f32 v20, v24, v25
v_mfma_f32_16x16x32_bf16 a[188:191], v[188:191], v[4:7], 0
ds_read_b64_tr_b16 v[180:181], v233 offset:8192
v_exp_f32 v26, v26
v_exp_f32 v27, v27
v_fma_f32 v28, v28, s51, -v243
s_waitcnt lgkmcnt(9)
v_mfma_f32_16x16x32_bf16 a[192:195], v[192:195], v[0:3], 0
ds_read_b64_tr_b16 v[182:183], v233 offset:10240
v_fma_f32 v29, v29, s51, -v243
v_add_f32 v245, v245, v26
v_add_f32 v245, v245, v27
v_cvt_pk_bf16_f32 v21, v26, v27
v_exp_f32 v28, v28
v_mfma_f32_16x16x32_bf16 a[200:203], v[192:195], v[4:7], 0
ds_read_b64_tr_b16 v[184:185], v232 offset:16384
v_exp_f32 v29, v29
v_fma_f32 v30, v30, s51, -v243
v_fma_f32 v31, v31, s51, -v243
v_add_f32 v245, v245, v28
v_mfma_f32_16x16x32_bf16 a[196:199], v[196:199], v[0:3], 0
ds_read_b64_tr_b16 v[186:187], v232 offset:18432
v_add_f32 v245, v245, v29
v_cvt_pk_bf16_f32 v22, v28, v29
v_exp_f32 v30, v30
v_mfma_f32_16x16x32_bf16 a[204:207], v[196:199], v[4:7], 0
ds_read_b64_tr_b16 v[188:189], v233 offset:16384
v_exp_f32 v31, v31
v_add_f32 v245, v245, v30
v_add_f32 v245, v245, v31
v_cvt_pk_bf16_f32 v23, v30, v31
ds_write_b128 v239, v[16:19] offset:24576
ds_write_b128 v239, v[20:23] offset:25600
s_waitcnt lgkmcnt(9)
v_mfma_f32_16x16x32_bf16 a[160:163], v[200:203], v[8:11], a[160:163]
ds_read_b64_tr_b16 v[190:191], v233 offset:18432
v_mfma_f32_16x16x32_bf16 a[168:171], v[200:203], v[12:15], a[168:171]
v_mfma_f32_16x16x32_bf16 a[164:167], v[204:207], v[8:11], a[164:167]
v_mfma_f32_16x16x32_bf16 a[172:175], v[204:207], v[12:15], a[172:175]
v_add_u32 v236, 139264, v250
v_xor_b32 v237, 32, v236
s_waitcnt lgkmcnt(6)
v_mfma_f32_16x16x32_bf16 a[176:179], v[176:179], v[8:11], a[176:179]
v_xor_b32 v232, 0x1000, v236
v_xor_b32 v233, 0x1000, v237
v_mfma_f32_16x16x32_bf16 a[184:187], v[176:179], v[12:15], a[184:187]
s_waitcnt vmcnt(12) lgkmcnt(0)
s_barrier
ds_read_b64_tr_b16 v[192:193], v236 offset:0
ds_read_b64_tr_b16 v[194:195], v236 offset:2048
ds_read_b64_tr_b16 v[196:197], v237 offset:0
ds_read_b64_tr_b16 v[198:199], v237 offset:2048
ds_read_b64_tr_b16 v[200:201], v236 offset:8192
ds_read_b64_tr_b16 v[202:203], v236 offset:10240
v_mfma_f32_16x16x32_bf16 a[180:183], v[180:183], v[8:11], a[180:183]
v_fma_f32 v32, v32, s51, -v242
v_fma_f32 v33, v33, s51, -v242
v_exp_f32 v32, v32
v_mfma_f32_16x16x32_bf16 a[188:191], v[180:183], v[12:15], a[188:191]
ds_read_b64_tr_b16 v[204:205], v237 offset:8192
v_exp_f32 v33, v33
v_mfma_f32_16x16x32_bf16 a[192:195], v[184:187], v[8:11], a[192:195]
ds_read_b64_tr_b16 v[206:207], v237 offset:10240
v_fma_f32 v34, v34, s51, -v242
v_fma_f32 v35, v35, s51, -v242
v_mfma_f32_16x16x32_bf16 a[200:203], v[184:187], v[12:15], a[200:203]
ds_read_b64_tr_b16 v[176:177], v236 offset:16384
v_add_f32 v244, v244, v32
v_add_f32 v244, v244, v33
v_mfma_f32_16x16x32_bf16 a[196:199], v[188:191], v[8:11], a[196:199]
ds_read_b64_tr_b16 v[178:179], v236 offset:18432
v_cvt_pk_bf16_f32 v32, v32, v33
v_exp_f32 v34, v34
v_mfma_f32_16x16x32_bf16 a[204:207], v[188:191], v[12:15], a[204:207]
ds_read_b64_tr_b16 v[180:181], v237 offset:16384
v_exp_f32 v35, v35
s_waitcnt lgkmcnt(7)
v_mfma_f32_16x16x32_bf16 a[160:163], v[192:195], v[16:19], a[160:163]
ds_read_b64_tr_b16 v[182:183], v237 offset:18432
v_fma_f32 v36, v36, s51, -v242
v_fma_f32 v37, v37, s51, -v242
v_mfma_f32_16x16x32_bf16 a[168:171], v[192:195], v[20:23], a[168:171]
ds_read_b128 v[24:27], v234 offset:24576
ds_read_b128 v[28:31], v234 offset:25600
v_add_f32 v244, v244, v34
v_mfma_f32_16x16x32_bf16 a[164:167], v[196:199], v[16:19], a[164:167]
ds_read_b64_tr_b16 v[184:185], v232 offset:0
ds_read_b64_tr_b16 v[186:187], v232 offset:2048
s_add_u32 s52, s79, 0
s_add_u32 m0, s48, 114688
v_mfma_f32_16x16x32_bf16 a[172:175], v[196:199], v[20:23], a[172:175]
ds_read_b64_tr_b16 v[188:189], v233 offset:0
buffer_load_dwordx4 v228, s[36:39], s52 offen lds
s_waitcnt lgkmcnt(9)
v_mfma_f32_16x16x32_bf16 a[176:179], v[200:203], v[16:19], a[176:179]
ds_read_b64_tr_b16 v[190:191], v233 offset:2048
v_add_f32 v244, v244, v35
v_cvt_pk_bf16_f32 v33, v34, v35
v_mfma_f32_16x16x32_bf16 a[184:187], v[200:203], v[20:23], a[184:187]
ds_read_b64_tr_b16 v[192:193], v232 offset:8192
buffer_load_dwordx4 v229, s[36:39], s52 offen offset:1024 lds
v_mfma_f32_16x16x32_bf16 a[180:183], v[204:207], v[16:19], a[180:183]
ds_read_b64_tr_b16 v[194:195], v232 offset:10240
v_exp_f32 v36, v36
v_mfma_f32_16x16x32_bf16 a[188:191], v[204:207], v[20:23], a[188:191]
ds_read_b64_tr_b16 v[196:197], v233 offset:8192
s_add_u32 s52, s79, 81920
s_add_u32 m0, s48, 122880
s_waitcnt lgkmcnt(9)
v_mfma_f32_16x16x32_bf16 a[192:195], v[176:179], v[16:19], a[192:195]
ds_read_b64_tr_b16 v[198:199], v233 offset:10240
buffer_load_dwordx4 v228, s[36:39], s52 offen lds
v_mfma_f32_16x16x32_bf16 a[200:203], v[176:179], v[20:23], a[200:203]
ds_read_b64_tr_b16 v[200:201], v232 offset:16384
v_exp_f32 v37, v37
v_mfma_f32_16x16x32_bf16 a[196:199], v[180:183], v[16:19], a[196:199]
ds_read_b64_tr_b16 v[202:203], v232 offset:18432
v_fma_f32 v38, v38, s51, -v242
v_fma_f32 v39, v39, s51, -v242
v_mfma_f32_16x16x32_bf16 a[204:207], v[180:183], v[20:23], a[204:207]
ds_read_b64_tr_b16 v[204:205], v233 offset:16384
buffer_load_dwordx4 v229, s[36:39], s52 offen offset:1024 lds
s_waitcnt lgkmcnt(7)
v_mfma_f32_16x16x32_bf16 a[160:163], v[184:187], v[24:27], a[160:163]
ds_read_b64_tr_b16 v[206:207], v233 offset:18432
v_add_f32 v244, v244, v36
v_add_f32 v244, v244, v37
v_mfma_f32_16x16x32_bf16 a[168:171], v[184:187], v[28:31], a[168:171]
s_add_u32 s52, s79, 163840
s_add_u32 m0, s48, 131072
v_cvt_pk_bf16_f32 v34, v36, v37
v_exp_f32 v38, v38
v_mfma_f32_16x16x32_bf16 a[164:167], v[188:191], v[24:27], a[164:167]
buffer_load_dwordx4 v228, s[36:39], s52 offen lds
v_mfma_f32_16x16x32_bf16 a[172:175], v[188:191], v[28:31], a[172:175]
v_add_u32 v236, 65536, v230
v_xor_b32 v237, 32, v236
v_exp_f32 v39, v39
s_waitcnt lgkmcnt(4)
v_mfma_f32_16x16x32_bf16 a[176:179], v[192:195], v[24:27], a[176:179]
v_fma_f32 v40, v40, s51, -v243
v_fma_f32 v41, v41, s51, -v243
v_add_f32 v244, v244, v38
v_mfma_f32_16x16x32_bf16 a[184:187], v[192:195], v[28:31], a[184:187]
buffer_load_dwordx4 v229, s[36:39], s52 offen offset:1024 lds
s_waitcnt vmcnt(12) lgkmcnt(0)
s_barrier
ds_read_b64_tr_b16 v[176:177], v236 offset:0
ds_read_b64_tr_b16 v[178:179], v237 offset:512
ds_read_b64_tr_b16 v[180:181], v237 offset:0
ds_read_b64_tr_b16 v[182:183], v236 offset:512
ds_read_b64_tr_b16 v[184:185], v236 offset:4096
ds_read_b64_tr_b16 v[186:187], v237 offset:4608
v_mfma_f32_16x16x32_bf16 a[180:183], v[196:199], v[24:27], a[180:183]
s_mov_b32 s52, 1646592
s_add_u32 m0, s48, 139264
s_nop 0
buffer_load_dwordx4 v224, s[28:31], s52 offen nt lds
v_add_f32 v244, v244, v39
v_mfma_f32_16x16x32_bf16 a[188:191], v[196:199], v[28:31], a[188:191]
ds_read_b64_tr_b16 v[188:189], v237 offset:4096
v_cvt_pk_bf16_f32 v35, v38, v39
v_exp_f32 v40, v40
v_mfma_f32_16x16x32_bf16 a[192:195], v[200:203], v[24:27], a[192:195]
ds_read_b64_tr_b16 v[190:191], v236 offset:4608
buffer_load_dwordx4 v225, s[28:31], s52 offen offset:1024 nt lds
v_mfma_f32_16x16x32_bf16 a[200:203], v[200:203], v[28:31], a[200:203]
ds_read_b64_tr_b16 v[192:193], v236 offset:8192
s_add_u32 m0, s48, 147328
v_exp_f32 v41, v41
v_mfma_f32_16x16x32_bf16 a[196:199], v[204:207], v[24:27], a[196:199]
ds_read_b64_tr_b16 v[194:195], v237 offset:8704
buffer_load_dwordx4 v224, s[28:31], s52 offen offset:128 nt lds
v_fma_f32 v42, v42, s51, -v243
v_mfma_f32_16x16x32_bf16 a[204:207], v[204:207], v[28:31], a[204:207]
ds_read_b64_tr_b16 v[196:197], v237 offset:8192
v_fma_f32 v43, v43, s51, -v243
v_add_f32 v245, v245, v40
v_add_f32 v245, v245, v41
s_waitcnt lgkmcnt(7)
v_mfma_f32_16x16x32_bf16 a[128:131], v[176:179], a[208:211], 0
ds_read_b64_tr_b16 v[198:199], v236 offset:8704
buffer_load_dwordx4 v225, s[28:31], s52 offen offset:1152 nt lds
v_cvt_pk_bf16_f32 v36, v40, v41
v_mfma_f32_16x16x32_bf16 a[136:139], v[176:179], a[212:215], 0
ds_read_b64_tr_b16 v[200:201], v236 offset:12288
s_add_u32 m0, s48, 155392
v_exp_f32 v42, v42
v_mfma_f32_16x16x32_bf16 a[132:135], v[180:183], a[208:211], 0
ds_read_b64_tr_b16 v[202:203], v237 offset:12800
buffer_load_dwordx4 v224, s[28:31], s52 offen offset:256 nt lds
v_mfma_f32_16x16x32_bf16 a[140:143], v[180:183], a[212:215], 0
ds_read_b64_tr_b16 v[204:205], v237 offset:12288
v_exp_f32 v43, v43
v_fma_f32 v44, v44, s51, -v243
s_waitcnt lgkmcnt(7)
v_mfma_f32_16x16x32_bf16 a[128:131], v[184:187], a[216:219], a[128:131]
ds_read_b64_tr_b16 v[206:207], v236 offset:12800
v_fma_f32 v45, v45, s51, -v243
v_add_f32 v245, v245, v42
v_add_f32 v245, v245, v43
v_mfma_f32_16x16x32_bf16 a[136:139], v[184:187], a[220:223], a[136:139]
ds_read_b64_tr_b16 v[176:177], v236 offset:16384
buffer_load_dwordx4 v225, s[28:31], s52 offen offset:1280 nt lds
v_cvt_pk_bf16_f32 v37, v42, v43
v_mfma_f32_16x16x32_bf16 a[132:135], v[188:191], a[216:219], a[132:135]
ds_read_b64_tr_b16 v[178:179], v237 offset:16896
v_exp_f32 v44, v44
v_mfma_f32_16x16x32_bf16 a[140:143], v[188:191], a[220:223], a[140:143]
ds_read_b64_tr_b16 v[180:181], v237 offset:16384
v_exp_f32 v45, v45
v_fma_f32 v46, v46, s51, -v243
s_waitcnt lgkmcnt(7)
v_mfma_f32_16x16x32_bf16 a[128:131], v[192:195], a[224:227], a[128:131]
ds_read_b64_tr_b16 v[182:183], v236 offset:16896
v_fma_f32 v47, v47, s51, -v243
v_add_f32 v245, v245, v44
v_add_f32 v245, v245, v45
v_mfma_f32_16x16x32_bf16 a[136:139], v[192:195], a[228:231], a[136:139]
ds_read_b64_tr_b16 v[184:185], v236 offset:20480
v_cvt_pk_bf16_f32 v38, v44, v45
v_exp_f32 v46, v46
v_mfma_f32_16x16x32_bf16 a[132:135], v[196:199], a[224:227], a[132:135]
ds_read_b64_tr_b16 v[186:187], v237 offset:20992
v_exp_f32 v47, v47
v_add_f32 v245, v245, v46
v_mfma_f32_16x16x32_bf16 a[140:143], v[196:199], a[228:231], a[140:143]
ds_read_b64_tr_b16 v[188:189], v237 offset:20480
v_add_f32 v245, v245, v47
v_cvt_pk_bf16_f32 v39, v46, v47
ds_write_b128 v239, v[32:35] offset:8192
ds_write_b128 v239, v[36:39] offset:9216
s_waitcnt lgkmcnt(9)
v_mfma_f32_16x16x32_bf16 a[128:131], v[200:203], a[232:235], a[128:131]
ds_read_b64_tr_b16 v[190:191], v236 offset:20992
v_mfma_f32_16x16x32_bf16 a[136:139], v[200:203], a[236:239], a[136:139]
v_mfma_f32_16x16x32_bf16 a[132:135], v[204:207], a[232:235], a[132:135]
v_mfma_f32_16x16x32_bf16 a[140:143], v[204:207], a[236:239], a[140:143]
v_add_u32 v236, 90112, v250
v_xor_b32 v237, 32, v236
s_waitcnt lgkmcnt(6)
v_mfma_f32_16x16x32_bf16 a[128:131], v[176:179], a[240:243], a[128:131]
v_xor_b32 v232, 0x1000, v236
v_xor_b32 v233, 0x1000, v237
v_mfma_f32_16x16x32_bf16 a[136:139], v[176:179], a[244:247], a[136:139]
s_waitcnt vmcnt(12) lgkmcnt(0)
s_barrier
ds_read_b64_tr_b16 v[192:193], v236 offset:0
ds_read_b64_tr_b16 v[194:195], v236 offset:2048
ds_read_b64_tr_b16 v[196:197], v237 offset:0
ds_read_b64_tr_b16 v[198:199], v237 offset:2048
ds_read_b64_tr_b16 v[200:201], v236 offset:8192
ds_read_b64_tr_b16 v[202:203], v236 offset:10240
v_mfma_f32_16x16x32_bf16 a[132:135], v[180:183], a[240:243], a[132:135]
v_fma_f32 v48, v48, s51, -v242
v_fma_f32 v49, v49, s51, -v242
v_exp_f32 v48, v48
v_mfma_f32_16x16x32_bf16 a[140:143], v[180:183], a[244:247], a[140:143]
ds_read_b64_tr_b16 v[204:205], v237 offset:8192
v_exp_f32 v49, v49
v_mfma_f32_16x16x32_bf16 a[128:131], v[184:187], a[248:251], a[128:131]
ds_read_b64_tr_b16 v[206:207], v237 offset:10240
v_fma_f32 v50, v50, s51, -v242
v_fma_f32 v51, v51, s51, -v242
v_mfma_f32_16x16x32_bf16 a[136:139], v[184:187], a[252:255], a[136:139]
ds_read_b64_tr_b16 v[176:177], v236 offset:16384
v_add_f32 v244, v244, v48
v_add_f32 v244, v244, v49
v_mfma_f32_16x16x32_bf16 a[132:135], v[188:191], a[248:251], a[132:135]
ds_read_b64_tr_b16 v[178:179], v236 offset:18432
v_cvt_pk_bf16_f32 v48, v48, v49
v_exp_f32 v50, v50
v_mfma_f32_16x16x32_bf16 a[140:143], v[188:191], a[252:255], a[140:143]
ds_read_b64_tr_b16 v[180:181], v237 offset:16384
v_exp_f32 v51, v51
s_waitcnt lgkmcnt(7)
v_mfma_f32_16x16x32_bf16 a[160:163], v[192:195], v[32:35], a[160:163]
ds_read_b64_tr_b16 v[182:183], v237 offset:18432
v_fma_f32 v52, v52, s51, -v242
v_fma_f32 v53, v53, s51, -v242
v_mfma_f32_16x16x32_bf16 a[168:171], v[192:195], v[36:39], a[168:171]
ds_read_b128 v[40:43], v234 offset:8192
ds_read_b128 v[44:47], v234 offset:9216
v_add_f32 v244, v244, v50
v_mfma_f32_16x16x32_bf16 a[164:167], v[196:199], v[32:35], a[164:167]
ds_read_b64_tr_b16 v[184:185], v232 offset:0
ds_read_b64_tr_b16 v[186:187], v232 offset:2048
s_add_u32 m0, s48, 0
v_add_f32 v244, v244, v51
v_mfma_f32_16x16x32_bf16 a[172:175], v[196:199], v[36:39], a[172:175]
ds_read_b64_tr_b16 v[188:189], v233 offset:0
buffer_load_dwordx4 v228, s[40:43], s66 offen lds
s_waitcnt lgkmcnt(9)
v_mfma_f32_16x16x32_bf16 a[176:179], v[200:203], v[32:35], a[176:179]
ds_read_b64_tr_b16 v[190:191], v233 offset:2048
v_cvt_pk_bf16_f32 v49, v50, v51
v_exp_f32 v52, v52
v_mfma_f32_16x16x32_bf16 a[184:187], v[200:203], v[36:39], a[184:187]
ds_read_b64_tr_b16 v[192:193], v232 offset:8192
buffer_load_dwordx4 v229, s[40:43], s66 offen offset:1024 lds
v_mfma_f32_16x16x32_bf16 a[180:183], v[204:207], v[32:35], a[180:183]
ds_read_b64_tr_b16 v[194:195], v232 offset:10240
s_mul_i32 s52, s66, 6144
s_add_u32 s52, s52, 6144
s_add_u32 m0, s48, 65536
v_mfma_f32_16x16x32_bf16 a[188:191], v[204:207], v[36:39], a[188:191]
ds_read_b64_tr_b16 v[196:197], v233 offset:8192
buffer_load_dwordx4 v226, s[32:35], s52 offen lds
s_waitcnt lgkmcnt(9)
v_mfma_f32_16x16x32_bf16 a[192:195], v[176:179], v[32:35], a[192:195]
ds_read_b64_tr_b16 v[198:199], v233 offset:10240
v_exp_f32 v53, v53
v_mfma_f32_16x16x32_bf16 a[200:203], v[176:179], v[36:39], a[200:203]
ds_read_b64_tr_b16 v[200:201], v232 offset:16384
buffer_load_dwordx4 v227, s[32:35], s52 offen offset:1024 lds
v_mfma_f32_16x16x32_bf16 a[196:199], v[180:183], v[32:35], a[196:199]
ds_read_b64_tr_b16 v[202:203], v232 offset:18432
s_add_u32 m0, s48, 73600
v_fma_f32 v54, v54, s51, -v242
v_fma_f32 v55, v55, s51, -v242
v_mfma_f32_16x16x32_bf16 a[204:207], v[180:183], v[36:39], a[204:207]
ds_read_b64_tr_b16 v[204:205], v233 offset:16384
buffer_load_dwordx4 v226, s[32:35], s52 offen offset:128 lds
s_waitcnt lgkmcnt(7)
v_mfma_f32_16x16x32_bf16 a[160:163], v[184:187], v[40:43], a[160:163]
ds_read_b64_tr_b16 v[206:207], v233 offset:18432
v_add_f32 v244, v244, v52
v_add_f32 v244, v244, v53
v_mfma_f32_16x16x32_bf16 a[168:171], v[184:187], v[44:47], a[168:171]
buffer_load_dwordx4 v227, s[32:35], s52 offen offset:1152 lds
v_cvt_pk_bf16_f32 v50, v52, v53
v_mfma_f32_16x16x32_bf16 a[164:167], v[188:191], v[40:43], a[164:167]
s_add_u32 m0, s48, 81664
v_exp_f32 v54, v54
v_mfma_f32_16x16x32_bf16 a[172:175], v[188:191], v[44:47], a[172:175]
buffer_load_dwordx4 v226, s[32:35], s52 offen offset:256 lds
v_add_u32 v236, 114688, v230
v_xor_b32 v237, 32, v236
s_waitcnt lgkmcnt(4)
v_mfma_f32_16x16x32_bf16 a[176:179], v[192:195], v[40:43], a[176:179]
v_exp_f32 v55, v55
v_fma_f32 v56, v56, s51, -v243
v_fma_f32 v57, v57, s51, -v243
v_mfma_f32_16x16x32_bf16 a[184:187], v[192:195], v[44:47], a[184:187]
buffer_load_dwordx4 v227, s[32:35], s52 offen offset:1280 lds
v_add_f32 v244, v244, v54
s_waitcnt vmcnt(14) lgkmcnt(0)
s_barrier
ds_read_b64_tr_b16 v[176:177], v236 offset:0
ds_read_b64_tr_b16 v[178:179], v237 offset:512
ds_read_b64_tr_b16 v[180:181], v237 offset:0
ds_read_b64_tr_b16 v[182:183], v236 offset:512
ds_read_b64_tr_b16 v[184:185], v236 offset:4096
ds_read_b64_tr_b16 v[186:187], v237 offset:4608
v_mfma_f32_16x16x32_bf16 a[180:183], v[196:199], v[40:43], a[180:183]
s_mov_b32 s52, 1671168
s_add_u32 m0, s48, 90112
s_nop 0
buffer_load_dwordx4 v224, s[28:31], s52 offen nt lds
v_add_f32 v244, v244, v55
v_mfma_f32_16x16x32_bf16 a[188:191], v[196:199], v[44:47], a[188:191]
ds_read_b64_tr_b16 v[188:189], v237 offset:4096
v_cvt_pk_bf16_f32 v51, v54, v55
v_exp_f32 v56, v56
v_mfma_f32_16x16x32_bf16 a[192:195], v[200:203], v[40:43], a[192:195]
ds_read_b64_tr_b16 v[190:191], v236 offset:4608
buffer_load_dwordx4 v225, s[28:31], s52 offen offset:1024 nt lds
v_mfma_f32_16x16x32_bf16 a[200:203], v[200:203], v[44:47], a[200:203]
ds_read_b64_tr_b16 v[192:193], v236 offset:8192
s_add_u32 m0, s48, 98176
v_exp_f32 v57, v57
v_mfma_f32_16x16x32_bf16 a[196:199], v[204:207], v[40:43], a[196:199]
ds_read_b64_tr_b16 v[194:195], v237 offset:8704
buffer_load_dwordx4 v224, s[28:31], s52 offen offset:128 nt lds
v_fma_f32 v58, v58, s51, -v243
v_mfma_f32_16x16x32_bf16 a[204:207], v[204:207], v[44:47], a[204:207]
ds_read_b64_tr_b16 v[196:197], v237 offset:8192
v_fma_f32 v59, v59, s51, -v243
v_add_f32 v245, v245, v56
v_add_f32 v245, v245, v57
s_waitcnt lgkmcnt(7)
v_mfma_f32_16x16x32_bf16 a[144:147], v[176:179], a[208:211], 0
ds_read_b64_tr_b16 v[198:199], v236 offset:8704
buffer_load_dwordx4 v225, s[28:31], s52 offen offset:1152 nt lds
v_cvt_pk_bf16_f32 v52, v56, v57
v_mfma_f32_16x16x32_bf16 a[152:155], v[176:179], a[212:215], 0
ds_read_b64_tr_b16 v[200:201], v236 offset:12288
s_add_u32 m0, s48, 106240
v_exp_f32 v58, v58
v_mfma_f32_16x16x32_bf16 a[148:151], v[180:183], a[208:211], 0
ds_read_b64_tr_b16 v[202:203], v237 offset:12800
buffer_load_dwordx4 v224, s[28:31], s52 offen offset:256 nt lds
v_mfma_f32_16x16x32_bf16 a[156:159], v[180:183], a[212:215], 0
ds_read_b64_tr_b16 v[204:205], v237 offset:12288
v_exp_f32 v59, v59
v_fma_f32 v60, v60, s51, -v243
s_waitcnt lgkmcnt(7)
v_mfma_f32_16x16x32_bf16 a[144:147], v[184:187], a[216:219], a[144:147]
ds_read_b64_tr_b16 v[206:207], v236 offset:12800
v_fma_f32 v61, v61, s51, -v243
v_add_f32 v245, v245, v58
v_add_f32 v245, v245, v59
v_mfma_f32_16x16x32_bf16 a[152:155], v[184:187], a[220:223], a[152:155]
ds_read_b64_tr_b16 v[176:177], v236 offset:16384
buffer_load_dwordx4 v225, s[28:31], s52 offen offset:1280 nt lds
v_cvt_pk_bf16_f32 v53, v58, v59
v_mfma_f32_16x16x32_bf16 a[148:151], v[188:191], a[216:219], a[148:151]
ds_read_b64_tr_b16 v[178:179], v237 offset:16896
v_exp_f32 v60, v60
v_mfma_f32_16x16x32_bf16 a[156:159], v[188:191], a[220:223], a[156:159]
ds_read_b64_tr_b16 v[180:181], v237 offset:16384
v_exp_f32 v61, v61
v_fma_f32 v62, v62, s51, -v243
s_waitcnt lgkmcnt(7)
v_mfma_f32_16x16x32_bf16 a[144:147], v[192:195], a[224:227], a[144:147]
ds_read_b64_tr_b16 v[182:183], v236 offset:16896
v_fma_f32 v63, v63, s51, -v243
v_add_f32 v245, v245, v60
v_add_f32 v245, v245, v61
v_mfma_f32_16x16x32_bf16 a[152:155], v[192:195], a[228:231], a[152:155]
ds_read_b64_tr_b16 v[184:185], v236 offset:20480
v_cvt_pk_bf16_f32 v54, v60, v61
v_exp_f32 v62, v62
v_mfma_f32_16x16x32_bf16 a[148:151], v[196:199], a[224:227], a[148:151]
ds_read_b64_tr_b16 v[186:187], v237 offset:20992
v_exp_f32 v63, v63
v_add_f32 v245, v245, v62
v_mfma_f32_16x16x32_bf16 a[156:159], v[196:199], a[228:231], a[156:159]
ds_read_b64_tr_b16 v[188:189], v237 offset:20480
v_add_f32 v245, v245, v63
v_cvt_pk_bf16_f32 v55, v62, v63
ds_write_b128 v239, v[48:51] offset:24576
ds_write_b128 v239, v[52:55] offset:25600
s_waitcnt lgkmcnt(9)
v_mfma_f32_16x16x32_bf16 a[144:147], v[200:203], a[232:235], a[144:147]
ds_read_b64_tr_b16 v[190:191], v236 offset:20992
v_mfma_f32_16x16x32_bf16 a[152:155], v[200:203], a[236:239], a[152:155]
v_mfma_f32_16x16x32_bf16 a[148:151], v[204:207], a[232:235], a[148:151]
v_mfma_f32_16x16x32_bf16 a[156:159], v[204:207], a[236:239], a[156:159]
v_add_u32 v236, 139264, v250
v_xor_b32 v237, 32, v236
s_waitcnt lgkmcnt(6)
v_mfma_f32_16x16x32_bf16 a[144:147], v[176:179], a[240:243], a[144:147]
v_xor_b32 v232, 0x1000, v236
v_xor_b32 v233, 0x1000, v237
v_mfma_f32_16x16x32_bf16 a[152:155], v[176:179], a[244:247], a[152:155]
s_waitcnt vmcnt(14) lgkmcnt(0)
s_barrier
ds_read_b64_tr_b16 v[192:193], v236 offset:0
ds_read_b64_tr_b16 v[194:195], v236 offset:2048
ds_read_b64_tr_b16 v[196:197], v237 offset:0
ds_read_b64_tr_b16 v[198:199], v237 offset:2048
ds_read_b64_tr_b16 v[200:201], v236 offset:8192
ds_read_b64_tr_b16 v[202:203], v236 offset:10240
v_mfma_f32_16x16x32_bf16 a[148:151], v[180:183], a[240:243], a[148:151]
v_fma_f32 v64, v64, s51, -v242
v_fma_f32 v65, v65, s51, -v242
v_exp_f32 v64, v64
v_mfma_f32_16x16x32_bf16 a[156:159], v[180:183], a[244:247], a[156:159]
ds_read_b64_tr_b16 v[204:205], v237 offset:8192
v_exp_f32 v65, v65
v_mfma_f32_16x16x32_bf16 a[144:147], v[184:187], a[248:251], a[144:147]
ds_read_b64_tr_b16 v[206:207], v237 offset:10240
v_fma_f32 v66, v66, s51, -v242
v_fma_f32 v67, v67, s51, -v242
v_mfma_f32_16x16x32_bf16 a[152:155], v[184:187], a[252:255], a[152:155]
ds_read_b64_tr_b16 v[176:177], v236 offset:16384
v_add_f32 v244, v244, v64
v_add_f32 v244, v244, v65
v_cvt_pk_bf16_f32 v64, v64, v65
v_mfma_f32_16x16x32_bf16 a[148:151], v[188:191], a[248:251], a[148:151]
ds_read_b64_tr_b16 v[178:179], v236 offset:18432
v_exp_f32 v66, v66
v_mfma_f32_16x16x32_bf16 a[156:159], v[188:191], a[252:255], a[156:159]
ds_read_b64_tr_b16 v[180:181], v237 offset:16384
v_exp_f32 v67, v67
v_fma_f32 v68, v68, s51, -v242
s_waitcnt lgkmcnt(7)
v_mfma_f32_16x16x32_bf16 a[160:163], v[192:195], v[48:51], a[160:163]
ds_read_b64_tr_b16 v[182:183], v237 offset:18432
v_fma_f32 v69, v69, s51, -v242
v_add_f32 v244, v244, v66
v_mfma_f32_16x16x32_bf16 a[168:171], v[192:195], v[52:55], a[168:171]
ds_read_b128 v[56:59], v234 offset:24576
ds_read_b128 v[60:63], v234 offset:25600
v_add_f32 v244, v244, v67
v_cvt_pk_bf16_f32 v65, v66, v67
v_mfma_f32_16x16x32_bf16 a[164:167], v[196:199], v[48:51], a[164:167]
ds_read_b64_tr_b16 v[184:185], v232 offset:0
ds_read_b64_tr_b16 v[186:187], v232 offset:2048
s_add_u32 m0, s48, 16384
v_mfma_f32_16x16x32_bf16 a[172:175], v[196:199], v[52:55], a[172:175]
ds_read_b64_tr_b16 v[188:189], v233 offset:0
buffer_load_dwordx4 v228, s[40:43], s67 offen lds
s_waitcnt lgkmcnt(9)
v_mfma_f32_16x16x32_bf16 a[176:179], v[200:203], v[48:51], a[176:179]
ds_read_b64_tr_b16 v[190:191], v233 offset:2048
v_exp_f32 v68, v68
v_mfma_f32_16x16x32_bf16 a[184:187], v[200:203], v[52:55], a[184:187]
ds_read_b64_tr_b16 v[192:193], v232 offset:8192
buffer_load_dwordx4 v229, s[40:43], s67 offen offset:1024 lds
v_mfma_f32_16x16x32_bf16 a[180:183], v[204:207], v[48:51], a[180:183]
ds_read_b64_tr_b16 v[194:195], v232 offset:10240
s_mul_i32 s52, s67, 6144
s_add_u32 s52, s52, 6144
s_add_u32 m0, s48, 114688
v_exp_f32 v69, v69
v_mfma_f32_16x16x32_bf16 a[188:191], v[204:207], v[52:55], a[188:191]
ds_read_b64_tr_b16 v[196:197], v233 offset:8192
buffer_load_dwordx4 v226, s[32:35], s52 offen lds
v_fma_f32 v70, v70, s51, -v242
s_waitcnt lgkmcnt(9)
v_mfma_f32_16x16x32_bf16 a[192:195], v[176:179], v[48:51], a[192:195]
ds_read_b64_tr_b16 v[198:199], v233 offset:10240
v_fma_f32 v71, v71, s51, -v242
v_add_f32 v244, v244, v68
v_add_f32 v244, v244, v69
v_mfma_f32_16x16x32_bf16 a[200:203], v[176:179], v[52:55], a[200:203]
ds_read_b64_tr_b16 v[200:201], v232 offset:16384
buffer_load_dwordx4 v227, s[32:35], s52 offen offset:1024 lds
v_cvt_pk_bf16_f32 v66, v68, v69
v_mfma_f32_16x16x32_bf16 a[196:199], v[180:183], v[48:51], a[196:199]
ds_read_b64_tr_b16 v[202:203], v232 offset:18432
s_add_u32 m0, s48, 122752
v_exp_f32 v70, v70
v_mfma_f32_16x16x32_bf16 a[204:207], v[180:183], v[52:55], a[204:207]
ds_read_b64_tr_b16 v[204:205], v233 offset:16384
buffer_load_dwordx4 v226, s[32:35], s52 offen offset:128 lds
s_waitcnt lgkmcnt(7)
v_mfma_f32_16x16x32_bf16 a[160:163], v[184:187], v[56:59], a[160:163]
ds_read_b64_tr_b16 v[206:207], v233 offset:18432
v_exp_f32 v71, v71
v_fma_f32 v72, v72, s51, -v243
v_mfma_f32_16x16x32_bf16 a[168:171], v[184:187], v[60:63], a[168:171]
buffer_load_dwordx4 v227, s[32:35], s52 offen offset:1152 lds
v_fma_f32 v73, v73, s51, -v243
v_mfma_f32_16x16x32_bf16 a[164:167], v[188:191], v[56:59], a[164:167]
s_add_u32 m0, s48, 130816
v_add_f32 v244, v244, v70
v_add_f32 v244, v244, v71
v_cvt_pk_bf16_f32 v67, v70, v71
v_mfma_f32_16x16x32_bf16 a[172:175], v[188:191], v[60:63], a[172:175]
buffer_load_dwordx4 v226, s[32:35], s52 offen offset:256 lds
s_add_u32 s53, s50, 0
v_add_u32 v232, s53, v231
s_waitcnt lgkmcnt(4)
v_mfma_f32_16x16x32_bf16 a[176:179], v[192:195], v[56:59], a[176:179]
v_xor_b32 v233, 64, v232
v_add_u32 v236, 65536, v230
v_exp_f32 v72, v72
v_mfma_f32_16x16x32_bf16 a[184:187], v[192:195], v[60:63], a[184:187]
buffer_load_dwordx4 v227, s[32:35], s52 offen offset:1280 lds
v_xor_b32 v237, 32, v236
s_waitcnt vmcnt(14) lgkmcnt(0)
s_barrier
ds_read_b128 v[208:211], v232 offset:0
ds_read_b128 v[212:215], v232 offset:2048
ds_read_b64_tr_b16 v[176:177], v236 offset:0
ds_read_b64_tr_b16 v[178:179], v237 offset:512
ds_read_b64_tr_b16 v[180:181], v237 offset:0
ds_read_b64_tr_b16 v[182:183], v236 offset:512
ds_read_b64_tr_b16 v[184:185], v236 offset:8192
ds_read_b64_tr_b16 v[186:187], v237 offset:8704
v_mfma_f32_16x16x32_bf16 a[180:183], v[196:199], v[56:59], a[180:183]
s_mov_b32 s52, 1695744
s_add_u32 m0, s48, 139264
s_nop 0
buffer_load_dwordx4 v224, s[28:31], s52 offen nt lds
v_mfma_f32_16x16x32_bf16 a[188:191], v[196:199], v[60:63], a[188:191]
ds_read_b64_tr_b16 v[188:189], v237 offset:8192
v_exp_f32 v73, v73
v_fma_f32 v74, v74, s51, -v243
v_mfma_f32_16x16x32_bf16 a[192:195], v[200:203], v[56:59], a[192:195]
ds_read_b64_tr_b16 v[190:191], v236 offset:8704
buffer_load_dwordx4 v225, s[28:31], s52 offen offset:1024 nt lds
v_fma_f32 v75, v75, s51, -v243
v_mfma_f32_16x16x32_bf16 a[200:203], v[200:203], v[60:63], a[200:203]
ds_read_b64_tr_b16 v[192:193], v236 offset:16384
s_add_u32 m0, s48, 147328
v_add_f32 v245, v245, v72
v_add_f32 v245, v245, v73
v_mfma_f32_16x16x32_bf16 a[196:199], v[204:207], v[56:59], a[196:199]
ds_read_b64_tr_b16 v[194:195], v237 offset:16896
buffer_load_dwordx4 v224, s[28:31], s52 offen offset:128 nt lds
v_cvt_pk_bf16_f32 v68, v72, v73
v_mfma_f32_16x16x32_bf16 a[204:207], v[204:207], v[60:63], a[204:207]
ds_read_b64_tr_b16 v[196:197], v237 offset:16384
v_exp_f32 v74, v74
s_waitcnt lgkmcnt(7)
v_mfma_f32_16x16x32_bf16 v[128:131], v[176:179], v[208:211], v[128:131]
ds_read_b64_tr_b16 v[198:199], v236 offset:16896
buffer_load_dwordx4 v225, s[28:31], s52 offen offset:1152 nt lds
v_mfma_f32_16x16x32_bf16 v[136:139], v[176:179], v[212:215], v[136:139]
ds_read_b128 v[216:219], v233 offset:0
ds_read_b128 v[220:223], v233 offset:2048
s_add_u32 m0, s48, 155392
v_exp_f32 v75, v75
v_mfma_f32_16x16x32_bf16 v[132:135], v[180:183], v[208:211], v[132:135]
ds_read_b64_tr_b16 v[200:201], v236 offset:4096
ds_read_b64_tr_b16 v[202:203], v237 offset:4608
buffer_load_dwordx4 v224, s[28:31], s52 offen offset:256 nt lds
v_mfma_f32_16x16x32_bf16 v[140:143], v[180:183], v[212:215], v[140:143]
ds_read_b64_tr_b16 v[204:205], v237 offset:4096
v_fma_f32 v76, v76, s51, -v243
v_fma_f32 v77, v77, s51, -v243
v_add_f32 v245, v245, v74
s_waitcnt lgkmcnt(9)
v_mfma_f32_16x16x32_bf16 v[144:147], v[184:187], v[208:211], v[144:147]
ds_read_b64_tr_b16 v[206:207], v236 offset:4608
v_add_f32 v245, v245, v75
v_cvt_pk_bf16_f32 v69, v74, v75
v_mfma_f32_16x16x32_bf16 v[152:155], v[184:187], v[212:215], v[152:155]
ds_read_b64_tr_b16 v[176:177], v236 offset:12288
buffer_load_dwordx4 v225, s[28:31], s52 offen offset:1280 nt lds
v_mfma_f32_16x16x32_bf16 v[148:151], v[188:191], v[208:211], v[148:151]
ds_read_b64_tr_b16 v[178:179], v237 offset:12800
v_exp_f32 v76, v76
v_mfma_f32_16x16x32_bf16 v[156:159], v[188:191], v[212:215], v[156:159]
ds_read_b64_tr_b16 v[180:181], v237 offset:12288
v_exp_f32 v77, v77
v_fma_f32 v78, v78, s51, -v243
s_waitcnt lgkmcnt(9)
v_mfma_f32_16x16x32_bf16 v[160:163], v[192:195], v[208:211], v[160:163]
ds_read_b64_tr_b16 v[182:183], v236 offset:12800
v_fma_f32 v79, v79, s51, -v243
v_add_f32 v245, v245, v76
v_add_f32 v245, v245, v77
v_mfma_f32_16x16x32_bf16 v[168:171], v[192:195], v[212:215], v[168:171]
ds_read_b64_tr_b16 v[184:185], v236 offset:20480
v_cvt_pk_bf16_f32 v70, v76, v77
v_exp_f32 v78, v78
v_mfma_f32_16x16x32_bf16 v[164:167], v[196:199], v[208:211], v[164:167]
ds_read_b64_tr_b16 v[186:187], v237 offset:20992
v_exp_f32 v79, v79
v_add_f32 v245, v245, v78
v_mfma_f32_16x16x32_bf16 v[172:175], v[196:199], v[212:215], v[172:175]
ds_read_b64_tr_b16 v[188:189], v237 offset:20480
v_add_f32 v245, v245, v79
v_cvt_pk_bf16_f32 v71, v78, v79
ds_write_b128 v239, v[64:67] offset:8192
ds_write_b128 v239, v[68:71] offset:9216
s_waitcnt lgkmcnt(9)
v_mfma_f32_16x16x32_bf16 v[128:131], v[200:203], v[216:219], v[128:131]
ds_read_b64_tr_b16 v[190:191], v236 offset:20992
v_mfma_f32_16x16x32_bf16 v[136:139], v[200:203], v[220:223], v[136:139]
v_mfma_f32_16x16x32_bf16 v[132:135], v[204:207], v[216:219], v[132:135]
v_mfma_f32_16x16x32_bf16 v[140:143], v[204:207], v[220:223], v[140:143]
v_add_u32 v236, 90112, v250
v_xor_b32 v237, 32, v236
s_waitcnt lgkmcnt(6)
v_mfma_f32_16x16x32_bf16 v[144:147], v[176:179], v[216:219], v[144:147]
v_xor_b32 v232, 0x1000, v236
v_xor_b32 v233, 0x1000, v237
v_mfma_f32_16x16x32_bf16 v[152:155], v[176:179], v[220:223], v[152:155]
s_waitcnt vmcnt(14) lgkmcnt(0)
s_barrier
ds_read_b64_tr_b16 v[192:193], v236 offset:0
ds_read_b64_tr_b16 v[194:195], v236 offset:2048
ds_read_b64_tr_b16 v[196:197], v237 offset:0
ds_read_b64_tr_b16 v[198:199], v237 offset:2048
ds_read_b64_tr_b16 v[200:201], v236 offset:8192
ds_read_b64_tr_b16 v[202:203], v236 offset:10240
v_mfma_f32_16x16x32_bf16 v[148:151], v[180:183], v[216:219], v[148:151]
v_fma_f32 v80, v80, s51, -v242
v_fma_f32 v81, v81, s51, -v242
v_exp_f32 v80, v80
v_mfma_f32_16x16x32_bf16 v[156:159], v[180:183], v[220:223], v[156:159]
ds_read_b64_tr_b16 v[204:205], v237 offset:8192
v_exp_f32 v81, v81
v_mfma_f32_16x16x32_bf16 v[160:163], v[184:187], v[216:219], v[160:163]
ds_read_b64_tr_b16 v[206:207], v237 offset:10240
v_fma_f32 v82, v82, s51, -v242
v_fma_f32 v83, v83, s51, -v242
v_mfma_f32_16x16x32_bf16 v[168:171], v[184:187], v[220:223], v[168:171]
ds_read_b64_tr_b16 v[176:177], v236 offset:16384
v_add_f32 v244, v244, v80
v_add_f32 v244, v244, v81
v_cvt_pk_bf16_f32 v80, v80, v81
v_mfma_f32_16x16x32_bf16 v[164:167], v[188:191], v[216:219], v[164:167]
ds_read_b64_tr_b16 v[178:179], v236 offset:18432
v_exp_f32 v82, v82
v_mfma_f32_16x16x32_bf16 v[172:175], v[188:191], v[220:223], v[172:175]
ds_read_b64_tr_b16 v[180:181], v237 offset:16384
v_exp_f32 v83, v83
v_fma_f32 v84, v84, s51, -v242
s_waitcnt lgkmcnt(7)
v_mfma_f32_16x16x32_bf16 a[160:163], v[192:195], v[64:67], a[160:163]
ds_read_b64_tr_b16 v[182:183], v237 offset:18432
v_fma_f32 v85, v85, s51, -v242
v_add_f32 v244, v244, v82
v_mfma_f32_16x16x32_bf16 a[168:171], v[192:195], v[68:71], a[168:171]
ds_read_b128 v[72:75], v234 offset:8192
ds_read_b128 v[76:79], v234 offset:9216
v_add_f32 v244, v244, v83
v_cvt_pk_bf16_f32 v81, v82, v83
v_mfma_f32_16x16x32_bf16 a[164:167], v[196:199], v[64:67], a[164:167]
ds_read_b64_tr_b16 v[184:185], v232 offset:0
ds_read_b64_tr_b16 v[186:187], v232 offset:2048
s_add_u32 m0, s48, 0
v_mfma_f32_16x16x32_bf16 a[172:175], v[196:199], v[68:71], a[172:175]
ds_read_b64_tr_b16 v[188:189], v233 offset:0
buffer_load_dwordx4 v228, s[40:43], s68 offen lds
s_waitcnt lgkmcnt(9)
v_mfma_f32_16x16x32_bf16 a[176:179], v[200:203], v[64:67], a[176:179]
ds_read_b64_tr_b16 v[190:191], v233 offset:2048
v_exp_f32 v84, v84
v_mfma_f32_16x16x32_bf16 a[184:187], v[200:203], v[68:71], a[184:187]
ds_read_b64_tr_b16 v[192:193], v232 offset:8192
buffer_load_dwordx4 v229, s[40:43], s68 offen offset:1024 lds
v_mfma_f32_16x16x32_bf16 a[180:183], v[204:207], v[64:67], a[180:183]
ds_read_b64_tr_b16 v[194:195], v232 offset:10240
s_mul_i32 s52, s68, 6144
s_add_u32 s52, s52, 6144
s_add_u32 m0, s48, 65536
v_exp_f32 v85, v85
v_mfma_f32_16x16x32_bf16 a[188:191], v[204:207], v[68:71], a[188:191]
ds_read_b64_tr_b16 v[196:197], v233 offset:8192
buffer_load_dwordx4 v226, s[32:35], s52 offen lds
v_fma_f32 v86, v86, s51, -v242
s_waitcnt lgkmcnt(9)
v_mfma_f32_16x16x32_bf16 a[192:195], v[176:179], v[64:67], a[192:195]
ds_read_b64_tr_b16 v[198:199], v233 offset:10240
v_fma_f32 v87, v87, s51, -v242
v_add_f32 v244, v244, v84
v_add_f32 v244, v244, v85
v_mfma_f32_16x16x32_bf16 a[200:203], v[176:179], v[68:71], a[200:203]
ds_read_b64_tr_b16 v[200:201], v232 offset:16384
buffer_load_dwordx4 v227, s[32:35], s52 offen offset:1024 lds
v_cvt_pk_bf16_f32 v82, v84, v85
v_mfma_f32_16x16x32_bf16 a[196:199], v[180:183], v[64:67], a[196:199]
ds_read_b64_tr_b16 v[202:203], v232 offset:18432
s_add_u32 m0, s48, 73600
v_exp_f32 v86, v86
v_mfma_f32_16x16x32_bf16 a[204:207], v[180:183], v[68:71], a[204:207]
ds_read_b64_tr_b16 v[204:205], v233 offset:16384
buffer_load_dwordx4 v226, s[32:35], s52 offen offset:128 lds
s_waitcnt lgkmcnt(7)
v_mfma_f32_16x16x32_bf16 a[160:163], v[184:187], v[72:75], a[160:163]
ds_read_b64_tr_b16 v[206:207], v233 offset:18432
v_exp_f32 v87, v87
v_fma_f32 v88, v88, s51, -v243
v_mfma_f32_16x16x32_bf16 a[168:171], v[184:187], v[76:79], a[168:171]
buffer_load_dwordx4 v227, s[32:35], s52 offen offset:1152 lds
v_fma_f32 v89, v89, s51, -v243
v_mfma_f32_16x16x32_bf16 a[164:167], v[188:191], v[72:75], a[164:167]
s_add_u32 m0, s48, 81664
v_add_f32 v244, v244, v86
v_add_f32 v244, v244, v87
v_cvt_pk_bf16_f32 v83, v86, v87
v_mfma_f32_16x16x32_bf16 a[172:175], v[188:191], v[76:79], a[172:175]
buffer_load_dwordx4 v226, s[32:35], s52 offen offset:256 lds
s_add_u32 s53, s50, 16384
v_add_u32 v232, s53, v231
s_waitcnt lgkmcnt(4)
v_mfma_f32_16x16x32_bf16 a[176:179], v[192:195], v[72:75], a[176:179]
v_xor_b32 v233, 64, v232
v_add_u32 v236, 114688, v230
v_exp_f32 v88, v88
v_mfma_f32_16x16x32_bf16 a[184:187], v[192:195], v[76:79], a[184:187]
buffer_load_dwordx4 v227, s[32:35], s52 offen offset:1280 lds
v_xor_b32 v237, 32, v236
s_waitcnt vmcnt(14) lgkmcnt(0)
s_barrier
ds_read_b128 v[208:211], v232 offset:0
ds_read_b128 v[212:215], v232 offset:2048
ds_read_b64_tr_b16 v[176:177], v236 offset:0
ds_read_b64_tr_b16 v[178:179], v237 offset:512
ds_read_b64_tr_b16 v[180:181], v237 offset:0
ds_read_b64_tr_b16 v[182:183], v236 offset:512
ds_read_b64_tr_b16 v[184:185], v236 offset:8192
ds_read_b64_tr_b16 v[186:187], v237 offset:8704
v_mfma_f32_16x16x32_bf16 a[180:183], v[196:199], v[72:75], a[180:183]
s_mov_b32 s52, 1720320
s_add_u32 m0, s48, 90112
s_nop 0
buffer_load_dwordx4 v224, s[28:31], s52 offen nt lds
v_mfma_f32_16x16x32_bf16 a[188:191], v[196:199], v[76:79], a[188:191]
ds_read_b64_tr_b16 v[188:189], v237 offset:8192
v_exp_f32 v89, v89
v_fma_f32 v90, v90, s51, -v243
v_mfma_f32_16x16x32_bf16 a[192:195], v[200:203], v[72:75], a[192:195]
ds_read_b64_tr_b16 v[190:191], v236 offset:8704
buffer_load_dwordx4 v225, s[28:31], s52 offen offset:1024 nt lds
v_fma_f32 v91, v91, s51, -v243
v_mfma_f32_16x16x32_bf16 a[200:203], v[200:203], v[76:79], a[200:203]
ds_read_b64_tr_b16 v[192:193], v236 offset:16384
s_add_u32 m0, s48, 98176
v_add_f32 v245, v245, v88
v_add_f32 v245, v245, v89
v_mfma_f32_16x16x32_bf16 a[196:199], v[204:207], v[72:75], a[196:199]
ds_read_b64_tr_b16 v[194:195], v237 offset:16896
buffer_load_dwordx4 v224, s[28:31], s52 offen offset:128 nt lds
v_cvt_pk_bf16_f32 v84, v88, v89
v_mfma_f32_16x16x32_bf16 a[204:207], v[204:207], v[76:79], a[204:207]
ds_read_b64_tr_b16 v[196:197], v237 offset:16384
v_exp_f32 v90, v90
s_waitcnt lgkmcnt(7)
v_mfma_f32_16x16x32_bf16 v[128:131], v[176:179], v[208:211], v[128:131]
ds_read_b64_tr_b16 v[198:199], v236 offset:16896
buffer_load_dwordx4 v225, s[28:31], s52 offen offset:1152 nt lds
v_mfma_f32_16x16x32_bf16 v[136:139], v[176:179], v[212:215], v[136:139]
ds_read_b128 v[216:219], v233 offset:0
ds_read_b128 v[220:223], v233 offset:2048
s_add_u32 m0, s48, 106240
v_exp_f32 v91, v91
v_mfma_f32_16x16x32_bf16 v[132:135], v[180:183], v[208:211], v[132:135]
ds_read_b64_tr_b16 v[200:201], v236 offset:4096
ds_read_b64_tr_b16 v[202:203], v237 offset:4608
buffer_load_dwordx4 v224, s[28:31], s52 offen offset:256 nt lds
v_mfma_f32_16x16x32_bf16 v[140:143], v[180:183], v[212:215], v[140:143]
ds_read_b64_tr_b16 v[204:205], v237 offset:4096
v_fma_f32 v92, v92, s51, -v243
v_fma_f32 v93, v93, s51, -v243
v_add_f32 v245, v245, v90
s_waitcnt lgkmcnt(9)
v_mfma_f32_16x16x32_bf16 v[144:147], v[184:187], v[208:211], v[144:147]
ds_read_b64_tr_b16 v[206:207], v236 offset:4608
v_add_f32 v245, v245, v91
v_cvt_pk_bf16_f32 v85, v90, v91
v_mfma_f32_16x16x32_bf16 v[152:155], v[184:187], v[212:215], v[152:155]
ds_read_b64_tr_b16 v[176:177], v236 offset:12288
buffer_load_dwordx4 v225, s[28:31], s52 offen offset:1280 nt lds
v_mfma_f32_16x16x32_bf16 v[148:151], v[188:191], v[208:211], v[148:151]
ds_read_b64_tr_b16 v[178:179], v237 offset:12800
v_exp_f32 v92, v92
v_mfma_f32_16x16x32_bf16 v[156:159], v[188:191], v[212:215], v[156:159]
ds_read_b64_tr_b16 v[180:181], v237 offset:12288
v_exp_f32 v93, v93
v_fma_f32 v94, v94, s51, -v243
s_waitcnt lgkmcnt(9)
v_mfma_f32_16x16x32_bf16 v[160:163], v[192:195], v[208:211], v[160:163]
ds_read_b64_tr_b16 v[182:183], v236 offset:12800
v_fma_f32 v95, v95, s51, -v243
v_add_f32 v245, v245, v92
v_add_f32 v245, v245, v93
v_mfma_f32_16x16x32_bf16 v[168:171], v[192:195], v[212:215], v[168:171]
ds_read_b64_tr_b16 v[184:185], v236 offset:20480
v_cvt_pk_bf16_f32 v86, v92, v93
v_exp_f32 v94, v94
v_mfma_f32_16x16x32_bf16 v[164:167], v[196:199], v[208:211], v[164:167]
ds_read_b64_tr_b16 v[186:187], v237 offset:20992
v_exp_f32 v95, v95
v_add_f32 v245, v245, v94
v_mfma_f32_16x16x32_bf16 v[172:175], v[196:199], v[212:215], v[172:175]
ds_read_b64_tr_b16 v[188:189], v237 offset:20480
v_add_f32 v245, v245, v95
v_cvt_pk_bf16_f32 v87, v94, v95
ds_write_b128 v239, v[80:83] offset:24576
ds_write_b128 v239, v[84:87] offset:25600
s_waitcnt lgkmcnt(9)
v_mfma_f32_16x16x32_bf16 v[128:131], v[200:203], v[216:219], v[128:131]
ds_read_b64_tr_b16 v[190:191], v236 offset:20992
v_mfma_f32_16x16x32_bf16 v[136:139], v[200:203], v[220:223], v[136:139]
v_mfma_f32_16x16x32_bf16 v[132:135], v[204:207], v[216:219], v[132:135]
v_mfma_f32_16x16x32_bf16 v[140:143], v[204:207], v[220:223], v[140:143]
v_add_u32 v236, 139264, v250
v_xor_b32 v237, 32, v236
s_waitcnt lgkmcnt(6)
v_mfma_f32_16x16x32_bf16 v[144:147], v[176:179], v[216:219], v[144:147]
v_xor_b32 v232, 0x1000, v236
v_xor_b32 v233, 0x1000, v237
v_mfma_f32_16x16x32_bf16 v[152:155], v[176:179], v[220:223], v[152:155]
s_waitcnt vmcnt(14) lgkmcnt(0)
s_barrier
ds_read_b64_tr_b16 v[192:193], v236 offset:0
ds_read_b64_tr_b16 v[194:195], v236 offset:2048
ds_read_b64_tr_b16 v[196:197], v237 offset:0
ds_read_b64_tr_b16 v[198:199], v237 offset:2048
ds_read_b64_tr_b16 v[200:201], v236 offset:8192
ds_read_b64_tr_b16 v[202:203], v236 offset:10240
v_mfma_f32_16x16x32_bf16 v[148:151], v[180:183], v[216:219], v[148:151]
v_fma_f32 v96, v96, s51, -v242
v_fma_f32 v97, v97, s51, -v242
v_exp_f32 v96, v96
v_mfma_f32_16x16x32_bf16 v[156:159], v[180:183], v[220:223], v[156:159]
ds_read_b64_tr_b16 v[204:205], v237 offset:8192
v_exp_f32 v97, v97
v_mfma_f32_16x16x32_bf16 v[160:163], v[184:187], v[216:219], v[160:163]
ds_read_b64_tr_b16 v[206:207], v237 offset:10240
v_fma_f32 v98, v98, s51, -v242
v_fma_f32 v99, v99, s51, -v242
v_mfma_f32_16x16x32_bf16 v[168:171], v[184:187], v[220:223], v[168:171]
ds_read_b64_tr_b16 v[176:177], v236 offset:16384
v_add_f32 v244, v244, v96
v_add_f32 v244, v244, v97
v_cvt_pk_bf16_f32 v96, v96, v97
v_mfma_f32_16x16x32_bf16 v[164:167], v[188:191], v[216:219], v[164:167]
ds_read_b64_tr_b16 v[178:179], v236 offset:18432
v_exp_f32 v98, v98
v_mfma_f32_16x16x32_bf16 v[172:175], v[188:191], v[220:223], v[172:175]
ds_read_b64_tr_b16 v[180:181], v237 offset:16384
v_exp_f32 v99, v99
v_fma_f32 v100, v100, s51, -v242
s_waitcnt lgkmcnt(7)
v_mfma_f32_16x16x32_bf16 a[160:163], v[192:195], v[80:83], a[160:163]
ds_read_b64_tr_b16 v[182:183], v237 offset:18432
v_fma_f32 v101, v101, s51, -v242
v_add_f32 v244, v244, v98
v_mfma_f32_16x16x32_bf16 a[168:171], v[192:195], v[84:87], a[168:171]
ds_read_b128 v[88:91], v234 offset:24576
ds_read_b128 v[92:95], v234 offset:25600
v_add_f32 v244, v244, v99
v_cvt_pk_bf16_f32 v97, v98, v99
v_mfma_f32_16x16x32_bf16 a[164:167], v[196:199], v[80:83], a[164:167]
ds_read_b64_tr_b16 v[184:185], v232 offset:0
ds_read_b64_tr_b16 v[186:187], v232 offset:2048
s_add_u32 m0, s48, 16384
v_mfma_f32_16x16x32_bf16 a[172:175], v[196:199], v[84:87], a[172:175]
ds_read_b64_tr_b16 v[188:189], v233 offset:0
buffer_load_dwordx4 v228, s[40:43], s69 offen lds
s_waitcnt lgkmcnt(9)
v_mfma_f32_16x16x32_bf16 a[176:179], v[200:203], v[80:83], a[176:179]
ds_read_b64_tr_b16 v[190:191], v233 offset:2048
v_exp_f32 v100, v100
v_mfma_f32_16x16x32_bf16 a[184:187], v[200:203], v[84:87], a[184:187]
ds_read_b64_tr_b16 v[192:193], v232 offset:8192
buffer_load_dwordx4 v229, s[40:43], s69 offen offset:1024 lds
v_mfma_f32_16x16x32_bf16 a[180:183], v[204:207], v[80:83], a[180:183]
ds_read_b64_tr_b16 v[194:195], v232 offset:10240
s_mul_i32 s52, s69, 6144
s_add_u32 s52, s52, 6144
s_add_u32 m0, s48, 114688
v_exp_f32 v101, v101
v_mfma_f32_16x16x32_bf16 a[188:191], v[204:207], v[84:87], a[188:191]
ds_read_b64_tr_b16 v[196:197], v233 offset:8192
buffer_load_dwordx4 v226, s[32:35], s52 offen lds
v_fma_f32 v102, v102, s51, -v242
s_waitcnt lgkmcnt(9)
v_mfma_f32_16x16x32_bf16 a[192:195], v[176:179], v[80:83], a[192:195]
ds_read_b64_tr_b16 v[198:199], v233 offset:10240
v_fma_f32 v103, v103, s51, -v242
v_add_f32 v244, v244, v100
v_add_f32 v244, v244, v101
v_mfma_f32_16x16x32_bf16 a[200:203], v[176:179], v[84:87], a[200:203]
ds_read_b64_tr_b16 v[200:201], v232 offset:16384
buffer_load_dwordx4 v227, s[32:35], s52 offen offset:1024 lds
v_cvt_pk_bf16_f32 v98, v100, v101
v_mfma_f32_16x16x32_bf16 a[196:199], v[180:183], v[80:83], a[196:199]
ds_read_b64_tr_b16 v[202:203], v232 offset:18432
s_add_u32 m0, s48, 122752
v_exp_f32 v102, v102
v_mfma_f32_16x16x32_bf16 a[204:207], v[180:183], v[84:87], a[204:207]
ds_read_b64_tr_b16 v[204:205], v233 offset:16384
buffer_load_dwordx4 v226, s[32:35], s52 offen offset:128 lds
s_waitcnt lgkmcnt(7)
v_mfma_f32_16x16x32_bf16 a[160:163], v[184:187], v[88:91], a[160:163]
ds_read_b64_tr_b16 v[206:207], v233 offset:18432
v_exp_f32 v103, v103
v_fma_f32 v104, v104, s51, -v243
v_mfma_f32_16x16x32_bf16 a[168:171], v[184:187], v[92:95], a[168:171]
buffer_load_dwordx4 v227, s[32:35], s52 offen offset:1152 lds
v_fma_f32 v105, v105, s51, -v243
v_mfma_f32_16x16x32_bf16 a[164:167], v[188:191], v[88:91], a[164:167]
s_add_u32 m0, s48, 130816
v_add_f32 v244, v244, v102
v_add_f32 v244, v244, v103
v_cvt_pk_bf16_f32 v99, v102, v103
v_mfma_f32_16x16x32_bf16 a[172:175], v[188:191], v[92:95], a[172:175]
buffer_load_dwordx4 v226, s[32:35], s52 offen offset:256 lds
s_add_u32 s53, s50, 0
v_add_u32 v232, s53, v231
s_waitcnt lgkmcnt(4)
v_mfma_f32_16x16x32_bf16 a[176:179], v[192:195], v[88:91], a[176:179]
v_xor_b32 v233, 64, v232
v_add_u32 v236, 65536, v230
v_exp_f32 v104, v104
v_mfma_f32_16x16x32_bf16 a[184:187], v[192:195], v[92:95], a[184:187]
buffer_load_dwordx4 v227, s[32:35], s52 offen offset:1280 lds
v_xor_b32 v237, 32, v236
s_waitcnt vmcnt(14) lgkmcnt(0)
s_barrier
ds_read_b128 v[208:211], v232 offset:0
ds_read_b128 v[212:215], v232 offset:2048
ds_read_b64_tr_b16 v[176:177], v236 offset:0
ds_read_b64_tr_b16 v[178:179], v237 offset:512
ds_read_b64_tr_b16 v[180:181], v237 offset:0
ds_read_b64_tr_b16 v[182:183], v236 offset:512
ds_read_b64_tr_b16 v[184:185], v236 offset:8192
ds_read_b64_tr_b16 v[186:187], v237 offset:8704
v_mfma_f32_16x16x32_bf16 a[180:183], v[196:199], v[88:91], a[180:183]
s_mov_b32 s52, 1744896
s_add_u32 m0, s48, 139264
s_nop 0
buffer_load_dwordx4 v224, s[28:31], s52 offen nt lds
v_mfma_f32_16x16x32_bf16 a[188:191], v[196:199], v[92:95], a[188:191]
ds_read_b64_tr_b16 v[188:189], v237 offset:8192
v_exp_f32 v105, v105
v_fma_f32 v106, v106, s51, -v243
v_mfma_f32_16x16x32_bf16 a[192:195], v[200:203], v[88:91], a[192:195]
ds_read_b64_tr_b16 v[190:191], v236 offset:8704
buffer_load_dwordx4 v225, s[28:31], s52 offen offset:1024 nt lds
v_fma_f32 v107, v107, s51, -v243
v_mfma_f32_16x16x32_bf16 a[200:203], v[200:203], v[92:95], a[200:203]
ds_read_b64_tr_b16 v[192:193], v236 offset:16384
s_add_u32 m0, s48, 147328
v_add_f32 v245, v245, v104
v_add_f32 v245, v245, v105
v_mfma_f32_16x16x32_bf16 a[196:199], v[204:207], v[88:91], a[196:199]
ds_read_b64_tr_b16 v[194:195], v237 offset:16896
buffer_load_dwordx4 v224, s[28:31], s52 offen offset:128 nt lds
v_cvt_pk_bf16_f32 v100, v104, v105
v_mfma_f32_16x16x32_bf16 a[204:207], v[204:207], v[92:95], a[204:207]
ds_read_b64_tr_b16 v[196:197], v237 offset:16384
v_exp_f32 v106, v106
s_waitcnt lgkmcnt(7)
v_mfma_f32_16x16x32_bf16 v[128:131], v[176:179], v[208:211], v[128:131]
ds_read_b64_tr_b16 v[198:199], v236 offset:16896
buffer_load_dwordx4 v225, s[28:31], s52 offen offset:1152 nt lds
v_mfma_f32_16x16x32_bf16 v[136:139], v[176:179], v[212:215], v[136:139]
ds_read_b128 v[216:219], v233 offset:0
ds_read_b128 v[220:223], v233 offset:2048
s_add_u32 m0, s48, 155392
v_exp_f32 v107, v107
v_mfma_f32_16x16x32_bf16 v[132:135], v[180:183], v[208:211], v[132:135]
ds_read_b64_tr_b16 v[200:201], v236 offset:4096
ds_read_b64_tr_b16 v[202:203], v237 offset:4608
buffer_load_dwordx4 v224, s[28:31], s52 offen offset:256 nt lds
v_mfma_f32_16x16x32_bf16 v[140:143], v[180:183], v[212:215], v[140:143]
ds_read_b64_tr_b16 v[204:205], v237 offset:4096
v_fma_f32 v108, v108, s51, -v243
v_fma_f32 v109, v109, s51, -v243
v_add_f32 v245, v245, v106
s_waitcnt lgkmcnt(9)
v_mfma_f32_16x16x32_bf16 v[144:147], v[184:187], v[208:211], v[144:147]
ds_read_b64_tr_b16 v[206:207], v236 offset:4608
v_add_f32 v245, v245, v107
v_cvt_pk_bf16_f32 v101, v106, v107
v_mfma_f32_16x16x32_bf16 v[152:155], v[184:187], v[212:215], v[152:155]
ds_read_b64_tr_b16 v[176:177], v236 offset:12288
buffer_load_dwordx4 v225, s[28:31], s52 offen offset:1280 nt lds
v_mfma_f32_16x16x32_bf16 v[148:151], v[188:191], v[208:211], v[148:151]
ds_read_b64_tr_b16 v[178:179], v237 offset:12800
v_exp_f32 v108, v108
v_mfma_f32_16x16x32_bf16 v[156:159], v[188:191], v[212:215], v[156:159]
ds_read_b64_tr_b16 v[180:181], v237 offset:12288
v_exp_f32 v109, v109
v_fma_f32 v110, v110, s51, -v243
s_waitcnt lgkmcnt(9)
v_mfma_f32_16x16x32_bf16 v[160:163], v[192:195], v[208:211], v[160:163]
ds_read_b64_tr_b16 v[182:183], v236 offset:12800
v_fma_f32 v111, v111, s51, -v243
v_add_f32 v245, v245, v108
v_add_f32 v245, v245, v109
v_mfma_f32_16x16x32_bf16 v[168:171], v[192:195], v[212:215], v[168:171]
ds_read_b64_tr_b16 v[184:185], v236 offset:20480
v_cvt_pk_bf16_f32 v102, v108, v109
v_exp_f32 v110, v110
v_mfma_f32_16x16x32_bf16 v[164:167], v[196:199], v[208:211], v[164:167]
ds_read_b64_tr_b16 v[186:187], v237 offset:20992
v_exp_f32 v111, v111
v_add_f32 v245, v245, v110
v_mfma_f32_16x16x32_bf16 v[172:175], v[196:199], v[212:215], v[172:175]
ds_read_b64_tr_b16 v[188:189], v237 offset:20480
v_add_f32 v245, v245, v111
v_cvt_pk_bf16_f32 v103, v110, v111
ds_write_b128 v239, v[96:99] offset:8192
ds_write_b128 v239, v[100:103] offset:9216
s_waitcnt lgkmcnt(9)
v_mfma_f32_16x16x32_bf16 v[128:131], v[200:203], v[216:219], v[128:131]
ds_read_b64_tr_b16 v[190:191], v236 offset:20992
v_mfma_f32_16x16x32_bf16 v[136:139], v[200:203], v[220:223], v[136:139]
v_mfma_f32_16x16x32_bf16 v[132:135], v[204:207], v[216:219], v[132:135]
v_mfma_f32_16x16x32_bf16 v[140:143], v[204:207], v[220:223], v[140:143]
v_add_u32 v236, 90112, v250
v_xor_b32 v237, 32, v236
s_waitcnt lgkmcnt(6)
v_mfma_f32_16x16x32_bf16 v[144:147], v[176:179], v[216:219], v[144:147]
v_xor_b32 v232, 0x1000, v236
v_xor_b32 v233, 0x1000, v237
v_mfma_f32_16x16x32_bf16 v[152:155], v[176:179], v[220:223], v[152:155]
s_waitcnt vmcnt(14) lgkmcnt(0)
s_barrier
ds_read_b64_tr_b16 v[192:193], v236 offset:0
ds_read_b64_tr_b16 v[194:195], v236 offset:2048
ds_read_b64_tr_b16 v[196:197], v237 offset:0
ds_read_b64_tr_b16 v[198:199], v237 offset:2048
ds_read_b64_tr_b16 v[200:201], v236 offset:8192
ds_read_b64_tr_b16 v[202:203], v236 offset:10240
v_mfma_f32_16x16x32_bf16 v[148:151], v[180:183], v[216:219], v[148:151]
v_fma_f32 v112, v112, s51, -v242
v_fma_f32 v113, v113, s51, -v242
v_exp_f32 v112, v112
v_mfma_f32_16x16x32_bf16 v[156:159], v[180:183], v[220:223], v[156:159]
ds_read_b64_tr_b16 v[204:205], v237 offset:8192
v_exp_f32 v113, v113
v_fma_f32 v114, v114, s51, -v242
v_mfma_f32_16x16x32_bf16 v[160:163], v[184:187], v[216:219], v[160:163]
ds_read_b64_tr_b16 v[206:207], v237 offset:10240
v_fma_f32 v115, v115, s51, -v242
v_add_f32 v244, v244, v112
v_add_f32 v244, v244, v113
v_mfma_f32_16x16x32_bf16 v[168:171], v[184:187], v[220:223], v[168:171]
ds_read_b64_tr_b16 v[176:177], v236 offset:16384
v_cvt_pk_bf16_f32 v112, v112, v113
v_exp_f32 v114, v114
v_mfma_f32_16x16x32_bf16 v[164:167], v[188:191], v[216:219], v[164:167]
ds_read_b64_tr_b16 v[178:179], v236 offset:18432
v_exp_f32 v115, v115
v_fma_f32 v116, v116, s51, -v242
v_mfma_f32_16x16x32_bf16 v[172:175], v[188:191], v[220:223], v[172:175]
ds_read_b64_tr_b16 v[180:181], v237 offset:16384
v_fma_f32 v117, v117, s51, -v242
v_add_f32 v244, v244, v114
v_add_f32 v244, v244, v115
s_waitcnt lgkmcnt(7)
v_mfma_f32_16x16x32_bf16 a[160:163], v[192:195], v[96:99], a[160:163]
ds_read_b64_tr_b16 v[182:183], v237 offset:18432
v_cvt_pk_bf16_f32 v113, v114, v115
v_exp_f32 v116, v116
v_mfma_f32_16x16x32_bf16 a[168:171], v[192:195], v[100:103], a[168:171]
ds_read_b128 v[104:107], v234 offset:8192
ds_read_b128 v[108:111], v234 offset:9216
v_exp_f32 v117, v117
v_mfma_f32_16x16x32_bf16 a[164:167], v[196:199], v[96:99], a[164:167]
ds_read_b64_tr_b16 v[184:185], v232 offset:0
ds_read_b64_tr_b16 v[186:187], v232 offset:2048
s_add_u32 m0, s48, 0
v_fma_f32 v118, v118, s51, -v242
v_mfma_f32_16x16x32_bf16 a[172:175], v[196:199], v[100:103], a[172:175]
ds_read_b64_tr_b16 v[188:189], v233 offset:0
buffer_load_dwordx4 v228, s[40:43], s60 offen lds
v_fma_f32 v119, v119, s51, -v242
s_waitcnt lgkmcnt(9)
v_mfma_f32_16x16x32_bf16 a[176:179], v[200:203], v[96:99], a[176:179]
ds_read_b64_tr_b16 v[190:191], v233 offset:2048
v_add_f32 v244, v244, v116
v_add_f32 v244, v244, v117
v_cvt_pk_bf16_f32 v114, v116, v117
v_mfma_f32_16x16x32_bf16 a[184:187], v[200:203], v[100:103], a[184:187]
ds_read_b64_tr_b16 v[192:193], v232 offset:8192
buffer_load_dwordx4 v229, s[40:43], s60 offen offset:1024 lds
v_mfma_f32_16x16x32_bf16 a[180:183], v[204:207], v[96:99], a[180:183]
ds_read_b64_tr_b16 v[194:195], v232 offset:10240
s_mul_i32 s52, s60, 6144
s_add_u32 s52, s52, 9216
s_add_u32 m0, s48, 65536
v_exp_f32 v118, v118
v_mfma_f32_16x16x32_bf16 a[188:191], v[204:207], v[100:103], a[188:191]
ds_read_b64_tr_b16 v[196:197], v233 offset:8192
buffer_load_dwordx4 v226, s[32:35], s52 offen lds
s_waitcnt lgkmcnt(9)
v_mfma_f32_16x16x32_bf16 a[192:195], v[176:179], v[96:99], a[192:195]
ds_read_b64_tr_b16 v[198:199], v233 offset:10240
v_exp_f32 v119, v119
v_fma_f32 v120, v120, s51, -v243
v_mfma_f32_16x16x32_bf16 a[200:203], v[176:179], v[100:103], a[200:203]
ds_read_b64_tr_b16 v[200:201], v232 offset:16384
buffer_load_dwordx4 v227, s[32:35], s52 offen offset:1024 lds
v_fma_f32 v121, v121, s51, -v243
v_mfma_f32_16x16x32_bf16 a[196:199], v[180:183], v[96:99], a[196:199]
ds_read_b64_tr_b16 v[202:203], v232 offset:18432
s_add_u32 m0, s48, 73600
v_add_f32 v244, v244, v118
v_add_f32 v244, v244, v119
v_mfma_f32_16x16x32_bf16 a[204:207], v[180:183], v[100:103], a[204:207]
ds_read_b64_tr_b16 v[204:205], v233 offset:16384
buffer_load_dwordx4 v226, s[32:35], s52 offen offset:128 lds
s_waitcnt lgkmcnt(7)
v_mfma_f32_16x16x32_bf16 a[160:163], v[184:187], v[104:107], a[160:163]
ds_read_b64_tr_b16 v[206:207], v233 offset:18432
v_cvt_pk_bf16_f32 v115, v118, v119
v_exp_f32 v120, v120
v_mfma_f32_16x16x32_bf16 a[168:171], v[184:187], v[108:111], a[168:171]
buffer_load_dwordx4 v227, s[32:35], s52 offen offset:1152 lds
v_exp_f32 v121, v121
v_mfma_f32_16x16x32_bf16 a[164:167], v[188:191], v[104:107], a[164:167]
s_add_u32 m0, s48, 81664
v_fma_f32 v122, v122, s51, -v243
v_fma_f32 v123, v123, s51, -v243
v_add_f32 v245, v245, v120
v_mfma_f32_16x16x32_bf16 a[172:175], v[188:191], v[108:111], a[172:175]
buffer_load_dwordx4 v226, s[32:35], s52 offen offset:256 lds
s_add_u32 s53, s50, 16384
v_add_u32 v232, s53, v231
s_waitcnt lgkmcnt(4)
v_mfma_f32_16x16x32_bf16 a[176:179], v[192:195], v[104:107], a[176:179]
v_xor_b32 v233, 64, v232
v_add_u32 v236, 114688, v230
v_add_f32 v245, v245, v121
v_mfma_f32_16x16x32_bf16 a[184:187], v[192:195], v[108:111], a[184:187]
buffer_load_dwordx4 v227, s[32:35], s52 offen offset:1280 lds
v_xor_b32 v237, 32, v236
s_waitcnt vmcnt(14) lgkmcnt(0)
s_barrier
ds_read_b128 v[208:211], v232 offset:0
ds_read_b128 v[212:215], v232 offset:2048
ds_read_b64_tr_b16 v[176:177], v236 offset:0
ds_read_b64_tr_b16 v[178:179], v237 offset:512
ds_read_b64_tr_b16 v[180:181], v237 offset:0
ds_read_b64_tr_b16 v[182:183], v236 offset:512
ds_read_b64_tr_b16 v[184:185], v236 offset:8192
ds_read_b64_tr_b16 v[186:187], v237 offset:8704
v_mfma_f32_16x16x32_bf16 a[180:183], v[196:199], v[104:107], a[180:183]
s_mov_b32 s52, 3145728
s_add_u32 m0, s48, 90112
s_nop 0
buffer_load_dwordx4 v224, s[24:27], s52 offen nt lds
v_cvt_pk_bf16_f32 v116, v120, v121
v_mfma_f32_16x16x32_bf16 a[188:191], v[196:199], v[108:111], a[188:191]
ds_read_b64_tr_b16 v[188:189], v237 offset:8192
v_exp_f32 v122, v122
v_mfma_f32_16x16x32_bf16 a[192:195], v[200:203], v[104:107], a[192:195]
ds_read_b64_tr_b16 v[190:191], v236 offset:8704
buffer_load_dwordx4 v225, s[24:27], s52 offen offset:1024 nt lds
v_exp_f32 v123, v123
v_mfma_f32_16x16x32_bf16 a[200:203], v[200:203], v[108:111], a[200:203]
ds_read_b64_tr_b16 v[192:193], v236 offset:16384
s_add_u32 m0, s48, 98176
v_fma_f32 v124, v124, s51, -v243
v_fma_f32 v125, v125, s51, -v243
v_mfma_f32_16x16x32_bf16 a[196:199], v[204:207], v[104:107], a[196:199]
ds_read_b64_tr_b16 v[194:195], v237 offset:16896
buffer_load_dwordx4 v224, s[24:27], s52 offen offset:128 nt lds
v_add_f32 v245, v245, v122
v_mfma_f32_16x16x32_bf16 a[204:207], v[204:207], v[108:111], a[204:207]
ds_read_b64_tr_b16 v[196:197], v237 offset:16384
v_add_f32 v245, v245, v123
v_cvt_pk_bf16_f32 v117, v122, v123
s_waitcnt lgkmcnt(7)
v_mfma_f32_16x16x32_bf16 v[128:131], v[176:179], v[208:211], v[128:131]
ds_read_b64_tr_b16 v[198:199], v236 offset:16896
buffer_load_dwordx4 v225, s[24:27], s52 offen offset:1152 nt lds
v_exp_f32 v124, v124
v_mfma_f32_16x16x32_bf16 v[136:139], v[176:179], v[212:215], v[136:139]
ds_read_b128 v[216:219], v233 offset:0
ds_read_b128 v[220:223], v233 offset:2048
s_add_u32 m0, s48, 106240
v_exp_f32 v125, v125
v_mfma_f32_16x16x32_bf16 v[132:135], v[180:183], v[208:211], v[132:135]
ds_read_b64_tr_b16 v[200:201], v236 offset:4096
ds_read_b64_tr_b16 v[202:203], v237 offset:4608
buffer_load_dwordx4 v224, s[24:27], s52 offen offset:256 nt lds
v_mfma_f32_16x16x32_bf16 v[140:143], v[180:183], v[212:215], v[140:143]
ds_read_b64_tr_b16 v[204:205], v237 offset:4096
v_fma_f32 v126, v126, s51, -v243
v_fma_f32 v127, v127, s51, -v243
v_add_f32 v245, v245, v124
s_waitcnt lgkmcnt(9)
v_mfma_f32_16x16x32_bf16 v[144:147], v[184:187], v[208:211], v[144:147]
ds_read_b64_tr_b16 v[206:207], v236 offset:4608
v_add_f32 v245, v245, v125
v_cvt_pk_bf16_f32 v118, v124, v125
v_mfma_f32_16x16x32_bf16 v[152:155], v[184:187], v[212:215], v[152:155]
ds_read_b64_tr_b16 v[176:177], v236 offset:12288
buffer_load_dwordx4 v225, s[24:27], s52 offen offset:1280 nt lds
v_exp_f32 v126, v126
v_mfma_f32_16x16x32_bf16 v[148:151], v[188:191], v[208:211], v[148:151]
ds_read_b64_tr_b16 v[178:179], v237 offset:12800
v_exp_f32 v127, v127
v_add_f32 v245, v245, v126
v_mfma_f32_16x16x32_bf16 v[156:159], v[188:191], v[212:215], v[156:159]
ds_read_b64_tr_b16 v[180:181], v237 offset:12288
v_add_f32 v245, v245, v127
v_cvt_pk_bf16_f32 v119, v126, v127
v_mov_b32 v246, v244
s_waitcnt lgkmcnt(9)
v_mfma_f32_16x16x32_bf16 v[160:163], v[192:195], v[208:211], v[160:163]
ds_read_b64_tr_b16 v[182:183], v236 offset:12800
v_mov_b32 v247, v245
v_permlane16_swap_b32 v246, v244
s_nop 0
v_permlane16_swap_b32 v247, v245
v_mfma_f32_16x16x32_bf16 v[168:171], v[192:195], v[212:215], v[168:171]
ds_read_b64_tr_b16 v[184:185], v236 offset:20480
v_add_f32 v244, v244, v246
v_add_f32 v245, v245, v247
v_mov_b32 v246, v244
v_mfma_f32_16x16x32_bf16 v[164:167], v[196:199], v[208:211], v[164:167]
ds_read_b64_tr_b16 v[186:187], v237 offset:20992
v_mov_b32 v247, v245
v_permlane32_swap_b32 v246, v244
s_nop 0
v_permlane32_swap_b32 v247, v245
v_mfma_f32_16x16x32_bf16 v[172:175], v[196:199], v[212:215], v[172:175]
ds_read_b64_tr_b16 v[188:189], v237 offset:20480
v_add_f32 v244, v244, v246
v_add_f32 v245, v245, v247
ds_write_b128 v239, v[112:115] offset:24576
ds_write_b128 v239, v[116:119] offset:25600
ds_write_b64 v239, v[244:245] offset:58368
s_waitcnt lgkmcnt(10)
v_mfma_f32_16x16x32_bf16 v[128:131], v[200:203], v[216:219], v[128:131]
ds_read_b64_tr_b16 v[190:191], v236 offset:20992
v_mfma_f32_16x16x32_bf16 v[136:139], v[200:203], v[220:223], v[136:139]
v_mfma_f32_16x16x32_bf16 v[132:135], v[204:207], v[216:219], v[132:135]
v_mfma_f32_16x16x32_bf16 v[140:143], v[204:207], v[220:223], v[140:143]
v_add_u32 v236, 139264, v250
v_xor_b32 v237, 32, v236
s_waitcnt lgkmcnt(7)
v_mfma_f32_16x16x32_bf16 v[144:147], v[176:179], v[216:219], v[144:147]
v_xor_b32 v232, 0x1000, v236
v_xor_b32 v233, 0x1000, v237
v_mfma_f32_16x16x32_bf16 v[152:155], v[176:179], v[220:223], v[152:155]
s_waitcnt vmcnt(14) lgkmcnt(0)
s_barrier
ds_read_b64_tr_b16 v[192:193], v236 offset:0
ds_read_b64_tr_b16 v[194:195], v236 offset:2048
ds_read_b64_tr_b16 v[196:197], v237 offset:0
ds_read_b64_tr_b16 v[198:199], v237 offset:2048
ds_read_b64_tr_b16 v[200:201], v236 offset:8192
ds_read_b64_tr_b16 v[202:203], v236 offset:10240
v_mfma_f32_16x16x32_bf16 v[148:151], v[180:183], v[216:219], v[148:151]
s_mov_b32 s52, 3170304
s_add_u32 m0, s48, 114688
s_nop 0
buffer_load_dwordx4 v224, s[24:27], s52 offen nt lds
v_mfma_f32_16x16x32_bf16 v[156:159], v[180:183], v[220:223], v[156:159]
ds_read_b64_tr_b16 v[204:205], v237 offset:8192
v_mfma_f32_16x16x32_bf16 v[160:163], v[184:187], v[216:219], v[160:163]
ds_read_b64_tr_b16 v[206:207], v237 offset:10240
buffer_load_dwordx4 v225, s[24:27], s52 offen offset:1024 nt lds
v_mfma_f32_16x16x32_bf16 v[168:171], v[184:187], v[220:223], v[168:171]
ds_read_b64_tr_b16 v[176:177], v236 offset:16384
s_add_u32 m0, s48, 122752
v_mfma_f32_16x16x32_bf16 v[164:167], v[188:191], v[216:219], v[164:167]
ds_read_b64_tr_b16 v[178:179], v236 offset:18432
buffer_load_dwordx4 v224, s[24:27], s52 offen offset:128 nt lds
v_mfma_f32_16x16x32_bf16 v[172:175], v[188:191], v[220:223], v[172:175]
ds_read_b64_tr_b16 v[180:181], v237 offset:16384
s_waitcnt lgkmcnt(7)
v_mfma_f32_16x16x32_bf16 a[160:163], v[192:195], v[112:115], a[160:163]
ds_read_b64_tr_b16 v[182:183], v237 offset:18432
buffer_load_dwordx4 v225, s[24:27], s52 offen offset:1152 nt lds
v_mfma_f32_16x16x32_bf16 a[168:171], v[192:195], v[116:119], a[168:171]
ds_read_b128 v[120:123], v234 offset:24576
ds_read_b128 v[124:127], v234 offset:25600
s_add_u32 m0, s48, 130816
v_mfma_f32_16x16x32_bf16 a[164:167], v[196:199], v[112:115], a[164:167]
ds_read_b64_tr_b16 v[184:185], v232 offset:0
ds_read_b64_tr_b16 v[186:187], v232 offset:2048
buffer_load_dwordx4 v224, s[24:27], s52 offen offset:256 nt lds
v_mfma_f32_16x16x32_bf16 a[172:175], v[196:199], v[116:119], a[172:175]
ds_read_b64_tr_b16 v[188:189], v233 offset:0
v_cvt_pk_bf16_f32 v128, v128, v129
v_cvt_pk_bf16_f32 v129, v130, v131
v_cvt_pk_bf16_f32 v130, v132, v133
s_waitcnt lgkmcnt(9)
v_mfma_f32_16x16x32_bf16 a[176:179], v[200:203], v[112:115], a[176:179]
ds_read_b64_tr_b16 v[190:191], v233 offset:2048
v_cvt_pk_bf16_f32 v131, v134, v135
v_cvt_pk_bf16_f32 v136, v136, v137
v_cvt_pk_bf16_f32 v137, v138, v139
v_mfma_f32_16x16x32_bf16 a[184:187], v[200:203], v[116:119], a[184:187]
ds_read_b64_tr_b16 v[192:193], v232 offset:8192
buffer_load_dwordx4 v225, s[24:27], s52 offen offset:1280 nt lds
v_cvt_pk_bf16_f32 v138, v140, v141
v_mfma_f32_16x16x32_bf16 a[180:183], v[204:207], v[112:115], a[180:183]
ds_read_b64_tr_b16 v[194:195], v232 offset:10240
v_cvt_pk_bf16_f32 v139, v142, v143
v_cvt_pk_bf16_f32 v144, v144, v145
v_cvt_pk_bf16_f32 v145, v146, v147
v_mfma_f32_16x16x32_bf16 a[188:191], v[204:207], v[116:119], a[188:191]
ds_read_b64_tr_b16 v[196:197], v233 offset:8192
v_cvt_pk_bf16_f32 v146, v148, v149
v_cvt_pk_bf16_f32 v147, v150, v151
v_cvt_pk_bf16_f32 v152, v152, v153
s_waitcnt lgkmcnt(9)
v_mfma_f32_16x16x32_bf16 a[192:195], v[176:179], v[112:115], a[192:195]
ds_read_b64_tr_b16 v[198:199], v233 offset:10240
v_cvt_pk_bf16_f32 v153, v154, v155
v_cvt_pk_bf16_f32 v154, v156, v157
v_cvt_pk_bf16_f32 v155, v158, v159
v_mfma_f32_16x16x32_bf16 a[200:203], v[176:179], v[116:119], a[200:203]
ds_read_b64_tr_b16 v[200:201], v232 offset:16384
v_cvt_pk_bf16_f32 v160, v160, v161
v_cvt_pk_bf16_f32 v161, v162, v163
v_cvt_pk_bf16_f32 v162, v164, v165
v_mfma_f32_16x16x32_bf16 a[196:199], v[180:183], v[112:115], a[196:199]
ds_read_b64_tr_b16 v[202:203], v232 offset:18432
v_cvt_pk_bf16_f32 v163, v166, v167
v_cvt_pk_bf16_f32 v168, v168, v169
v_cvt_pk_bf16_f32 v169, v170, v171
v_mfma_f32_16x16x32_bf16 a[204:207], v[180:183], v[116:119], a[204:207]
ds_read_b64_tr_b16 v[204:205], v233 offset:16384
v_cvt_pk_bf16_f32 v170, v172, v173
v_cvt_pk_bf16_f32 v171, v174, v175
ds_write_b64 v251, v[128:129] offset:32768
ds_write_b64 v251, v[130:131] offset:33280
ds_write_b64 v251, v[136:137] offset:33792
ds_write_b64 v251, v[138:139] offset:34304
ds_write_b64 v251, v[144:145] offset:40960
ds_write_b64 v251, v[146:147] offset:41472
ds_write_b64 v251, v[152:153] offset:41984
ds_write_b64 v251, v[154:155] offset:42496
ds_write_b64 v251, v[160:161] offset:49152
ds_write_b64 v251, v[162:163] offset:49664
ds_write_b64 v251, v[168:169] offset:50176
ds_write_b64 v251, v[170:171] offset:50688
s_waitcnt lgkmcnt(15)
v_mfma_f32_16x16x32_bf16 a[160:163], v[184:187], v[120:123], a[160:163]
ds_read_b64_tr_b16 v[206:207], v233 offset:18432
v_mfma_f32_16x16x32_bf16 a[168:171], v[184:187], v[124:127], a[168:171]
v_mfma_f32_16x16x32_bf16 a[164:167], v[188:191], v[120:123], a[164:167]
v_mfma_f32_16x16x32_bf16 a[172:175], v[188:191], v[124:127], a[172:175]
s_add_u32 s53, s50, 0
v_add_u32 v232, s53, v231
v_mfma_f32_16x16x32_bf16 a[176:179], v[192:195], v[120:123], a[176:179]
v_xor_b32 v233, 64, v232
v_add_u32 v236, 65536, v230
v_mfma_f32_16x16x32_bf16 a[184:187], v[192:195], v[124:127], a[184:187]
v_xor_b32 v237, 32, v236
s_waitcnt vmcnt(12) lgkmcnt(0)
s_barrier
ds_read_b128 v[208:211], v232 offset:0
ds_read_b128 v[212:215], v232 offset:2048
ds_read_b64_tr_b16 v[176:177], v236 offset:0
ds_read_b64_tr_b16 v[178:179], v237 offset:512
ds_read_b64_tr_b16 v[180:181], v237 offset:0
ds_read_b64_tr_b16 v[182:183], v236 offset:512
ds_read_b64_tr_b16 v[184:185], v236 offset:8192
ds_read_b64_tr_b16 v[186:187], v237 offset:8704
v_mfma_f32_16x16x32_bf16 a[180:183], v[196:199], v[120:123], a[180:183]
ds_read_b64 v[246:247], v238 offset:58368
ds_read_b64 v[248:249], v238 offset:60416
s_waitcnt lgkmcnt(0)
v_add_f32 v246, v246, v248
v_mfma_f32_16x16x32_bf16 a[188:191], v[196:199], v[124:127], a[188:191]
ds_read_b64_tr_b16 v[188:189], v237 offset:8192
v_add_f32 v247, v247, v249
v_rcp_f32 v248, v246
v_mfma_f32_16x16x32_bf16 a[192:195], v[200:203], v[120:123], a[192:195]
ds_read_b64_tr_b16 v[190:191], v236 offset:8704
v_rcp_f32 v249, v247
v_mfma_f32_16x16x32_bf16 a[200:203], v[200:203], v[124:127], a[200:203]
ds_read_b64_tr_b16 v[192:193], v236 offset:16384
v_mfma_f32_16x16x32_bf16 a[196:199], v[204:207], v[120:123], a[196:199]
ds_read_b64_tr_b16 v[194:195], v237 offset:16896
v_mfma_f32_16x16x32_bf16 a[204:207], v[204:207], v[124:127], a[204:207]
ds_read_b64_tr_b16 v[196:197], v237 offset:16384
v_mfma_f32_16x16x32_bf16 v[128:131], v[176:179], v[208:211], 0
ds_read_b64_tr_b16 v[198:199], v236 offset:16896
v_mfma_f32_16x16x32_bf16 v[136:139], v[176:179], v[212:215], 0
ds_read_b128 v[216:219], v233 offset:0
ds_read_b128 v[220:223], v233 offset:2048
v_mfma_f32_16x16x32_bf16 v[132:135], v[180:183], v[208:211], 0
ds_read_b64_tr_b16 v[200:201], v236 offset:4096
ds_read_b64_tr_b16 v[202:203], v237 offset:4608
s_add_u32 s52, s70, 1966080
s_add_u32 m0, s48, 139264
v_accvgpr_read_b32 v64, a160
v_mfma_f32_16x16x32_bf16 v[140:143], v[180:183], v[212:215], 0
ds_read_b64_tr_b16 v[204:205], v237 offset:4096
buffer_load_dwordx4 v228, s[36:39], s52 offen lds
v_accvgpr_read_b32 v65, a161
s_waitcnt lgkmcnt(9)
v_mfma_f32_16x16x32_bf16 v[144:147], v[184:187], v[208:211], 0
ds_read_b64_tr_b16 v[206:207], v236 offset:4608
v_accvgpr_read_b32 v66, a162
v_accvgpr_read_b32 v67, a163
v_accvgpr_read_b32 v68, a164
v_mfma_f32_16x16x32_bf16 v[152:155], v[184:187], v[212:215], 0
ds_read_b64_tr_b16 v[176:177], v236 offset:12288
buffer_load_dwordx4 v229, s[36:39], s52 offen offset:1024 lds
v_accvgpr_read_b32 v69, a165
v_mfma_f32_16x16x32_bf16 v[148:151], v[188:191], v[208:211], 0
ds_read_b64_tr_b16 v[178:179], v237 offset:12800
v_accvgpr_read_b32 v70, a166
v_accvgpr_read_b32 v71, a167
v_mul_f32 v64, v64, v248
v_mfma_f32_16x16x32_bf16 v[156:159], v[188:191], v[212:215], 0
ds_read_b64_tr_b16 v[180:181], v237 offset:12288
s_add_u32 s52, s70, 2048000
s_add_u32 m0, s48, 147456
v_mul_f32 v65, v65, v248
v_mul_f32 v66, v66, v248
s_waitcnt lgkmcnt(9)
v_mfma_f32_16x16x32_bf16 v[160:163], v[192:195], v[208:211], 0
ds_read_b64_tr_b16 v[182:183], v236 offset:12800
buffer_load_dwordx4 v228, s[36:39], s52 offen lds
v_mul_f32 v67, v67, v248
v_mfma_f32_16x16x32_bf16 v[168:171], v[192:195], v[212:215], 0
ds_read_b64_tr_b16 v[184:185], v236 offset:20480
v_mul_f32 v68, v68, v248
v_mul_f32 v69, v69, v248
v_mul_f32 v70, v70, v248
v_mfma_f32_16x16x32_bf16 v[164:167], v[196:199], v[208:211], 0
ds_read_b64_tr_b16 v[186:187], v237 offset:20992
v_mul_f32 v71, v71, v248
v_cvt_pk_bf16_f32 v64, v64, v65
v_cvt_pk_bf16_f32 v65, v66, v67
v_mfma_f32_16x16x32_bf16 v[172:175], v[196:199], v[212:215], 0
ds_read_b64_tr_b16 v[188:189], v237 offset:20480
buffer_load_dwordx4 v229, s[36:39], s52 offen offset:1024 lds
v_cvt_pk_bf16_f32 v66, v68, v69
s_waitcnt lgkmcnt(7)
v_mfma_f32_16x16x32_bf16 v[128:131], v[200:203], v[216:219], v[128:131]
ds_read_b64_tr_b16 v[190:191], v236 offset:20992
v_cvt_pk_bf16_f32 v67, v70, v71
v_accvgpr_read_b32 v72, a168
v_mfma_f32_16x16x32_bf16 v[136:139], v[200:203], v[220:223], v[136:139]
s_add_u32 s52, s70, 2129920
s_add_u32 m0, s48, 155648
v_accvgpr_read_b32 v73, a169
v_accvgpr_read_b32 v74, a170
v_accvgpr_read_b32 v75, a171
v_mfma_f32_16x16x32_bf16 v[132:135], v[204:207], v[216:219], v[132:135]
buffer_load_dwordx4 v228, s[36:39], s52 offen lds
v_accvgpr_read_b32 v76, a172
v_mfma_f32_16x16x32_bf16 v[140:143], v[204:207], v[220:223], v[140:143]
s_add_u32 s53, s49, 90112
v_add_u32 v232, s53, v231
v_accvgpr_read_b32 v77, a173
v_accvgpr_read_b32 v78, a174
s_waitcnt lgkmcnt(4)
v_mfma_f32_16x16x32_bf16 v[144:147], v[176:179], v[216:219], v[144:147]
v_xor_b32 v233, 64, v232
v_accvgpr_read_b32 v79, a175
v_mul_f32 v72, v72, v249
v_mul_f32 v73, v73, v249
v_mfma_f32_16x16x32_bf16 v[152:155], v[176:179], v[220:223], v[152:155]
buffer_load_dwordx4 v229, s[36:39], s52 offen offset:1024 lds
v_mul_f32 v74, v74, v249
s_waitcnt vmcnt(12) lgkmcnt(0)
s_barrier
ds_read_b128 a[208:211], v238 offset:32768
ds_read_b128 a[212:215], v238 offset:33792
ds_read_b128 v[192:195], v232 offset:0
ds_read_b128 v[196:199], v232 offset:2048
ds_read_b128 a[216:219], v238 offset:34816
ds_read_b128 a[220:223], v238 offset:35840
ds_read_b128 v[200:203], v233 offset:0
v_mfma_f32_16x16x32_bf16 v[148:151], v[180:183], v[216:219], v[148:151]
s_mov_b32 s52, 3194880
s_add_u32 m0, s48, 65536
s_nop 0
buffer_load_dwordx4 v224, s[24:27], s52 offen nt lds
v_mul_f32 v75, v75, v249
v_mfma_f32_16x16x32_bf16 v[156:159], v[180:183], v[220:223], v[156:159]
ds_read_b128 v[204:207], v233 offset:2048
v_mul_f32 v76, v76, v249
v_mul_f32 v77, v77, v249
v_mul_f32 v78, v78, v249
v_mfma_f32_16x16x32_bf16 v[160:163], v[184:187], v[216:219], v[160:163]
buffer_load_dwordx4 v225, s[24:27], s52 offen offset:1024 nt lds
v_mul_f32 v79, v79, v249
v_cvt_pk_bf16_f32 v72, v72, v73
v_mfma_f32_16x16x32_bf16 v[168:171], v[184:187], v[220:223], v[168:171]
ds_read_b128 a[224:227], v238 offset:40960
ds_read_b128 a[228:231], v238 offset:41984
s_add_u32 m0, s48, 73600
v_cvt_pk_bf16_f32 v73, v74, v75
v_mfma_f32_16x16x32_bf16 v[164:167], v[188:191], v[216:219], v[164:167]
ds_read_b128 v[176:179], v232 offset:8192
buffer_load_dwordx4 v224, s[24:27], s52 offen offset:128 nt lds
v_cvt_pk_bf16_f32 v74, v76, v77
v_mfma_f32_16x16x32_bf16 v[172:175], v[188:191], v[220:223], v[172:175]
ds_read_b128 v[180:183], v232 offset:10240
v_cvt_pk_bf16_f32 v75, v78, v79
v_accvgpr_read_b32 v80, a176
v_accvgpr_read_b32 v81, a177
s_waitcnt lgkmcnt(8)
v_mfma_f32_16x16x32_bf16 v[0:3], v[192:195], a[208:211], 0
buffer_load_dwordx4 v225, s[24:27], s52 offen offset:1152 nt lds
v_accvgpr_read_b32 v82, a178
v_accvgpr_read_b32 v83, a179
v_mfma_f32_16x16x32_bf16 v[8:11], v[192:195], a[212:215], 0
ds_read_b128 a[232:235], v238 offset:43008
ds_read_b128 a[236:239], v238 offset:44032
s_add_u32 m0, s48, 81664
v_accvgpr_read_b32 v84, a180
v_mfma_f32_16x16x32_bf16 v[4:7], v[196:199], a[208:211], 0
ds_read_b128 v[184:187], v233 offset:8192
buffer_load_dwordx4 v224, s[24:27], s52 offen offset:256 nt lds
v_accvgpr_read_b32 v85, a181
v_mfma_f32_16x16x32_bf16 v[12:15], v[196:199], a[212:215], 0
ds_read_b128 v[188:191], v233 offset:10240
v_accvgpr_read_b32 v86, a182
v_accvgpr_read_b32 v87, a183
v_mul_f32 v80, v80, v248
s_waitcnt lgkmcnt(8)
v_mfma_f32_16x16x32_bf16 v[0:3], v[200:203], a[216:219], v[0:3]
v_mul_f32 v81, v81, v248
v_mul_f32 v82, v82, v248
v_mul_f32 v83, v83, v248
v_mul_f32 v84, v84, v248
v_mfma_f32_16x16x32_bf16 v[8:11], v[200:203], a[220:223], v[8:11]
ds_read_b128 a[240:243], v238 offset:49152
ds_read_b128 a[244:247], v238 offset:50176
buffer_load_dwordx4 v225, s[24:27], s52 offen offset:1280 nt lds
v_mfma_f32_16x16x32_bf16 v[4:7], v[204:207], a[216:219], v[4:7]
ds_read_b128 v[192:195], v232 offset:16384
v_mul_f32 v85, v85, v248
v_mul_f32 v86, v86, v248
v_mul_f32 v87, v87, v248
v_mfma_f32_16x16x32_bf16 v[12:15], v[204:207], a[220:223], v[12:15]
ds_read_b128 v[196:199], v232 offset:18432
v_cvt_pk_bf16_f32 v80, v80, v81
v_cvt_pk_bf16_f32 v81, v82, v83
v_cvt_pk_bf16_f32 v82, v84, v85
s_waitcnt lgkmcnt(8)
v_mfma_f32_16x16x32_bf16 v[0:3], v[176:179], a[224:227], v[0:3]
v_cvt_pk_bf16_f32 v83, v86, v87
v_accvgpr_read_b32 v88, a184
v_accvgpr_read_b32 v89, a185
v_mfma_f32_16x16x32_bf16 v[8:11], v[176:179], a[228:231], v[8:11]
ds_read_b128 a[248:251], v238 offset:51200
ds_read_b128 a[252:255], v238 offset:52224
v_accvgpr_read_b32 v90, a186
v_accvgpr_read_b32 v91, a187
v_mfma_f32_16x16x32_bf16 v[4:7], v[180:183], a[224:227], v[4:7]
ds_read_b128 v[200:203], v233 offset:16384
v_accvgpr_read_b32 v92, a188
v_accvgpr_read_b32 v93, a189
v_mfma_f32_16x16x32_bf16 v[12:15], v[180:183], a[228:231], v[12:15]
ds_read_b128 v[204:207], v233 offset:18432
v_accvgpr_read_b32 v94, a190
v_accvgpr_read_b32 v95, a191
v_mul_f32 v88, v88, v249
s_waitcnt lgkmcnt(8)
v_mfma_f32_16x16x32_bf16 v[0:3], v[184:187], a[232:235], v[0:3]
v_mul_f32 v89, v89, v249
v_mul_f32 v90, v90, v249
v_mul_f32 v91, v91, v249
v_mfma_f32_16x16x32_bf16 v[8:11], v[184:187], a[236:239], v[8:11]
v_mul_f32 v92, v92, v249
v_mul_f32 v93, v93, v249
v_mul_f32 v94, v94, v249
v_mul_f32 v95, v95, v249
v_mfma_f32_16x16x32_bf16 v[4:7], v[188:191], a[232:235], v[4:7]
v_cvt_pk_bf16_f32 v88, v88, v89
v_cvt_pk_bf16_f32 v89, v90, v91
v_cvt_pk_bf16_f32 v90, v92, v93
v_mfma_f32_16x16x32_bf16 v[12:15], v[188:191], a[236:239], v[12:15]
s_add_u32 s53, s49, 114688
v_add_u32 v232, s53, v231
v_cvt_pk_bf16_f32 v91, v94, v95
v_accvgpr_read_b32 v96, a192
s_waitcnt lgkmcnt(4)
v_mfma_f32_16x16x32_bf16 v[0:3], v[192:195], a[240:243], v[0:3]
v_xor_b32 v233, 64, v232
v_accvgpr_read_b32 v97, a193
v_accvgpr_read_b32 v98, a194
v_accvgpr_read_b32 v99, a195
v_mfma_f32_16x16x32_bf16 v[8:11], v[192:195], a[244:247], v[8:11]
v_accvgpr_read_b32 v100, a196
v_accvgpr_read_b32 v101, a197
v_accvgpr_read_b32 v102, a198
s_waitcnt vmcnt(12) lgkmcnt(0)
s_barrier
ds_read_b128 v[176:179], v232 offset:0
ds_read_b128 v[180:183], v232 offset:2048
ds_read_b128 v[184:187], v233 offset:0
v_mfma_f32_16x16x32_bf16 v[4:7], v[196:199], a[240:243], v[4:7]
v_accvgpr_read_b32 v103, a199
v_mul_f32 v96, v96, v248
v_mul_f32 v97, v97, v248
v_mfma_f32_16x16x32_bf16 v[12:15], v[196:199], a[244:247], v[12:15]
ds_read_b128 v[188:191], v233 offset:2048
v_mul_f32 v98, v98, v248
v_mul_f32 v99, v99, v248
v_mul_f32 v100, v100, v248
v_mfma_f32_16x16x32_bf16 v[0:3], v[200:203], a[248:251], v[0:3]
v_mul_f32 v101, v101, v248
v_mul_f32 v102, v102, v248
v_mul_f32 v103, v103, v248
v_mfma_f32_16x16x32_bf16 v[8:11], v[200:203], a[252:255], v[8:11]
ds_read_b128 v[192:195], v232 offset:8192
v_cvt_pk_bf16_f32 v96, v96, v97
v_cvt_pk_bf16_f32 v97, v98, v99
v_cvt_pk_bf16_f32 v98, v100, v101
v_mfma_f32_16x16x32_bf16 v[4:7], v[204:207], a[248:251], v[4:7]
v_cvt_pk_bf16_f32 v99, v102, v103
v_accvgpr_read_b32 v104, a200
v_accvgpr_read_b32 v105, a201
v_mfma_f32_16x16x32_bf16 v[12:15], v[204:207], a[252:255], v[12:15]
ds_read_b128 v[196:199], v232 offset:10240
v_accvgpr_read_b32 v106, a202
v_accvgpr_read_b32 v107, a203
v_accvgpr_read_b32 v108, a204
s_waitcnt lgkmcnt(4)
v_mfma_f32_16x16x32_bf16 v[16:19], v[176:179], a[208:211], 0
v_accvgpr_read_b32 v109, a205
v_accvgpr_read_b32 v110, a206
v_accvgpr_read_b32 v111, a207
v_mfma_f32_16x16x32_bf16 v[24:27], v[176:179], a[212:215], 0
ds_read_b128 v[200:203], v233 offset:8192
v_mul_f32 v104, v104, v249
v_mul_f32 v105, v105, v249
v_mul_f32 v106, v106, v249
v_mfma_f32_16x16x32_bf16 v[20:23], v[180:183], a[208:211], 0
s_add_u32 m0, s48, 8192
v_mul_f32 v107, v107, v249
v_mul_f32 v108, v108, v249
v_mul_f32 v109, v109, v249
v_mfma_f32_16x16x32_bf16 v[28:31], v[180:183], a[212:215], 0
ds_read_b128 v[204:207], v233 offset:10240
buffer_load_dwordx4 v228, s[40:43], s61 offen lds
s_waitcnt lgkmcnt(4)
v_mfma_f32_16x16x32_bf16 v[16:19], v[184:187], a[216:219], v[16:19]
v_mul_f32 v110, v110, v249
v_mul_f32 v111, v111, v249
v_cvt_pk_bf16_f32 v104, v104, v105
v_cvt_pk_bf16_f32 v105, v106, v107
v_mfma_f32_16x16x32_bf16 v[24:27], v[184:187], a[220:223], v[24:27]
ds_read_b128 v[176:179], v232 offset:16384
buffer_load_dwordx4 v229, s[40:43], s61 offen offset:1024 lds
v_mfma_f32_16x16x32_bf16 v[20:23], v[188:191], a[216:219], v[20:23]
s_mul_i32 s52, s61, 6144
s_add_u32 s52, s52, 9216
s_add_u32 m0, s48, 90112
v_cvt_pk_bf16_f32 v106, v108, v109
v_cvt_pk_bf16_f32 v107, v110, v111
v_mfma_f32_16x16x32_bf16 v[28:31], v[188:191], a[220:223], v[28:31]
ds_read_b128 v[180:183], v232 offset:18432
buffer_load_dwordx4 v226, s[32:35], s52 offen lds
v_max3_f32 v240, v0, v1, v2
s_waitcnt lgkmcnt(4)
v_mfma_f32_16x16x32_bf16 v[16:19], v[192:195], a[224:227], v[16:19]
v_max3_f32 v241, v8, v9, v10
v_max3_f32 v240, v240, v3, v4
v_max3_f32 v241, v241, v11, v12
v_mfma_f32_16x16x32_bf16 v[24:27], v[192:195], a[228:231], v[24:27]
ds_read_b128 v[184:187], v233 offset:16384
buffer_load_dwordx4 v227, s[32:35], s52 offen offset:1024 lds
v_max3_f32 v240, v240, v5, v6
v_mfma_f32_16x16x32_bf16 v[20:23], v[196:199], a[224:227], v[20:23]
s_add_u32 m0, s48, 98176
v_max3_f32 v241, v241, v13, v14
v_max_f32 v240, v240, v7
v_max_f32 v241, v241, v15
v_mfma_f32_16x16x32_bf16 v[28:31], v[196:199], a[228:231], v[28:31]
ds_read_b128 v[188:191], v233 offset:18432
buffer_load_dwordx4 v226, s[32:35], s52 offen offset:128 lds
ds_write_b64 v251, v[64:65] offset:0
ds_write_b64 v251, v[66:67] offset:512
ds_write_b64 v251, v[72:73] offset:1024
ds_write_b64 v251, v[74:75] offset:1536
ds_write_b64 v251, v[80:81] offset:16384
ds_write_b64 v251, v[82:83] offset:16896
ds_write_b64 v251, v[88:89] offset:17408
ds_write_b64 v251, v[90:91] offset:17920
ds_write_b64 v251, v[96:97] offset:24576
ds_write_b64 v251, v[98:99] offset:25088
ds_write_b64 v251, v[104:105] offset:25600
ds_write_b64 v251, v[106:107] offset:26112
s_waitcnt lgkmcnt(15)
v_mfma_f32_16x16x32_bf16 v[16:19], v[200:203], a[232:235], v[16:19]
v_mfma_f32_16x16x32_bf16 v[24:27], v[200:203], a[236:239], v[24:27]
buffer_load_dwordx4 v227, s[32:35], s52 offen offset:1152 lds
v_mfma_f32_16x16x32_bf16 v[20:23], v[204:207], a[232:235], v[20:23]
s_add_u32 m0, s48, 106240
v_mfma_f32_16x16x32_bf16 v[28:31], v[204:207], a[236:239], v[28:31]
buffer_load_dwordx4 v226, s[32:35], s52 offen offset:256 lds
v_add_u32 v236, 139264, v230
v_xor_b32 v237, 32, v236
s_waitcnt lgkmcnt(14)
v_mfma_f32_16x16x32_bf16 v[16:19], v[176:179], a[240:243], v[16:19]
v_mfma_f32_16x16x32_bf16 v[24:27], v[176:179], a[244:247], v[24:27]
buffer_load_dwordx4 v227, s[32:35], s52 offen offset:1280 lds
s_waitcnt vmcnt(14) lgkmcnt(0)
s_barrier
ds_read_b128 a[160:163], v238 offset:0
ds_read_b128 a[164:167], v238 offset:1024
ds_read_b64_tr_b16 v[192:193], v236 offset:0
ds_read_b64_tr_b16 v[194:195], v237 offset:512
ds_read_b64_tr_b16 v[196:197], v237 offset:0
ds_read_b64_tr_b16 v[198:199], v236 offset:512
ds_read_b128 a[168:171], v238 offset:2048
ds_read_b128 a[172:175], v238 offset:3072
ds_read_b64_tr_b16 v[200:201], v236 offset:4096
ds_read_b64_tr_b16 v[202:203], v237 offset:4608
v_mfma_f32_16x16x32_bf16 v[20:23], v[180:183], a[240:243], v[20:23]
s_mov_b32 s52, 3219456
s_add_u32 m0, s48, 114688
s_nop 0
buffer_load_dwordx4 v224, s[24:27], s52 offen nt lds
v_mfma_f32_16x16x32_bf16 v[28:31], v[180:183], a[244:247], v[28:31]
ds_read_b64_tr_b16 v[204:205], v237 offset:4096
v_mfma_f32_16x16x32_bf16 v[16:19], v[184:187], a[248:251], v[16:19]
ds_read_b64_tr_b16 v[206:207], v236 offset:4608
buffer_load_dwordx4 v225, s[24:27], s52 offen offset:1024 nt lds
v_mfma_f32_16x16x32_bf16 v[24:27], v[184:187], a[252:255], v[24:27]
ds_read_b128 a[176:179], v238 offset:16384
ds_read_b128 a[180:183], v238 offset:17408
s_add_u32 m0, s48, 122752
v_mfma_f32_16x16x32_bf16 v[20:23], v[188:191], a[248:251], v[20:23]
ds_read_b64_tr_b16 v[176:177], v236 offset:8192
ds_read_b64_tr_b16 v[178:179], v237 offset:8704
buffer_load_dwordx4 v224, s[24:27], s52 offen offset:128 nt lds
v_mfma_f32_16x16x32_bf16 v[28:31], v[188:191], a[252:255], v[28:31]
ds_read_b64_tr_b16 v[180:181], v237 offset:8192
s_waitcnt lgkmcnt(11)
v_mfma_f32_16x16x32_bf16 a[0:3], v[192:195], a[160:163], a[0:3]
ds_read_b64_tr_b16 v[182:183], v236 offset:8704
buffer_load_dwordx4 v225, s[24:27], s52 offen offset:1152 nt lds
v_mfma_f32_16x16x32_bf16 a[8:11], v[192:195], a[164:167], a[8:11]
ds_read_b128 a[184:187], v238 offset:18432
ds_read_b128 a[188:191], v238 offset:19456
s_add_u32 m0, s48, 130816
v_mfma_f32_16x16x32_bf16 a[4:7], v[196:199], a[160:163], a[4:7]
ds_read_b64_tr_b16 v[184:185], v236 offset:12288
ds_read_b64_tr_b16 v[186:187], v237 offset:12800
buffer_load_dwordx4 v224, s[24:27], s52 offen offset:256 nt lds
v_mfma_f32_16x16x32_bf16 a[12:15], v[196:199], a[164:167], a[12:15]
ds_read_b64_tr_b16 v[188:189], v237 offset:12288
v_max3_f32 v240, v240, v16, v17
s_waitcnt lgkmcnt(11)
v_mfma_f32_16x16x32_bf16 a[0:3], v[200:203], a[168:171], a[0:3]
ds_read_b64_tr_b16 v[190:191], v236 offset:12800
v_max3_f32 v241, v241, v24, v25
v_mfma_f32_16x16x32_bf16 a[8:11], v[200:203], a[172:175], a[8:11]
ds_read_b128 a[192:195], v238 offset:24576
ds_read_b128 a[196:199], v238 offset:25600
buffer_load_dwordx4 v225, s[24:27], s52 offen offset:1280 nt lds
v_mfma_f32_16x16x32_bf16 a[4:7], v[204:207], a[168:171], a[4:7]
ds_read_b64_tr_b16 v[192:193], v236 offset:16384
ds_read_b64_tr_b16 v[194:195], v237 offset:16896
v_mfma_f32_16x16x32_bf16 a[12:15], v[204:207], a[172:175], a[12:15]
ds_read_b64_tr_b16 v[196:197], v237 offset:16384
v_max3_f32 v240, v240, v18, v19
s_waitcnt lgkmcnt(11)
v_mfma_f32_16x16x32_bf16 a[0:3], v[176:179], a[176:179], a[0:3]
ds_read_b64_tr_b16 v[198:199], v236 offset:16896
v_max3_f32 v241, v241, v26, v27
v_mfma_f32_16x16x32_bf16 a[8:11], v[176:179], a[180:183], a[8:11]
ds_read_b128 a[200:203], v238 offset:26624
ds_read_b128 a[204:207], v238 offset:27648
v_mfma_f32_16x16x32_bf16 a[4:7], v[180:183], a[176:179], a[4:7]
ds_read_b64_tr_b16 v[200:201], v236 offset:20480
ds_read_b64_tr_b16 v[202:203], v237 offset:20992
v_mfma_f32_16x16x32_bf16 a[12:15], v[180:183], a[180:183], a[12:15]
ds_read_b64_tr_b16 v[204:205], v237 offset:20480
v_max3_f32 v240, v240, v20, v21
s_waitcnt lgkmcnt(11)
v_mfma_f32_16x16x32_bf16 a[0:3], v[184:187], a[184:187], a[0:3]
ds_read_b64_tr_b16 v[206:207], v236 offset:20992
v_max3_f32 v241, v241, v28, v29
v_mfma_f32_16x16x32_bf16 a[8:11], v[184:187], a[188:191], a[8:11]
v_max3_f32 v240, v240, v22, v23
v_max3_f32 v241, v241, v30, v31
v_mfma_f32_16x16x32_bf16 a[4:7], v[188:191], a[184:187], a[4:7]
v_mfma_f32_16x16x32_bf16 a[12:15], v[188:191], a[188:191], a[12:15]
s_add_u32 s53, s49, 65536
v_add_u32 v232, s53, v231
s_waitcnt lgkmcnt(6)
v_mfma_f32_16x16x32_bf16 a[0:3], v[192:195], a[192:195], a[0:3]
v_xor_b32 v233, 64, v232
v_mfma_f32_16x16x32_bf16 a[8:11], v[192:195], a[196:199], a[8:11]
s_waitcnt vmcnt(14) lgkmcnt(0)
s_barrier
ds_read_b128 v[176:179], v232 offset:0
ds_read_b128 v[180:183], v232 offset:2048
ds_read_b128 v[184:187], v233 offset:0
v_mfma_f32_16x16x32_bf16 a[4:7], v[196:199], a[192:195], a[4:7]
v_mfma_f32_16x16x32_bf16 a[12:15], v[196:199], a[196:199], a[12:15]
ds_read_b128 v[188:191], v233 offset:2048
v_mfma_f32_16x16x32_bf16 a[0:3], v[200:203], a[200:203], a[0:3]
v_mfma_f32_16x16x32_bf16 a[8:11], v[200:203], a[204:207], a[8:11]
ds_read_b128 v[192:195], v232 offset:8192
v_mfma_f32_16x16x32_bf16 a[4:7], v[204:207], a[200:203], a[4:7]
v_mfma_f32_16x16x32_bf16 a[12:15], v[204:207], a[204:207], a[12:15]
ds_read_b128 v[196:199], v232 offset:10240
s_waitcnt lgkmcnt(4)
v_mfma_f32_16x16x32_bf16 v[32:35], v[176:179], a[208:211], 0
v_mfma_f32_16x16x32_bf16 v[40:43], v[176:179], a[212:215], 0
ds_read_b128 v[200:203], v233 offset:8192
v_mfma_f32_16x16x32_bf16 v[36:39], v[180:183], a[208:211], 0
s_add_u32 s52, s71, 1966080
s_add_u32 m0, s48, 139264
v_mfma_f32_16x16x32_bf16 v[44:47], v[180:183], a[212:215], 0
ds_read_b128 v[204:207], v233 offset:10240
buffer_load_dwordx4 v228, s[36:39], s52 offen lds
s_waitcnt lgkmcnt(4)
v_mfma_f32_16x16x32_bf16 v[32:35], v[184:187], a[216:219], v[32:35]
v_mfma_f32_16x16x32_bf16 v[40:43], v[184:187], a[220:223], v[40:43]
ds_read_b128 v[176:179], v232 offset:16384
buffer_load_dwordx4 v229, s[36:39], s52 offen offset:1024 lds
v_mfma_f32_16x16x32_bf16 v[36:39], v[188:191], a[216:219], v[36:39]
v_mfma_f32_16x16x32_bf16 v[44:47], v[188:191], a[220:223], v[44:47]
ds_read_b128 v[180:183], v232 offset:18432
s_add_u32 s52, s71, 2048000
s_add_u32 m0, s48, 147456
s_waitcnt lgkmcnt(4)
v_mfma_f32_16x16x32_bf16 v[32:35], v[192:195], a[224:227], v[32:35]
buffer_load_dwordx4 v228, s[36:39], s52 offen lds
v_mfma_f32_16x16x32_bf16 v[40:43], v[192:195], a[228:231], v[40:43]
ds_read_b128 v[184:187], v233 offset:16384
v_mfma_f32_16x16x32_bf16 v[36:39], v[196:199], a[224:227], v[36:39]
v_mfma_f32_16x16x32_bf16 v[44:47], v[196:199], a[228:231], v[44:47]
ds_read_b128 v[188:191], v233 offset:18432
buffer_load_dwordx4 v229, s[36:39], s52 offen offset:1024 lds
s_waitcnt lgkmcnt(4)
v_mfma_f32_16x16x32_bf16 v[32:35], v[200:203], a[232:235], v[32:35]
v_mfma_f32_16x16x32_bf16 v[40:43], v[200:203], a[236:239], v[40:43]
s_add_u32 s52, s71, 2129920
s_add_u32 m0, s48, 155648
v_mfma_f32_16x16x32_bf16 v[36:39], v[204:207], a[232:235], v[36:39]
buffer_load_dwordx4 v228, s[36:39], s52 offen lds
v_mfma_f32_16x16x32_bf16 v[44:47], v[204:207], a[236:239], v[44:47]
s_add_u32 s53, s50, 8192
v_add_u32 v232, s53, v231
s_waitcnt lgkmcnt(2)
v_mfma_f32_16x16x32_bf16 v[32:35], v[176:179], a[240:243], v[32:35]
v_xor_b32 v233, 64, v232
v_add_u32 v236, 90112, v230
v_mfma_f32_16x16x32_bf16 v[40:43], v[176:179], a[244:247], v[40:43]
buffer_load_dwordx4 v229, s[36:39], s52 offen offset:1024 lds
v_xor_b32 v237, 32, v236
s_waitcnt vmcnt(12) lgkmcnt(0)
s_barrier
ds_read_b128 v[208:211], v232 offset:0
ds_read_b128 v[212:215], v232 offset:2048
ds_read_b64_tr_b16 v[192:193], v236 offset:0
ds_read_b64_tr_b16 v[194:195], v237 offset:512
ds_read_b64_tr_b16 v[196:197], v237 offset:0
ds_read_b64_tr_b16 v[198:199], v236 offset:512
ds_read_b64_tr_b16 v[200:201], v236 offset:8192
ds_read_b64_tr_b16 v[202:203], v237 offset:8704
v_mfma_f32_16x16x32_bf16 v[36:39], v[180:183], a[240:243], v[36:39]
s_mov_b32 s52, 3244032
s_add_u32 m0, s48, 65536
s_nop 0
buffer_load_dwordx4 v224, s[24:27], s52 offen nt lds
v_mfma_f32_16x16x32_bf16 v[44:47], v[180:183], a[244:247], v[44:47]
ds_read_b64_tr_b16 v[204:205], v237 offset:8192
v_mfma_f32_16x16x32_bf16 v[32:35], v[184:187], a[248:251], v[32:35]
ds_read_b64_tr_b16 v[206:207], v236 offset:8704
buffer_load_dwordx4 v225, s[24:27], s52 offen offset:1024 nt lds
v_mfma_f32_16x16x32_bf16 v[40:43], v[184:187], a[252:255], v[40:43]
ds_read_b64_tr_b16 v[176:177], v236 offset:16384
s_add_u32 m0, s48, 73600
v_mfma_f32_16x16x32_bf16 v[36:39], v[188:191], a[248:251], v[36:39]
ds_read_b64_tr_b16 v[178:179], v237 offset:16896
buffer_load_dwordx4 v224, s[24:27], s52 offen offset:128 nt lds
v_mfma_f32_16x16x32_bf16 v[44:47], v[188:191], a[252:255], v[44:47]
ds_read_b64_tr_b16 v[180:181], v237 offset:16384
s_waitcnt lgkmcnt(7)
v_mfma_f32_16x16x32_bf16 v[128:131], v[192:195], v[208:211], v[128:131]
ds_read_b64_tr_b16 v[182:183], v236 offset:16896
buffer_load_dwordx4 v225, s[24:27], s52 offen offset:1152 nt lds
v_mfma_f32_16x16x32_bf16 v[136:139], v[192:195], v[212:215], v[136:139]
ds_read_b128 v[216:219], v233 offset:0
ds_read_b128 v[220:223], v233 offset:2048
s_add_u32 m0, s48, 81664
v_mfma_f32_16x16x32_bf16 v[132:135], v[196:199], v[208:211], v[132:135]
ds_read_b64_tr_b16 v[184:185], v236 offset:4096
ds_read_b64_tr_b16 v[186:187], v237 offset:4608
buffer_load_dwordx4 v224, s[24:27], s52 offen offset:256 nt lds
v_mfma_f32_16x16x32_bf16 v[140:143], v[196:199], v[212:215], v[140:143]
ds_read_b64_tr_b16 v[188:189], v237 offset:4096
v_max3_f32 v240, v240, v32, v33
s_waitcnt lgkmcnt(9)
v_mfma_f32_16x16x32_bf16 v[144:147], v[200:203], v[208:211], v[144:147]
ds_read_b64_tr_b16 v[190:191], v236 offset:4608
v_max3_f32 v241, v241, v40, v41
v_mfma_f32_16x16x32_bf16 v[152:155], v[200:203], v[212:215], v[152:155]
ds_read_b64_tr_b16 v[192:193], v236 offset:12288
buffer_load_dwordx4 v225, s[24:27], s52 offen offset:1280 nt lds
v_mfma_f32_16x16x32_bf16 v[148:151], v[204:207], v[208:211], v[148:151]
ds_read_b64_tr_b16 v[194:195], v237 offset:12800
v_max3_f32 v240, v240, v34, v35
v_mfma_f32_16x16x32_bf16 v[156:159], v[204:207], v[212:215], v[156:159]
ds_read_b64_tr_b16 v[196:197], v237 offset:12288
v_max3_f32 v241, v241, v42, v43
s_waitcnt lgkmcnt(9)
v_mfma_f32_16x16x32_bf16 v[160:163], v[176:179], v[208:211], v[160:163]
ds_read_b64_tr_b16 v[198:199], v236 offset:12800
v_max3_f32 v240, v240, v36, v37
v_mfma_f32_16x16x32_bf16 v[168:171], v[176:179], v[212:215], v[168:171]
ds_read_b64_tr_b16 v[200:201], v236 offset:20480
v_max3_f32 v241, v241, v44, v45
v_mfma_f32_16x16x32_bf16 v[164:167], v[180:183], v[208:211], v[164:167]
ds_read_b64_tr_b16 v[202:203], v237 offset:20992
v_max3_f32 v240, v240, v38, v39
v_mfma_f32_16x16x32_bf16 v[172:175], v[180:183], v[212:215], v[172:175]
ds_read_b64_tr_b16 v[204:205], v237 offset:20480
v_max3_f32 v241, v241, v46, v47
s_waitcnt lgkmcnt(7)
v_mfma_f32_16x16x32_bf16 v[128:131], v[184:187], v[216:219], v[128:131]
ds_read_b64_tr_b16 v[206:207], v236 offset:20992
v_mfma_f32_16x16x32_bf16 v[136:139], v[184:187], v[220:223], v[136:139]
v_mfma_f32_16x16x32_bf16 v[132:135], v[188:191], v[216:219], v[132:135]
v_mfma_f32_16x16x32_bf16 v[140:143], v[188:191], v[220:223], v[140:143]
s_add_u32 s53, s49, 114688
v_add_u32 v232, s53, v231
s_waitcnt lgkmcnt(4)
v_mfma_f32_16x16x32_bf16 v[144:147], v[192:195], v[216:219], v[144:147]
v_xor_b32 v233, 64, v232
v_mfma_f32_16x16x32_bf16 v[152:155], v[192:195], v[220:223], v[152:155]
s_waitcnt vmcnt(12) lgkmcnt(0)
s_barrier
ds_read_b128 v[176:179], v232 offset:0
ds_read_b128 v[180:183], v232 offset:2048
ds_read_b128 v[184:187], v233 offset:0
v_mfma_f32_16x16x32_bf16 v[148:151], v[196:199], v[216:219], v[148:151]
v_mfma_f32_16x16x32_bf16 v[156:159], v[196:199], v[220:223], v[156:159]
ds_read_b128 v[188:191], v233 offset:2048
v_mfma_f32_16x16x32_bf16 v[160:163], v[200:203], v[216:219], v[160:163]
v_mfma_f32_16x16x32_bf16 v[168:171], v[200:203], v[220:223], v[168:171]
ds_read_b128 v[192:195], v232 offset:8192
v_mfma_f32_16x16x32_bf16 v[164:167], v[204:207], v[216:219], v[164:167]
v_mfma_f32_16x16x32_bf16 v[172:175], v[204:207], v[220:223], v[172:175]
ds_read_b128 v[196:199], v232 offset:10240
s_waitcnt lgkmcnt(4)
v_mfma_f32_16x16x32_bf16 v[48:51], v[176:179], a[208:211], 0
v_mfma_f32_16x16x32_bf16 v[56:59], v[176:179], a[212:215], 0
ds_read_b128 v[200:203], v233 offset:8192
v_mfma_f32_16x16x32_bf16 v[52:55], v[180:183], a[208:211], 0
s_add_u32 m0, s48, 8192
v_mfma_f32_16x16x32_bf16 v[60:63], v[180:183], a[212:215], 0
ds_read_b128 v[204:207], v233 offset:10240
buffer_load_dwordx4 v228, s[40:43], s62 offen lds
s_waitcnt lgkmcnt(4)
v_mfma_f32_16x16x32_bf16 v[48:51], v[184:187], a[216:219], v[48:51]
v_mfma_f32_16x16x32_bf16 v[56:59], v[184:187], a[220:223], v[56:59]
ds_read_b128 v[176:179], v232 offset:16384
buffer_load_dwordx4 v229, s[40:43], s62 offen offset:1024 lds
v_mfma_f32_16x16x32_bf16 v[52:55], v[188:191], a[216:219], v[52:55]
s_mul_i32 s52, s62, 6144
s_add_u32 s52, s52, 9216
s_add_u32 m0, s48, 90112
v_mfma_f32_16x16x32_bf16 v[60:63], v[188:191], a[220:223], v[60:63]
ds_read_b128 v[180:183], v232 offset:18432
buffer_load_dwordx4 v226, s[32:35], s52 offen lds
s_waitcnt lgkmcnt(4)
v_mfma_f32_16x16x32_bf16 v[48:51], v[192:195], a[224:227], v[48:51]
v_mfma_f32_16x16x32_bf16 v[56:59], v[192:195], a[228:231], v[56:59]
ds_read_b128 v[184:187], v233 offset:16384
buffer_load_dwordx4 v227, s[32:35], s52 offen offset:1024 lds
v_mfma_f32_16x16x32_bf16 v[52:55], v[196:199], a[224:227], v[52:55]
s_add_u32 m0, s48, 98176
v_mfma_f32_16x16x32_bf16 v[60:63], v[196:199], a[228:231], v[60:63]
ds_read_b128 v[188:191], v233 offset:18432
buffer_load_dwordx4 v226, s[32:35], s52 offen offset:128 lds
s_waitcnt lgkmcnt(4)
v_mfma_f32_16x16x32_bf16 v[48:51], v[200:203], a[232:235], v[48:51]
v_mfma_f32_16x16x32_bf16 v[56:59], v[200:203], a[236:239], v[56:59]
buffer_load_dwordx4 v227, s[32:35], s52 offen offset:1152 lds
v_mfma_f32_16x16x32_bf16 v[52:55], v[204:207], a[232:235], v[52:55]
s_add_u32 m0, s48, 106240
v_mfma_f32_16x16x32_bf16 v[60:63], v[204:207], a[236:239], v[60:63]
buffer_load_dwordx4 v226, s[32:35], s52 offen offset:256 lds
v_add_u32 v236, 139264, v230
v_xor_b32 v237, 32, v236
s_waitcnt lgkmcnt(2)
v_mfma_f32_16x16x32_bf16 v[48:51], v[176:179], a[240:243], v[48:51]
v_mfma_f32_16x16x32_bf16 v[56:59], v[176:179], a[244:247], v[56:59]
buffer_load_dwordx4 v227, s[32:35], s52 offen offset:1280 lds
s_waitcnt vmcnt(14) lgkmcnt(0)
s_barrier
ds_read_b64_tr_b16 v[192:193], v236 offset:0
ds_read_b64_tr_b16 v[194:195], v237 offset:512
ds_read_b64_tr_b16 v[196:197], v237 offset:0
ds_read_b64_tr_b16 v[198:199], v236 offset:512
ds_read_b64_tr_b16 v[200:201], v236 offset:4096
ds_read_b64_tr_b16 v[202:203], v237 offset:4608
v_mfma_f32_16x16x32_bf16 v[52:55], v[180:183], a[240:243], v[52:55]
s_mov_b32 s52, 3268608
s_add_u32 m0, s48, 114688
s_nop 0
buffer_load_dwordx4 v224, s[24:27], s52 offen nt lds
v_mfma_f32_16x16x32_bf16 v[60:63], v[180:183], a[244:247], v[60:63]
ds_read_b64_tr_b16 v[204:205], v237 offset:4096
v_mfma_f32_16x16x32_bf16 v[48:51], v[184:187], a[248:251], v[48:51]
ds_read_b64_tr_b16 v[206:207], v236 offset:4608
buffer_load_dwordx4 v225, s[24:27], s52 offen offset:1024 nt lds
v_mfma_f32_16x16x32_bf16 v[56:59], v[184:187], a[252:255], v[56:59]
ds_read_b64_tr_b16 v[176:177], v236 offset:8192
s_add_u32 m0, s48, 122752
v_mfma_f32_16x16x32_bf16 v[52:55], v[188:191], a[248:251], v[52:55]
ds_read_b64_tr_b16 v[178:179], v237 offset:8704
buffer_load_dwordx4 v224, s[24:27], s52 offen offset:128 nt lds
v_mfma_f32_16x16x32_bf16 v[60:63], v[188:191], a[252:255], v[60:63]
ds_read_b64_tr_b16 v[180:181], v237 offset:8192
s_waitcnt lgkmcnt(7)
v_mfma_f32_16x16x32_bf16 a[16:19], v[192:195], a[160:163], a[16:19]
ds_read_b64_tr_b16 v[182:183], v236 offset:8704
buffer_load_dwordx4 v225, s[24:27], s52 offen offset:1152 nt lds
v_mfma_f32_16x16x32_bf16 a[24:27], v[192:195], a[164:167], a[24:27]
ds_read_b64_tr_b16 v[184:185], v236 offset:12288
s_add_u32 m0, s48, 130816
v_mfma_f32_16x16x32_bf16 a[20:23], v[196:199], a[160:163], a[20:23]
ds_read_b64_tr_b16 v[186:187], v237 offset:12800
buffer_load_dwordx4 v224, s[24:27], s52 offen offset:256 nt lds
v_mfma_f32_16x16x32_bf16 a[28:31], v[196:199], a[164:167], a[28:31]
ds_read_b64_tr_b16 v[188:189], v237 offset:12288
v_max3_f32 v240, v240, v48, v49
s_waitcnt lgkmcnt(7)
v_mfma_f32_16x16x32_bf16 a[16:19], v[200:203], a[168:171], a[16:19]
ds_read_b64_tr_b16 v[190:191], v236 offset:12800
v_max3_f32 v241, v241, v56, v57
v_mfma_f32_16x16x32_bf16 a[24:27], v[200:203], a[172:175], a[24:27]
ds_read_b64_tr_b16 v[192:193], v236 offset:16384
buffer_load_dwordx4 v225, s[24:27], s52 offen offset:1280 nt lds
v_mfma_f32_16x16x32_bf16 a[20:23], v[204:207], a[168:171], a[20:23]
ds_read_b64_tr_b16 v[194:195], v237 offset:16896
v_max3_f32 v240, v240, v50, v51
v_mfma_f32_16x16x32_bf16 a[28:31], v[204:207], a[172:175], a[28:31]
ds_read_b64_tr_b16 v[196:197], v237 offset:16384
v_max3_f32 v241, v241, v58, v59
s_waitcnt lgkmcnt(7)
v_mfma_f32_16x16x32_bf16 a[16:19], v[176:179], a[176:179], a[16:19]
ds_read_b64_tr_b16 v[198:199], v236 offset:16896
v_max3_f32 v240, v240, v52, v53
v_mfma_f32_16x16x32_bf16 a[24:27], v[176:179], a[180:183], a[24:27]
ds_read_b64_tr_b16 v[200:201], v236 offset:20480
v_max3_f32 v241, v241, v60, v61
v_mfma_f32_16x16x32_bf16 a[20:23], v[180:183], a[176:179], a[20:23]
ds_read_b64_tr_b16 v[202:203], v237 offset:20992
v_max3_f32 v240, v240, v54, v55
v_mfma_f32_16x16x32_bf16 a[28:31], v[180:183], a[180:183], a[28:31]
ds_read_b64_tr_b16 v[204:205], v237 offset:20480
v_max3_f32 v241, v241, v62, v63
s_waitcnt lgkmcnt(7)
v_mfma_f32_16x16x32_bf16 a[16:19], v[184:187], a[184:187], a[16:19]
ds_read_b64_tr_b16 v[206:207], v236 offset:20992
v_mfma_f32_16x16x32_bf16 a[24:27], v[184:187], a[188:191], a[24:27]
v_mfma_f32_16x16x32_bf16 a[20:23], v[188:191], a[184:187], a[20:23]
v_mfma_f32_16x16x32_bf16 a[28:31], v[188:191], a[188:191], a[28:31]
s_add_u32 s53, s49, 65536
v_add_u32 v232, s53, v231
s_waitcnt lgkmcnt(4)
v_mfma_f32_16x16x32_bf16 a[16:19], v[192:195], a[192:195], a[16:19]
v_xor_b32 v233, 64, v232
v_mfma_f32_16x16x32_bf16 a[24:27], v[192:195], a[196:199], a[24:27]
s_waitcnt vmcnt(14) lgkmcnt(0)
s_barrier
ds_read_b128 v[176:179], v232 offset:0
ds_read_b128 v[180:183], v232 offset:2048
ds_read_b128 v[184:187], v233 offset:0
v_mfma_f32_16x16x32_bf16 a[20:23], v[196:199], a[192:195], a[20:23]
v_mfma_f32_16x16x32_bf16 a[28:31], v[196:199], a[196:199], a[28:31]
ds_read_b128 v[188:191], v233 offset:2048
v_mfma_f32_16x16x32_bf16 a[16:19], v[200:203], a[200:203], a[16:19]
v_mfma_f32_16x16x32_bf16 a[24:27], v[200:203], a[204:207], a[24:27]
ds_read_b128 v[192:195], v232 offset:8192
v_mfma_f32_16x16x32_bf16 a[20:23], v[204:207], a[200:203], a[20:23]
v_mfma_f32_16x16x32_bf16 a[28:31], v[204:207], a[204:207], a[28:31]
ds_read_b128 v[196:199], v232 offset:10240
s_waitcnt lgkmcnt(4)
v_mfma_f32_16x16x32_bf16 v[64:67], v[176:179], a[208:211], 0
v_mfma_f32_16x16x32_bf16 v[72:75], v[176:179], a[212:215], 0
ds_read_b128 v[200:203], v233 offset:8192
v_mfma_f32_16x16x32_bf16 v[68:71], v[180:183], a[208:211], 0
s_add_u32 s52, s72, 1966080
s_add_u32 m0, s48, 139264
v_mfma_f32_16x16x32_bf16 v[76:79], v[180:183], a[212:215], 0
ds_read_b128 v[204:207], v233 offset:10240
buffer_load_dwordx4 v228, s[36:39], s52 offen lds
s_waitcnt lgkmcnt(4)
v_mfma_f32_16x16x32_bf16 v[64:67], v[184:187], a[216:219], v[64:67]
v_mfma_f32_16x16x32_bf16 v[72:75], v[184:187], a[220:223], v[72:75]
ds_read_b128 v[176:179], v232 offset:16384
buffer_load_dwordx4 v229, s[36:39], s52 offen offset:1024 lds
v_mfma_f32_16x16x32_bf16 v[68:71], v[188:191], a[216:219], v[68:71]
v_mfma_f32_16x16x32_bf16 v[76:79], v[188:191], a[220:223], v[76:79]
ds_read_b128 v[180:183], v232 offset:18432
s_add_u32 s52, s72, 2048000
s_add_u32 m0, s48, 147456
s_waitcnt lgkmcnt(4)
v_mfma_f32_16x16x32_bf16 v[64:67], v[192:195], a[224:227], v[64:67]
buffer_load_dwordx4 v228, s[36:39], s52 offen lds
v_mfma_f32_16x16x32_bf16 v[72:75], v[192:195], a[228:231], v[72:75]
ds_read_b128 v[184:187], v233 offset:16384
v_mfma_f32_16x16x32_bf16 v[68:71], v[196:199], a[224:227], v[68:71]
v_mfma_f32_16x16x32_bf16 v[76:79], v[196:199], a[228:231], v[76:79]
ds_read_b128 v[188:191], v233 offset:18432
buffer_load_dwordx4 v229, s[36:39], s52 offen offset:1024 lds
s_waitcnt lgkmcnt(4)
v_mfma_f32_16x16x32_bf16 v[64:67], v[200:203], a[232:235], v[64:67]
v_mfma_f32_16x16x32_bf16 v[72:75], v[200:203], a[236:239], v[72:75]
s_add_u32 s52, s72, 2129920
s_add_u32 m0, s48, 155648
v_mfma_f32_16x16x32_bf16 v[68:71], v[204:207], a[232:235], v[68:71]
buffer_load_dwordx4 v228, s[36:39], s52 offen lds
v_mfma_f32_16x16x32_bf16 v[76:79], v[204:207], a[236:239], v[76:79]
s_add_u32 s53, s50, 8192
v_add_u32 v232, s53, v231
s_waitcnt lgkmcnt(2)
v_mfma_f32_16x16x32_bf16 v[64:67], v[176:179], a[240:243], v[64:67]
v_xor_b32 v233, 64, v232
v_add_u32 v236, 90112, v230
v_mfma_f32_16x16x32_bf16 v[72:75], v[176:179], a[244:247], v[72:75]
buffer_load_dwordx4 v229, s[36:39], s52 offen offset:1024 lds
v_xor_b32 v237, 32, v236
s_waitcnt vmcnt(12) lgkmcnt(0)
s_barrier
ds_read_b128 v[208:211], v232 offset:0
ds_read_b128 v[212:215], v232 offset:2048
ds_read_b64_tr_b16 v[192:193], v236 offset:0
ds_read_b64_tr_b16 v[194:195], v237 offset:512
ds_read_b64_tr_b16 v[196:197], v237 offset:0
ds_read_b64_tr_b16 v[198:199], v236 offset:512
ds_read_b64_tr_b16 v[200:201], v236 offset:8192
ds_read_b64_tr_b16 v[202:203], v237 offset:8704
v_mfma_f32_16x16x32_bf16 v[68:71], v[180:183], a[240:243], v[68:71]
s_mov_b32 s52, 3293184
s_add_u32 m0, s48, 65536
s_nop 0
buffer_load_dwordx4 v224, s[24:27], s52 offen nt lds
v_mfma_f32_16x16x32_bf16 v[76:79], v[180:183], a[244:247], v[76:79]
ds_read_b64_tr_b16 v[204:205], v237 offset:8192
v_mfma_f32_16x16x32_bf16 v[64:67], v[184:187], a[248:251], v[64:67]
ds_read_b64_tr_b16 v[206:207], v236 offset:8704
buffer_load_dwordx4 v225, s[24:27], s52 offen offset:1024 nt lds
v_mfma_f32_16x16x32_bf16 v[72:75], v[184:187], a[252:255], v[72:75]
ds_read_b64_tr_b16 v[176:177], v236 offset:16384
s_add_u32 m0, s48, 73600
v_mfma_f32_16x16x32_bf16 v[68:71], v[188:191], a[248:251], v[68:71]
ds_read_b64_tr_b16 v[178:179], v237 offset:16896
buffer_load_dwordx4 v224, s[24:27], s52 offen offset:128 nt lds
v_mfma_f32_16x16x32_bf16 v[76:79], v[188:191], a[252:255], v[76:79]
ds_read_b64_tr_b16 v[180:181], v237 offset:16384
s_waitcnt lgkmcnt(7)
v_mfma_f32_16x16x32_bf16 v[128:131], v[192:195], v[208:211], v[128:131]
ds_read_b64_tr_b16 v[182:183], v236 offset:16896
buffer_load_dwordx4 v225, s[24:27], s52 offen offset:1152 nt lds
v_mfma_f32_16x16x32_bf16 v[136:139], v[192:195], v[212:215], v[136:139]
ds_read_b128 v[216:219], v233 offset:0
ds_read_b128 v[220:223], v233 offset:2048
s_add_u32 m0, s48, 81664
v_mfma_f32_16x16x32_bf16 v[132:135], v[196:199], v[208:211], v[132:135]
ds_read_b64_tr_b16 v[184:185], v236 offset:4096
ds_read_b64_tr_b16 v[186:187], v237 offset:4608
buffer_load_dwordx4 v224, s[24:27], s52 offen offset:256 nt lds
v_mfma_f32_16x16x32_bf16 v[140:143], v[196:199], v[212:215], v[140:143]
ds_read_b64_tr_b16 v[188:189], v237 offset:4096
v_max3_f32 v240, v240, v64, v65
s_waitcnt lgkmcnt(9)
v_mfma_f32_16x16x32_bf16 v[144:147], v[200:203], v[208:211], v[144:147]
ds_read_b64_tr_b16 v[190:191], v236 offset:4608
v_max3_f32 v241, v241, v72, v73
v_mfma_f32_16x16x32_bf16 v[152:155], v[200:203], v[212:215], v[152:155]
ds_read_b64_tr_b16 v[192:193], v236 offset:12288
buffer_load_dwordx4 v225, s[24:27], s52 offen offset:1280 nt lds
v_mfma_f32_16x16x32_bf16 v[148:151], v[204:207], v[208:211], v[148:151]
ds_read_b64_tr_b16 v[194:195], v237 offset:12800
v_max3_f32 v240, v240, v66, v67
v_mfma_f32_16x16x32_bf16 v[156:159], v[204:207], v[212:215], v[156:159]
ds_read_b64_tr_b16 v[196:197], v237 offset:12288
v_max3_f32 v241, v241, v74, v75
s_waitcnt lgkmcnt(9)
v_mfma_f32_16x16x32_bf16 v[160:163], v[176:179], v[208:211], v[160:163]
ds_read_b64_tr_b16 v[198:199], v236 offset:12800
v_max3_f32 v240, v240, v68, v69
v_mfma_f32_16x16x32_bf16 v[168:171], v[176:179], v[212:215], v[168:171]
ds_read_b64_tr_b16 v[200:201], v236 offset:20480
v_max3_f32 v241, v241, v76, v77
v_mfma_f32_16x16x32_bf16 v[164:167], v[180:183], v[208:211], v[164:167]
ds_read_b64_tr_b16 v[202:203], v237 offset:20992
v_max3_f32 v240, v240, v70, v71
v_mfma_f32_16x16x32_bf16 v[172:175], v[180:183], v[212:215], v[172:175]
ds_read_b64_tr_b16 v[204:205], v237 offset:20480
v_max3_f32 v241, v241, v78, v79
s_waitcnt lgkmcnt(7)
v_mfma_f32_16x16x32_bf16 v[128:131], v[184:187], v[216:219], v[128:131]
ds_read_b64_tr_b16 v[206:207], v236 offset:20992
v_mfma_f32_16x16x32_bf16 v[136:139], v[184:187], v[220:223], v[136:139]
v_mfma_f32_16x16x32_bf16 v[132:135], v[188:191], v[216:219], v[132:135]
v_mfma_f32_16x16x32_bf16 v[140:143], v[188:191], v[220:223], v[140:143]
s_add_u32 s53, s49, 114688
v_add_u32 v232, s53, v231
s_waitcnt lgkmcnt(4)
v_mfma_f32_16x16x32_bf16 v[144:147], v[192:195], v[216:219], v[144:147]
v_xor_b32 v233, 64, v232
v_mfma_f32_16x16x32_bf16 v[152:155], v[192:195], v[220:223], v[152:155]
s_waitcnt vmcnt(12) lgkmcnt(0)
s_barrier
ds_read_b128 v[176:179], v232 offset:0
ds_read_b128 v[180:183], v232 offset:2048
ds_read_b128 v[184:187], v233 offset:0
v_mfma_f32_16x16x32_bf16 v[148:151], v[196:199], v[216:219], v[148:151]
v_mfma_f32_16x16x32_bf16 v[156:159], v[196:199], v[220:223], v[156:159]
ds_read_b128 v[188:191], v233 offset:2048
v_mfma_f32_16x16x32_bf16 v[160:163], v[200:203], v[216:219], v[160:163]
v_mfma_f32_16x16x32_bf16 v[168:171], v[200:203], v[220:223], v[168:171]
ds_read_b128 v[192:195], v232 offset:8192
v_mfma_f32_16x16x32_bf16 v[164:167], v[204:207], v[216:219], v[164:167]
v_mfma_f32_16x16x32_bf16 v[172:175], v[204:207], v[220:223], v[172:175]
ds_read_b128 v[196:199], v232 offset:10240
s_waitcnt lgkmcnt(4)
v_mfma_f32_16x16x32_bf16 v[80:83], v[176:179], a[208:211], 0
v_mfma_f32_16x16x32_bf16 v[88:91], v[176:179], a[212:215], 0
ds_read_b128 v[200:203], v233 offset:8192
v_mfma_f32_16x16x32_bf16 v[84:87], v[180:183], a[208:211], 0
s_add_u32 m0, s48, 8192
v_mfma_f32_16x16x32_bf16 v[92:95], v[180:183], a[212:215], 0
ds_read_b128 v[204:207], v233 offset:10240
buffer_load_dwordx4 v228, s[40:43], s63 offen lds
s_waitcnt lgkmcnt(4)
v_mfma_f32_16x16x32_bf16 v[80:83], v[184:187], a[216:219], v[80:83]
v_mfma_f32_16x16x32_bf16 v[88:91], v[184:187], a[220:223], v[88:91]
ds_read_b128 v[176:179], v232 offset:16384
buffer_load_dwordx4 v229, s[40:43], s63 offen offset:1024 lds
v_mfma_f32_16x16x32_bf16 v[84:87], v[188:191], a[216:219], v[84:87]
s_mul_i32 s52, s63, 6144
s_add_u32 s52, s52, 9216
s_add_u32 m0, s48, 90112
v_mfma_f32_16x16x32_bf16 v[92:95], v[188:191], a[220:223], v[92:95]
ds_read_b128 v[180:183], v232 offset:18432
buffer_load_dwordx4 v226, s[32:35], s52 offen lds
s_waitcnt lgkmcnt(4)
v_mfma_f32_16x16x32_bf16 v[80:83], v[192:195], a[224:227], v[80:83]
v_mfma_f32_16x16x32_bf16 v[88:91], v[192:195], a[228:231], v[88:91]
ds_read_b128 v[184:187], v233 offset:16384
buffer_load_dwordx4 v227, s[32:35], s52 offen offset:1024 lds
v_mfma_f32_16x16x32_bf16 v[84:87], v[196:199], a[224:227], v[84:87]
s_add_u32 m0, s48, 98176
v_mfma_f32_16x16x32_bf16 v[92:95], v[196:199], a[228:231], v[92:95]
ds_read_b128 v[188:191], v233 offset:18432
buffer_load_dwordx4 v226, s[32:35], s52 offen offset:128 lds
s_waitcnt lgkmcnt(4)
v_mfma_f32_16x16x32_bf16 v[80:83], v[200:203], a[232:235], v[80:83]
v_mfma_f32_16x16x32_bf16 v[88:91], v[200:203], a[236:239], v[88:91]
buffer_load_dwordx4 v227, s[32:35], s52 offen offset:1152 lds
v_mfma_f32_16x16x32_bf16 v[84:87], v[204:207], a[232:235], v[84:87]
s_add_u32 m0, s48, 106240
v_mfma_f32_16x16x32_bf16 v[92:95], v[204:207], a[236:239], v[92:95]
buffer_load_dwordx4 v226, s[32:35], s52 offen offset:256 lds
v_add_u32 v236, 139264, v230
v_xor_b32 v237, 32, v236
s_waitcnt lgkmcnt(2)
v_mfma_f32_16x16x32_bf16 v[80:83], v[176:179], a[240:243], v[80:83]
v_mfma_f32_16x16x32_bf16 v[88:91], v[176:179], a[244:247], v[88:91]
buffer_load_dwordx4 v227, s[32:35], s52 offen offset:1280 lds
s_waitcnt vmcnt(14) lgkmcnt(0)
s_barrier
ds_read_b64_tr_b16 v[192:193], v236 offset:0
ds_read_b64_tr_b16 v[194:195], v237 offset:512
ds_read_b64_tr_b16 v[196:197], v237 offset:0
ds_read_b64_tr_b16 v[198:199], v236 offset:512
ds_read_b64_tr_b16 v[200:201], v236 offset:4096
ds_read_b64_tr_b16 v[202:203], v237 offset:4608
v_mfma_f32_16x16x32_bf16 v[84:87], v[180:183], a[240:243], v[84:87]
s_mov_b32 s52, 3317760
s_add_u32 m0, s48, 114688
s_nop 0
buffer_load_dwordx4 v224, s[24:27], s52 offen nt lds
v_mfma_f32_16x16x32_bf16 v[92:95], v[180:183], a[244:247], v[92:95]
ds_read_b64_tr_b16 v[204:205], v237 offset:4096
v_mfma_f32_16x16x32_bf16 v[80:83], v[184:187], a[248:251], v[80:83]
ds_read_b64_tr_b16 v[206:207], v236 offset:4608
buffer_load_dwordx4 v225, s[24:27], s52 offen offset:1024 nt lds
v_mfma_f32_16x16x32_bf16 v[88:91], v[184:187], a[252:255], v[88:91]
ds_read_b64_tr_b16 v[176:177], v236 offset:8192
s_add_u32 m0, s48, 122752
v_mfma_f32_16x16x32_bf16 v[84:87], v[188:191], a[248:251], v[84:87]
ds_read_b64_tr_b16 v[178:179], v237 offset:8704
buffer_load_dwordx4 v224, s[24:27], s52 offen offset:128 nt lds
v_mfma_f32_16x16x32_bf16 v[92:95], v[188:191], a[252:255], v[92:95]
ds_read_b64_tr_b16 v[180:181], v237 offset:8192
s_waitcnt lgkmcnt(7)
v_mfma_f32_16x16x32_bf16 a[32:35], v[192:195], a[160:163], a[32:35]
ds_read_b64_tr_b16 v[182:183], v236 offset:8704
buffer_load_dwordx4 v225, s[24:27], s52 offen offset:1152 nt lds
v_mfma_f32_16x16x32_bf16 a[40:43], v[192:195], a[164:167], a[40:43]
ds_read_b64_tr_b16 v[184:185], v236 offset:12288
s_add_u32 m0, s48, 130816
v_mfma_f32_16x16x32_bf16 a[36:39], v[196:199], a[160:163], a[36:39]
ds_read_b64_tr_b16 v[186:187], v237 offset:12800
buffer_load_dwordx4 v224, s[24:27], s52 offen offset:256 nt lds
v_mfma_f32_16x16x32_bf16 a[44:47], v[196:199], a[164:167], a[44:47]
ds_read_b64_tr_b16 v[188:189], v237 offset:12288
v_max3_f32 v240, v240, v80, v81
s_waitcnt lgkmcnt(7)
v_mfma_f32_16x16x32_bf16 a[32:35], v[200:203], a[168:171], a[32:35]
ds_read_b64_tr_b16 v[190:191], v236 offset:12800
v_max3_f32 v241, v241, v88, v89
v_mfma_f32_16x16x32_bf16 a[40:43], v[200:203], a[172:175], a[40:43]
ds_read_b64_tr_b16 v[192:193], v236 offset:16384
buffer_load_dwordx4 v225, s[24:27], s52 offen offset:1280 nt lds
v_mfma_f32_16x16x32_bf16 a[36:39], v[204:207], a[168:171], a[36:39]
ds_read_b64_tr_b16 v[194:195], v237 offset:16896
v_max3_f32 v240, v240, v82, v83
v_mfma_f32_16x16x32_bf16 a[44:47], v[204:207], a[172:175], a[44:47]
ds_read_b64_tr_b16 v[196:197], v237 offset:16384
v_max3_f32 v241, v241, v90, v91
s_waitcnt lgkmcnt(7)
v_mfma_f32_16x16x32_bf16 a[32:35], v[176:179], a[176:179], a[32:35]
ds_read_b64_tr_b16 v[198:199], v236 offset:16896
v_max3_f32 v240, v240, v84, v85
v_mfma_f32_16x16x32_bf16 a[40:43], v[176:179], a[180:183], a[40:43]
ds_read_b64_tr_b16 v[200:201], v236 offset:20480
v_max3_f32 v241, v241, v92, v93
v_mfma_f32_16x16x32_bf16 a[36:39], v[180:183], a[176:179], a[36:39]
ds_read_b64_tr_b16 v[202:203], v237 offset:20992
v_max3_f32 v240, v240, v86, v87
v_mfma_f32_16x16x32_bf16 a[44:47], v[180:183], a[180:183], a[44:47]
ds_read_b64_tr_b16 v[204:205], v237 offset:20480
v_max3_f32 v241, v241, v94, v95
s_waitcnt lgkmcnt(7)
v_mfma_f32_16x16x32_bf16 a[32:35], v[184:187], a[184:187], a[32:35]
ds_read_b64_tr_b16 v[206:207], v236 offset:20992
v_mfma_f32_16x16x32_bf16 a[40:43], v[184:187], a[188:191], a[40:43]
v_mfma_f32_16x16x32_bf16 a[36:39], v[188:191], a[184:187], a[36:39]
v_mfma_f32_16x16x32_bf16 a[44:47], v[188:191], a[188:191], a[44:47]
s_add_u32 s53, s49, 65536
v_add_u32 v232, s53, v231
s_waitcnt lgkmcnt(4)
v_mfma_f32_16x16x32_bf16 a[32:35], v[192:195], a[192:195], a[32:35]
v_xor_b32 v233, 64, v232
v_mfma_f32_16x16x32_bf16 a[40:43], v[192:195], a[196:199], a[40:43]
s_waitcnt vmcnt(14) lgkmcnt(0)
s_barrier
ds_read_b128 v[176:179], v232 offset:0
ds_read_b128 v[180:183], v232 offset:2048
ds_read_b128 v[184:187], v233 offset:0
v_mfma_f32_16x16x32_bf16 a[36:39], v[196:199], a[192:195], a[36:39]
v_mfma_f32_16x16x32_bf16 a[44:47], v[196:199], a[196:199], a[44:47]
ds_read_b128 v[188:191], v233 offset:2048
v_mfma_f32_16x16x32_bf16 a[32:35], v[200:203], a[200:203], a[32:35]
v_mfma_f32_16x16x32_bf16 a[40:43], v[200:203], a[204:207], a[40:43]
ds_read_b128 v[192:195], v232 offset:8192
v_mfma_f32_16x16x32_bf16 a[36:39], v[204:207], a[200:203], a[36:39]
v_mfma_f32_16x16x32_bf16 a[44:47], v[204:207], a[204:207], a[44:47]
ds_read_b128 v[196:199], v232 offset:10240
s_waitcnt lgkmcnt(4)
v_mfma_f32_16x16x32_bf16 v[96:99], v[176:179], a[208:211], 0
v_mfma_f32_16x16x32_bf16 v[104:107], v[176:179], a[212:215], 0
ds_read_b128 v[200:203], v233 offset:8192
v_mfma_f32_16x16x32_bf16 v[100:103], v[180:183], a[208:211], 0
s_add_u32 s52, s73, 1966080
s_add_u32 m0, s48, 139264
v_mfma_f32_16x16x32_bf16 v[108:111], v[180:183], a[212:215], 0
ds_read_b128 v[204:207], v233 offset:10240
buffer_load_dwordx4 v228, s[36:39], s52 offen lds
s_waitcnt lgkmcnt(4)
v_mfma_f32_16x16x32_bf16 v[96:99], v[184:187], a[216:219], v[96:99]
v_mfma_f32_16x16x32_bf16 v[104:107], v[184:187], a[220:223], v[104:107]
ds_read_b128 v[176:179], v232 offset:16384
buffer_load_dwordx4 v229, s[36:39], s52 offen offset:1024 lds
v_mfma_f32_16x16x32_bf16 v[100:103], v[188:191], a[216:219], v[100:103]
v_mfma_f32_16x16x32_bf16 v[108:111], v[188:191], a[220:223], v[108:111]
ds_read_b128 v[180:183], v232 offset:18432
s_add_u32 s52, s73, 2048000
s_add_u32 m0, s48, 147456
s_waitcnt lgkmcnt(4)
v_mfma_f32_16x16x32_bf16 v[96:99], v[192:195], a[224:227], v[96:99]
buffer_load_dwordx4 v228, s[36:39], s52 offen lds
v_mfma_f32_16x16x32_bf16 v[104:107], v[192:195], a[228:231], v[104:107]
ds_read_b128 v[184:187], v233 offset:16384
v_mfma_f32_16x16x32_bf16 v[100:103], v[196:199], a[224:227], v[100:103]
v_mfma_f32_16x16x32_bf16 v[108:111], v[196:199], a[228:231], v[108:111]
ds_read_b128 v[188:191], v233 offset:18432
buffer_load_dwordx4 v229, s[36:39], s52 offen offset:1024 lds
s_waitcnt lgkmcnt(4)
v_mfma_f32_16x16x32_bf16 v[96:99], v[200:203], a[232:235], v[96:99]
v_mfma_f32_16x16x32_bf16 v[104:107], v[200:203], a[236:239], v[104:107]
s_add_u32 s52, s73, 2129920
s_add_u32 m0, s48, 155648
v_mfma_f32_16x16x32_bf16 v[100:103], v[204:207], a[232:235], v[100:103]
buffer_load_dwordx4 v228, s[36:39], s52 offen lds
v_mfma_f32_16x16x32_bf16 v[108:111], v[204:207], a[236:239], v[108:111]
s_add_u32 s53, s50, 8192
v_add_u32 v232, s53, v231
s_waitcnt lgkmcnt(2)
v_mfma_f32_16x16x32_bf16 v[96:99], v[176:179], a[240:243], v[96:99]
v_xor_b32 v233, 64, v232
v_add_u32 v236, 90112, v230
v_mfma_f32_16x16x32_bf16 v[104:107], v[176:179], a[244:247], v[104:107]
buffer_load_dwordx4 v229, s[36:39], s52 offen offset:1024 lds
v_xor_b32 v237, 32, v236
s_waitcnt vmcnt(12) lgkmcnt(0)
s_barrier
ds_read_b128 v[208:211], v232 offset:0
ds_read_b128 v[212:215], v232 offset:2048
ds_read_b64_tr_b16 v[192:193], v236 offset:0
ds_read_b64_tr_b16 v[194:195], v237 offset:512
ds_read_b64_tr_b16 v[196:197], v237 offset:0
ds_read_b64_tr_b16 v[198:199], v236 offset:512
ds_read_b64_tr_b16 v[200:201], v236 offset:8192
ds_read_b64_tr_b16 v[202:203], v237 offset:8704
v_mfma_f32_16x16x32_bf16 v[100:103], v[180:183], a[240:243], v[100:103]
s_add_u32 m0, s48, 0
s_nop 0
buffer_load_dwordx4 v228, s[40:43], s64 offen lds
v_mfma_f32_16x16x32_bf16 v[108:111], v[180:183], a[244:247], v[108:111]
ds_read_b64_tr_b16 v[204:205], v237 offset:8192
v_mfma_f32_16x16x32_bf16 v[96:99], v[184:187], a[248:251], v[96:99]
ds_read_b64_tr_b16 v[206:207], v236 offset:8704
buffer_load_dwordx4 v229, s[40:43], s64 offen offset:1024 lds
v_mfma_f32_16x16x32_bf16 v[104:107], v[184:187], a[252:255], v[104:107]
ds_read_b64_tr_b16 v[176:177], v236 offset:16384
v_mfma_f32_16x16x32_bf16 v[100:103], v[188:191], a[248:251], v[100:103]
ds_read_b64_tr_b16 v[178:179], v237 offset:16896
s_mul_i32 s52, s64, 6144
s_add_u32 s52, s52, 9216
s_add_u32 m0, s48, 65536
v_mfma_f32_16x16x32_bf16 v[108:111], v[188:191], a[252:255], v[108:111]
ds_read_b64_tr_b16 v[180:181], v237 offset:16384
buffer_load_dwordx4 v226, s[32:35], s52 offen lds
s_waitcnt lgkmcnt(7)
v_mfma_f32_16x16x32_bf16 v[128:131], v[192:195], v[208:211], v[128:131]
ds_read_b64_tr_b16 v[182:183], v236 offset:16896
v_mfma_f32_16x16x32_bf16 v[136:139], v[192:195], v[212:215], v[136:139]
ds_read_b128 v[216:219], v233 offset:0
ds_read_b128 v[220:223], v233 offset:2048
buffer_load_dwordx4 v227, s[32:35], s52 offen offset:1024 lds
v_mfma_f32_16x16x32_bf16 v[132:135], v[196:199], v[208:211], v[132:135]
ds_read_b64_tr_b16 v[184:185], v236 offset:4096
ds_read_b64_tr_b16 v[186:187], v237 offset:4608
v_mfma_f32_16x16x32_bf16 v[140:143], v[196:199], v[212:215], v[140:143]
ds_read_b64_tr_b16 v[188:189], v237 offset:4096
s_add_u32 m0, s48, 73600
v_max3_f32 v240, v240, v96, v97
s_waitcnt lgkmcnt(9)
v_mfma_f32_16x16x32_bf16 v[144:147], v[200:203], v[208:211], v[144:147]
ds_read_b64_tr_b16 v[190:191], v236 offset:4608
buffer_load_dwordx4 v226, s[32:35], s52 offen offset:128 lds
v_mfma_f32_16x16x32_bf16 v[152:155], v[200:203], v[212:215], v[152:155]
ds_read_b64_tr_b16 v[192:193], v236 offset:12288
v_max3_f32 v241, v241, v104, v105
v_mfma_f32_16x16x32_bf16 v[148:151], v[204:207], v[208:211], v[148:151]
ds_read_b64_tr_b16 v[194:195], v237 offset:12800
buffer_load_dwordx4 v227, s[32:35], s52 offen offset:1152 lds
v_mfma_f32_16x16x32_bf16 v[156:159], v[204:207], v[212:215], v[156:159]
ds_read_b64_tr_b16 v[196:197], v237 offset:12288
v_max3_f32 v240, v240, v98, v99
s_waitcnt lgkmcnt(9)
v_mfma_f32_16x16x32_bf16 v[160:163], v[176:179], v[208:211], v[160:163]
ds_read_b64_tr_b16 v[198:199], v236 offset:12800
s_add_u32 m0, s48, 81664
v_max3_f32 v241, v241, v106, v107
v_mfma_f32_16x16x32_bf16 v[168:171], v[176:179], v[212:215], v[168:171]
ds_read_b64_tr_b16 v[200:201], v236 offset:20480
buffer_load_dwordx4 v226, s[32:35], s52 offen offset:256 lds
v_mfma_f32_16x16x32_bf16 v[164:167], v[180:183], v[208:211], v[164:167]
ds_read_b64_tr_b16 v[202:203], v237 offset:20992
v_max3_f32 v240, v240, v100, v101
v_mfma_f32_16x16x32_bf16 v[172:175], v[180:183], v[212:215], v[172:175]
ds_read_b64_tr_b16 v[204:205], v237 offset:20480
v_max3_f32 v241, v241, v108, v109
s_waitcnt lgkmcnt(7)
v_mfma_f32_16x16x32_bf16 v[128:131], v[184:187], v[216:219], v[128:131]
ds_read_b64_tr_b16 v[206:207], v236 offset:20992
buffer_load_dwordx4 v227, s[32:35], s52 offen offset:1280 lds
v_mfma_f32_16x16x32_bf16 v[136:139], v[184:187], v[220:223], v[136:139]
v_max3_f32 v240, v240, v102, v103
v_max3_f32 v241, v241, v110, v111
v_mfma_f32_16x16x32_bf16 v[132:135], v[188:191], v[216:219], v[132:135]
v_mfma_f32_16x16x32_bf16 v[140:143], v[188:191], v[220:223], v[140:143]
s_add_u32 s53, s49, 114688
v_add_u32 v232, s53, v231
s_waitcnt lgkmcnt(4)
v_mfma_f32_16x16x32_bf16 v[144:147], v[192:195], v[216:219], v[144:147]
v_xor_b32 v233, 64, v232
v_mfma_f32_16x16x32_bf16 v[152:155], v[192:195], v[220:223], v[152:155]
s_waitcnt vmcnt(14) lgkmcnt(0)
s_barrier
ds_read_b128 v[176:179], v232 offset:0
ds_read_b128 v[180:183], v232 offset:2048
ds_read_b128 v[184:187], v233 offset:0
v_mfma_f32_16x16x32_bf16 v[148:151], v[196:199], v[216:219], v[148:151]
s_mov_b32 s52, 3145728
s_add_u32 m0, s48, 90112
s_nop 0
buffer_load_dwordx4 v224, s[28:31], s52 offen nt lds
v_mfma_f32_16x16x32_bf16 v[156:159], v[196:199], v[220:223], v[156:159]
ds_read_b128 v[188:191], v233 offset:2048
v_mfma_f32_16x16x32_bf16 v[160:163], v[200:203], v[216:219], v[160:163]
buffer_load_dwordx4 v225, s[28:31], s52 offen offset:1024 nt lds
v_mfma_f32_16x16x32_bf16 v[168:171], v[200:203], v[220:223], v[168:171]
ds_read_b128 v[192:195], v232 offset:8192
s_add_u32 m0, s48, 98176
v_mfma_f32_16x16x32_bf16 v[164:167], v[204:207], v[216:219], v[164:167]
buffer_load_dwordx4 v224, s[28:31], s52 offen offset:128 nt lds
v_mfma_f32_16x16x32_bf16 v[172:175], v[204:207], v[220:223], v[172:175]
ds_read_b128 v[196:199], v232 offset:10240
s_waitcnt lgkmcnt(4)
v_mfma_f32_16x16x32_bf16 v[112:115], v[176:179], a[208:211], 0
buffer_load_dwordx4 v225, s[28:31], s52 offen offset:1152 nt lds
v_mfma_f32_16x16x32_bf16 v[120:123], v[176:179], a[212:215], 0
ds_read_b128 v[200:203], v233 offset:8192
s_add_u32 m0, s48, 106240
v_mfma_f32_16x16x32_bf16 v[116:119], v[180:183], a[208:211], 0
buffer_load_dwordx4 v224, s[28:31], s52 offen offset:256 nt lds
v_mfma_f32_16x16x32_bf16 v[124:127], v[180:183], a[212:215], 0
ds_read_b128 v[204:207], v233 offset:10240
s_waitcnt lgkmcnt(4)
v_mfma_f32_16x16x32_bf16 v[112:115], v[184:187], a[216:219], v[112:115]
v_mfma_f32_16x16x32_bf16 v[120:123], v[184:187], a[220:223], v[120:123]
ds_read_b128 v[176:179], v232 offset:16384
buffer_load_dwordx4 v225, s[28:31], s52 offen offset:1280 nt lds
v_mfma_f32_16x16x32_bf16 v[116:119], v[188:191], a[216:219], v[116:119]
v_mfma_f32_16x16x32_bf16 v[124:127], v[188:191], a[220:223], v[124:127]
ds_read_b128 v[180:183], v232 offset:18432
s_waitcnt lgkmcnt(4)
v_mfma_f32_16x16x32_bf16 v[112:115], v[192:195], a[224:227], v[112:115]
v_mfma_f32_16x16x32_bf16 v[120:123], v[192:195], a[228:231], v[120:123]
ds_read_b128 v[184:187], v233 offset:16384
v_mfma_f32_16x16x32_bf16 v[116:119], v[196:199], a[224:227], v[116:119]
v_mfma_f32_16x16x32_bf16 v[124:127], v[196:199], a[228:231], v[124:127]
ds_read_b128 v[188:191], v233 offset:18432
s_waitcnt lgkmcnt(4)
v_mfma_f32_16x16x32_bf16 v[112:115], v[200:203], a[232:235], v[112:115]
v_mfma_f32_16x16x32_bf16 v[120:123], v[200:203], a[236:239], v[120:123]
v_mfma_f32_16x16x32_bf16 v[116:119], v[204:207], a[232:235], v[116:119]
v_mfma_f32_16x16x32_bf16 v[124:127], v[204:207], a[236:239], v[124:127]
v_add_u32 v236, 139264, v230
v_xor_b32 v237, 32, v236
s_waitcnt lgkmcnt(2)
v_mfma_f32_16x16x32_bf16 v[112:115], v[176:179], a[240:243], v[112:115]
v_mfma_f32_16x16x32_bf16 v[120:123], v[176:179], a[244:247], v[120:123]
s_waitcnt vmcnt(14) lgkmcnt(0)
s_barrier
ds_read_b64_tr_b16 v[192:193], v236 offset:0
ds_read_b64_tr_b16 v[194:195], v237 offset:512
ds_read_b64_tr_b16 v[196:197], v237 offset:0
ds_read_b64_tr_b16 v[198:199], v236 offset:512
ds_read_b64_tr_b16 v[200:201], v236 offset:4096
ds_read_b64_tr_b16 v[202:203], v237 offset:4608
v_mfma_f32_16x16x32_bf16 v[116:119], v[180:183], a[240:243], v[116:119]
s_mov_b32 s52, 3170304
s_add_u32 m0, s48, 114688
s_nop 0
buffer_load_dwordx4 v224, s[28:31], s52 offen nt lds
v_mfma_f32_16x16x32_bf16 v[124:127], v[180:183], a[244:247], v[124:127]
ds_read_b64_tr_b16 v[204:205], v237 offset:4096
v_mfma_f32_16x16x32_bf16 v[112:115], v[184:187], a[248:251], v[112:115]
ds_read_b64_tr_b16 v[206:207], v236 offset:4608
buffer_load_dwordx4 v225, s[28:31], s52 offen offset:1024 nt lds
v_mfma_f32_16x16x32_bf16 v[120:123], v[184:187], a[252:255], v[120:123]
ds_read_b64_tr_b16 v[176:177], v236 offset:8192
s_add_u32 m0, s48, 122752
v_mfma_f32_16x16x32_bf16 v[116:119], v[188:191], a[248:251], v[116:119]
ds_read_b64_tr_b16 v[178:179], v237 offset:8704
buffer_load_dwordx4 v224, s[28:31], s52 offen offset:128 nt lds
v_mfma_f32_16x16x32_bf16 v[124:127], v[188:191], a[252:255], v[124:127]
ds_read_b64_tr_b16 v[180:181], v237 offset:8192
s_waitcnt lgkmcnt(7)
v_mfma_f32_16x16x32_bf16 a[48:51], v[192:195], a[160:163], a[48:51]
ds_read_b64_tr_b16 v[182:183], v236 offset:8704
buffer_load_dwordx4 v225, s[28:31], s52 offen offset:1152 nt lds
v_mfma_f32_16x16x32_bf16 a[56:59], v[192:195], a[164:167], a[56:59]
ds_read_b64_tr_b16 v[184:185], v236 offset:12288
s_add_u32 m0, s48, 130816
v_mfma_f32_16x16x32_bf16 a[52:55], v[196:199], a[160:163], a[52:55]
ds_read_b64_tr_b16 v[186:187], v237 offset:12800
buffer_load_dwordx4 v224, s[28:31], s52 offen offset:256 nt lds
v_max3_f32 v240, v240, v112, v113
v_max3_f32 v241, v241, v120, v121
v_max3_f32 v240, v240, v114, v115
v_max3_f32 v241, v241, v122, v123
v_max3_f32 v240, v240, v116, v117
v_mfma_f32_16x16x32_bf16 a[60:63], v[196:199], a[164:167], a[60:63]
ds_read_b64_tr_b16 v[188:189], v237 offset:12288
v_max3_f32 v241, v241, v124, v125
v_max3_f32 v240, v240, v118, v119
v_max3_f32 v241, v241, v126, v127
v_mov_b32 v246, v240
v_mov_b32 v247, v241
s_nop 0
v_permlane16_swap_b32 v246, v240
v_permlane16_swap_b32 v247, v241
s_waitcnt lgkmcnt(7)
v_mfma_f32_16x16x32_bf16 a[48:51], v[200:203], a[168:171], a[48:51]
ds_read_b64_tr_b16 v[190:191], v236 offset:12800
v_max_f32 v240, v240, v246
v_max_f32 v241, v241, v247
v_mov_b32 v246, v240
v_mov_b32 v247, v241
s_nop 0
v_permlane32_swap_b32 v246, v240
v_permlane32_swap_b32 v247, v241
v_max_f32 v240, v240, v246
v_mfma_f32_16x16x32_bf16 a[56:59], v[200:203], a[172:175], a[56:59]
ds_read_b64_tr_b16 v[192:193], v236 offset:16384
buffer_load_dwordx4 v225, s[28:31], s52 offen offset:1280 nt lds
v_max_f32 v241, v241, v247
v_accvgpr_mov_b32 a208, a160
v_accvgpr_mov_b32 a209, a161
v_accvgpr_mov_b32 a210, a162
v_accvgpr_mov_b32 a211, a163
v_mfma_f32_16x16x32_bf16 a[52:55], v[204:207], a[168:171], a[52:55]
ds_read_b64_tr_b16 v[194:195], v237 offset:16896
v_accvgpr_mov_b32 a212, a164
v_accvgpr_mov_b32 a213, a165
v_accvgpr_mov_b32 a214, a166
v_accvgpr_mov_b32 a215, a167
v_accvgpr_mov_b32 a216, a168
v_accvgpr_mov_b32 a217, a169
v_accvgpr_mov_b32 a218, a170
v_mfma_f32_16x16x32_bf16 a[60:63], v[204:207], a[172:175], a[60:63]
ds_read_b64_tr_b16 v[196:197], v237 offset:16384
v_accvgpr_mov_b32 a219, a171
v_accvgpr_mov_b32 a220, a172
v_accvgpr_mov_b32 a221, a173
v_accvgpr_mov_b32 a222, a174
v_accvgpr_mov_b32 a223, a175
v_accvgpr_mov_b32 a224, a176
v_accvgpr_mov_b32 a225, a177
s_waitcnt lgkmcnt(7)
v_mfma_f32_16x16x32_bf16 a[48:51], v[176:179], a[176:179], a[48:51]
ds_read_b64_tr_b16 v[198:199], v236 offset:16896
v_accvgpr_mov_b32 a226, a178
v_accvgpr_mov_b32 a227, a179
v_accvgpr_mov_b32 a228, a180
v_accvgpr_mov_b32 a229, a181
v_accvgpr_mov_b32 a230, a182
v_accvgpr_mov_b32 a231, a183
v_accvgpr_mov_b32 a232, a184
v_accvgpr_mov_b32 a233, a185
v_mfma_f32_16x16x32_bf16 a[56:59], v[176:179], a[180:183], a[56:59]
ds_read_b64_tr_b16 v[200:201], v236 offset:20480
v_accvgpr_mov_b32 a234, a186
v_accvgpr_mov_b32 a235, a187
v_accvgpr_mov_b32 a236, a188
v_accvgpr_mov_b32 a237, a189
v_accvgpr_mov_b32 a238, a190
v_accvgpr_mov_b32 a239, a191
v_accvgpr_mov_b32 a240, a192
v_mfma_f32_16x16x32_bf16 a[52:55], v[180:183], a[176:179], a[52:55]
ds_read_b64_tr_b16 v[202:203], v237 offset:20992
v_accvgpr_mov_b32 a241, a193
v_accvgpr_mov_b32 a242, a194
v_accvgpr_mov_b32 a243, a195
v_accvgpr_mov_b32 a244, a196
v_accvgpr_mov_b32 a245, a197
v_accvgpr_mov_b32 a246, a198
v_accvgpr_mov_b32 a247, a199
v_accvgpr_mov_b32 a248, a200
v_mfma_f32_16x16x32_bf16 a[60:63], v[180:183], a[180:183], a[60:63]
ds_read_b64_tr_b16 v[204:205], v237 offset:20480
v_accvgpr_mov_b32 a249, a201
v_accvgpr_mov_b32 a250, a202
v_accvgpr_mov_b32 a251, a203
v_accvgpr_mov_b32 a252, a204
v_accvgpr_mov_b32 a253, a205
v_accvgpr_mov_b32 a254, a206
v_accvgpr_mov_b32 a255, a207
ds_write_b64 v239, v[240:241] offset:57344
s_waitcnt lgkmcnt(8)
v_mfma_f32_16x16x32_bf16 a[48:51], v[184:187], a[184:187], a[48:51]
ds_read_b64_tr_b16 v[206:207], v236 offset:20992
v_mfma_f32_16x16x32_bf16 a[56:59], v[184:187], a[188:191], a[56:59]
v_mfma_f32_16x16x32_bf16 a[52:55], v[188:191], a[184:187], a[52:55]
v_mfma_f32_16x16x32_bf16 a[60:63], v[188:191], a[188:191], a[60:63]
s_add_u32 s53, s50, 0
v_add_u32 v232, s53, v231
s_waitcnt lgkmcnt(5)
v_mfma_f32_16x16x32_bf16 a[48:51], v[192:195], a[192:195], a[48:51]
v_xor_b32 v233, 64, v232
v_add_u32 v236, 65536, v230
v_mfma_f32_16x16x32_bf16 a[56:59], v[192:195], a[196:199], a[56:59]
v_xor_b32 v237, 32, v236
s_waitcnt vmcnt(12) lgkmcnt(0)
s_barrier
ds_read_b128 v[208:211], v232 offset:0
ds_read_b128 v[212:215], v232 offset:2048
ds_read_b64_tr_b16 v[176:177], v236 offset:0
ds_read_b64_tr_b16 v[178:179], v237 offset:512
ds_read_b64_tr_b16 v[180:181], v237 offset:0
ds_read_b64_tr_b16 v[182:183], v236 offset:512
ds_read_b64_tr_b16 v[184:185], v236 offset:8192
ds_read_b64_tr_b16 v[186:187], v237 offset:8704
v_mfma_f32_16x16x32_bf16 a[52:55], v[196:199], a[192:195], a[52:55]
ds_read_b64 v[246:247], v238 offset:57344
ds_read_b64 v[248:249], v238 offset:59392
s_waitcnt lgkmcnt(0)
v_max_f32 v246, v246, v248
v_max_f32 v247, v247, v249
v_mul_f32 v242, s51, v246
v_mul_f32 v243, s51, v247
v_mfma_f32_16x16x32_bf16 a[60:63], v[196:199], a[196:199], a[60:63]
ds_read_b64_tr_b16 v[188:189], v237 offset:8192
v_fma_f32 v0, v0, s51, -v242
v_fma_f32 v1, v1, s51, -v242
v_exp_f32 v0, v0
v_mfma_f32_16x16x32_bf16 a[48:51], v[200:203], a[200:203], a[48:51]
ds_read_b64_tr_b16 v[190:191], v236 offset:8704
v_exp_f32 v1, v1
v_fma_f32 v2, v2, s51, -v242
v_fma_f32 v3, v3, s51, -v242
v_add_f32 v244, v0, v1
v_mfma_f32_16x16x32_bf16 a[56:59], v[200:203], a[204:207], a[56:59]
ds_read_b64_tr_b16 v[192:193], v236 offset:16384
v_cvt_pk_bf16_f32 v0, v0, v1
v_exp_f32 v2, v2
v_exp_f32 v3, v3
v_mfma_f32_16x16x32_bf16 a[52:55], v[204:207], a[200:203], a[52:55]
ds_read_b64_tr_b16 v[194:195], v237 offset:16896
v_fma_f32 v4, v4, s51, -v242
v_fma_f32 v5, v5, s51, -v242
v_add_f32 v244, v244, v2
v_add_f32 v244, v244, v3
v_cvt_pk_bf16_f32 v1, v2, v3
v_mfma_f32_16x16x32_bf16 a[60:63], v[204:207], a[204:207], a[60:63]
ds_read_b64_tr_b16 v[196:197], v237 offset:16384
v_exp_f32 v4, v4
v_exp_f32 v5, v5
v_fma_f32 v6, v6, s51, -v242
v_mfma_f32_16x16x32_bf16 v[128:131], v[176:179], v[208:211], v[128:131]
ds_read_b64_tr_b16 v[198:199], v236 offset:16896
v_fma_f32 v7, v7, s51, -v242
v_add_f32 v244, v244, v4
v_add_f32 v244, v244, v5
v_cvt_pk_bf16_f32 v2, v4, v5
v_exp_f32 v6, v6
v_mfma_f32_16x16x32_bf16 v[136:139], v[176:179], v[212:215], v[136:139]
ds_read_b128 v[216:219], v233 offset:0
ds_read_b128 v[220:223], v233 offset:2048
v_exp_f32 v7, v7
v_fma_f32 v8, v8, s51, -v243
v_fma_f32 v9, v9, s51, -v243
v_mfma_f32_16x16x32_bf16 v[132:135], v[180:183], v[208:211], v[132:135]
ds_read_b64_tr_b16 v[200:201], v236 offset:4096
ds_read_b64_tr_b16 v[202:203], v237 offset:4608
s_add_u32 m0, s48, 24576
v_add_f32 v244, v244, v6
v_add_f32 v244, v244, v7
v_cvt_pk_bf16_f32 v3, v6, v7
v_mfma_f32_16x16x32_bf16 v[140:143], v[180:183], v[212:215], v[140:143]
ds_read_b64_tr_b16 v[204:205], v237 offset:4096
buffer_load_dwordx4 v228, s[40:43], s65 offen lds
v_exp_f32 v8, v8
v_exp_f32 v9, v9
s_waitcnt lgkmcnt(9)
v_mfma_f32_16x16x32_bf16 v[144:147], v[184:187], v[208:211], v[144:147]
ds_read_b64_tr_b16 v[206:207], v236 offset:4608
v_fma_f32 v10, v10, s51, -v243
v_fma_f32 v11, v11, s51, -v243
v_add_f32 v245, v8, v9
v_cvt_pk_bf16_f32 v4, v8, v9
v_mfma_f32_16x16x32_bf16 v[152:155], v[184:187], v[212:215], v[152:155]
ds_read_b64_tr_b16 v[176:177], v236 offset:12288
buffer_load_dwordx4 v229, s[40:43], s65 offen offset:1024 lds
v_exp_f32 v10, v10
v_exp_f32 v11, v11
v_mfma_f32_16x16x32_bf16 v[148:151], v[188:191], v[208:211], v[148:151]
ds_read_b64_tr_b16 v[178:179], v237 offset:12800
s_mul_i32 s52, s65, 6144
s_add_u32 s52, s52, 9216
s_add_u32 m0, s48, 139264
v_fma_f32 v12, v12, s51, -v243
v_fma_f32 v13, v13, s51, -v243
v_add_f32 v245, v245, v10
v_mfma_f32_16x16x32_bf16 v[156:159], v[188:191], v[212:215], v[156:159]
ds_read_b64_tr_b16 v[180:181], v237 offset:12288
buffer_load_dwordx4 v226, s[32:35], s52 offen lds
v_add_f32 v245, v245, v11
v_cvt_pk_bf16_f32 v5, v10, v11
s_waitcnt lgkmcnt(9)
v_mfma_f32_16x16x32_bf16 v[160:163], v[192:195], v[208:211], v[160:163]
ds_read_b64_tr_b16 v[182:183], v236 offset:12800
v_exp_f32 v12, v12
v_exp_f32 v13, v13
v_fma_f32 v14, v14, s51, -v243
v_mfma_f32_16x16x32_bf16 v[168:171], v[192:195], v[212:215], v[168:171]
ds_read_b64_tr_b16 v[184:185], v236 offset:20480
buffer_load_dwordx4 v227, s[32:35], s52 offen offset:1024 lds
v_fma_f32 v15, v15, s51, -v243
v_add_f32 v245, v245, v12
v_add_f32 v245, v245, v13
v_mfma_f32_16x16x32_bf16 v[164:167], v[196:199], v[208:211], v[164:167]
ds_read_b64_tr_b16 v[186:187], v237 offset:20992
s_add_u32 m0, s48, 147328
v_cvt_pk_bf16_f32 v6, v12, v13
v_exp_f32 v14, v14
v_exp_f32 v15, v15
v_mfma_f32_16x16x32_bf16 v[172:175], v[196:199], v[212:215], v[172:175]
ds_read_b64_tr_b16 v[188:189], v237 offset:20480
buffer_load_dwordx4 v226, s[32:35], s52 offen offset:128 lds
v_add_f32 v245, v245, v14
v_add_f32 v245, v245, v15
v_cvt_pk_bf16_f32 v7, v14, v15
ds_write_b128 v239, v[0:3] offset:8192
ds_write_b128 v239, v[4:7] offset:9216
s_waitcnt lgkmcnt(9)
v_mfma_f32_16x16x32_bf16 v[128:131], v[200:203], v[216:219], v[128:131]
ds_read_b64_tr_b16 v[190:191], v236 offset:20992
v_mfma_f32_16x16x32_bf16 v[136:139], v[200:203], v[220:223], v[136:139]
buffer_load_dwordx4 v227, s[32:35], s52 offen offset:1152 lds
v_mfma_f32_16x16x32_bf16 v[132:135], v[204:207], v[216:219], v[132:135]
s_add_u32 m0, s48, 155392
v_mfma_f32_16x16x32_bf16 v[140:143], v[204:207], v[220:223], v[140:143]
buffer_load_dwordx4 v226, s[32:35], s52 offen offset:256 lds
v_add_u32 v236, 90112, v250
v_xor_b32 v237, 32, v236
s_waitcnt lgkmcnt(6)
v_mfma_f32_16x16x32_bf16 v[144:147], v[176:179], v[216:219], v[144:147]
v_xor_b32 v232, 0x1000, v236
v_xor_b32 v233, 0x1000, v237
v_mfma_f32_16x16x32_bf16 v[152:155], v[176:179], v[220:223], v[152:155]
buffer_load_dwordx4 v227, s[32:35], s52 offen offset:1280 lds
s_waitcnt vmcnt(14) lgkmcnt(0)
s_barrier
ds_read_b64_tr_b16 v[192:193], v236 offset:0
ds_read_b64_tr_b16 v[194:195], v236 offset:2048
ds_read_b64_tr_b16 v[196:197], v237 offset:0
ds_read_b64_tr_b16 v[198:199], v237 offset:2048
ds_read_b64_tr_b16 v[200:201], v236 offset:8192
ds_read_b64_tr_b16 v[202:203], v236 offset:10240
v_mfma_f32_16x16x32_bf16 v[148:151], v[180:183], v[216:219], v[148:151]
s_mov_b32 s52, 3194880
s_add_u32 m0, s48, 65536
s_nop 0
buffer_load_dwordx4 v224, s[28:31], s52 offen nt lds
v_fma_f32 v16, v16, s51, -v242
v_fma_f32 v17, v17, s51, -v242
v_mfma_f32_16x16x32_bf16 v[156:159], v[180:183], v[220:223], v[156:159]
ds_read_b64_tr_b16 v[204:205], v237 offset:8192
v_exp_f32 v16, v16
v_exp_f32 v17, v17
v_fma_f32 v18, v18, s51, -v242
v_mfma_f32_16x16x32_bf16 v[160:163], v[184:187], v[216:219], v[160:163]
ds_read_b64_tr_b16 v[206:207], v237 offset:10240
buffer_load_dwordx4 v225, s[28:31], s52 offen offset:1024 nt lds
v_fma_f32 v19, v19, s51, -v242
v_add_f32 v244, v244, v16
v_add_f32 v244, v244, v17
v_mfma_f32_16x16x32_bf16 v[168:171], v[184:187], v[220:223], v[168:171]
ds_read_b64_tr_b16 v[176:177], v236 offset:16384
s_add_u32 m0, s48, 73600
v_cvt_pk_bf16_f32 v16, v16, v17
v_exp_f32 v18, v18
v_exp_f32 v19, v19
v_mfma_f32_16x16x32_bf16 v[164:167], v[188:191], v[216:219], v[164:167]
ds_read_b64_tr_b16 v[178:179], v236 offset:18432
buffer_load_dwordx4 v224, s[28:31], s52 offen offset:128 nt lds
v_fma_f32 v20, v20, s51, -v242
v_fma_f32 v21, v21, s51, -v242
v_add_f32 v244, v244, v18
v_mfma_f32_16x16x32_bf16 v[172:175], v[188:191], v[220:223], v[172:175]
ds_read_b64_tr_b16 v[180:181], v237 offset:16384
v_add_f32 v244, v244, v19
v_cvt_pk_bf16_f32 v17, v18, v19
v_exp_f32 v20, v20
s_waitcnt lgkmcnt(7)
v_mfma_f32_16x16x32_bf16 a[160:163], v[192:195], v[0:3], 0
ds_read_b64_tr_b16 v[182:183], v237 offset:18432
buffer_load_dwordx4 v225, s[28:31], s52 offen offset:1152 nt lds
v_exp_f32 v21, v21
v_fma_f32 v22, v22, s51, -v242
v_mfma_f32_16x16x32_bf16 a[168:171], v[192:195], v[4:7], 0
ds_read_b128 v[8:11], v234 offset:8192
ds_read_b128 v[12:15], v234 offset:9216
s_add_u32 m0, s48, 81664
v_fma_f32 v23, v23, s51, -v242
v_add_f32 v244, v244, v20
v_add_f32 v244, v244, v21
v_mfma_f32_16x16x32_bf16 a[164:167], v[196:199], v[0:3], 0
ds_read_b64_tr_b16 v[184:185], v232 offset:0
ds_read_b64_tr_b16 v[186:187], v232 offset:2048
buffer_load_dwordx4 v224, s[28:31], s52 offen offset:256 nt lds
v_cvt_pk_bf16_f32 v18, v20, v21
v_mfma_f32_16x16x32_bf16 a[172:175], v[196:199], v[4:7], 0
ds_read_b64_tr_b16 v[188:189], v233 offset:0
v_exp_f32 v22, v22
v_exp_f32 v23, v23
v_fma_f32 v24, v24, s51, -v243
s_waitcnt lgkmcnt(9)
v_mfma_f32_16x16x32_bf16 a[176:179], v[200:203], v[0:3], 0
ds_read_b64_tr_b16 v[190:191], v233 offset:2048
v_fma_f32 v25, v25, s51, -v243
v_add_f32 v244, v244, v22
v_add_f32 v244, v244, v23
v_cvt_pk_bf16_f32 v19, v22, v23
v_exp_f32 v24, v24
v_mfma_f32_16x16x32_bf16 a[184:187], v[200:203], v[4:7], 0
ds_read_b64_tr_b16 v[192:193], v232 offset:8192
buffer_load_dwordx4 v225, s[28:31], s52 offen offset:1280 nt lds
v_exp_f32 v25, v25
v_fma_f32 v26, v26, s51, -v243
v_mfma_f32_16x16x32_bf16 a[180:183], v[204:207], v[0:3], 0
ds_read_b64_tr_b16 v[194:195], v232 offset:10240
v_fma_f32 v27, v27, s51, -v243
v_add_f32 v245, v245, v24
v_add_f32 v245, v245, v25
v_cvt_pk_bf16_f32 v20, v24, v25
v_mfma_f32_16x16x32_bf16 a[188:191], v[204:207], v[4:7], 0
ds_read_b64_tr_b16 v[196:197], v233 offset:8192
v_exp_f32 v26, v26
v_exp_f32 v27, v27
v_fma_f32 v28, v28, s51, -v243
s_waitcnt lgkmcnt(9)
v_mfma_f32_16x16x32_bf16 a[192:195], v[176:179], v[0:3], 0
ds_read_b64_tr_b16 v[198:199], v233 offset:10240
v_fma_f32 v29, v29, s51, -v243
v_add_f32 v245, v245, v26
v_add_f32 v245, v245, v27
v_cvt_pk_bf16_f32 v21, v26, v27
v_exp_f32 v28, v28
v_mfma_f32_16x16x32_bf16 a[200:203], v[176:179], v[4:7], 0
ds_read_b64_tr_b16 v[200:201], v232 offset:16384
v_exp_f32 v29, v29
v_fma_f32 v30, v30, s51, -v243
v_fma_f32 v31, v31, s51, -v243
v_add_f32 v245, v245, v28
v_mfma_f32_16x16x32_bf16 a[196:199], v[180:183], v[0:3], 0
ds_read_b64_tr_b16 v[202:203], v232 offset:18432
v_add_f32 v245, v245, v29
v_cvt_pk_bf16_f32 v22, v28, v29
v_exp_f32 v30, v30
v_mfma_f32_16x16x32_bf16 a[204:207], v[180:183], v[4:7], 0
ds_read_b64_tr_b16 v[204:205], v233 offset:16384
v_exp_f32 v31, v31
v_add_f32 v245, v245, v30
v_add_f32 v245, v245, v31
v_cvt_pk_bf16_f32 v23, v30, v31
ds_write_b128 v239, v[16:19] offset:16384
ds_write_b128 v239, v[20:23] offset:17408
s_waitcnt lgkmcnt(9)
v_mfma_f32_16x16x32_bf16 a[160:163], v[184:187], v[8:11], a[160:163]
ds_read_b64_tr_b16 v[206:207], v233 offset:18432
v_mfma_f32_16x16x32_bf16 a[168:171], v[184:187], v[12:15], a[168:171]
v_mfma_f32_16x16x32_bf16 a[164:167], v[188:191], v[8:11], a[164:167]
v_mfma_f32_16x16x32_bf16 a[172:175], v[188:191], v[12:15], a[172:175]
v_add_u32 v236, 114688, v250
v_xor_b32 v237, 32, v236
s_waitcnt lgkmcnt(6)
v_mfma_f32_16x16x32_bf16 a[176:179], v[192:195], v[8:11], a[176:179]
v_xor_b32 v232, 0x1000, v236
v_xor_b32 v233, 0x1000, v237
v_mfma_f32_16x16x32_bf16 a[184:187], v[192:195], v[12:15], a[184:187]
s_waitcnt vmcnt(14) lgkmcnt(0)
s_barrier
ds_read_b64_tr_b16 v[176:177], v236 offset:0
ds_read_b64_tr_b16 v[178:179], v236 offset:2048
ds_read_b64_tr_b16 v[180:181], v237 offset:0
ds_read_b64_tr_b16 v[182:183], v237 offset:2048
ds_read_b64_tr_b16 v[184:185], v236 offset:8192
ds_read_b64_tr_b16 v[186:187], v236 offset:10240
v_mfma_f32_16x16x32_bf16 a[180:183], v[196:199], v[8:11], a[180:183]
v_fma_f32 v32, v32, s51, -v242
v_fma_f32 v33, v33, s51, -v242
v_exp_f32 v32, v32
v_mfma_f32_16x16x32_bf16 a[188:191], v[196:199], v[12:15], a[188:191]
ds_read_b64_tr_b16 v[188:189], v237 offset:8192
v_exp_f32 v33, v33
v_mfma_f32_16x16x32_bf16 a[192:195], v[200:203], v[8:11], a[192:195]
ds_read_b64_tr_b16 v[190:191], v237 offset:10240
v_fma_f32 v34, v34, s51, -v242
v_fma_f32 v35, v35, s51, -v242
v_mfma_f32_16x16x32_bf16 a[200:203], v[200:203], v[12:15], a[200:203]
ds_read_b64_tr_b16 v[192:193], v236 offset:16384
v_add_f32 v244, v244, v32
v_add_f32 v244, v244, v33
v_cvt_pk_bf16_f32 v32, v32, v33
v_mfma_f32_16x16x32_bf16 a[196:199], v[204:207], v[8:11], a[196:199]
ds_read_b64_tr_b16 v[194:195], v236 offset:18432
v_exp_f32 v34, v34
v_mfma_f32_16x16x32_bf16 a[204:207], v[204:207], v[12:15], a[204:207]
ds_read_b64_tr_b16 v[196:197], v237 offset:16384
v_exp_f32 v35, v35
v_fma_f32 v36, v36, s51, -v242
s_waitcnt lgkmcnt(7)
v_mfma_f32_16x16x32_bf16 a[160:163], v[176:179], v[16:19], a[160:163]
ds_read_b64_tr_b16 v[198:199], v237 offset:18432
v_fma_f32 v37, v37, s51, -v242
v_add_f32 v244, v244, v34
v_mfma_f32_16x16x32_bf16 a[168:171], v[176:179], v[20:23], a[168:171]
ds_read_b128 v[24:27], v234 offset:16384
ds_read_b128 v[28:31], v234 offset:17408
v_add_f32 v244, v244, v35
v_cvt_pk_bf16_f32 v33, v34, v35
v_mfma_f32_16x16x32_bf16 a[164:167], v[180:183], v[16:19], a[164:167]
ds_read_b64_tr_b16 v[200:201], v232 offset:0
ds_read_b64_tr_b16 v[202:203], v232 offset:2048
s_add_u32 m0, s48, 8192
v_mfma_f32_16x16x32_bf16 a[172:175], v[180:183], v[20:23], a[172:175]
ds_read_b64_tr_b16 v[204:205], v233 offset:0
buffer_load_dwordx4 v228, s[40:43], s66 offen lds
s_waitcnt lgkmcnt(9)
v_mfma_f32_16x16x32_bf16 a[176:179], v[184:187], v[16:19], a[176:179]
ds_read_b64_tr_b16 v[206:207], v233 offset:2048
v_exp_f32 v36, v36
v_mfma_f32_16x16x32_bf16 a[184:187], v[184:187], v[20:23], a[184:187]
ds_read_b64_tr_b16 v[176:177], v232 offset:8192
buffer_load_dwordx4 v229, s[40:43], s66 offen offset:1024 lds
v_mfma_f32_16x16x32_bf16 a[180:183], v[188:191], v[16:19], a[180:183]
ds_read_b64_tr_b16 v[178:179], v232 offset:10240
s_mul_i32 s52, s66, 6144
s_add_u32 s52, s52, 9216
s_add_u32 m0, s48, 90112
v_exp_f32 v37, v37
v_mfma_f32_16x16x32_bf16 a[188:191], v[188:191], v[20:23], a[188:191]
ds_read_b64_tr_b16 v[180:181], v233 offset:8192
buffer_load_dwordx4 v226, s[32:35], s52 offen lds
v_fma_f32 v38, v38, s51, -v242
s_waitcnt lgkmcnt(9)
v_mfma_f32_16x16x32_bf16 a[192:195], v[192:195], v[16:19], a[192:195]
ds_read_b64_tr_b16 v[182:183], v233 offset:10240
v_fma_f32 v39, v39, s51, -v242
v_add_f32 v244, v244, v36
v_add_f32 v244, v244, v37
v_mfma_f32_16x16x32_bf16 a[200:203], v[192:195], v[20:23], a[200:203]
ds_read_b64_tr_b16 v[184:185], v232 offset:16384
buffer_load_dwordx4 v227, s[32:35], s52 offen offset:1024 lds
v_cvt_pk_bf16_f32 v34, v36, v37
v_mfma_f32_16x16x32_bf16 a[196:199], v[196:199], v[16:19], a[196:199]
ds_read_b64_tr_b16 v[186:187], v232 offset:18432
s_add_u32 m0, s48, 98176
v_exp_f32 v38, v38
v_mfma_f32_16x16x32_bf16 a[204:207], v[196:199], v[20:23], a[204:207]
ds_read_b64_tr_b16 v[188:189], v233 offset:16384
buffer_load_dwordx4 v226, s[32:35], s52 offen offset:128 lds
s_waitcnt lgkmcnt(7)
v_mfma_f32_16x16x32_bf16 a[160:163], v[200:203], v[24:27], a[160:163]
ds_read_b64_tr_b16 v[190:191], v233 offset:18432
v_exp_f32 v39, v39
v_fma_f32 v40, v40, s51, -v243
v_mfma_f32_16x16x32_bf16 a[168:171], v[200:203], v[28:31], a[168:171]
buffer_load_dwordx4 v227, s[32:35], s52 offen offset:1152 lds
v_fma_f32 v41, v41, s51, -v243
v_mfma_f32_16x16x32_bf16 a[164:167], v[204:207], v[24:27], a[164:167]
s_add_u32 m0, s48, 106240
v_add_f32 v244, v244, v38
v_add_f32 v244, v244, v39
v_cvt_pk_bf16_f32 v35, v38, v39
v_mfma_f32_16x16x32_bf16 a[172:175], v[204:207], v[28:31], a[172:175]
buffer_load_dwordx4 v226, s[32:35], s52 offen offset:256 lds
s_add_u32 s53, s50, 24576
v_add_u32 v232, s53, v231
s_waitcnt lgkmcnt(4)
v_mfma_f32_16x16x32_bf16 a[176:179], v[176:179], v[24:27], a[176:179]
v_xor_b32 v233, 64, v232
v_add_u32 v236, 139264, v230
v_exp_f32 v40, v40
v_mfma_f32_16x16x32_bf16 a[184:187], v[176:179], v[28:31], a[184:187]
buffer_load_dwordx4 v227, s[32:35], s52 offen offset:1280 lds
v_xor_b32 v237, 32, v236
s_waitcnt vmcnt(14) lgkmcnt(0)
s_barrier
ds_read_b128 v[208:211], v232 offset:0
ds_read_b128 v[212:215], v232 offset:2048
ds_read_b64_tr_b16 v[192:193], v236 offset:0
ds_read_b64_tr_b16 v[194:195], v237 offset:512
ds_read_b64_tr_b16 v[196:197], v237 offset:0
ds_read_b64_tr_b16 v[198:199], v236 offset:512
ds_read_b64_tr_b16 v[200:201], v236 offset:8192
ds_read_b64_tr_b16 v[202:203], v237 offset:8704
v_mfma_f32_16x16x32_bf16 a[180:183], v[180:183], v[24:27], a[180:183]
s_mov_b32 s52, 3219456
s_add_u32 m0, s48, 114688
s_nop 0
buffer_load_dwordx4 v224, s[28:31], s52 offen nt lds
v_mfma_f32_16x16x32_bf16 a[188:191], v[180:183], v[28:31], a[188:191]
ds_read_b64_tr_b16 v[204:205], v237 offset:8192
v_exp_f32 v41, v41
v_fma_f32 v42, v42, s51, -v243
v_mfma_f32_16x16x32_bf16 a[192:195], v[184:187], v[24:27], a[192:195]
ds_read_b64_tr_b16 v[206:207], v236 offset:8704
buffer_load_dwordx4 v225, s[28:31], s52 offen offset:1024 nt lds
v_fma_f32 v43, v43, s51, -v243
v_mfma_f32_16x16x32_bf16 a[200:203], v[184:187], v[28:31], a[200:203]
ds_read_b64_tr_b16 v[176:177], v236 offset:16384
s_add_u32 m0, s48, 122752
v_add_f32 v245, v245, v40
v_add_f32 v245, v245, v41
v_mfma_f32_16x16x32_bf16 a[196:199], v[188:191], v[24:27], a[196:199]
ds_read_b64_tr_b16 v[178:179], v237 offset:16896
buffer_load_dwordx4 v224, s[28:31], s52 offen offset:128 nt lds
v_cvt_pk_bf16_f32 v36, v40, v41
v_mfma_f32_16x16x32_bf16 a[204:207], v[188:191], v[28:31], a[204:207]
ds_read_b64_tr_b16 v[180:181], v237 offset:16384
v_exp_f32 v42, v42
s_waitcnt lgkmcnt(7)
v_mfma_f32_16x16x32_bf16 v[128:131], v[192:195], v[208:211], v[128:131]
ds_read_b64_tr_b16 v[182:183], v236 offset:16896
buffer_load_dwordx4 v225, s[28:31], s52 offen offset:1152 nt lds
v_mfma_f32_16x16x32_bf16 v[136:139], v[192:195], v[212:215], v[136:139]
ds_read_b128 v[216:219], v233 offset:0
ds_read_b128 v[220:223], v233 offset:2048
s_add_u32 m0, s48, 130816
v_exp_f32 v43, v43
v_mfma_f32_16x16x32_bf16 v[132:135], v[196:199], v[208:211], v[132:135]
ds_read_b64_tr_b16 v[184:185], v236 offset:4096
ds_read_b64_tr_b16 v[186:187], v237 offset:4608
buffer_load_dwordx4 v224, s[28:31], s52 offen offset:256 nt lds
v_mfma_f32_16x16x32_bf16 v[140:143], v[196:199], v[212:215], v[140:143]
ds_read_b64_tr_b16 v[188:189], v237 offset:4096
v_fma_f32 v44, v44, s51, -v243
v_fma_f32 v45, v45, s51, -v243
v_add_f32 v245, v245, v42
s_waitcnt lgkmcnt(9)
v_mfma_f32_16x16x32_bf16 v[144:147], v[200:203], v[208:211], v[144:147]
ds_read_b64_tr_b16 v[190:191], v236 offset:4608
v_add_f32 v245, v245, v43
v_cvt_pk_bf16_f32 v37, v42, v43
v_mfma_f32_16x16x32_bf16 v[152:155], v[200:203], v[212:215], v[152:155]
ds_read_b64_tr_b16 v[192:193], v236 offset:12288
buffer_load_dwordx4 v225, s[28:31], s52 offen offset:1280 nt lds
v_mfma_f32_16x16x32_bf16 v[148:151], v[204:207], v[208:211], v[148:151]
ds_read_b64_tr_b16 v[194:195], v237 offset:12800
v_exp_f32 v44, v44
v_mfma_f32_16x16x32_bf16 v[156:159], v[204:207], v[212:215], v[156:159]
ds_read_b64_tr_b16 v[196:197], v237 offset:12288
v_exp_f32 v45, v45
v_fma_f32 v46, v46, s51, -v243
s_waitcnt lgkmcnt(9)
v_mfma_f32_16x16x32_bf16 v[160:163], v[176:179], v[208:211], v[160:163]
ds_read_b64_tr_b16 v[198:199], v236 offset:12800
v_fma_f32 v47, v47, s51, -v243
v_add_f32 v245, v245, v44
v_add_f32 v245, v245, v45
v_mfma_f32_16x16x32_bf16 v[168:171], v[176:179], v[212:215], v[168:171]
ds_read_b64_tr_b16 v[200:201], v236 offset:20480
v_cvt_pk_bf16_f32 v38, v44, v45
v_exp_f32 v46, v46
v_mfma_f32_16x16x32_bf16 v[164:167], v[180:183], v[208:211], v[164:167]
ds_read_b64_tr_b16 v[202:203], v237 offset:20992
v_exp_f32 v47, v47
v_add_f32 v245, v245, v46
v_mfma_f32_16x16x32_bf16 v[172:175], v[180:183], v[212:215], v[172:175]
ds_read_b64_tr_b16 v[204:205], v237 offset:20480
v_add_f32 v245, v245, v47
v_cvt_pk_bf16_f32 v39, v46, v47
ds_write_b128 v239, v[32:35] offset:0
ds_write_b128 v239, v[36:39] offset:1024
s_waitcnt lgkmcnt(9)
v_mfma_f32_16x16x32_bf16 v[128:131], v[184:187], v[216:219], v[128:131]
ds_read_b64_tr_b16 v[206:207], v236 offset:20992
v_mfma_f32_16x16x32_bf16 v[136:139], v[184:187], v[220:223], v[136:139]
v_mfma_f32_16x16x32_bf16 v[132:135], v[188:191], v[216:219], v[132:135]
v_mfma_f32_16x16x32_bf16 v[140:143], v[188:191], v[220:223], v[140:143]
v_add_u32 v236, 65536, v250
v_xor_b32 v237, 32, v236
s_waitcnt lgkmcnt(6)
v_mfma_f32_16x16x32_bf16 v[144:147], v[192:195], v[216:219], v[144:147]
v_xor_b32 v232, 0x1000, v236
v_xor_b32 v233, 0x1000, v237
v_mfma_f32_16x16x32_bf16 v[152:155], v[192:195], v[220:223], v[152:155]
s_waitcnt vmcnt(14) lgkmcnt(0)
s_barrier
ds_read_b64_tr_b16 v[176:177], v236 offset:0
ds_read_b64_tr_b16 v[178:179], v236 offset:2048
ds_read_b64_tr_b16 v[180:181], v237 offset:0
ds_read_b64_tr_b16 v[182:183], v237 offset:2048
ds_read_b64_tr_b16 v[184:185], v236 offset:8192
ds_read_b64_tr_b16 v[186:187], v236 offset:10240
v_mfma_f32_16x16x32_bf16 v[148:151], v[196:199], v[216:219], v[148:151]
v_fma_f32 v48, v48, s51, -v242
v_fma_f32 v49, v49, s51, -v242
v_exp_f32 v48, v48
v_mfma_f32_16x16x32_bf16 v[156:159], v[196:199], v[220:223], v[156:159]
ds_read_b64_tr_b16 v[188:189], v237 offset:8192
v_exp_f32 v49, v49
v_mfma_f32_16x16x32_bf16 v[160:163], v[200:203], v[216:219], v[160:163]
ds_read_b64_tr_b16 v[190:191], v237 offset:10240
v_fma_f32 v50, v50, s51, -v242
v_fma_f32 v51, v51, s51, -v242
v_mfma_f32_16x16x32_bf16 v[168:171], v[200:203], v[220:223], v[168:171]
ds_read_b64_tr_b16 v[192:193], v236 offset:16384
v_add_f32 v244, v244, v48
v_add_f32 v244, v244, v49
v_cvt_pk_bf16_f32 v48, v48, v49
v_mfma_f32_16x16x32_bf16 v[164:167], v[204:207], v[216:219], v[164:167]
ds_read_b64_tr_b16 v[194:195], v236 offset:18432
v_exp_f32 v50, v50
v_mfma_f32_16x16x32_bf16 v[172:175], v[204:207], v[220:223], v[172:175]
ds_read_b64_tr_b16 v[196:197], v237 offset:16384
v_exp_f32 v51, v51
v_fma_f32 v52, v52, s51, -v242
s_waitcnt lgkmcnt(7)
v_mfma_f32_16x16x32_bf16 a[160:163], v[176:179], v[32:35], a[160:163]
ds_read_b64_tr_b16 v[198:199], v237 offset:18432
v_fma_f32 v53, v53, s51, -v242
v_add_f32 v244, v244, v50
v_mfma_f32_16x16x32_bf16 a[168:171], v[176:179], v[36:39], a[168:171]
ds_read_b128 v[40:43], v234 offset:0
ds_read_b128 v[44:47], v234 offset:1024
v_add_f32 v244, v244, v51
v_cvt_pk_bf16_f32 v49, v50, v51
v_mfma_f32_16x16x32_bf16 a[164:167], v[180:183], v[32:35], a[164:167]
ds_read_b64_tr_b16 v[200:201], v232 offset:0
ds_read_b64_tr_b16 v[202:203], v232 offset:2048
s_add_u32 m0, s48, 24576
v_mfma_f32_16x16x32_bf16 a[172:175], v[180:183], v[36:39], a[172:175]
ds_read_b64_tr_b16 v[204:205], v233 offset:0
buffer_load_dwordx4 v228, s[40:43], s67 offen lds
s_waitcnt lgkmcnt(9)
v_mfma_f32_16x16x32_bf16 a[176:179], v[184:187], v[32:35], a[176:179]
ds_read_b64_tr_b16 v[206:207], v233 offset:2048
v_exp_f32 v52, v52
v_mfma_f32_16x16x32_bf16 a[184:187], v[184:187], v[36:39], a[184:187]
ds_read_b64_tr_b16 v[176:177], v232 offset:8192
buffer_load_dwordx4 v229, s[40:43], s67 offen offset:1024 lds
v_mfma_f32_16x16x32_bf16 a[180:183], v[188:191], v[32:35], a[180:183]
ds_read_b64_tr_b16 v[178:179], v232 offset:10240
s_mul_i32 s52, s67, 6144
s_add_u32 s52, s52, 9216
s_add_u32 m0, s48, 139264
v_exp_f32 v53, v53
v_mfma_f32_16x16x32_bf16 a[188:191], v[188:191], v[36:39], a[188:191]
ds_read_b64_tr_b16 v[180:181], v233 offset:8192
buffer_load_dwordx4 v226, s[32:35], s52 offen lds
v_fma_f32 v54, v54, s51, -v242
s_waitcnt lgkmcnt(9)
v_mfma_f32_16x16x32_bf16 a[192:195], v[192:195], v[32:35], a[192:195]
ds_read_b64_tr_b16 v[182:183], v233 offset:10240
v_fma_f32 v55, v55, s51, -v242
v_add_f32 v244, v244, v52
v_add_f32 v244, v244, v53
v_mfma_f32_16x16x32_bf16 a[200:203], v[192:195], v[36:39], a[200:203]
ds_read_b64_tr_b16 v[184:185], v232 offset:16384
buffer_load_dwordx4 v227, s[32:35], s52 offen offset:1024 lds
v_cvt_pk_bf16_f32 v50, v52, v53
v_mfma_f32_16x16x32_bf16 a[196:199], v[196:199], v[32:35], a[196:199]
ds_read_b64_tr_b16 v[186:187], v232 offset:18432
s_add_u32 m0, s48, 147328
v_exp_f32 v54, v54
v_mfma_f32_16x16x32_bf16 a[204:207], v[196:199], v[36:39], a[204:207]
ds_read_b64_tr_b16 v[188:189], v233 offset:16384
buffer_load_dwordx4 v226, s[32:35], s52 offen offset:128 lds
s_waitcnt lgkmcnt(7)
v_mfma_f32_16x16x32_bf16 a[160:163], v[200:203], v[40:43], a[160:163]
ds_read_b64_tr_b16 v[190:191], v233 offset:18432
v_exp_f32 v55, v55
v_fma_f32 v56, v56, s51, -v243
v_mfma_f32_16x16x32_bf16 a[168:171], v[200:203], v[44:47], a[168:171]
buffer_load_dwordx4 v227, s[32:35], s52 offen offset:1152 lds
v_fma_f32 v57, v57, s51, -v243
v_mfma_f32_16x16x32_bf16 a[164:167], v[204:207], v[40:43], a[164:167]
s_add_u32 m0, s48, 155392
v_add_f32 v244, v244, v54
v_add_f32 v244, v244, v55
v_cvt_pk_bf16_f32 v51, v54, v55
v_mfma_f32_16x16x32_bf16 a[172:175], v[204:207], v[44:47], a[172:175]
buffer_load_dwordx4 v226, s[32:35], s52 offen offset:256 lds
s_add_u32 s53, s50, 8192
v_add_u32 v232, s53, v231
s_waitcnt lgkmcnt(4)
v_mfma_f32_16x16x32_bf16 a[176:179], v[176:179], v[40:43], a[176:179]
v_xor_b32 v233, 64, v232
v_add_u32 v236, 90112, v230
v_exp_f32 v56, v56
v_mfma_f32_16x16x32_bf16 a[184:187], v[176:179], v[44:47], a[184:187]
buffer_load_dwordx4 v227, s[32:35], s52 offen offset:1280 lds
v_xor_b32 v237, 32, v236
s_waitcnt vmcnt(14) lgkmcnt(0)
s_barrier
ds_read_b128 v[208:211], v232 offset:0
ds_read_b128 v[212:215], v232 offset:2048
ds_read_b64_tr_b16 v[192:193], v236 offset:0
ds_read_b64_tr_b16 v[194:195], v237 offset:512
ds_read_b64_tr_b16 v[196:197], v237 offset:0
ds_read_b64_tr_b16 v[198:199], v236 offset:512
ds_read_b64_tr_b16 v[200:201], v236 offset:8192
ds_read_b64_tr_b16 v[202:203], v237 offset:8704
v_mfma_f32_16x16x32_bf16 a[180:183], v[180:183], v[40:43], a[180:183]
s_mov_b32 s52, 3244032
s_add_u32 m0, s48, 65536
s_nop 0
buffer_load_dwordx4 v224, s[28:31], s52 offen nt lds
v_mfma_f32_16x16x32_bf16 a[188:191], v[180:183], v[44:47], a[188:191]
ds_read_b64_tr_b16 v[204:205], v237 offset:8192
v_exp_f32 v57, v57
v_fma_f32 v58, v58, s51, -v243
v_mfma_f32_16x16x32_bf16 a[192:195], v[184:187], v[40:43], a[192:195]
ds_read_b64_tr_b16 v[206:207], v236 offset:8704
buffer_load_dwordx4 v225, s[28:31], s52 offen offset:1024 nt lds
v_fma_f32 v59, v59, s51, -v243
v_mfma_f32_16x16x32_bf16 a[200:203], v[184:187], v[44:47], a[200:203]
ds_read_b64_tr_b16 v[176:177], v236 offset:16384
s_add_u32 m0, s48, 73600
v_add_f32 v245, v245, v56
v_add_f32 v245, v245, v57
v_mfma_f32_16x16x32_bf16 a[196:199], v[188:191], v[40:43], a[196:199]
ds_read_b64_tr_b16 v[178:179], v237 offset:16896
buffer_load_dwordx4 v224, s[28:31], s52 offen offset:128 nt lds
v_cvt_pk_bf16_f32 v52, v56, v57
v_mfma_f32_16x16x32_bf16 a[204:207], v[188:191], v[44:47], a[204:207]
ds_read_b64_tr_b16 v[180:181], v237 offset:16384
v_exp_f32 v58, v58
s_waitcnt lgkmcnt(7)
v_mfma_f32_16x16x32_bf16 v[128:131], v[192:195], v[208:211], v[128:131]
ds_read_b64_tr_b16 v[182:183], v236 offset:16896
buffer_load_dwordx4 v225, s[28:31], s52 offen offset:1152 nt lds
v_mfma_f32_16x16x32_bf16 v[136:139], v[192:195], v[212:215], v[136:139]
ds_read_b128 v[216:219], v233 offset:0
ds_read_b128 v[220:223], v233 offset:2048
s_add_u32 m0, s48, 81664
v_exp_f32 v59, v59
v_mfma_f32_16x16x32_bf16 v[132:135], v[196:199], v[208:211], v[132:135]
ds_read_b64_tr_b16 v[184:185], v236 offset:4096
ds_read_b64_tr_b16 v[186:187], v237 offset:4608
buffer_load_dwordx4 v224, s[28:31], s52 offen offset:256 nt lds
v_mfma_f32_16x16x32_bf16 v[140:143], v[196:199], v[212:215], v[140:143]
ds_read_b64_tr_b16 v[188:189], v237 offset:4096
v_fma_f32 v60, v60, s51, -v243
v_fma_f32 v61, v61, s51, -v243
v_add_f32 v245, v245, v58
s_waitcnt lgkmcnt(9)
v_mfma_f32_16x16x32_bf16 v[144:147], v[200:203], v[208:211], v[144:147]
ds_read_b64_tr_b16 v[190:191], v236 offset:4608
v_add_f32 v245, v245, v59
v_cvt_pk_bf16_f32 v53, v58, v59
v_mfma_f32_16x16x32_bf16 v[152:155], v[200:203], v[212:215], v[152:155]
ds_read_b64_tr_b16 v[192:193], v236 offset:12288
buffer_load_dwordx4 v225, s[28:31], s52 offen offset:1280 nt lds
v_mfma_f32_16x16x32_bf16 v[148:151], v[204:207], v[208:211], v[148:151]
ds_read_b64_tr_b16 v[194:195], v237 offset:12800
v_exp_f32 v60, v60
v_mfma_f32_16x16x32_bf16 v[156:159], v[204:207], v[212:215], v[156:159]
ds_read_b64_tr_b16 v[196:197], v237 offset:12288
v_exp_f32 v61, v61
v_fma_f32 v62, v62, s51, -v243
s_waitcnt lgkmcnt(9)
v_mfma_f32_16x16x32_bf16 v[160:163], v[176:179], v[208:211], v[160:163]
ds_read_b64_tr_b16 v[198:199], v236 offset:12800
v_fma_f32 v63, v63, s51, -v243
v_add_f32 v245, v245, v60
v_add_f32 v245, v245, v61
v_mfma_f32_16x16x32_bf16 v[168:171], v[176:179], v[212:215], v[168:171]
ds_read_b64_tr_b16 v[200:201], v236 offset:20480
v_cvt_pk_bf16_f32 v54, v60, v61
v_exp_f32 v62, v62
v_mfma_f32_16x16x32_bf16 v[164:167], v[180:183], v[208:211], v[164:167]
ds_read_b64_tr_b16 v[202:203], v237 offset:20992
v_exp_f32 v63, v63
v_add_f32 v245, v245, v62
v_mfma_f32_16x16x32_bf16 v[172:175], v[180:183], v[212:215], v[172:175]
ds_read_b64_tr_b16 v[204:205], v237 offset:20480
v_add_f32 v245, v245, v63
v_cvt_pk_bf16_f32 v55, v62, v63
ds_write_b128 v239, v[48:51] offset:16384
ds_write_b128 v239, v[52:55] offset:17408
s_waitcnt lgkmcnt(9)
v_mfma_f32_16x16x32_bf16 v[128:131], v[184:187], v[216:219], v[128:131]
ds_read_b64_tr_b16 v[206:207], v236 offset:20992
v_mfma_f32_16x16x32_bf16 v[136:139], v[184:187], v[220:223], v[136:139]
v_mfma_f32_16x16x32_bf16 v[132:135], v[188:191], v[216:219], v[132:135]
v_mfma_f32_16x16x32_bf16 v[140:143], v[188:191], v[220:223], v[140:143]
v_add_u32 v236, 114688, v250
v_xor_b32 v237, 32, v236
s_waitcnt lgkmcnt(6)
v_mfma_f32_16x16x32_bf16 v[144:147], v[192:195], v[216:219], v[144:147]
v_xor_b32 v232, 0x1000, v236
v_xor_b32 v233, 0x1000, v237
v_mfma_f32_16x16x32_bf16 v[152:155], v[192:195], v[220:223], v[152:155]
s_waitcnt vmcnt(14) lgkmcnt(0)
s_barrier
ds_read_b64_tr_b16 v[176:177], v236 offset:0
ds_read_b64_tr_b16 v[178:179], v236 offset:2048
ds_read_b64_tr_b16 v[180:181], v237 offset:0
ds_read_b64_tr_b16 v[182:183], v237 offset:2048
ds_read_b64_tr_b16 v[184:185], v236 offset:8192
ds_read_b64_tr_b16 v[186:187], v236 offset:10240
v_mfma_f32_16x16x32_bf16 v[148:151], v[196:199], v[216:219], v[148:151]
v_fma_f32 v64, v64, s51, -v242
v_fma_f32 v65, v65, s51, -v242
v_exp_f32 v64, v64
v_mfma_f32_16x16x32_bf16 v[156:159], v[196:199], v[220:223], v[156:159]
ds_read_b64_tr_b16 v[188:189], v237 offset:8192
v_exp_f32 v65, v65
v_mfma_f32_16x16x32_bf16 v[160:163], v[200:203], v[216:219], v[160:163]
ds_read_b64_tr_b16 v[190:191], v237 offset:10240
v_fma_f32 v66, v66, s51, -v242
v_fma_f32 v67, v67, s51, -v242
v_mfma_f32_16x16x32_bf16 v[168:171], v[200:203], v[220:223], v[168:171]
ds_read_b64_tr_b16 v[192:193], v236 offset:16384
v_add_f32 v244, v244, v64
v_add_f32 v244, v244, v65
v_cvt_pk_bf16_f32 v64, v64, v65
v_mfma_f32_16x16x32_bf16 v[164:167], v[204:207], v[216:219], v[164:167]
ds_read_b64_tr_b16 v[194:195], v236 offset:18432
v_exp_f32 v66, v66
v_mfma_f32_16x16x32_bf16 v[172:175], v[204:207], v[220:223], v[172:175]
ds_read_b64_tr_b16 v[196:197], v237 offset:16384
v_exp_f32 v67, v67
v_fma_f32 v68, v68, s51, -v242
s_waitcnt lgkmcnt(7)
v_mfma_f32_16x16x32_bf16 a[160:163], v[176:179], v[48:51], a[160:163]
ds_read_b64_tr_b16 v[198:199], v237 offset:18432
v_fma_f32 v69, v69, s51, -v242
v_add_f32 v244, v244, v66
v_mfma_f32_16x16x32_bf16 a[168:171], v[176:179], v[52:55], a[168:171]
ds_read_b128 v[56:59], v234 offset:16384
ds_read_b128 v[60:63], v234 offset:17408
v_add_f32 v244, v244, v67
v_cvt_pk_bf16_f32 v65, v66, v67
v_mfma_f32_16x16x32_bf16 a[164:167], v[180:183], v[48:51], a[164:167]
ds_read_b64_tr_b16 v[200:201], v232 offset:0
ds_read_b64_tr_b16 v[202:203], v232 offset:2048
s_add_u32 m0, s48, 8192
v_mfma_f32_16x16x32_bf16 a[172:175], v[180:183], v[52:55], a[172:175]
ds_read_b64_tr_b16 v[204:205], v233 offset:0
buffer_load_dwordx4 v228, s[40:43], s68 offen lds
s_waitcnt lgkmcnt(9)
v_mfma_f32_16x16x32_bf16 a[176:179], v[184:187], v[48:51], a[176:179]
ds_read_b64_tr_b16 v[206:207], v233 offset:2048
v_exp_f32 v68, v68
v_mfma_f32_16x16x32_bf16 a[184:187], v[184:187], v[52:55], a[184:187]
ds_read_b64_tr_b16 v[176:177], v232 offset:8192
buffer_load_dwordx4 v229, s[40:43], s68 offen offset:1024 lds
v_mfma_f32_16x16x32_bf16 a[180:183], v[188:191], v[48:51], a[180:183]
ds_read_b64_tr_b16 v[178:179], v232 offset:10240
s_mul_i32 s52, s68, 6144
s_add_u32 s52, s52, 9216
s_add_u32 m0, s48, 90112
v_exp_f32 v69, v69
v_mfma_f32_16x16x32_bf16 a[188:191], v[188:191], v[52:55], a[188:191]
ds_read_b64_tr_b16 v[180:181], v233 offset:8192
buffer_load_dwordx4 v226, s[32:35], s52 offen lds
v_fma_f32 v70, v70, s51, -v242
s_waitcnt lgkmcnt(9)
v_mfma_f32_16x16x32_bf16 a[192:195], v[192:195], v[48:51], a[192:195]
ds_read_b64_tr_b16 v[182:183], v233 offset:10240
v_fma_f32 v71, v71, s51, -v242
v_add_f32 v244, v244, v68
v_add_f32 v244, v244, v69
v_mfma_f32_16x16x32_bf16 a[200:203], v[192:195], v[52:55], a[200:203]
ds_read_b64_tr_b16 v[184:185], v232 offset:16384
buffer_load_dwordx4 v227, s[32:35], s52 offen offset:1024 lds
v_cvt_pk_bf16_f32 v66, v68, v69
v_mfma_f32_16x16x32_bf16 a[196:199], v[196:199], v[48:51], a[196:199]
ds_read_b64_tr_b16 v[186:187], v232 offset:18432
s_add_u32 m0, s48, 98176
v_exp_f32 v70, v70
v_mfma_f32_16x16x32_bf16 a[204:207], v[196:199], v[52:55], a[204:207]
ds_read_b64_tr_b16 v[188:189], v233 offset:16384
buffer_load_dwordx4 v226, s[32:35], s52 offen offset:128 lds
s_waitcnt lgkmcnt(7)
v_mfma_f32_16x16x32_bf16 a[160:163], v[200:203], v[56:59], a[160:163]
ds_read_b64_tr_b16 v[190:191], v233 offset:18432
v_exp_f32 v71, v71
v_fma_f32 v72, v72, s51, -v243
v_mfma_f32_16x16x32_bf16 a[168:171], v[200:203], v[60:63], a[168:171]
buffer_load_dwordx4 v227, s[32:35], s52 offen offset:1152 lds
v_fma_f32 v73, v73, s51, -v243
v_mfma_f32_16x16x32_bf16 a[164:167], v[204:207], v[56:59], a[164:167]
s_add_u32 m0, s48, 106240
v_add_f32 v244, v244, v70
v_add_f32 v244, v244, v71
v_cvt_pk_bf16_f32 v67, v70, v71
v_mfma_f32_16x16x32_bf16 a[172:175], v[204:207], v[60:63], a[172:175]
buffer_load_dwordx4 v226, s[32:35], s52 offen offset:256 lds
s_add_u32 s53, s50, 24576
v_add_u32 v232, s53, v231
s_waitcnt lgkmcnt(4)
v_mfma_f32_16x16x32_bf16 a[176:179], v[176:179], v[56:59], a[176:179]
v_xor_b32 v233, 64, v232
v_add_u32 v236, 139264, v230
v_exp_f32 v72, v72
v_mfma_f32_16x16x32_bf16 a[184:187], v[176:179], v[60:63], a[184:187]
buffer_load_dwordx4 v227, s[32:35], s52 offen offset:1280 lds
v_xor_b32 v237, 32, v236
s_waitcnt vmcnt(14) lgkmcnt(0)
s_barrier
ds_read_b128 v[208:211], v232 offset:0
ds_read_b128 v[212:215], v232 offset:2048
ds_read_b64_tr_b16 v[192:193], v236 offset:0
ds_read_b64_tr_b16 v[194:195], v237 offset:512
ds_read_b64_tr_b16 v[196:197], v237 offset:0
ds_read_b64_tr_b16 v[198:199], v236 offset:512
ds_read_b64_tr_b16 v[200:201], v236 offset:8192
ds_read_b64_tr_b16 v[202:203], v237 offset:8704
v_mfma_f32_16x16x32_bf16 a[180:183], v[180:183], v[56:59], a[180:183]
s_mov_b32 s52, 3268608
s_add_u32 m0, s48, 114688
s_nop 0
buffer_load_dwordx4 v224, s[28:31], s52 offen nt lds
v_mfma_f32_16x16x32_bf16 a[188:191], v[180:183], v[60:63], a[188:191]
ds_read_b64_tr_b16 v[204:205], v237 offset:8192
v_exp_f32 v73, v73
v_fma_f32 v74, v74, s51, -v243
v_mfma_f32_16x16x32_bf16 a[192:195], v[184:187], v[56:59], a[192:195]
ds_read_b64_tr_b16 v[206:207], v236 offset:8704
buffer_load_dwordx4 v225, s[28:31], s52 offen offset:1024 nt lds
v_fma_f32 v75, v75, s51, -v243
v_mfma_f32_16x16x32_bf16 a[200:203], v[184:187], v[60:63], a[200:203]
ds_read_b64_tr_b16 v[176:177], v236 offset:16384
s_add_u32 m0, s48, 122752
v_add_f32 v245, v245, v72
v_add_f32 v245, v245, v73
v_mfma_f32_16x16x32_bf16 a[196:199], v[188:191], v[56:59], a[196:199]
ds_read_b64_tr_b16 v[178:179], v237 offset:16896
buffer_load_dwordx4 v224, s[28:31], s52 offen offset:128 nt lds
v_cvt_pk_bf16_f32 v68, v72, v73
v_mfma_f32_16x16x32_bf16 a[204:207], v[188:191], v[60:63], a[204:207]
ds_read_b64_tr_b16 v[180:181], v237 offset:16384
v_exp_f32 v74, v74
s_waitcnt lgkmcnt(7)
v_mfma_f32_16x16x32_bf16 v[128:131], v[192:195], v[208:211], v[128:131]
ds_read_b64_tr_b16 v[182:183], v236 offset:16896
buffer_load_dwordx4 v225, s[28:31], s52 offen offset:1152 nt lds
v_mfma_f32_16x16x32_bf16 v[136:139], v[192:195], v[212:215], v[136:139]
ds_read_b128 v[216:219], v233 offset:0
ds_read_b128 v[220:223], v233 offset:2048
s_add_u32 m0, s48, 130816
v_exp_f32 v75, v75
v_mfma_f32_16x16x32_bf16 v[132:135], v[196:199], v[208:211], v[132:135]
ds_read_b64_tr_b16 v[184:185], v236 offset:4096
ds_read_b64_tr_b16 v[186:187], v237 offset:4608
buffer_load_dwordx4 v224, s[28:31], s52 offen offset:256 nt lds
v_mfma_f32_16x16x32_bf16 v[140:143], v[196:199], v[212:215], v[140:143]
ds_read_b64_tr_b16 v[188:189], v237 offset:4096
v_fma_f32 v76, v76, s51, -v243
v_fma_f32 v77, v77, s51, -v243
v_add_f32 v245, v245, v74
s_waitcnt lgkmcnt(9)
v_mfma_f32_16x16x32_bf16 v[144:147], v[200:203], v[208:211], v[144:147]
ds_read_b64_tr_b16 v[190:191], v236 offset:4608
v_add_f32 v245, v245, v75
v_cvt_pk_bf16_f32 v69, v74, v75
v_mfma_f32_16x16x32_bf16 v[152:155], v[200:203], v[212:215], v[152:155]
ds_read_b64_tr_b16 v[192:193], v236 offset:12288
buffer_load_dwordx4 v225, s[28:31], s52 offen offset:1280 nt lds
v_mfma_f32_16x16x32_bf16 v[148:151], v[204:207], v[208:211], v[148:151]
ds_read_b64_tr_b16 v[194:195], v237 offset:12800
v_exp_f32 v76, v76
v_mfma_f32_16x16x32_bf16 v[156:159], v[204:207], v[212:215], v[156:159]
ds_read_b64_tr_b16 v[196:197], v237 offset:12288
v_exp_f32 v77, v77
v_fma_f32 v78, v78, s51, -v243
s_waitcnt lgkmcnt(9)
v_mfma_f32_16x16x32_bf16 v[160:163], v[176:179], v[208:211], v[160:163]
ds_read_b64_tr_b16 v[198:199], v236 offset:12800
v_fma_f32 v79, v79, s51, -v243
v_add_f32 v245, v245, v76
v_add_f32 v245, v245, v77
v_mfma_f32_16x16x32_bf16 v[168:171], v[176:179], v[212:215], v[168:171]
ds_read_b64_tr_b16 v[200:201], v236 offset:20480
v_cvt_pk_bf16_f32 v70, v76, v77
v_exp_f32 v78, v78
v_mfma_f32_16x16x32_bf16 v[164:167], v[180:183], v[208:211], v[164:167]
ds_read_b64_tr_b16 v[202:203], v237 offset:20992
v_exp_f32 v79, v79
v_add_f32 v245, v245, v78
v_mfma_f32_16x16x32_bf16 v[172:175], v[180:183], v[212:215], v[172:175]
ds_read_b64_tr_b16 v[204:205], v237 offset:20480
v_add_f32 v245, v245, v79
v_cvt_pk_bf16_f32 v71, v78, v79
ds_write_b128 v239, v[64:67] offset:0
ds_write_b128 v239, v[68:71] offset:1024
s_waitcnt lgkmcnt(9)
v_mfma_f32_16x16x32_bf16 v[128:131], v[184:187], v[216:219], v[128:131]
ds_read_b64_tr_b16 v[206:207], v236 offset:20992
v_mfma_f32_16x16x32_bf16 v[136:139], v[184:187], v[220:223], v[136:139]
v_mfma_f32_16x16x32_bf16 v[132:135], v[188:191], v[216:219], v[132:135]
v_mfma_f32_16x16x32_bf16 v[140:143], v[188:191], v[220:223], v[140:143]
v_add_u32 v236, 65536, v250
v_xor_b32 v237, 32, v236
s_waitcnt lgkmcnt(6)
v_mfma_f32_16x16x32_bf16 v[144:147], v[192:195], v[216:219], v[144:147]
v_xor_b32 v232, 0x1000, v236
v_xor_b32 v233, 0x1000, v237
v_mfma_f32_16x16x32_bf16 v[152:155], v[192:195], v[220:223], v[152:155]
s_waitcnt vmcnt(14) lgkmcnt(0)
s_barrier
ds_read_b64_tr_b16 v[176:177], v236 offset:0
ds_read_b64_tr_b16 v[178:179], v236 offset:2048
ds_read_b64_tr_b16 v[180:181], v237 offset:0
ds_read_b64_tr_b16 v[182:183], v237 offset:2048
ds_read_b64_tr_b16 v[184:185], v236 offset:8192
ds_read_b64_tr_b16 v[186:187], v236 offset:10240
v_mfma_f32_16x16x32_bf16 v[148:151], v[196:199], v[216:219], v[148:151]
v_fma_f32 v80, v80, s51, -v242
v_fma_f32 v81, v81, s51, -v242
v_exp_f32 v80, v80
v_mfma_f32_16x16x32_bf16 v[156:159], v[196:199], v[220:223], v[156:159]
ds_read_b64_tr_b16 v[188:189], v237 offset:8192
v_exp_f32 v81, v81
v_mfma_f32_16x16x32_bf16 v[160:163], v[200:203], v[216:219], v[160:163]
ds_read_b64_tr_b16 v[190:191], v237 offset:10240
v_fma_f32 v82, v82, s51, -v242
v_fma_f32 v83, v83, s51, -v242
v_mfma_f32_16x16x32_bf16 v[168:171], v[200:203], v[220:223], v[168:171]
ds_read_b64_tr_b16 v[192:193], v236 offset:16384
v_add_f32 v244, v244, v80
v_add_f32 v244, v244, v81
v_cvt_pk_bf16_f32 v80, v80, v81
v_mfma_f32_16x16x32_bf16 v[164:167], v[204:207], v[216:219], v[164:167]
ds_read_b64_tr_b16 v[194:195], v236 offset:18432
v_exp_f32 v82, v82
v_mfma_f32_16x16x32_bf16 v[172:175], v[204:207], v[220:223], v[172:175]
ds_read_b64_tr_b16 v[196:197], v237 offset:16384
v_exp_f32 v83, v83
v_fma_f32 v84, v84, s51, -v242
s_waitcnt lgkmcnt(7)
v_mfma_f32_16x16x32_bf16 a[160:163], v[176:179], v[64:67], a[160:163]
ds_read_b64_tr_b16 v[198:199], v237 offset:18432
v_fma_f32 v85, v85, s51, -v242
v_add_f32 v244, v244, v82
v_mfma_f32_16x16x32_bf16 a[168:171], v[176:179], v[68:71], a[168:171]
ds_read_b128 v[72:75], v234 offset:0
ds_read_b128 v[76:79], v234 offset:1024
v_add_f32 v244, v244, v83
v_cvt_pk_bf16_f32 v81, v82, v83
v_mfma_f32_16x16x32_bf16 a[164:167], v[180:183], v[64:67], a[164:167]
ds_read_b64_tr_b16 v[200:201], v232 offset:0
ds_read_b64_tr_b16 v[202:203], v232 offset:2048
s_add_u32 m0, s48, 24576
v_mfma_f32_16x16x32_bf16 a[172:175], v[180:183], v[68:71], a[172:175]
ds_read_b64_tr_b16 v[204:205], v233 offset:0
buffer_load_dwordx4 v228, s[40:43], s69 offen lds
s_waitcnt lgkmcnt(9)
v_mfma_f32_16x16x32_bf16 a[176:179], v[184:187], v[64:67], a[176:179]
ds_read_b64_tr_b16 v[206:207], v233 offset:2048
v_exp_f32 v84, v84
v_mfma_f32_16x16x32_bf16 a[184:187], v[184:187], v[68:71], a[184:187]
ds_read_b64_tr_b16 v[176:177], v232 offset:8192
buffer_load_dwordx4 v229, s[40:43], s69 offen offset:1024 lds
v_mfma_f32_16x16x32_bf16 a[180:183], v[188:191], v[64:67], a[180:183]
ds_read_b64_tr_b16 v[178:179], v232 offset:10240
s_mul_i32 s52, s69, 6144
s_add_u32 s52, s52, 9216
s_add_u32 m0, s48, 139264
v_exp_f32 v85, v85
v_mfma_f32_16x16x32_bf16 a[188:191], v[188:191], v[68:71], a[188:191]
ds_read_b64_tr_b16 v[180:181], v233 offset:8192
buffer_load_dwordx4 v226, s[32:35], s52 offen lds
v_fma_f32 v86, v86, s51, -v242
s_waitcnt lgkmcnt(9)
v_mfma_f32_16x16x32_bf16 a[192:195], v[192:195], v[64:67], a[192:195]
ds_read_b64_tr_b16 v[182:183], v233 offset:10240
v_fma_f32 v87, v87, s51, -v242
v_add_f32 v244, v244, v84
v_add_f32 v244, v244, v85
v_mfma_f32_16x16x32_bf16 a[200:203], v[192:195], v[68:71], a[200:203]
ds_read_b64_tr_b16 v[184:185], v232 offset:16384
buffer_load_dwordx4 v227, s[32:35], s52 offen offset:1024 lds
v_cvt_pk_bf16_f32 v82, v84, v85
v_mfma_f32_16x16x32_bf16 a[196:199], v[196:199], v[64:67], a[196:199]
ds_read_b64_tr_b16 v[186:187], v232 offset:18432
s_add_u32 m0, s48, 147328
v_exp_f32 v86, v86
v_mfma_f32_16x16x32_bf16 a[204:207], v[196:199], v[68:71], a[204:207]
ds_read_b64_tr_b16 v[188:189], v233 offset:16384
buffer_load_dwordx4 v226, s[32:35], s52 offen offset:128 lds
s_waitcnt lgkmcnt(7)
v_mfma_f32_16x16x32_bf16 a[160:163], v[200:203], v[72:75], a[160:163]
ds_read_b64_tr_b16 v[190:191], v233 offset:18432
v_exp_f32 v87, v87
v_fma_f32 v88, v88, s51, -v243
v_mfma_f32_16x16x32_bf16 a[168:171], v[200:203], v[76:79], a[168:171]
buffer_load_dwordx4 v227, s[32:35], s52 offen offset:1152 lds
v_fma_f32 v89, v89, s51, -v243
v_mfma_f32_16x16x32_bf16 a[164:167], v[204:207], v[72:75], a[164:167]
s_add_u32 m0, s48, 155392
v_add_f32 v244, v244, v86
v_add_f32 v244, v244, v87
v_cvt_pk_bf16_f32 v83, v86, v87
v_mfma_f32_16x16x32_bf16 a[172:175], v[204:207], v[76:79], a[172:175]
buffer_load_dwordx4 v226, s[32:35], s52 offen offset:256 lds
s_add_u32 s53, s50, 8192
v_add_u32 v232, s53, v231
s_waitcnt lgkmcnt(4)
v_mfma_f32_16x16x32_bf16 a[176:179], v[176:179], v[72:75], a[176:179]
v_xor_b32 v233, 64, v232
v_add_u32 v236, 90112, v230
v_exp_f32 v88, v88
v_mfma_f32_16x16x32_bf16 a[184:187], v[176:179], v[76:79], a[184:187]
buffer_load_dwordx4 v227, s[32:35], s52 offen offset:1280 lds
v_xor_b32 v237, 32, v236
s_waitcnt vmcnt(14) lgkmcnt(0)
s_barrier
ds_read_b128 v[208:211], v232 offset:0
ds_read_b128 v[212:215], v232 offset:2048
ds_read_b64_tr_b16 v[192:193], v236 offset:0
ds_read_b64_tr_b16 v[194:195], v237 offset:512
ds_read_b64_tr_b16 v[196:197], v237 offset:0
ds_read_b64_tr_b16 v[198:199], v236 offset:512
ds_read_b64_tr_b16 v[200:201], v236 offset:8192
ds_read_b64_tr_b16 v[202:203], v237 offset:8704
v_mfma_f32_16x16x32_bf16 a[180:183], v[180:183], v[72:75], a[180:183]
s_mov_b32 s52, 3293184
s_add_u32 m0, s48, 65536
s_nop 0
buffer_load_dwordx4 v224, s[28:31], s52 offen nt lds
v_mfma_f32_16x16x32_bf16 a[188:191], v[180:183], v[76:79], a[188:191]
ds_read_b64_tr_b16 v[204:205], v237 offset:8192
v_exp_f32 v89, v89
v_fma_f32 v90, v90, s51, -v243
v_mfma_f32_16x16x32_bf16 a[192:195], v[184:187], v[72:75], a[192:195]
ds_read_b64_tr_b16 v[206:207], v236 offset:8704
buffer_load_dwordx4 v225, s[28:31], s52 offen offset:1024 nt lds
v_fma_f32 v91, v91, s51, -v243
v_mfma_f32_16x16x32_bf16 a[200:203], v[184:187], v[76:79], a[200:203]
ds_read_b64_tr_b16 v[176:177], v236 offset:16384
s_add_u32 m0, s48, 73600
v_add_f32 v245, v245, v88
v_add_f32 v245, v245, v89
v_mfma_f32_16x16x32_bf16 a[196:199], v[188:191], v[72:75], a[196:199]
ds_read_b64_tr_b16 v[178:179], v237 offset:16896
buffer_load_dwordx4 v224, s[28:31], s52 offen offset:128 nt lds
v_cvt_pk_bf16_f32 v84, v88, v89
v_mfma_f32_16x16x32_bf16 a[204:207], v[188:191], v[76:79], a[204:207]
ds_read_b64_tr_b16 v[180:181], v237 offset:16384
v_exp_f32 v90, v90
s_waitcnt lgkmcnt(7)
v_mfma_f32_16x16x32_bf16 v[128:131], v[192:195], v[208:211], v[128:131]
ds_read_b64_tr_b16 v[182:183], v236 offset:16896
buffer_load_dwordx4 v225, s[28:31], s52 offen offset:1152 nt lds
v_mfma_f32_16x16x32_bf16 v[136:139], v[192:195], v[212:215], v[136:139]
ds_read_b128 v[216:219], v233 offset:0
ds_read_b128 v[220:223], v233 offset:2048
s_add_u32 m0, s48, 81664
v_exp_f32 v91, v91
v_mfma_f32_16x16x32_bf16 v[132:135], v[196:199], v[208:211], v[132:135]
ds_read_b64_tr_b16 v[184:185], v236 offset:4096
ds_read_b64_tr_b16 v[186:187], v237 offset:4608
buffer_load_dwordx4 v224, s[28:31], s52 offen offset:256 nt lds
v_mfma_f32_16x16x32_bf16 v[140:143], v[196:199], v[212:215], v[140:143]
ds_read_b64_tr_b16 v[188:189], v237 offset:4096
v_fma_f32 v92, v92, s51, -v243
v_fma_f32 v93, v93, s51, -v243
v_add_f32 v245, v245, v90
s_waitcnt lgkmcnt(9)
v_mfma_f32_16x16x32_bf16 v[144:147], v[200:203], v[208:211], v[144:147]
ds_read_b64_tr_b16 v[190:191], v236 offset:4608
v_add_f32 v245, v245, v91
v_cvt_pk_bf16_f32 v85, v90, v91
v_mfma_f32_16x16x32_bf16 v[152:155], v[200:203], v[212:215], v[152:155]
ds_read_b64_tr_b16 v[192:193], v236 offset:12288
buffer_load_dwordx4 v225, s[28:31], s52 offen offset:1280 nt lds
v_mfma_f32_16x16x32_bf16 v[148:151], v[204:207], v[208:211], v[148:151]
ds_read_b64_tr_b16 v[194:195], v237 offset:12800
v_exp_f32 v92, v92
v_mfma_f32_16x16x32_bf16 v[156:159], v[204:207], v[212:215], v[156:159]
ds_read_b64_tr_b16 v[196:197], v237 offset:12288
v_exp_f32 v93, v93
v_fma_f32 v94, v94, s51, -v243
s_waitcnt lgkmcnt(9)
v_mfma_f32_16x16x32_bf16 v[160:163], v[176:179], v[208:211], v[160:163]
ds_read_b64_tr_b16 v[198:199], v236 offset:12800
v_fma_f32 v95, v95, s51, -v243
v_add_f32 v245, v245, v92
v_add_f32 v245, v245, v93
v_mfma_f32_16x16x32_bf16 v[168:171], v[176:179], v[212:215], v[168:171]
ds_read_b64_tr_b16 v[200:201], v236 offset:20480
v_cvt_pk_bf16_f32 v86, v92, v93
v_exp_f32 v94, v94
v_mfma_f32_16x16x32_bf16 v[164:167], v[180:183], v[208:211], v[164:167]
ds_read_b64_tr_b16 v[202:203], v237 offset:20992
v_exp_f32 v95, v95
v_add_f32 v245, v245, v94
v_mfma_f32_16x16x32_bf16 v[172:175], v[180:183], v[212:215], v[172:175]
ds_read_b64_tr_b16 v[204:205], v237 offset:20480
v_add_f32 v245, v245, v95
v_cvt_pk_bf16_f32 v87, v94, v95
ds_write_b128 v239, v[80:83] offset:16384
ds_write_b128 v239, v[84:87] offset:17408
s_waitcnt lgkmcnt(9)
v_mfma_f32_16x16x32_bf16 v[128:131], v[184:187], v[216:219], v[128:131]
ds_read_b64_tr_b16 v[206:207], v236 offset:20992
v_mfma_f32_16x16x32_bf16 v[136:139], v[184:187], v[220:223], v[136:139]
v_mfma_f32_16x16x32_bf16 v[132:135], v[188:191], v[216:219], v[132:135]
v_mfma_f32_16x16x32_bf16 v[140:143], v[188:191], v[220:223], v[140:143]
v_add_u32 v236, 114688, v250
v_xor_b32 v237, 32, v236
s_waitcnt lgkmcnt(6)
v_mfma_f32_16x16x32_bf16 v[144:147], v[192:195], v[216:219], v[144:147]
v_xor_b32 v232, 0x1000, v236
v_xor_b32 v233, 0x1000, v237
v_mfma_f32_16x16x32_bf16 v[152:155], v[192:195], v[220:223], v[152:155]
s_waitcnt vmcnt(14) lgkmcnt(0)
s_barrier
ds_read_b64_tr_b16 v[176:177], v236 offset:0
ds_read_b64_tr_b16 v[178:179], v236 offset:2048
ds_read_b64_tr_b16 v[180:181], v237 offset:0
ds_read_b64_tr_b16 v[182:183], v237 offset:2048
ds_read_b64_tr_b16 v[184:185], v236 offset:8192
ds_read_b64_tr_b16 v[186:187], v236 offset:10240
v_mfma_f32_16x16x32_bf16 v[148:151], v[196:199], v[216:219], v[148:151]
v_fma_f32 v96, v96, s51, -v242
v_fma_f32 v97, v97, s51, -v242
v_exp_f32 v96, v96
v_mfma_f32_16x16x32_bf16 v[156:159], v[196:199], v[220:223], v[156:159]
ds_read_b64_tr_b16 v[188:189], v237 offset:8192
v_exp_f32 v97, v97
v_mfma_f32_16x16x32_bf16 v[160:163], v[200:203], v[216:219], v[160:163]
ds_read_b64_tr_b16 v[190:191], v237 offset:10240
v_fma_f32 v98, v98, s51, -v242
v_fma_f32 v99, v99, s51, -v242
v_mfma_f32_16x16x32_bf16 v[168:171], v[200:203], v[220:223], v[168:171]
ds_read_b64_tr_b16 v[192:193], v236 offset:16384
v_add_f32 v244, v244, v96
v_add_f32 v244, v244, v97
v_mfma_f32_16x16x32_bf16 v[164:167], v[204:207], v[216:219], v[164:167]
ds_read_b64_tr_b16 v[194:195], v236 offset:18432
v_cvt_pk_bf16_f32 v96, v96, v97
v_exp_f32 v98, v98
v_mfma_f32_16x16x32_bf16 v[172:175], v[204:207], v[220:223], v[172:175]
ds_read_b64_tr_b16 v[196:197], v237 offset:16384
v_exp_f32 v99, v99
s_waitcnt lgkmcnt(7)
v_mfma_f32_16x16x32_bf16 a[160:163], v[176:179], v[80:83], a[160:163]
ds_read_b64_tr_b16 v[198:199], v237 offset:18432
v_fma_f32 v100, v100, s51, -v242
v_fma_f32 v101, v101, s51, -v242
v_mfma_f32_16x16x32_bf16 a[168:171], v[176:179], v[84:87], a[168:171]
ds_read_b128 v[88:91], v234 offset:16384
ds_read_b128 v[92:95], v234 offset:17408
v_add_f32 v244, v244, v98
v_mfma_f32_16x16x32_bf16 a[164:167], v[180:183], v[80:83], a[164:167]
ds_read_b64_tr_b16 v[200:201], v232 offset:0
ds_read_b64_tr_b16 v[202:203], v232 offset:2048
s_add_u32 s52, s74, 1966080
s_add_u32 m0, s48, 90112
v_mfma_f32_16x16x32_bf16 a[172:175], v[180:183], v[84:87], a[172:175]
ds_read_b64_tr_b16 v[204:205], v233 offset:0
buffer_load_dwordx4 v228, s[36:39], s52 offen lds
s_waitcnt lgkmcnt(9)
v_mfma_f32_16x16x32_bf16 a[176:179], v[184:187], v[80:83], a[176:179]
ds_read_b64_tr_b16 v[206:207], v233 offset:2048
v_add_f32 v244, v244, v99
v_cvt_pk_bf16_f32 v97, v98, v99
v_mfma_f32_16x16x32_bf16 a[184:187], v[184:187], v[84:87], a[184:187]
ds_read_b64_tr_b16 v[176:177], v232 offset:8192
buffer_load_dwordx4 v229, s[36:39], s52 offen offset:1024 lds
v_mfma_f32_16x16x32_bf16 a[180:183], v[188:191], v[80:83], a[180:183]
ds_read_b64_tr_b16 v[178:179], v232 offset:10240
v_exp_f32 v100, v100
v_mfma_f32_16x16x32_bf16 a[188:191], v[188:191], v[84:87], a[188:191]
ds_read_b64_tr_b16 v[180:181], v233 offset:8192
s_add_u32 s52, s74, 2048000
s_add_u32 m0, s48, 98304
v_exp_f32 v101, v101
s_waitcnt lgkmcnt(9)
v_mfma_f32_16x16x32_bf16 a[192:195], v[192:195], v[80:83], a[192:195]
ds_read_b64_tr_b16 v[182:183], v233 offset:10240
buffer_load_dwordx4 v228, s[36:39], s52 offen lds
v_mfma_f32_16x16x32_bf16 a[200:203], v[192:195], v[84:87], a[200:203]
ds_read_b64_tr_b16 v[184:185], v232 offset:16384
v_fma_f32 v102, v102, s51, -v242
v_fma_f32 v103, v103, s51, -v242
v_add_f32 v244, v244, v100
v_mfma_f32_16x16x32_bf16 a[196:199], v[196:199], v[80:83], a[196:199]
ds_read_b64_tr_b16 v[186:187], v232 offset:18432
v_add_f32 v244, v244, v101
v_cvt_pk_bf16_f32 v98, v100, v101
v_mfma_f32_16x16x32_bf16 a[204:207], v[196:199], v[84:87], a[204:207]
ds_read_b64_tr_b16 v[188:189], v233 offset:16384
buffer_load_dwordx4 v229, s[36:39], s52 offen offset:1024 lds
s_waitcnt lgkmcnt(7)
v_mfma_f32_16x16x32_bf16 a[160:163], v[200:203], v[88:91], a[160:163]
ds_read_b64_tr_b16 v[190:191], v233 offset:18432
v_exp_f32 v102, v102
v_mfma_f32_16x16x32_bf16 a[168:171], v[200:203], v[92:95], a[168:171]
s_add_u32 s52, s74, 2129920
s_add_u32 m0, s48, 106496
v_exp_f32 v103, v103
v_fma_f32 v104, v104, s51, -v243
v_mfma_f32_16x16x32_bf16 a[164:167], v[204:207], v[88:91], a[164:167]
buffer_load_dwordx4 v228, s[36:39], s52 offen lds
v_fma_f32 v105, v105, s51, -v243
v_add_f32 v244, v244, v102
v_mfma_f32_16x16x32_bf16 a[172:175], v[204:207], v[92:95], a[172:175]
s_add_u32 s53, s50, 24576
v_add_u32 v232, s53, v231
v_add_f32 v244, v244, v103
v_cvt_pk_bf16_f32 v99, v102, v103
s_waitcnt lgkmcnt(4)
v_mfma_f32_16x16x32_bf16 a[176:179], v[176:179], v[88:91], a[176:179]
v_xor_b32 v233, 64, v232
v_add_u32 v236, 139264, v230
v_exp_f32 v104, v104
v_mfma_f32_16x16x32_bf16 a[184:187], v[176:179], v[92:95], a[184:187]
buffer_load_dwordx4 v229, s[36:39], s52 offen offset:1024 lds
v_xor_b32 v237, 32, v236
s_waitcnt vmcnt(12) lgkmcnt(0)
s_barrier
ds_read_b128 v[208:211], v232 offset:0
ds_read_b128 v[212:215], v232 offset:2048
ds_read_b64_tr_b16 v[192:193], v236 offset:0
ds_read_b64_tr_b16 v[194:195], v237 offset:512
ds_read_b64_tr_b16 v[196:197], v237 offset:0
ds_read_b64_tr_b16 v[198:199], v236 offset:512
ds_read_b64_tr_b16 v[200:201], v236 offset:8192
ds_read_b64_tr_b16 v[202:203], v237 offset:8704
v_mfma_f32_16x16x32_bf16 a[180:183], v[180:183], v[88:91], a[180:183]
s_mov_b32 s52, 3317760
s_add_u32 m0, s48, 114688
s_nop 0
buffer_load_dwordx4 v224, s[28:31], s52 offen nt lds
v_mfma_f32_16x16x32_bf16 a[188:191], v[180:183], v[92:95], a[188:191]
ds_read_b64_tr_b16 v[204:205], v237 offset:8192
v_exp_f32 v105, v105
v_fma_f32 v106, v106, s51, -v243
v_mfma_f32_16x16x32_bf16 a[192:195], v[184:187], v[88:91], a[192:195]
ds_read_b64_tr_b16 v[206:207], v236 offset:8704
buffer_load_dwordx4 v225, s[28:31], s52 offen offset:1024 nt lds
v_fma_f32 v107, v107, s51, -v243
v_mfma_f32_16x16x32_bf16 a[200:203], v[184:187], v[92:95], a[200:203]
ds_read_b64_tr_b16 v[176:177], v236 offset:16384
s_add_u32 m0, s48, 122752
v_add_f32 v245, v245, v104
v_add_f32 v245, v245, v105
v_mfma_f32_16x16x32_bf16 a[196:199], v[188:191], v[88:91], a[196:199]
ds_read_b64_tr_b16 v[178:179], v237 offset:16896
buffer_load_dwordx4 v224, s[28:31], s52 offen offset:128 nt lds
v_cvt_pk_bf16_f32 v100, v104, v105
v_mfma_f32_16x16x32_bf16 a[204:207], v[188:191], v[92:95], a[204:207]
ds_read_b64_tr_b16 v[180:181], v237 offset:16384
v_exp_f32 v106, v106
s_waitcnt lgkmcnt(7)
v_mfma_f32_16x16x32_bf16 v[128:131], v[192:195], v[208:211], v[128:131]
ds_read_b64_tr_b16 v[182:183], v236 offset:16896
buffer_load_dwordx4 v225, s[28:31], s52 offen offset:1152 nt lds
v_mfma_f32_16x16x32_bf16 v[136:139], v[192:195], v[212:215], v[136:139]
ds_read_b128 v[216:219], v233 offset:0
ds_read_b128 v[220:223], v233 offset:2048
s_add_u32 m0, s48, 130816
v_exp_f32 v107, v107
v_mfma_f32_16x16x32_bf16 v[132:135], v[196:199], v[208:211], v[132:135]
ds_read_b64_tr_b16 v[184:185], v236 offset:4096
ds_read_b64_tr_b16 v[186:187], v237 offset:4608
buffer_load_dwordx4 v224, s[28:31], s52 offen offset:256 nt lds
v_mfma_f32_16x16x32_bf16 v[140:143], v[196:199], v[212:215], v[140:143]
ds_read_b64_tr_b16 v[188:189], v237 offset:4096
v_fma_f32 v108, v108, s51, -v243
v_fma_f32 v109, v109, s51, -v243
v_add_f32 v245, v245, v106
s_waitcnt lgkmcnt(9)
v_mfma_f32_16x16x32_bf16 v[144:147], v[200:203], v[208:211], v[144:147]
ds_read_b64_tr_b16 v[190:191], v236 offset:4608
v_add_f32 v245, v245, v107
v_cvt_pk_bf16_f32 v101, v106, v107
v_mfma_f32_16x16x32_bf16 v[152:155], v[200:203], v[212:215], v[152:155]
ds_read_b64_tr_b16 v[192:193], v236 offset:12288
buffer_load_dwordx4 v225, s[28:31], s52 offen offset:1280 nt lds
v_mfma_f32_16x16x32_bf16 v[148:151], v[204:207], v[208:211], v[148:151]
ds_read_b64_tr_b16 v[194:195], v237 offset:12800
v_exp_f32 v108, v108
v_mfma_f32_16x16x32_bf16 v[156:159], v[204:207], v[212:215], v[156:159]
ds_read_b64_tr_b16 v[196:197], v237 offset:12288
v_exp_f32 v109, v109
v_fma_f32 v110, v110, s51, -v243
s_waitcnt lgkmcnt(9)
v_mfma_f32_16x16x32_bf16 v[160:163], v[176:179], v[208:211], v[160:163]
ds_read_b64_tr_b16 v[198:199], v236 offset:12800
v_fma_f32 v111, v111, s51, -v243
v_add_f32 v245, v245, v108
v_add_f32 v245, v245, v109
v_mfma_f32_16x16x32_bf16 v[168:171], v[176:179], v[212:215], v[168:171]
ds_read_b64_tr_b16 v[200:201], v236 offset:20480
v_cvt_pk_bf16_f32 v102, v108, v109
v_exp_f32 v110, v110
v_mfma_f32_16x16x32_bf16 v[164:167], v[180:183], v[208:211], v[164:167]
ds_read_b64_tr_b16 v[202:203], v237 offset:20992
v_exp_f32 v111, v111
v_add_f32 v245, v245, v110
v_mfma_f32_16x16x32_bf16 v[172:175], v[180:183], v[212:215], v[172:175]
ds_read_b64_tr_b16 v[204:205], v237 offset:20480
v_add_f32 v245, v245, v111
v_cvt_pk_bf16_f32 v103, v110, v111
ds_write_b128 v239, v[96:99] offset:0
ds_write_b128 v239, v[100:103] offset:1024
s_waitcnt lgkmcnt(9)
v_mfma_f32_16x16x32_bf16 v[128:131], v[184:187], v[216:219], v[128:131]
ds_read_b64_tr_b16 v[206:207], v236 offset:20992
v_mfma_f32_16x16x32_bf16 v[136:139], v[184:187], v[220:223], v[136:139]
v_mfma_f32_16x16x32_bf16 v[132:135], v[188:191], v[216:219], v[132:135]
v_mfma_f32_16x16x32_bf16 v[140:143], v[188:191], v[220:223], v[140:143]
v_add_u32 v236, 65536, v250
v_xor_b32 v237, 32, v236
s_waitcnt lgkmcnt(6)
v_mfma_f32_16x16x32_bf16 v[144:147], v[192:195], v[216:219], v[144:147]
v_xor_b32 v232, 0x1000, v236
v_xor_b32 v233, 0x1000, v237
v_mfma_f32_16x16x32_bf16 v[152:155], v[192:195], v[220:223], v[152:155]
s_waitcnt vmcnt(12) lgkmcnt(0)
s_barrier
ds_read_b64_tr_b16 v[176:177], v236 offset:0
ds_read_b64_tr_b16 v[178:179], v236 offset:2048
ds_read_b64_tr_b16 v[180:181], v237 offset:0
ds_read_b64_tr_b16 v[182:183], v237 offset:2048
ds_read_b64_tr_b16 v[184:185], v236 offset:8192
ds_read_b64_tr_b16 v[186:187], v236 offset:10240
v_mfma_f32_16x16x32_bf16 v[148:151], v[196:199], v[216:219], v[148:151]
v_fma_f32 v112, v112, s51, -v242
v_fma_f32 v113, v113, s51, -v242
v_exp_f32 v112, v112
v_mfma_f32_16x16x32_bf16 v[156:159], v[196:199], v[220:223], v[156:159]
ds_read_b64_tr_b16 v[188:189], v237 offset:8192
v_exp_f32 v113, v113
v_fma_f32 v114, v114, s51, -v242
v_mfma_f32_16x16x32_bf16 v[160:163], v[200:203], v[216:219], v[160:163]
ds_read_b64_tr_b16 v[190:191], v237 offset:10240
v_fma_f32 v115, v115, s51, -v242
v_add_f32 v244, v244, v112
v_add_f32 v244, v244, v113
v_mfma_f32_16x16x32_bf16 v[168:171], v[200:203], v[220:223], v[168:171]
ds_read_b64_tr_b16 v[192:193], v236 offset:16384
v_cvt_pk_bf16_f32 v112, v112, v113
v_exp_f32 v114, v114
v_mfma_f32_16x16x32_bf16 v[164:167], v[204:207], v[216:219], v[164:167]
ds_read_b64_tr_b16 v[194:195], v236 offset:18432
v_exp_f32 v115, v115
v_fma_f32 v116, v116, s51, -v242
v_mfma_f32_16x16x32_bf16 v[172:175], v[204:207], v[220:223], v[172:175]
ds_read_b64_tr_b16 v[196:197], v237 offset:16384
v_fma_f32 v117, v117, s51, -v242
v_add_f32 v244, v244, v114
v_add_f32 v244, v244, v115
s_waitcnt lgkmcnt(7)
v_mfma_f32_16x16x32_bf16 a[160:163], v[176:179], v[96:99], a[160:163]
ds_read_b64_tr_b16 v[198:199], v237 offset:18432
v_cvt_pk_bf16_f32 v113, v114, v115
v_exp_f32 v116, v116
v_mfma_f32_16x16x32_bf16 a[168:171], v[176:179], v[100:103], a[168:171]
ds_read_b128 v[104:107], v234 offset:0
ds_read_b128 v[108:111], v234 offset:1024
v_exp_f32 v117, v117
v_mfma_f32_16x16x32_bf16 a[164:167], v[180:183], v[96:99], a[164:167]
ds_read_b64_tr_b16 v[200:201], v232 offset:0
ds_read_b64_tr_b16 v[202:203], v232 offset:2048
s_add_u32 s52, s75, 1966080
s_add_u32 m0, s48, 139264
v_fma_f32 v118, v118, s51, -v242
v_mfma_f32_16x16x32_bf16 a[172:175], v[180:183], v[100:103], a[172:175]
ds_read_b64_tr_b16 v[204:205], v233 offset:0
buffer_load_dwordx4 v228, s[36:39], s52 offen lds
v_fma_f32 v119, v119, s51, -v242
s_waitcnt lgkmcnt(9)
v_mfma_f32_16x16x32_bf16 a[176:179], v[184:187], v[96:99], a[176:179]
ds_read_b64_tr_b16 v[206:207], v233 offset:2048
v_add_f32 v244, v244, v116
v_add_f32 v244, v244, v117
v_cvt_pk_bf16_f32 v114, v116, v117
v_mfma_f32_16x16x32_bf16 a[184:187], v[184:187], v[100:103], a[184:187]
ds_read_b64_tr_b16 v[176:177], v232 offset:8192
buffer_load_dwordx4 v229, s[36:39], s52 offen offset:1024 lds
v_exp_f32 v118, v118
v_mfma_f32_16x16x32_bf16 a[180:183], v[188:191], v[96:99], a[180:183]
ds_read_b64_tr_b16 v[178:179], v232 offset:10240
v_exp_f32 v119, v119
v_fma_f32 v120, v120, s51, -v243
v_mfma_f32_16x16x32_bf16 a[188:191], v[188:191], v[100:103], a[188:191]
ds_read_b64_tr_b16 v[180:181], v233 offset:8192
s_add_u32 s52, s75, 2048000
s_add_u32 m0, s48, 147456
v_fma_f32 v121, v121, s51, -v243
v_add_f32 v244, v244, v118
s_waitcnt lgkmcnt(9)
v_mfma_f32_16x16x32_bf16 a[192:195], v[192:195], v[96:99], a[192:195]
ds_read_b64_tr_b16 v[182:183], v233 offset:10240
buffer_load_dwordx4 v228, s[36:39], s52 offen lds
v_add_f32 v244, v244, v119
v_mfma_f32_16x16x32_bf16 a[200:203], v[192:195], v[100:103], a[200:203]
ds_read_b64_tr_b16 v[184:185], v232 offset:16384
v_cvt_pk_bf16_f32 v115, v118, v119
v_exp_f32 v120, v120
v_mfma_f32_16x16x32_bf16 a[196:199], v[196:199], v[96:99], a[196:199]
ds_read_b64_tr_b16 v[186:187], v232 offset:18432
v_exp_f32 v121, v121
v_fma_f32 v122, v122, s51, -v243
v_mfma_f32_16x16x32_bf16 a[204:207], v[196:199], v[100:103], a[204:207]
ds_read_b64_tr_b16 v[188:189], v233 offset:16384
buffer_load_dwordx4 v229, s[36:39], s52 offen offset:1024 lds
v_fma_f32 v123, v123, s51, -v243
s_waitcnt lgkmcnt(7)
v_mfma_f32_16x16x32_bf16 a[160:163], v[200:203], v[104:107], a[160:163]
ds_read_b64_tr_b16 v[190:191], v233 offset:18432
v_cvt_pk_bf16_f32 v128, v128, v129
v_cvt_pk_bf16_f32 v129, v130, v131
v_cvt_pk_bf16_f32 v130, v132, v133
v_mfma_f32_16x16x32_bf16 a[168:171], v[200:203], v[108:111], a[168:171]
s_add_u32 s52, s75, 2129920
s_add_u32 m0, s48, 155648
v_cvt_pk_bf16_f32 v131, v134, v135
v_cvt_pk_bf16_f32 v136, v136, v137
v_cvt_pk_bf16_f32 v137, v138, v139
v_mfma_f32_16x16x32_bf16 a[164:167], v[204:207], v[104:107], a[164:167]
buffer_load_dwordx4 v228, s[36:39], s52 offen lds
v_cvt_pk_bf16_f32 v138, v140, v141
v_cvt_pk_bf16_f32 v139, v142, v143
v_mfma_f32_16x16x32_bf16 a[172:175], v[204:207], v[108:111], a[172:175]
v_add_u32 v236, 90112, v230
v_xor_b32 v237, 32, v236
v_cvt_pk_bf16_f32 v144, v144, v145
v_cvt_pk_bf16_f32 v145, v146, v147
s_waitcnt lgkmcnt(4)
v_mfma_f32_16x16x32_bf16 a[176:179], v[176:179], v[104:107], a[176:179]
v_cvt_pk_bf16_f32 v146, v148, v149
v_cvt_pk_bf16_f32 v147, v150, v151
v_cvt_pk_bf16_f32 v152, v152, v153
v_cvt_pk_bf16_f32 v153, v154, v155
v_mfma_f32_16x16x32_bf16 a[184:187], v[176:179], v[108:111], a[184:187]
buffer_load_dwordx4 v229, s[36:39], s52 offen offset:1024 lds
v_cvt_pk_bf16_f32 v154, v156, v157
v_cvt_pk_bf16_f32 v155, v158, v159
s_waitcnt vmcnt(12) lgkmcnt(0)
s_barrier
ds_read_b64_tr_b16 v[192:193], v236 offset:0
ds_read_b64_tr_b16 v[194:195], v237 offset:512
ds_read_b64_tr_b16 v[196:197], v237 offset:0
ds_read_b64_tr_b16 v[198:199], v236 offset:512
ds_read_b64_tr_b16 v[200:201], v236 offset:4096
ds_read_b64_tr_b16 v[202:203], v237 offset:4608
v_mfma_f32_16x16x32_bf16 a[180:183], v[180:183], v[104:107], a[180:183]
s_mov_b32 s52, 4718592
s_add_u32 m0, s48, 65536
s_nop 0
buffer_load_dwordx4 v224, s[24:27], s52 offen nt lds
v_cvt_pk_bf16_f32 v160, v160, v161
v_mfma_f32_16x16x32_bf16 a[188:191], v[180:183], v[108:111], a[188:191]
ds_read_b64_tr_b16 v[204:205], v237 offset:4096
v_cvt_pk_bf16_f32 v161, v162, v163
v_cvt_pk_bf16_f32 v162, v164, v165
v_cvt_pk_bf16_f32 v163, v166, v167
v_mfma_f32_16x16x32_bf16 a[192:195], v[184:187], v[104:107], a[192:195]
ds_read_b64_tr_b16 v[206:207], v236 offset:4608
buffer_load_dwordx4 v225, s[24:27], s52 offen offset:1024 nt lds
v_cvt_pk_bf16_f32 v168, v168, v169
v_mfma_f32_16x16x32_bf16 a[200:203], v[184:187], v[108:111], a[200:203]
ds_read_b64_tr_b16 v[176:177], v236 offset:8192
s_add_u32 m0, s48, 73600
v_cvt_pk_bf16_f32 v169, v170, v171
v_cvt_pk_bf16_f32 v170, v172, v173
v_cvt_pk_bf16_f32 v171, v174, v175
v_mfma_f32_16x16x32_bf16 a[196:199], v[188:191], v[104:107], a[196:199]
ds_read_b64_tr_b16 v[178:179], v237 offset:8704
buffer_load_dwordx4 v224, s[24:27], s52 offen offset:128 nt lds
v_add_f32 v245, v245, v120
v_mfma_f32_16x16x32_bf16 a[204:207], v[188:191], v[108:111], a[204:207]
ds_read_b64_tr_b16 v[180:181], v237 offset:8192
v_add_f32 v245, v245, v121
v_cvt_pk_bf16_f32 v116, v120, v121
v_exp_f32 v122, v122
s_waitcnt lgkmcnt(7)
v_mfma_f32_16x16x32_bf16 a[64:67], v[192:195], a[208:211], a[64:67]
ds_read_b64_tr_b16 v[182:183], v236 offset:8704
buffer_load_dwordx4 v225, s[24:27], s52 offen offset:1152 nt lds
v_exp_f32 v123, v123
v_mfma_f32_16x16x32_bf16 a[72:75], v[192:195], a[212:215], a[72:75]
ds_read_b64_tr_b16 v[184:185], v236 offset:12288
s_add_u32 m0, s48, 81664
v_fma_f32 v124, v124, s51, -v243
v_fma_f32 v125, v125, s51, -v243
v_add_f32 v245, v245, v122
v_mfma_f32_16x16x32_bf16 a[68:71], v[196:199], a[208:211], a[68:71]
ds_read_b64_tr_b16 v[186:187], v237 offset:12800
buffer_load_dwordx4 v224, s[24:27], s52 offen offset:256 nt lds
v_add_f32 v245, v245, v123
v_mfma_f32_16x16x32_bf16 a[76:79], v[196:199], a[212:215], a[76:79]
ds_read_b64_tr_b16 v[188:189], v237 offset:12288
v_cvt_pk_bf16_f32 v117, v122, v123
v_exp_f32 v124, v124
s_waitcnt lgkmcnt(7)
v_mfma_f32_16x16x32_bf16 a[64:67], v[200:203], a[216:219], a[64:67]
ds_read_b64_tr_b16 v[190:191], v236 offset:12800
v_exp_f32 v125, v125
v_fma_f32 v126, v126, s51, -v243
v_fma_f32 v127, v127, s51, -v243
v_mfma_f32_16x16x32_bf16 a[72:75], v[200:203], a[220:223], a[72:75]
ds_read_b64_tr_b16 v[192:193], v236 offset:16384
buffer_load_dwordx4 v225, s[24:27], s52 offen offset:1280 nt lds
v_add_f32 v245, v245, v124
v_mfma_f32_16x16x32_bf16 a[68:71], v[204:207], a[216:219], a[68:71]
ds_read_b64_tr_b16 v[194:195], v237 offset:16896
v_add_f32 v245, v245, v125
v_cvt_pk_bf16_f32 v118, v124, v125
v_exp_f32 v126, v126
v_mfma_f32_16x16x32_bf16 a[76:79], v[204:207], a[220:223], a[76:79]
ds_read_b64_tr_b16 v[196:197], v237 offset:16384
v_exp_f32 v127, v127
v_add_f32 v245, v245, v126
s_waitcnt lgkmcnt(7)
v_mfma_f32_16x16x32_bf16 a[64:67], v[176:179], a[224:227], a[64:67]
ds_read_b64_tr_b16 v[198:199], v236 offset:16896
v_add_f32 v245, v245, v127
v_cvt_pk_bf16_f32 v119, v126, v127
v_mov_b32 v246, v244
v_mov_b32 v247, v245
v_mfma_f32_16x16x32_bf16 a[72:75], v[176:179], a[228:231], a[72:75]
ds_read_b64_tr_b16 v[200:201], v236 offset:20480
v_permlane16_swap_b32 v246, v244
v_permlane16_swap_b32 v247, v245
v_add_f32 v244, v244, v246
v_mfma_f32_16x16x32_bf16 a[68:71], v[180:183], a[224:227], a[68:71]
ds_read_b64_tr_b16 v[202:203], v237 offset:20992
v_add_f32 v245, v245, v247
v_mov_b32 v246, v244
v_mov_b32 v247, v245
s_nop 0
v_permlane32_swap_b32 v246, v244
v_mfma_f32_16x16x32_bf16 a[76:79], v[180:183], a[228:231], a[76:79]
ds_read_b64_tr_b16 v[204:205], v237 offset:20480
v_permlane32_swap_b32 v247, v245
v_add_f32 v244, v244, v246
v_add_f32 v245, v245, v247
ds_write_b64 v251, v[128:129] offset:32768
ds_write_b64 v251, v[130:131] offset:33280
ds_write_b64 v251, v[136:137] offset:33792
ds_write_b64 v251, v[138:139] offset:34304
ds_write_b64 v251, v[144:145] offset:40960
ds_write_b64 v251, v[146:147] offset:41472
ds_write_b64 v251, v[152:153] offset:41984
ds_write_b64 v251, v[154:155] offset:42496
ds_write_b64 v251, v[160:161] offset:49152
ds_write_b64 v251, v[162:163] offset:49664
ds_write_b64 v251, v[168:169] offset:50176
ds_write_b64 v251, v[170:171] offset:50688
ds_write_b128 v239, v[112:115] offset:16384
ds_write_b128 v239, v[116:119] offset:17408
ds_write_b64 v239, v[244:245] offset:58368
s_waitcnt lgkmcnt(15)
v_mfma_f32_16x16x32_bf16 a[64:67], v[184:187], a[232:235], a[64:67]
ds_read_b64_tr_b16 v[206:207], v236 offset:20992
v_mfma_f32_16x16x32_bf16 a[72:75], v[184:187], a[236:239], a[72:75]
v_mfma_f32_16x16x32_bf16 a[68:71], v[188:191], a[232:235], a[68:71]
v_mfma_f32_16x16x32_bf16 a[76:79], v[188:191], a[236:239], a[76:79]
v_add_u32 v236, 114688, v250
v_xor_b32 v237, 32, v236
v_mfma_f32_16x16x32_bf16 a[64:67], v[192:195], a[240:243], a[64:67]
v_xor_b32 v232, 0x1000, v236
v_xor_b32 v233, 0x1000, v237
v_mfma_f32_16x16x32_bf16 a[72:75], v[192:195], a[244:247], a[72:75]
s_waitcnt vmcnt(12) lgkmcnt(0)
s_barrier
ds_read_b64_tr_b16 v[176:177], v236 offset:0
ds_read_b64_tr_b16 v[178:179], v236 offset:2048
ds_read_b64_tr_b16 v[180:181], v237 offset:0
ds_read_b64_tr_b16 v[182:183], v237 offset:2048
ds_read_b64_tr_b16 v[184:185], v236 offset:8192
ds_read_b64_tr_b16 v[186:187], v236 offset:10240
v_mfma_f32_16x16x32_bf16 a[68:71], v[196:199], a[240:243], a[68:71]
v_accvgpr_read_b32 v128, a208
v_accvgpr_read_b32 v129, a209
v_accvgpr_read_b32 v130, a210
v_accvgpr_read_b32 v131, a211
v_mfma_f32_16x16x32_bf16 a[76:79], v[196:199], a[244:247], a[76:79]
ds_read_b64_tr_b16 v[188:189], v237 offset:8192
v_accvgpr_read_b32 v132, a212
v_accvgpr_read_b32 v133, a213
v_accvgpr_read_b32 v134, a214
v_mfma_f32_16x16x32_bf16 a[64:67], v[200:203], a[248:251], a[64:67]
ds_read_b64_tr_b16 v[190:191], v237 offset:10240
v_accvgpr_read_b32 v135, a215
v_accvgpr_read_b32 v136, a216
v_accvgpr_read_b32 v137, a217
v_mfma_f32_16x16x32_bf16 a[72:75], v[200:203], a[252:255], a[72:75]
ds_read_b64_tr_b16 v[192:193], v236 offset:16384
v_accvgpr_read_b32 v138, a218
v_accvgpr_read_b32 v139, a219
v_mfma_f32_16x16x32_bf16 a[68:71], v[204:207], a[248:251], a[68:71]
ds_read_b64_tr_b16 v[194:195], v236 offset:18432
v_accvgpr_read_b32 v140, a220
v_accvgpr_read_b32 v141, a221
v_accvgpr_read_b32 v142, a222
v_mfma_f32_16x16x32_bf16 a[76:79], v[204:207], a[252:255], a[76:79]
ds_read_b64_tr_b16 v[196:197], v237 offset:16384
v_accvgpr_read_b32 v143, a223
v_accvgpr_read_b32 v144, a224
s_waitcnt lgkmcnt(7)
v_mfma_f32_16x16x32_bf16 a[160:163], v[176:179], v[112:115], a[160:163]
ds_read_b64_tr_b16 v[198:199], v237 offset:18432
v_accvgpr_read_b32 v145, a225
v_accvgpr_read_b32 v146, a226
v_accvgpr_read_b32 v147, a227
v_mfma_f32_16x16x32_bf16 a[168:171], v[176:179], v[116:119], a[168:171]
ds_read_b128 v[120:123], v234 offset:16384
ds_read_b128 v[124:127], v234 offset:17408
v_accvgpr_read_b32 v148, a228
v_mfma_f32_16x16x32_bf16 a[164:167], v[180:183], v[112:115], a[164:167]
ds_read_b64_tr_b16 v[200:201], v232 offset:0
ds_read_b64_tr_b16 v[202:203], v232 offset:2048
s_add_u32 s52, s76, 1966080
s_add_u32 m0, s48, 90112
v_accvgpr_read_b32 v149, a229
v_mfma_f32_16x16x32_bf16 a[172:175], v[180:183], v[116:119], a[172:175]
ds_read_b64_tr_b16 v[204:205], v233 offset:0
buffer_load_dwordx4 v228, s[36:39], s52 offen lds
s_waitcnt lgkmcnt(9)
v_mfma_f32_16x16x32_bf16 a[176:179], v[184:187], v[112:115], a[176:179]
ds_read_b64_tr_b16 v[206:207], v233 offset:2048
v_accvgpr_read_b32 v150, a230
v_accvgpr_read_b32 v151, a231
v_accvgpr_read_b32 v152, a232
v_mfma_f32_16x16x32_bf16 a[184:187], v[184:187], v[116:119], a[184:187]
ds_read_b64_tr_b16 v[176:177], v232 offset:8192
buffer_load_dwordx4 v229, s[36:39], s52 offen offset:1024 lds
v_mfma_f32_16x16x32_bf16 a[180:183], v[188:191], v[112:115], a[180:183]
ds_read_b64_tr_b16 v[178:179], v232 offset:10240
v_accvgpr_read_b32 v153, a233
v_accvgpr_read_b32 v154, a234
v_accvgpr_read_b32 v155, a235
v_mfma_f32_16x16x32_bf16 a[188:191], v[188:191], v[116:119], a[188:191]
ds_read_b64_tr_b16 v[180:181], v233 offset:8192
s_add_u32 s52, s76, 2048000
s_add_u32 m0, s48, 98304
v_accvgpr_read_b32 v156, a236
s_waitcnt lgkmcnt(9)
v_mfma_f32_16x16x32_bf16 a[192:195], v[192:195], v[112:115], a[192:195]
ds_read_b64_tr_b16 v[182:183], v233 offset:10240
buffer_load_dwordx4 v228, s[36:39], s52 offen lds
v_accvgpr_read_b32 v157, a237
v_mfma_f32_16x16x32_bf16 a[200:203], v[192:195], v[116:119], a[200:203]
ds_read_b64_tr_b16 v[184:185], v232 offset:16384
v_accvgpr_read_b32 v158, a238
v_accvgpr_read_b32 v159, a239
v_mfma_f32_16x16x32_bf16 a[196:199], v[196:199], v[112:115], a[196:199]
ds_read_b64_tr_b16 v[186:187], v232 offset:18432
v_accvgpr_read_b32 v160, a240
v_accvgpr_read_b32 v161, a241
v_accvgpr_read_b32 v162, a242
v_mfma_f32_16x16x32_bf16 a[204:207], v[196:199], v[116:119], a[204:207]
ds_read_b64_tr_b16 v[188:189], v233 offset:16384
buffer_load_dwordx4 v229, s[36:39], s52 offen offset:1024 lds
s_waitcnt lgkmcnt(7)
v_mfma_f32_16x16x32_bf16 a[160:163], v[200:203], v[120:123], a[160:163]
ds_read_b64_tr_b16 v[190:191], v233 offset:18432
v_accvgpr_read_b32 v163, a243
v_accvgpr_read_b32 v164, a244
v_accvgpr_read_b32 v165, a245
v_mfma_f32_16x16x32_bf16 a[168:171], v[200:203], v[124:127], a[168:171]
s_add_u32 s52, s76, 2129920
s_add_u32 m0, s48, 106496
v_accvgpr_read_b32 v166, a246
v_accvgpr_read_b32 v167, a247
v_mfma_f32_16x16x32_bf16 a[164:167], v[204:207], v[120:123], a[164:167]
buffer_load_dwordx4 v228, s[36:39], s52 offen lds
v_accvgpr_read_b32 v168, a248
v_accvgpr_read_b32 v169, a249
v_mfma_f32_16x16x32_bf16 a[172:175], v[204:207], v[124:127], a[172:175]
v_add_u32 v236, 139264, v230
v_xor_b32 v237, 32, v236
v_accvgpr_read_b32 v170, a250
s_waitcnt lgkmcnt(4)
v_mfma_f32_16x16x32_bf16 a[176:179], v[176:179], v[120:123], a[176:179]
v_accvgpr_read_b32 v171, a251
v_accvgpr_read_b32 v172, a252
v_accvgpr_read_b32 v173, a253
v_accvgpr_read_b32 v174, a254
v_mfma_f32_16x16x32_bf16 a[184:187], v[176:179], v[124:127], a[184:187]
buffer_load_dwordx4 v229, s[36:39], s52 offen offset:1024 lds
v_accvgpr_read_b32 v175, a255
s_waitcnt vmcnt(12) lgkmcnt(0)
s_barrier
ds_read_b64_tr_b16 v[192:193], v236 offset:0
ds_read_b64_tr_b16 v[194:195], v237 offset:512
ds_read_b64_tr_b16 v[196:197], v237 offset:0
ds_read_b64_tr_b16 v[198:199], v236 offset:512
ds_read_b64_tr_b16 v[200:201], v236 offset:4096
ds_read_b64_tr_b16 v[202:203], v237 offset:4608
v_mfma_f32_16x16x32_bf16 a[180:183], v[180:183], v[120:123], a[180:183]
s_mov_b32 s52, 4743168
s_add_u32 m0, s48, 114688
s_nop 0
buffer_load_dwordx4 v224, s[24:27], s52 offen nt lds
v_mfma_f32_16x16x32_bf16 a[188:191], v[180:183], v[124:127], a[188:191]
ds_read_b64_tr_b16 v[204:205], v237 offset:4096
ds_read_b64 v[246:247], v238 offset:58368
ds_read_b64 v[248:249], v238 offset:60416
v_mfma_f32_16x16x32_bf16 a[192:195], v[184:187], v[120:123], a[192:195]
ds_read_b64_tr_b16 v[206:207], v236 offset:4608
buffer_load_dwordx4 v225, s[24:27], s52 offen offset:1024 nt lds
v_mfma_f32_16x16x32_bf16 a[200:203], v[184:187], v[124:127], a[200:203]
ds_read_b64_tr_b16 v[176:177], v236 offset:8192
s_add_u32 m0, s48, 122752
s_waitcnt lgkmcnt(2)
v_add_f32 v246, v246, v248
v_add_f32 v247, v247, v249
v_mfma_f32_16x16x32_bf16 a[196:199], v[188:191], v[120:123], a[196:199]
ds_read_b64_tr_b16 v[178:179], v237 offset:8704
buffer_load_dwordx4 v224, s[24:27], s52 offen offset:128 nt lds
v_mfma_f32_16x16x32_bf16 a[204:207], v[188:191], v[124:127], a[204:207]
ds_read_b64_tr_b16 v[180:181], v237 offset:8192
v_rcp_f32 v248, v246
v_mfma_f32_16x16x32_bf16 a[80:83], v[192:195], v[128:131], a[80:83]
ds_read_b64_tr_b16 v[182:183], v236 offset:8704
buffer_load_dwordx4 v225, s[24:27], s52 offen offset:1152 nt lds
v_mfma_f32_16x16x32_bf16 a[88:91], v[192:195], v[132:135], a[88:91]
ds_read_b64_tr_b16 v[184:185], v236 offset:12288
s_add_u32 m0, s48, 130816
v_rcp_f32 v249, v247
v_mfma_f32_16x16x32_bf16 a[84:87], v[196:199], v[128:131], a[84:87]
ds_read_b64_tr_b16 v[186:187], v237 offset:12800
buffer_load_dwordx4 v224, s[24:27], s52 offen offset:256 nt lds
v_mfma_f32_16x16x32_bf16 a[92:95], v[196:199], v[132:135], a[92:95]
ds_read_b64_tr_b16 v[188:189], v237 offset:12288
v_accvgpr_read_b32 v64, a160
v_accvgpr_read_b32 v65, a161
v_accvgpr_read_b32 v66, a162
s_waitcnt lgkmcnt(7)
v_mfma_f32_16x16x32_bf16 a[80:83], v[200:203], v[136:139], a[80:83]
ds_read_b64_tr_b16 v[190:191], v236 offset:12800
v_accvgpr_read_b32 v67, a163
v_accvgpr_read_b32 v68, a164
v_mfma_f32_16x16x32_bf16 a[88:91], v[200:203], v[140:143], a[88:91]
ds_read_b64_tr_b16 v[192:193], v236 offset:16384
buffer_load_dwordx4 v225, s[24:27], s52 offen offset:1280 nt lds
v_accvgpr_read_b32 v69, a165
v_mfma_f32_16x16x32_bf16 a[84:87], v[204:207], v[136:139], a[84:87]
ds_read_b64_tr_b16 v[194:195], v237 offset:16896
v_accvgpr_read_b32 v70, a166
v_accvgpr_read_b32 v71, a167
v_mfma_f32_16x16x32_bf16 a[92:95], v[204:207], v[140:143], a[92:95]
ds_read_b64_tr_b16 v[196:197], v237 offset:16384
v_mul_f32 v64, v64, v248
v_mul_f32 v65, v65, v248
v_mul_f32 v66, v66, v248
s_waitcnt lgkmcnt(7)
v_mfma_f32_16x16x32_bf16 a[80:83], v[176:179], v[144:147], a[80:83]
ds_read_b64_tr_b16 v[198:199], v236 offset:16896
v_mul_f32 v67, v67, v248
v_mul_f32 v68, v68, v248
v_mfma_f32_16x16x32_bf16 a[88:91], v[176:179], v[148:151], a[88:91]
ds_read_b64_tr_b16 v[200:201], v236 offset:20480
v_mul_f32 v69, v69, v248
v_mul_f32 v70, v70, v248
v_mul_f32 v71, v71, v248
v_mfma_f32_16x16x32_bf16 a[84:87], v[180:183], v[144:147], a[84:87]
ds_read_b64_tr_b16 v[202:203], v237 offset:20992
v_cvt_pk_bf16_f32 v64, v64, v65
v_cvt_pk_bf16_f32 v65, v66, v67
v_mfma_f32_16x16x32_bf16 a[92:95], v[180:183], v[148:151], a[92:95]
ds_read_b64_tr_b16 v[204:205], v237 offset:20480
v_cvt_pk_bf16_f32 v66, v68, v69
v_cvt_pk_bf16_f32 v67, v70, v71
v_accvgpr_read_b32 v72, a168
s_waitcnt lgkmcnt(7)
v_mfma_f32_16x16x32_bf16 a[80:83], v[184:187], v[152:155], a[80:83]
ds_read_b64_tr_b16 v[206:207], v236 offset:20992
v_accvgpr_read_b32 v73, a169
v_accvgpr_read_b32 v74, a170
v_mfma_f32_16x16x32_bf16 a[88:91], v[184:187], v[156:159], a[88:91]
v_accvgpr_read_b32 v75, a171
v_accvgpr_read_b32 v76, a172
v_accvgpr_read_b32 v77, a173
v_accvgpr_read_b32 v78, a174
v_mfma_f32_16x16x32_bf16 a[84:87], v[188:191], v[152:155], a[84:87]
v_accvgpr_read_b32 v79, a175
v_mul_f32 v72, v72, v249
v_mul_f32 v73, v73, v249
v_mfma_f32_16x16x32_bf16 a[92:95], v[188:191], v[156:159], a[92:95]
s_add_u32 s53, s49, 65536
v_add_u32 v232, s53, v231
v_mul_f32 v74, v74, v249
v_mul_f32 v75, v75, v249
s_waitcnt lgkmcnt(4)
v_mfma_f32_16x16x32_bf16 a[80:83], v[192:195], v[160:163], a[80:83]
v_xor_b32 v233, 64, v232
v_mul_f32 v76, v76, v249
v_mul_f32 v77, v77, v249
v_mul_f32 v78, v78, v249
v_mfma_f32_16x16x32_bf16 a[88:91], v[192:195], v[164:167], a[88:91]
v_mul_f32 v79, v79, v249
v_cvt_pk_bf16_f32 v72, v72, v73
v_cvt_pk_bf16_f32 v73, v74, v75
s_waitcnt vmcnt(12) lgkmcnt(0)
s_barrier
ds_read_b128 a[208:211], v238 offset:32768
ds_read_b128 a[212:215], v238 offset:33792
ds_read_b128 v[176:179], v232 offset:0
ds_read_b128 v[180:183], v232 offset:2048
ds_read_b128 a[216:219], v238 offset:34816
ds_read_b128 a[220:223], v238 offset:35840
ds_read_b128 v[184:187], v233 offset:0
v_mfma_f32_16x16x32_bf16 a[84:87], v[196:199], v[160:163], a[84:87]
v_cvt_pk_bf16_f32 v74, v76, v77
v_cvt_pk_bf16_f32 v75, v78, v79
v_accvgpr_read_b32 v80, a176
v_accvgpr_read_b32 v81, a177
v_mfma_f32_16x16x32_bf16 a[92:95], v[196:199], v[164:167], a[92:95]
ds_read_b128 v[188:191], v233 offset:2048
v_accvgpr_read_b32 v82, a178
v_accvgpr_read_b32 v83, a179
v_accvgpr_read_b32 v84, a180
v_mfma_f32_16x16x32_bf16 a[80:83], v[200:203], v[168:171], a[80:83]
v_accvgpr_read_b32 v85, a181
v_accvgpr_read_b32 v86, a182
v_accvgpr_read_b32 v87, a183
v_mul_f32 v80, v80, v248
v_mfma_f32_16x16x32_bf16 a[88:91], v[200:203], v[172:175], a[88:91]
ds_read_b128 a[224:227], v238 offset:40960
ds_read_b128 a[228:231], v238 offset:41984
v_mul_f32 v81, v81, v248
v_mul_f32 v82, v82, v248
v_mfma_f32_16x16x32_bf16 a[84:87], v[204:207], v[168:171], a[84:87]
ds_read_b128 v[192:195], v232 offset:8192
v_mul_f32 v83, v83, v248
v_mul_f32 v84, v84, v248
v_mul_f32 v85, v85, v248
v_mfma_f32_16x16x32_bf16 a[92:95], v[204:207], v[172:175], a[92:95]
ds_read_b128 v[196:199], v232 offset:10240
v_mul_f32 v86, v86, v248
v_mul_f32 v87, v87, v248
v_cvt_pk_bf16_f32 v80, v80, v81
s_waitcnt lgkmcnt(8)
v_mfma_f32_16x16x32_bf16 v[0:3], v[176:179], a[208:211], 0
v_cvt_pk_bf16_f32 v81, v82, v83
v_cvt_pk_bf16_f32 v82, v84, v85
v_cvt_pk_bf16_f32 v83, v86, v87
v_accvgpr_read_b32 v88, a184
v_mfma_f32_16x16x32_bf16 v[8:11], v[176:179], a[212:215], 0
ds_read_b128 a[232:235], v238 offset:43008
ds_read_b128 a[236:239], v238 offset:44032
v_accvgpr_read_b32 v89, a185
v_accvgpr_read_b32 v90, a186
v_mfma_f32_16x16x32_bf16 v[4:7], v[180:183], a[208:211], 0
ds_read_b128 v[200:203], v233 offset:8192
s_add_u32 s52, s77, 1966080
s_add_u32 m0, s48, 139264
v_accvgpr_read_b32 v91, a187
v_accvgpr_read_b32 v92, a188
v_mfma_f32_16x16x32_bf16 v[12:15], v[180:183], a[212:215], 0
ds_read_b128 v[204:207], v233 offset:10240
buffer_load_dwordx4 v228, s[36:39], s52 offen lds
v_accvgpr_read_b32 v93, a189
s_waitcnt lgkmcnt(8)
v_mfma_f32_16x16x32_bf16 v[0:3], v[184:187], a[216:219], v[0:3]
v_accvgpr_read_b32 v94, a190
v_accvgpr_read_b32 v95, a191
v_mul_f32 v88, v88, v249
v_mul_f32 v89, v89, v249
v_mfma_f32_16x16x32_bf16 v[8:11], v[184:187], a[220:223], v[8:11]
ds_read_b128 a[240:243], v238 offset:49152
ds_read_b128 a[244:247], v238 offset:50176
buffer_load_dwordx4 v229, s[36:39], s52 offen offset:1024 lds
v_mfma_f32_16x16x32_bf16 v[4:7], v[188:191], a[216:219], v[4:7]
ds_read_b128 v[176:179], v232 offset:16384
v_mul_f32 v90, v90, v249
v_mul_f32 v91, v91, v249
v_mul_f32 v92, v92, v249
v_mfma_f32_16x16x32_bf16 v[12:15], v[188:191], a[220:223], v[12:15]
ds_read_b128 v[180:183], v232 offset:18432
s_add_u32 s52, s77, 2048000
s_add_u32 m0, s48, 147456
v_mul_f32 v93, v93, v249
s_waitcnt lgkmcnt(8)
v_mfma_f32_16x16x32_bf16 v[0:3], v[192:195], a[224:227], v[0:3]
buffer_load_dwordx4 v228, s[36:39], s52 offen lds
v_mul_f32 v94, v94, v249
v_mul_f32 v95, v95, v249
v_mfma_f32_16x16x32_bf16 v[8:11], v[192:195], a[228:231], v[8:11]
ds_read_b128 a[248:251], v238 offset:51200
ds_read_b128 a[252:255], v238 offset:52224
v_cvt_pk_bf16_f32 v88, v88, v89
v_mfma_f32_16x16x32_bf16 v[4:7], v[196:199], a[224:227], v[4:7]
ds_read_b128 v[184:187], v233 offset:16384
v_cvt_pk_bf16_f32 v89, v90, v91
v_cvt_pk_bf16_f32 v90, v92, v93
v_cvt_pk_bf16_f32 v91, v94, v95
v_mfma_f32_16x16x32_bf16 v[12:15], v[196:199], a[228:231], v[12:15]
ds_read_b128 v[188:191], v233 offset:18432
buffer_load_dwordx4 v229, s[36:39], s52 offen offset:1024 lds
s_waitcnt lgkmcnt(8)
v_mfma_f32_16x16x32_bf16 v[0:3], v[200:203], a[232:235], v[0:3]
v_accvgpr_read_b32 v96, a192
v_accvgpr_read_b32 v97, a193
v_accvgpr_read_b32 v98, a194
v_accvgpr_read_b32 v99, a195
v_mfma_f32_16x16x32_bf16 v[8:11], v[200:203], a[236:239], v[8:11]
s_add_u32 s52, s77, 2129920
s_add_u32 m0, s48, 155648
v_accvgpr_read_b32 v100, a196
v_accvgpr_read_b32 v101, a197
v_mfma_f32_16x16x32_bf16 v[4:7], v[204:207], a[232:235], v[4:7]
buffer_load_dwordx4 v228, s[36:39], s52 offen lds
v_accvgpr_read_b32 v102, a198
v_accvgpr_read_b32 v103, a199
v_mfma_f32_16x16x32_bf16 v[12:15], v[204:207], a[236:239], v[12:15]
v_add_u32 v236, 90112, v230
v_xor_b32 v237, 32, v236
v_mul_f32 v96, v96, v248
s_waitcnt lgkmcnt(4)
v_mfma_f32_16x16x32_bf16 v[0:3], v[176:179], a[240:243], v[0:3]
v_mul_f32 v97, v97, v248
v_mul_f32 v98, v98, v248
v_mul_f32 v99, v99, v248
v_mul_f32 v100, v100, v248
v_mfma_f32_16x16x32_bf16 v[8:11], v[176:179], a[244:247], v[8:11]
buffer_load_dwordx4 v229, s[36:39], s52 offen offset:1024 lds
v_mul_f32 v101, v101, v248
s_waitcnt vmcnt(12) lgkmcnt(0)
s_barrier
ds_read_b64_tr_b16 v[192:193], v236 offset:0
ds_read_b64_tr_b16 v[194:195], v237 offset:512
ds_read_b64_tr_b16 v[196:197], v237 offset:0
ds_read_b64_tr_b16 v[198:199], v236 offset:512
ds_read_b64_tr_b16 v[200:201], v236 offset:4096
ds_read_b64_tr_b16 v[202:203], v237 offset:4608
v_mfma_f32_16x16x32_bf16 v[4:7], v[180:183], a[240:243], v[4:7]
s_mov_b32 s52, 4767744
s_add_u32 m0, s48, 65536
s_nop 0
buffer_load_dwordx4 v224, s[24:27], s52 offen nt lds
v_mul_f32 v102, v102, v248
v_mfma_f32_16x16x32_bf16 v[12:15], v[180:183], a[244:247], v[12:15]
ds_read_b64_tr_b16 v[204:205], v237 offset:4096
v_mul_f32 v103, v103, v248
v_cvt_pk_bf16_f32 v96, v96, v97
v_cvt_pk_bf16_f32 v97, v98, v99
v_mfma_f32_16x16x32_bf16 v[0:3], v[184:187], a[248:251], v[0:3]
ds_read_b64_tr_b16 v[206:207], v236 offset:4608
buffer_load_dwordx4 v225, s[24:27], s52 offen offset:1024 nt lds
v_cvt_pk_bf16_f32 v98, v100, v101
v_mfma_f32_16x16x32_bf16 v[8:11], v[184:187], a[252:255], v[8:11]
ds_read_b64_tr_b16 v[176:177], v236 offset:8192
s_add_u32 m0, s48, 73600
v_cvt_pk_bf16_f32 v99, v102, v103
v_accvgpr_read_b32 v104, a200
v_mfma_f32_16x16x32_bf16 v[4:7], v[188:191], a[248:251], v[4:7]
ds_read_b64_tr_b16 v[178:179], v237 offset:8704
buffer_load_dwordx4 v224, s[24:27], s52 offen offset:128 nt lds
v_accvgpr_read_b32 v105, a201
v_mfma_f32_16x16x32_bf16 v[12:15], v[188:191], a[252:255], v[12:15]
ds_read_b64_tr_b16 v[180:181], v237 offset:8192
v_accvgpr_read_b32 v106, a202
v_accvgpr_read_b32 v107, a203
v_accvgpr_read_b32 v108, a204
s_waitcnt lgkmcnt(7)
v_mfma_f32_16x16x32_bf16 a[96:99], v[192:195], v[128:131], a[96:99]
ds_read_b64_tr_b16 v[182:183], v236 offset:8704
buffer_load_dwordx4 v225, s[24:27], s52 offen offset:1152 nt lds
v_mfma_f32_16x16x32_bf16 a[104:107], v[192:195], v[132:135], a[104:107]
ds_read_b64_tr_b16 v[184:185], v236 offset:12288
s_add_u32 m0, s48, 81664
v_accvgpr_read_b32 v109, a205
v_accvgpr_read_b32 v110, a206
v_mfma_f32_16x16x32_bf16 a[100:103], v[196:199], v[128:131], a[100:103]
ds_read_b64_tr_b16 v[186:187], v237 offset:12800
buffer_load_dwordx4 v224, s[24:27], s52 offen offset:256 nt lds
v_accvgpr_read_b32 v111, a207
v_mfma_f32_16x16x32_bf16 a[108:111], v[196:199], v[132:135], a[108:111]
ds_read_b64_tr_b16 v[188:189], v237 offset:12288
v_mul_f32 v104, v104, v249
v_mul_f32 v105, v105, v249
s_waitcnt lgkmcnt(7)
v_mfma_f32_16x16x32_bf16 a[96:99], v[200:203], v[136:139], a[96:99]
ds_read_b64_tr_b16 v[190:191], v236 offset:12800
v_mul_f32 v106, v106, v249
v_mul_f32 v107, v107, v249
v_mul_f32 v108, v108, v249
v_mfma_f32_16x16x32_bf16 a[104:107], v[200:203], v[140:143], a[104:107]
ds_read_b64_tr_b16 v[192:193], v236 offset:16384
buffer_load_dwordx4 v225, s[24:27], s52 offen offset:1280 nt lds
v_mfma_f32_16x16x32_bf16 a[100:103], v[204:207], v[136:139], a[100:103]
ds_read_b64_tr_b16 v[194:195], v237 offset:16896
v_mul_f32 v109, v109, v249
v_mul_f32 v110, v110, v249
v_mul_f32 v111, v111, v249
v_mfma_f32_16x16x32_bf16 a[108:111], v[204:207], v[140:143], a[108:111]
ds_read_b64_tr_b16 v[196:197], v237 offset:16384
v_cvt_pk_bf16_f32 v104, v104, v105
v_cvt_pk_bf16_f32 v105, v106, v107
s_waitcnt lgkmcnt(7)
v_mfma_f32_16x16x32_bf16 a[96:99], v[176:179], v[144:147], a[96:99]
ds_read_b64_tr_b16 v[198:199], v236 offset:16896
v_cvt_pk_bf16_f32 v106, v108, v109
v_cvt_pk_bf16_f32 v107, v110, v111
v_max3_f32 v240, v0, v1, v2
v_mfma_f32_16x16x32_bf16 a[104:107], v[176:179], v[148:151], a[104:107]
ds_read_b64_tr_b16 v[200:201], v236 offset:20480
v_max3_f32 v241, v8, v9, v10
v_max3_f32 v240, v240, v3, v4
v_mfma_f32_16x16x32_bf16 a[100:103], v[180:183], v[144:147], a[100:103]
ds_read_b64_tr_b16 v[202:203], v237 offset:20992
v_max3_f32 v241, v241, v11, v12
v_max3_f32 v240, v240, v5, v6
v_max3_f32 v241, v241, v13, v14
v_mfma_f32_16x16x32_bf16 a[108:111], v[180:183], v[148:151], a[108:111]
ds_read_b64_tr_b16 v[204:205], v237 offset:20480
v_max_f32 v240, v240, v7
v_max_f32 v241, v241, v15
ds_write_b64 v251, v[64:65] offset:0
ds_write_b64 v251, v[66:67] offset:512
ds_write_b64 v251, v[72:73] offset:1024
ds_write_b64 v251, v[74:75] offset:1536
ds_write_b64 v251, v[80:81] offset:8192
ds_write_b64 v251, v[82:83] offset:8704
ds_write_b64 v251, v[88:89] offset:9216
ds_write_b64 v251, v[90:91] offset:9728
ds_write_b64 v251, v[96:97] offset:16384
ds_write_b64 v251, v[98:99] offset:16896
ds_write_b64 v251, v[104:105] offset:17408
ds_write_b64 v251, v[106:107] offset:17920
s_waitcnt lgkmcnt(15)
v_mfma_f32_16x16x32_bf16 a[96:99], v[184:187], v[152:155], a[96:99]
ds_read_b64_tr_b16 v[206:207], v236 offset:20992
v_mfma_f32_16x16x32_bf16 a[104:107], v[184:187], v[156:159], a[104:107]
v_mfma_f32_16x16x32_bf16 a[100:103], v[188:191], v[152:155], a[100:103]
v_mfma_f32_16x16x32_bf16 a[108:111], v[188:191], v[156:159], a[108:111]
s_add_u32 s53, s49, 114688
v_add_u32 v232, s53, v231
v_mfma_f32_16x16x32_bf16 a[96:99], v[192:195], v[160:163], a[96:99]
v_xor_b32 v233, 64, v232
v_mfma_f32_16x16x32_bf16 a[104:107], v[192:195], v[164:167], a[104:107]
s_waitcnt vmcnt(12) lgkmcnt(0)
s_barrier
ds_read_b128 v[176:179], v232 offset:0
ds_read_b128 v[180:183], v232 offset:2048
ds_read_b128 v[184:187], v233 offset:0
v_mfma_f32_16x16x32_bf16 a[100:103], v[196:199], v[160:163], a[100:103]
v_mfma_f32_16x16x32_bf16 a[108:111], v[196:199], v[164:167], a[108:111]
ds_read_b128 v[188:191], v233 offset:2048
v_mfma_f32_16x16x32_bf16 a[96:99], v[200:203], v[168:171], a[96:99]
v_mfma_f32_16x16x32_bf16 a[104:107], v[200:203], v[172:175], a[104:107]
ds_read_b128 v[192:195], v232 offset:8192
v_mfma_f32_16x16x32_bf16 a[100:103], v[204:207], v[168:171], a[100:103]
v_mfma_f32_16x16x32_bf16 a[108:111], v[204:207], v[172:175], a[108:111]
ds_read_b128 v[196:199], v232 offset:10240
s_waitcnt lgkmcnt(4)
v_mfma_f32_16x16x32_bf16 v[16:19], v[176:179], a[208:211], 0
v_mfma_f32_16x16x32_bf16 v[24:27], v[176:179], a[212:215], 0
ds_read_b128 v[200:203], v233 offset:8192
v_mfma_f32_16x16x32_bf16 v[20:23], v[180:183], a[208:211], 0
s_add_u32 s52, s78, 1966080
s_add_u32 m0, s48, 90112
v_mfma_f32_16x16x32_bf16 v[28:31], v[180:183], a[212:215], 0
ds_read_b128 v[204:207], v233 offset:10240
buffer_load_dwordx4 v228, s[36:39], s52 offen lds
s_waitcnt lgkmcnt(4)
v_mfma_f32_16x16x32_bf16 v[16:19], v[184:187], a[216:219], v[16:19]
v_mfma_f32_16x16x32_bf16 v[24:27], v[184:187], a[220:223], v[24:27]
ds_read_b128 v[176:179], v232 offset:16384
buffer_load_dwordx4 v229, s[36:39], s52 offen offset:1024 lds
v_mfma_f32_16x16x32_bf16 v[20:23], v[188:191], a[216:219], v[20:23]
v_mfma_f32_16x16x32_bf16 v[28:31], v[188:191], a[220:223], v[28:31]
ds_read_b128 v[180:183], v232 offset:18432
s_add_u32 s52, s78, 2048000
s_add_u32 m0, s48, 98304
s_waitcnt lgkmcnt(4)
v_mfma_f32_16x16x32_bf16 v[16:19], v[192:195], a[224:227], v[16:19]
buffer_load_dwordx4 v228, s[36:39], s52 offen lds
v_mfma_f32_16x16x32_bf16 v[24:27], v[192:195], a[228:231], v[24:27]
ds_read_b128 v[184:187], v233 offset:16384
v_mfma_f32_16x16x32_bf16 v[20:23], v[196:199], a[224:227], v[20:23]
v_mfma_f32_16x16x32_bf16 v[28:31], v[196:199], a[228:231], v[28:31]
ds_read_b128 v[188:191], v233 offset:18432
buffer_load_dwordx4 v229, s[36:39], s52 offen offset:1024 lds
s_waitcnt lgkmcnt(4)
v_mfma_f32_16x16x32_bf16 v[16:19], v[200:203], a[232:235], v[16:19]
v_mfma_f32_16x16x32_bf16 v[24:27], v[200:203], a[236:239], v[24:27]
s_add_u32 s52, s78, 2129920
s_add_u32 m0, s48, 106496
v_mfma_f32_16x16x32_bf16 v[20:23], v[204:207], a[232:235], v[20:23]
buffer_load_dwordx4 v228, s[36:39], s52 offen lds
v_mfma_f32_16x16x32_bf16 v[28:31], v[204:207], a[236:239], v[28:31]
v_add_u32 v236, 139264, v230
v_xor_b32 v237, 32, v236
s_waitcnt lgkmcnt(2)
v_mfma_f32_16x16x32_bf16 v[16:19], v[176:179], a[240:243], v[16:19]
v_mfma_f32_16x16x32_bf16 v[24:27], v[176:179], a[244:247], v[24:27]
buffer_load_dwordx4 v229, s[36:39], s52 offen offset:1024 lds
s_waitcnt vmcnt(12) lgkmcnt(0)
s_barrier
ds_read_b64_tr_b16 v[192:193], v236 offset:0
ds_read_b64_tr_b16 v[194:195], v237 offset:512
ds_read_b64_tr_b16 v[196:197], v237 offset:0
ds_read_b64_tr_b16 v[198:199], v236 offset:512
ds_read_b64_tr_b16 v[200:201], v236 offset:4096
ds_read_b64_tr_b16 v[202:203], v237 offset:4608
v_mfma_f32_16x16x32_bf16 v[20:23], v[180:183], a[240:243], v[20:23]
s_mov_b32 s52, 4792320
s_add_u32 m0, s48, 114688
s_nop 0
buffer_load_dwordx4 v224, s[24:27], s52 offen nt lds
v_mfma_f32_16x16x32_bf16 v[28:31], v[180:183], a[244:247], v[28:31]
ds_read_b64_tr_b16 v[204:205], v237 offset:4096
v_mfma_f32_16x16x32_bf16 v[16:19], v[184:187], a[248:251], v[16:19]
ds_read_b64_tr_b16 v[206:207], v236 offset:4608
buffer_load_dwordx4 v225, s[24:27], s52 offen offset:1024 nt lds
v_mfma_f32_16x16x32_bf16 v[24:27], v[184:187], a[252:255], v[24:27]
ds_read_b64_tr_b16 v[176:177], v236 offset:8192
s_add_u32 m0, s48, 122752
v_mfma_f32_16x16x32_bf16 v[20:23], v[188:191], a[248:251], v[20:23]
ds_read_b64_tr_b16 v[178:179], v237 offset:8704
buffer_load_dwordx4 v224, s[24:27], s52 offen offset:128 nt lds
v_mfma_f32_16x16x32_bf16 v[28:31], v[188:191], a[252:255], v[28:31]
ds_read_b64_tr_b16 v[180:181], v237 offset:8192
s_waitcnt lgkmcnt(7)
v_mfma_f32_16x16x32_bf16 a[112:115], v[192:195], v[128:131], a[112:115]
ds_read_b64_tr_b16 v[182:183], v236 offset:8704
buffer_load_dwordx4 v225, s[24:27], s52 offen offset:1152 nt lds
v_mfma_f32_16x16x32_bf16 a[120:123], v[192:195], v[132:135], a[120:123]
ds_read_b64_tr_b16 v[184:185], v236 offset:12288
s_add_u32 m0, s48, 130816
v_mfma_f32_16x16x32_bf16 a[116:119], v[196:199], v[128:131], a[116:119]
ds_read_b64_tr_b16 v[186:187], v237 offset:12800
buffer_load_dwordx4 v224, s[24:27], s52 offen offset:256 nt lds
v_mfma_f32_16x16x32_bf16 a[124:127], v[196:199], v[132:135], a[124:127]
ds_read_b64_tr_b16 v[188:189], v237 offset:12288
v_max3_f32 v240, v240, v16, v17
s_waitcnt lgkmcnt(7)
v_mfma_f32_16x16x32_bf16 a[112:115], v[200:203], v[136:139], a[112:115]
ds_read_b64_tr_b16 v[190:191], v236 offset:12800
v_max3_f32 v241, v241, v24, v25
v_mfma_f32_16x16x32_bf16 a[120:123], v[200:203], v[140:143], a[120:123]
ds_read_b64_tr_b16 v[192:193], v236 offset:16384
buffer_load_dwordx4 v225, s[24:27], s52 offen offset:1280 nt lds
v_mfma_f32_16x16x32_bf16 a[116:119], v[204:207], v[136:139], a[116:119]
ds_read_b64_tr_b16 v[194:195], v237 offset:16896
v_max3_f32 v240, v240, v18, v19
v_mfma_f32_16x16x32_bf16 a[124:127], v[204:207], v[140:143], a[124:127]
ds_read_b64_tr_b16 v[196:197], v237 offset:16384
v_max3_f32 v241, v241, v26, v27
s_waitcnt lgkmcnt(7)
v_mfma_f32_16x16x32_bf16 a[112:115], v[176:179], v[144:147], a[112:115]
ds_read_b64_tr_b16 v[198:199], v236 offset:16896
v_max3_f32 v240, v240, v20, v21
v_mfma_f32_16x16x32_bf16 a[120:123], v[176:179], v[148:151], a[120:123]
ds_read_b64_tr_b16 v[200:201], v236 offset:20480
v_max3_f32 v241, v241, v28, v29
v_mfma_f32_16x16x32_bf16 a[116:119], v[180:183], v[144:147], a[116:119]
ds_read_b64_tr_b16 v[202:203], v237 offset:20992
v_max3_f32 v240, v240, v22, v23
v_mfma_f32_16x16x32_bf16 a[124:127], v[180:183], v[148:151], a[124:127]
ds_read_b64_tr_b16 v[204:205], v237 offset:20480
v_max3_f32 v241, v241, v30, v31
s_waitcnt lgkmcnt(7)
v_mfma_f32_16x16x32_bf16 a[112:115], v[184:187], v[152:155], a[112:115]
ds_read_b64_tr_b16 v[206:207], v236 offset:20992
v_mfma_f32_16x16x32_bf16 a[120:123], v[184:187], v[156:159], a[120:123]
v_mfma_f32_16x16x32_bf16 a[116:119], v[188:191], v[152:155], a[116:119]
v_mfma_f32_16x16x32_bf16 a[124:127], v[188:191], v[156:159], a[124:127]
s_add_u32 s53, s49, 65536
v_add_u32 v232, s53, v231
s_waitcnt lgkmcnt(4)
v_mfma_f32_16x16x32_bf16 a[112:115], v[192:195], v[160:163], a[112:115]
v_xor_b32 v233, 64, v232
v_mfma_f32_16x16x32_bf16 a[120:123], v[192:195], v[164:167], a[120:123]
s_waitcnt vmcnt(12) lgkmcnt(0)
s_barrier
ds_read_b128 v[176:179], v232 offset:0
ds_read_b128 v[180:183], v232 offset:2048
ds_read_b128 v[184:187], v233 offset:0
v_mfma_f32_16x16x32_bf16 a[116:119], v[196:199], v[160:163], a[116:119]
v_mfma_f32_16x16x32_bf16 a[124:127], v[196:199], v[164:167], a[124:127]
ds_read_b128 v[188:191], v233 offset:2048
v_mfma_f32_16x16x32_bf16 a[112:115], v[200:203], v[168:171], a[112:115]
v_mfma_f32_16x16x32_bf16 a[120:123], v[200:203], v[172:175], a[120:123]
ds_read_b128 v[192:195], v232 offset:8192
v_mfma_f32_16x16x32_bf16 a[116:119], v[204:207], v[168:171], a[116:119]
v_mfma_f32_16x16x32_bf16 a[124:127], v[204:207], v[172:175], a[124:127]
ds_read_b128 v[196:199], v232 offset:10240
s_waitcnt lgkmcnt(4)
v_mfma_f32_16x16x32_bf16 v[32:35], v[176:179], a[208:211], 0
v_mfma_f32_16x16x32_bf16 v[40:43], v[176:179], a[212:215], 0
ds_read_b128 v[200:203], v233 offset:8192
v_mfma_f32_16x16x32_bf16 v[36:39], v[180:183], a[208:211], 0
s_add_u32 s52, s79, 1966080
s_add_u32 m0, s48, 139264
v_mfma_f32_16x16x32_bf16 v[44:47], v[180:183], a[212:215], 0
ds_read_b128 v[204:207], v233 offset:10240
buffer_load_dwordx4 v228, s[36:39], s52 offen lds
s_waitcnt lgkmcnt(4)
v_mfma_f32_16x16x32_bf16 v[32:35], v[184:187], a[216:219], v[32:35]
v_mfma_f32_16x16x32_bf16 v[40:43], v[184:187], a[220:223], v[40:43]
ds_read_b128 v[176:179], v232 offset:16384
buffer_load_dwordx4 v229, s[36:39], s52 offen offset:1024 lds
v_mfma_f32_16x16x32_bf16 v[36:39], v[188:191], a[216:219], v[36:39]
v_mfma_f32_16x16x32_bf16 v[44:47], v[188:191], a[220:223], v[44:47]
ds_read_b128 v[180:183], v232 offset:18432
s_add_u32 s52, s79, 2048000
s_add_u32 m0, s48, 147456
s_waitcnt lgkmcnt(4)
v_mfma_f32_16x16x32_bf16 v[32:35], v[192:195], a[224:227], v[32:35]
buffer_load_dwordx4 v228, s[36:39], s52 offen lds
v_mfma_f32_16x16x32_bf16 v[40:43], v[192:195], a[228:231], v[40:43]
ds_read_b128 v[184:187], v233 offset:16384
v_mfma_f32_16x16x32_bf16 v[36:39], v[196:199], a[224:227], v[36:39]
v_mfma_f32_16x16x32_bf16 v[44:47], v[196:199], a[228:231], v[44:47]
ds_read_b128 v[188:191], v233 offset:18432
buffer_load_dwordx4 v229, s[36:39], s52 offen offset:1024 lds
s_waitcnt lgkmcnt(4)
v_mfma_f32_16x16x32_bf16 v[32:35], v[200:203], a[232:235], v[32:35]
v_mfma_f32_16x16x32_bf16 v[40:43], v[200:203], a[236:239], v[40:43]
s_add_u32 s52, s79, 2129920
s_add_u32 m0, s48, 155648
v_mfma_f32_16x16x32_bf16 v[36:39], v[204:207], a[232:235], v[36:39]
buffer_load_dwordx4 v228, s[36:39], s52 offen lds
v_mfma_f32_16x16x32_bf16 v[44:47], v[204:207], a[236:239], v[44:47]
v_add_u32 v236, 90112, v230
v_xor_b32 v237, 32, v236
s_waitcnt lgkmcnt(2)
v_mfma_f32_16x16x32_bf16 v[32:35], v[176:179], a[240:243], v[32:35]
v_mfma_f32_16x16x32_bf16 v[40:43], v[176:179], a[244:247], v[40:43]
buffer_load_dwordx4 v229, s[36:39], s52 offen offset:1024 lds
s_waitcnt vmcnt(12) lgkmcnt(0)
s_barrier
s_cmp_eq_u32 s58, 0
s_cbranch_scc0 L_chk_skip
v_mov_b32 v253, 0
buffer_load_dword v252, v253, s[12:15], 0 offen sc1
L_chk_skip:
ds_read_b64_tr_b16 v[192:193], v236 offset:0
ds_read_b64_tr_b16 v[194:195], v237 offset:512
ds_read_b64_tr_b16 v[196:197], v237 offset:0
ds_read_b64_tr_b16 v[198:199], v236 offset:512
ds_read_b64_tr_b16 v[200:201], v236 offset:4096
ds_read_b64_tr_b16 v[202:203], v237 offset:4608
v_mfma_f32_16x16x32_bf16 v[36:39], v[180:183], a[240:243], v[36:39]
s_mov_b32 s52, 4816896
s_add_u32 m0, s48, 65536
s_nop 0
buffer_load_dwordx4 v224, s[24:27], s52 offen nt lds
v_mfma_f32_16x16x32_bf16 v[44:47], v[180:183], a[244:247], v[44:47]
ds_read_b64_tr_b16 v[204:205], v237 offset:4096
v_mfma_f32_16x16x32_bf16 v[32:35], v[184:187], a[248:251], v[32:35]
ds_read_b64_tr_b16 v[206:207], v236 offset:4608
buffer_load_dwordx4 v225, s[24:27], s52 offen offset:1024 nt lds
v_mfma_f32_16x16x32_bf16 v[40:43], v[184:187], a[252:255], v[40:43]
ds_read_b64_tr_b16 v[176:177], v236 offset:8192
s_add_u32 m0, s48, 73600
v_mfma_f32_16x16x32_bf16 v[36:39], v[188:191], a[248:251], v[36:39]
ds_read_b64_tr_b16 v[178:179], v237 offset:8704
buffer_load_dwordx4 v224, s[24:27], s52 offen offset:128 nt lds
v_mfma_f32_16x16x32_bf16 v[44:47], v[188:191], a[252:255], v[44:47]
ds_read_b64_tr_b16 v[180:181], v237 offset:8192
s_waitcnt lgkmcnt(7)
v_mfma_f32_16x16x32_bf16 a[128:131], v[192:195], v[128:131], a[128:131]
ds_read_b64_tr_b16 v[182:183], v236 offset:8704
buffer_load_dwordx4 v225, s[24:27], s52 offen offset:1152 nt lds
v_mfma_f32_16x16x32_bf16 a[136:139], v[192:195], v[132:135], a[136:139]
ds_read_b64_tr_b16 v[184:185], v236 offset:12288
s_add_u32 m0, s48, 81664
v_mfma_f32_16x16x32_bf16 a[132:135], v[196:199], v[128:131], a[132:135]
ds_read_b64_tr_b16 v[186:187], v237 offset:12800
buffer_load_dwordx4 v224, s[24:27], s52 offen offset:256 nt lds
v_mfma_f32_16x16x32_bf16 a[140:143], v[196:199], v[132:135], a[140:143]
ds_read_b64_tr_b16 v[188:189], v237 offset:12288
v_max3_f32 v240, v240, v32, v33
s_waitcnt lgkmcnt(7)
v_mfma_f32_16x16x32_bf16 a[128:131], v[200:203], v[136:139], a[128:131]
ds_read_b64_tr_b16 v[190:191], v236 offset:12800
v_max3_f32 v241, v241, v40, v41
v_mfma_f32_16x16x32_bf16 a[136:139], v[200:203], v[140:143], a[136:139]
ds_read_b64_tr_b16 v[192:193], v236 offset:16384
buffer_load_dwordx4 v225, s[24:27], s52 offen offset:1280 nt lds
v_mfma_f32_16x16x32_bf16 a[132:135], v[204:207], v[136:139], a[132:135]
ds_read_b64_tr_b16 v[194:195], v237 offset:16896
v_max3_f32 v240, v240, v34, v35
v_mfma_f32_16x16x32_bf16 a[140:143], v[204:207], v[140:143], a[140:143]
ds_read_b64_tr_b16 v[196:197], v237 offset:16384
v_max3_f32 v241, v241, v42, v43
s_waitcnt lgkmcnt(7)
v_mfma_f32_16x16x32_bf16 a[128:131], v[176:179], v[144:147], a[128:131]
ds_read_b64_tr_b16 v[198:199], v236 offset:16896
v_max3_f32 v240, v240, v36, v37
v_mfma_f32_16x16x32_bf16 a[136:139], v[176:179], v[148:151], a[136:139]
ds_read_b64_tr_b16 v[200:201], v236 offset:20480
v_max3_f32 v241, v241, v44, v45
v_mfma_f32_16x16x32_bf16 a[132:135], v[180:183], v[144:147], a[132:135]
ds_read_b64_tr_b16 v[202:203], v237 offset:20992
v_max3_f32 v240, v240, v38, v39
v_mfma_f32_16x16x32_bf16 a[140:143], v[180:183], v[148:151], a[140:143]
ds_read_b64_tr_b16 v[204:205], v237 offset:20480
v_max3_f32 v241, v241, v46, v47
s_waitcnt lgkmcnt(7)
v_mfma_f32_16x16x32_bf16 a[128:131], v[184:187], v[152:155], a[128:131]
ds_read_b64_tr_b16 v[206:207], v236 offset:20992
v_mfma_f32_16x16x32_bf16 a[136:139], v[184:187], v[156:159], a[136:139]
v_mfma_f32_16x16x32_bf16 a[132:135], v[188:191], v[152:155], a[132:135]
v_mfma_f32_16x16x32_bf16 a[140:143], v[188:191], v[156:159], a[140:143]
s_add_u32 s53, s49, 114688
v_add_u32 v232, s53, v231
s_waitcnt lgkmcnt(4)
v_mfma_f32_16x16x32_bf16 a[128:131], v[192:195], v[160:163], a[128:131]
v_xor_b32 v233, 64, v232
v_mfma_f32_16x16x32_bf16 a[136:139], v[192:195], v[164:167], a[136:139]
s_waitcnt vmcnt(12) lgkmcnt(0)
s_barrier
ds_read_b128 v[176:179], v232 offset:0
ds_read_b128 v[180:183], v232 offset:2048
ds_read_b128 v[184:187], v233 offset:0
v_mfma_f32_16x16x32_bf16 a[132:135], v[196:199], v[160:163], a[132:135]
v_mfma_f32_16x16x32_bf16 a[140:143], v[196:199], v[164:167], a[140:143]
ds_read_b128 v[188:191], v233 offset:2048
v_mfma_f32_16x16x32_bf16 a[128:131], v[200:203], v[168:171], a[128:131]
v_mfma_f32_16x16x32_bf16 a[136:139], v[200:203], v[172:175], a[136:139]
ds_read_b128 v[192:195], v232 offset:8192
v_mfma_f32_16x16x32_bf16 a[132:135], v[204:207], v[168:171], a[132:135]
v_mfma_f32_16x16x32_bf16 a[140:143], v[204:207], v[172:175], a[140:143]
ds_read_b128 v[196:199], v232 offset:10240
s_waitcnt lgkmcnt(4)
v_mfma_f32_16x16x32_bf16 v[48:51], v[176:179], a[208:211], 0
v_mfma_f32_16x16x32_bf16 v[56:59], v[176:179], a[212:215], 0
ds_read_b128 v[200:203], v233 offset:8192
v_mfma_f32_16x16x32_bf16 v[52:55], v[180:183], a[208:211], 0
s_add_u32 s52, s70, 3932160
s_add_u32 m0, s48, 90112
v_mfma_f32_16x16x32_bf16 v[60:63], v[180:183], a[212:215], 0
ds_read_b128 v[204:207], v233 offset:10240
buffer_load_dwordx4 v228, s[36:39], s52 offen lds
s_waitcnt lgkmcnt(4)
v_mfma_f32_16x16x32_bf16 v[48:51], v[184:187], a[216:219], v[48:51]
v_mfma_f32_16x16x32_bf16 v[56:59], v[184:187], a[220:223], v[56:59]
ds_read_b128 v[176:179], v232 offset:16384
buffer_load_dwordx4 v229, s[36:39], s52 offen offset:1024 lds
v_mfma_f32_16x16x32_bf16 v[52:55], v[188:191], a[216:219], v[52:55]
v_mfma_f32_16x16x32_bf16 v[60:63], v[188:191], a[220:223], v[60:63]
ds_read_b128 v[180:183], v232 offset:18432
s_add_u32 s52, s70, 4014080
s_add_u32 m0, s48, 98304
s_waitcnt lgkmcnt(4)
v_mfma_f32_16x16x32_bf16 v[48:51], v[192:195], a[224:227], v[48:51]
buffer_load_dwordx4 v228, s[36:39], s52 offen lds
v_mfma_f32_16x16x32_bf16 v[56:59], v[192:195], a[228:231], v[56:59]
ds_read_b128 v[184:187], v233 offset:16384
v_mfma_f32_16x16x32_bf16 v[52:55], v[196:199], a[224:227], v[52:55]
v_mfma_f32_16x16x32_bf16 v[60:63], v[196:199], a[228:231], v[60:63]
ds_read_b128 v[188:191], v233 offset:18432
buffer_load_dwordx4 v229, s[36:39], s52 offen offset:1024 lds
s_waitcnt lgkmcnt(4)
v_mfma_f32_16x16x32_bf16 v[48:51], v[200:203], a[232:235], v[48:51]
v_mfma_f32_16x16x32_bf16 v[56:59], v[200:203], a[236:239], v[56:59]
s_add_u32 s52, s70, 4096000
s_add_u32 m0, s48, 106496
v_mfma_f32_16x16x32_bf16 v[52:55], v[204:207], a[232:235], v[52:55]
buffer_load_dwordx4 v228, s[36:39], s52 offen lds
v_mfma_f32_16x16x32_bf16 v[60:63], v[204:207], a[236:239], v[60:63]
v_add_u32 v236, 139264, v230
v_xor_b32 v237, 32, v236
s_waitcnt lgkmcnt(2)
v_mfma_f32_16x16x32_bf16 v[48:51], v[176:179], a[240:243], v[48:51]
v_mfma_f32_16x16x32_bf16 v[56:59], v[176:179], a[244:247], v[56:59]
buffer_load_dwordx4 v229, s[36:39], s52 offen offset:1024 lds
s_waitcnt vmcnt(12) lgkmcnt(0)
s_barrier
ds_read_b64_tr_b16 v[192:193], v236 offset:0
ds_read_b64_tr_b16 v[194:195], v237 offset:512
ds_read_b64_tr_b16 v[196:197], v237 offset:0
ds_read_b64_tr_b16 v[198:199], v236 offset:512
ds_read_b64_tr_b16 v[200:201], v236 offset:4096
ds_read_b64_tr_b16 v[202:203], v237 offset:4608
v_mfma_f32_16x16x32_bf16 v[52:55], v[180:183], a[240:243], v[52:55]
s_mov_b32 s52, 4841472
s_add_u32 m0, s48, 114688
s_nop 0
buffer_load_dwordx4 v224, s[24:27], s52 offen nt lds
v_mfma_f32_16x16x32_bf16 v[60:63], v[180:183], a[244:247], v[60:63]
ds_read_b64_tr_b16 v[204:205], v237 offset:4096
v_mfma_f32_16x16x32_bf16 v[48:51], v[184:187], a[248:251], v[48:51]
ds_read_b64_tr_b16 v[206:207], v236 offset:4608
buffer_load_dwordx4 v225, s[24:27], s52 offen offset:1024 nt lds
v_mfma_f32_16x16x32_bf16 v[56:59], v[184:187], a[252:255], v[56:59]
ds_read_b64_tr_b16 v[176:177], v236 offset:8192
s_add_u32 m0, s48, 122752
v_mfma_f32_16x16x32_bf16 v[52:55], v[188:191], a[248:251], v[52:55]
ds_read_b64_tr_b16 v[178:179], v237 offset:8704
buffer_load_dwordx4 v224, s[24:27], s52 offen offset:128 nt lds
v_mfma_f32_16x16x32_bf16 v[60:63], v[188:191], a[252:255], v[60:63]
ds_read_b64_tr_b16 v[180:181], v237 offset:8192
s_waitcnt lgkmcnt(7)
v_mfma_f32_16x16x32_bf16 a[144:147], v[192:195], v[128:131], a[144:147]
ds_read_b64_tr_b16 v[182:183], v236 offset:8704
buffer_load_dwordx4 v225, s[24:27], s52 offen offset:1152 nt lds
v_mfma_f32_16x16x32_bf16 a[152:155], v[192:195], v[132:135], a[152:155]
ds_read_b64_tr_b16 v[184:185], v236 offset:12288
s_add_u32 m0, s48, 130816
v_mfma_f32_16x16x32_bf16 a[148:151], v[196:199], v[128:131], a[148:151]
ds_read_b64_tr_b16 v[186:187], v237 offset:12800
buffer_load_dwordx4 v224, s[24:27], s52 offen offset:256 nt lds
v_mfma_f32_16x16x32_bf16 a[156:159], v[196:199], v[132:135], a[156:159]
ds_read_b64_tr_b16 v[188:189], v237 offset:12288
v_max3_f32 v240, v240, v48, v49
s_waitcnt lgkmcnt(7)
v_mfma_f32_16x16x32_bf16 a[144:147], v[200:203], v[136:139], a[144:147]
ds_read_b64_tr_b16 v[190:191], v236 offset:12800
v_max3_f32 v241, v241, v56, v57
v_mfma_f32_16x16x32_bf16 a[152:155], v[200:203], v[140:143], a[152:155]
ds_read_b64_tr_b16 v[192:193], v236 offset:16384
buffer_load_dwordx4 v225, s[24:27], s52 offen offset:1280 nt lds
v_mfma_f32_16x16x32_bf16 a[148:151], v[204:207], v[136:139], a[148:151]
ds_read_b64_tr_b16 v[194:195], v237 offset:16896
v_max3_f32 v240, v240, v50, v51
v_mfma_f32_16x16x32_bf16 a[156:159], v[204:207], v[140:143], a[156:159]
ds_read_b64_tr_b16 v[196:197], v237 offset:16384
v_max3_f32 v241, v241, v58, v59
s_waitcnt lgkmcnt(7)
v_mfma_f32_16x16x32_bf16 a[144:147], v[176:179], v[144:147], a[144:147]
ds_read_b64_tr_b16 v[198:199], v236 offset:16896
v_max3_f32 v240, v240, v52, v53
v_mfma_f32_16x16x32_bf16 a[152:155], v[176:179], v[148:151], a[152:155]
ds_read_b64_tr_b16 v[200:201], v236 offset:20480
v_max3_f32 v241, v241, v60, v61
v_mfma_f32_16x16x32_bf16 a[148:151], v[180:183], v[144:147], a[148:151]
ds_read_b64_tr_b16 v[202:203], v237 offset:20992
v_max3_f32 v240, v240, v54, v55
v_mfma_f32_16x16x32_bf16 a[156:159], v[180:183], v[148:151], a[156:159]
ds_read_b64_tr_b16 v[204:205], v237 offset:20480
v_max3_f32 v241, v241, v62, v63
s_waitcnt lgkmcnt(7)
v_mfma_f32_16x16x32_bf16 a[144:147], v[184:187], v[152:155], a[144:147]
ds_read_b64_tr_b16 v[206:207], v236 offset:20992
v_mfma_f32_16x16x32_bf16 a[152:155], v[184:187], v[156:159], a[152:155]
v_mfma_f32_16x16x32_bf16 a[148:151], v[188:191], v[152:155], a[148:151]
v_mfma_f32_16x16x32_bf16 a[156:159], v[188:191], v[156:159], a[156:159]
s_add_u32 s53, s49, 65536
v_add_u32 v232, s53, v231
s_waitcnt lgkmcnt(4)
v_mfma_f32_16x16x32_bf16 a[144:147], v[192:195], v[160:163], a[144:147]
v_xor_b32 v233, 64, v232
v_mfma_f32_16x16x32_bf16 a[152:155], v[192:195], v[164:167], a[152:155]
s_waitcnt vmcnt(12) lgkmcnt(0)
s_barrier
ds_read_b128 v[176:179], v232 offset:0
ds_read_b128 v[180:183], v232 offset:2048
ds_read_b128 v[184:187], v233 offset:0
v_mfma_f32_16x16x32_bf16 a[148:151], v[196:199], v[160:163], a[148:151]
v_mfma_f32_16x16x32_bf16 a[156:159], v[196:199], v[164:167], a[156:159]
ds_read_b128 v[188:191], v233 offset:2048
v_mfma_f32_16x16x32_bf16 a[144:147], v[200:203], v[168:171], a[144:147]
v_mfma_f32_16x16x32_bf16 a[152:155], v[200:203], v[172:175], a[152:155]
ds_read_b128 v[192:195], v232 offset:8192
v_mfma_f32_16x16x32_bf16 a[148:151], v[204:207], v[168:171], a[148:151]
v_mfma_f32_16x16x32_bf16 a[156:159], v[204:207], v[172:175], a[156:159]
ds_read_b128 v[196:199], v232 offset:10240
s_waitcnt lgkmcnt(4)
v_mfma_f32_16x16x32_bf16 v[64:67], v[176:179], a[208:211], 0
v_mfma_f32_16x16x32_bf16 v[72:75], v[176:179], a[212:215], 0
ds_read_b128 v[200:203], v233 offset:8192
v_mfma_f32_16x16x32_bf16 v[68:71], v[180:183], a[208:211], 0
s_add_u32 s52, s71, 3932160
s_add_u32 m0, s48, 139264
v_mfma_f32_16x16x32_bf16 v[76:79], v[180:183], a[212:215], 0
ds_read_b128 v[204:207], v233 offset:10240
buffer_load_dwordx4 v228, s[36:39], s52 offen lds
s_waitcnt lgkmcnt(4)
v_mfma_f32_16x16x32_bf16 v[64:67], v[184:187], a[216:219], v[64:67]
v_mfma_f32_16x16x32_bf16 v[72:75], v[184:187], a[220:223], v[72:75]
ds_read_b128 v[176:179], v232 offset:16384
buffer_load_dwordx4 v229, s[36:39], s52 offen offset:1024 lds
v_mfma_f32_16x16x32_bf16 v[68:71], v[188:191], a[216:219], v[68:71]
v_mfma_f32_16x16x32_bf16 v[76:79], v[188:191], a[220:223], v[76:79]
ds_read_b128 v[180:183], v232 offset:18432
s_add_u32 s52, s71, 4014080
s_add_u32 m0, s48, 147456
s_waitcnt lgkmcnt(4)
v_mfma_f32_16x16x32_bf16 v[64:67], v[192:195], a[224:227], v[64:67]
buffer_load_dwordx4 v228, s[36:39], s52 offen lds
v_mfma_f32_16x16x32_bf16 v[72:75], v[192:195], a[228:231], v[72:75]
ds_read_b128 v[184:187], v233 offset:16384
v_mfma_f32_16x16x32_bf16 v[68:71], v[196:199], a[224:227], v[68:71]
v_mfma_f32_16x16x32_bf16 v[76:79], v[196:199], a[228:231], v[76:79]
ds_read_b128 v[188:191], v233 offset:18432
buffer_load_dwordx4 v229, s[36:39], s52 offen offset:1024 lds
s_waitcnt lgkmcnt(4)
v_mfma_f32_16x16x32_bf16 v[64:67], v[200:203], a[232:235], v[64:67]
v_mfma_f32_16x16x32_bf16 v[72:75], v[200:203], a[236:239], v[72:75]
s_add_u32 s52, s71, 4096000
s_add_u32 m0, s48, 155648
v_mfma_f32_16x16x32_bf16 v[68:71], v[204:207], a[232:235], v[68:71]
buffer_load_dwordx4 v228, s[36:39], s52 offen lds
v_mfma_f32_16x16x32_bf16 v[76:79], v[204:207], a[236:239], v[76:79]
v_add_u32 v236, 90112, v230
v_xor_b32 v237, 32, v236
s_waitcnt lgkmcnt(2)
v_mfma_f32_16x16x32_bf16 v[64:67], v[176:179], a[240:243], v[64:67]
v_mfma_f32_16x16x32_bf16 v[72:75], v[176:179], a[244:247], v[72:75]
buffer_load_dwordx4 v229, s[36:39], s52 offen offset:1024 lds
s_waitcnt vmcnt(12) lgkmcnt(0)
s_barrier
ds_read_b128 a[160:163], v238 offset:0
ds_read_b128 a[164:167], v238 offset:1024
ds_read_b64_tr_b16 v[192:193], v236 offset:0
ds_read_b64_tr_b16 v[194:195], v237 offset:512
ds_read_b64_tr_b16 v[196:197], v237 offset:0
ds_read_b64_tr_b16 v[198:199], v236 offset:512
ds_read_b128 a[168:171], v238 offset:2048
ds_read_b128 a[172:175], v238 offset:3072
ds_read_b64_tr_b16 v[200:201], v236 offset:4096
ds_read_b64_tr_b16 v[202:203], v237 offset:4608
v_mfma_f32_16x16x32_bf16 v[68:71], v[180:183], a[240:243], v[68:71]
s_mov_b32 s52, 4866048
s_add_u32 m0, s48, 65536
s_nop 0
buffer_load_dwordx4 v224, s[24:27], s52 offen nt lds
v_mfma_f32_16x16x32_bf16 v[76:79], v[180:183], a[244:247], v[76:79]
ds_read_b64_tr_b16 v[204:205], v237 offset:4096
v_mfma_f32_16x16x32_bf16 v[64:67], v[184:187], a[248:251], v[64:67]
ds_read_b64_tr_b16 v[206:207], v236 offset:4608
buffer_load_dwordx4 v225, s[24:27], s52 offen offset:1024 nt lds
v_mfma_f32_16x16x32_bf16 v[72:75], v[184:187], a[252:255], v[72:75]
ds_read_b128 a[176:179], v238 offset:8192
ds_read_b128 a[180:183], v238 offset:9216
s_add_u32 m0, s48, 73600
v_mfma_f32_16x16x32_bf16 v[68:71], v[188:191], a[248:251], v[68:71]
ds_read_b64_tr_b16 v[176:177], v236 offset:8192
ds_read_b64_tr_b16 v[178:179], v237 offset:8704
buffer_load_dwordx4 v224, s[24:27], s52 offen offset:128 nt lds
v_mfma_f32_16x16x32_bf16 v[76:79], v[188:191], a[252:255], v[76:79]
ds_read_b64_tr_b16 v[180:181], v237 offset:8192
s_waitcnt lgkmcnt(11)
v_mfma_f32_16x16x32_bf16 a[0:3], v[192:195], a[160:163], a[0:3]
ds_read_b64_tr_b16 v[182:183], v236 offset:8704
buffer_load_dwordx4 v225, s[24:27], s52 offen offset:1152 nt lds
v_mfma_f32_16x16x32_bf16 a[8:11], v[192:195], a[164:167], a[8:11]
ds_read_b128 a[184:187], v238 offset:10240
ds_read_b128 a[188:191], v238 offset:11264
s_add_u32 m0, s48, 81664
v_mfma_f32_16x16x32_bf16 a[4:7], v[196:199], a[160:163], a[4:7]
ds_read_b64_tr_b16 v[184:185], v236 offset:12288
ds_read_b64_tr_b16 v[186:187], v237 offset:12800
buffer_load_dwordx4 v224, s[24:27], s52 offen offset:256 nt lds
v_mfma_f32_16x16x32_bf16 a[12:15], v[196:199], a[164:167], a[12:15]
ds_read_b64_tr_b16 v[188:189], v237 offset:12288
v_max3_f32 v240, v240, v64, v65
s_waitcnt lgkmcnt(11)
v_mfma_f32_16x16x32_bf16 a[0:3], v[200:203], a[168:171], a[0:3]
ds_read_b64_tr_b16 v[190:191], v236 offset:12800
v_max3_f32 v241, v241, v72, v73
v_mfma_f32_16x16x32_bf16 a[8:11], v[200:203], a[172:175], a[8:11]
ds_read_b128 a[192:195], v238 offset:16384
ds_read_b128 a[196:199], v238 offset:17408
buffer_load_dwordx4 v225, s[24:27], s52 offen offset:1280 nt lds
v_mfma_f32_16x16x32_bf16 a[4:7], v[204:207], a[168:171], a[4:7]
ds_read_b64_tr_b16 v[192:193], v236 offset:16384
ds_read_b64_tr_b16 v[194:195], v237 offset:16896
v_mfma_f32_16x16x32_bf16 a[12:15], v[204:207], a[172:175], a[12:15]
ds_read_b64_tr_b16 v[196:197], v237 offset:16384
v_max3_f32 v240, v240, v66, v67
s_waitcnt lgkmcnt(11)
v_mfma_f32_16x16x32_bf16 a[0:3], v[176:179], a[176:179], a[0:3]
ds_read_b64_tr_b16 v[198:199], v236 offset:16896
v_max3_f32 v241, v241, v74, v75
v_mfma_f32_16x16x32_bf16 a[8:11], v[176:179], a[180:183], a[8:11]
ds_read_b128 a[200:203], v238 offset:18432
ds_read_b128 a[204:207], v238 offset:19456
v_mfma_f32_16x16x32_bf16 a[4:7], v[180:183], a[176:179], a[4:7]
ds_read_b64_tr_b16 v[200:201], v236 offset:20480
ds_read_b64_tr_b16 v[202:203], v237 offset:20992
v_mfma_f32_16x16x32_bf16 a[12:15], v[180:183], a[180:183], a[12:15]
ds_read_b64_tr_b16 v[204:205], v237 offset:20480
v_max3_f32 v240, v240, v68, v69
s_waitcnt lgkmcnt(11)
v_mfma_f32_16x16x32_bf16 a[0:3], v[184:187], a[184:187], a[0:3]
ds_read_b64_tr_b16 v[206:207], v236 offset:20992
v_max3_f32 v241, v241, v76, v77
v_mfma_f32_16x16x32_bf16 a[8:11], v[184:187], a[188:191], a[8:11]
v_max3_f32 v240, v240, v70, v71
v_max3_f32 v241, v241, v78, v79
v_mfma_f32_16x16x32_bf16 a[4:7], v[188:191], a[184:187], a[4:7]
v_mfma_f32_16x16x32_bf16 a[12:15], v[188:191], a[188:191], a[12:15]
s_add_u32 s53, s49, 114688
v_add_u32 v232, s53, v231
s_waitcnt lgkmcnt(6)
v_mfma_f32_16x16x32_bf16 a[0:3], v[192:195], a[192:195], a[0:3]
v_xor_b32 v233, 64, v232
v_mfma_f32_16x16x32_bf16 a[8:11], v[192:195], a[196:199], a[8:11]
s_waitcnt vmcnt(12) lgkmcnt(0)
s_barrier
ds_read_b128 v[176:179], v232 offset:0
ds_read_b128 v[180:183], v232 offset:2048
ds_read_b128 v[184:187], v233 offset:0
v_mfma_f32_16x16x32_bf16 a[4:7], v[196:199], a[192:195], a[4:7]
s_mov_b32 s52, 4890624
s_add_u32 m0, s48, 90112
s_nop 0
buffer_load_dwordx4 v224, s[24:27], s52 offen nt lds
v_mfma_f32_16x16x32_bf16 a[12:15], v[196:199], a[196:199], a[12:15]
ds_read_b128 v[188:191], v233 offset:2048
v_mfma_f32_16x16x32_bf16 a[0:3], v[200:203], a[200:203], a[0:3]
buffer_load_dwordx4 v225, s[24:27], s52 offen offset:1024 nt lds
v_mfma_f32_16x16x32_bf16 a[8:11], v[200:203], a[204:207], a[8:11]
ds_read_b128 v[192:195], v232 offset:8192
s_add_u32 m0, s48, 98176
v_mfma_f32_16x16x32_bf16 a[4:7], v[204:207], a[200:203], a[4:7]
buffer_load_dwordx4 v224, s[24:27], s52 offen offset:128 nt lds
v_mfma_f32_16x16x32_bf16 a[12:15], v[204:207], a[204:207], a[12:15]
ds_read_b128 v[196:199], v232 offset:10240
s_waitcnt lgkmcnt(4)
v_mfma_f32_16x16x32_bf16 v[80:83], v[176:179], a[208:211], 0
buffer_load_dwordx4 v225, s[24:27], s52 offen offset:1152 nt lds
v_mfma_f32_16x16x32_bf16 v[88:91], v[176:179], a[212:215], 0
ds_read_b128 v[200:203], v233 offset:8192
s_add_u32 m0, s48, 106240
v_mfma_f32_16x16x32_bf16 v[84:87], v[180:183], a[208:211], 0
buffer_load_dwordx4 v224, s[24:27], s52 offen offset:256 nt lds
v_mfma_f32_16x16x32_bf16 v[92:95], v[180:183], a[212:215], 0
ds_read_b128 v[204:207], v233 offset:10240
s_waitcnt lgkmcnt(4)
v_mfma_f32_16x16x32_bf16 v[80:83], v[184:187], a[216:219], v[80:83]
v_mfma_f32_16x16x32_bf16 v[88:91], v[184:187], a[220:223], v[88:91]
ds_read_b128 v[176:179], v232 offset:16384
buffer_load_dwordx4 v225, s[24:27], s52 offen offset:1280 nt lds
v_mfma_f32_16x16x32_bf16 v[84:87], v[188:191], a[216:219], v[84:87]
v_mfma_f32_16x16x32_bf16 v[92:95], v[188:191], a[220:223], v[92:95]
ds_read_b128 v[180:183], v232 offset:18432
s_waitcnt lgkmcnt(4)
v_mfma_f32_16x16x32_bf16 v[80:83], v[192:195], a[224:227], v[80:83]
v_mfma_f32_16x16x32_bf16 v[88:91], v[192:195], a[228:231], v[88:91]
ds_read_b128 v[184:187], v233 offset:16384
v_mfma_f32_16x16x32_bf16 v[84:87], v[196:199], a[224:227], v[84:87]
v_mfma_f32_16x16x32_bf16 v[92:95], v[196:199], a[228:231], v[92:95]
ds_read_b128 v[188:191], v233 offset:18432
s_waitcnt lgkmcnt(4)
v_mfma_f32_16x16x32_bf16 v[80:83], v[200:203], a[232:235], v[80:83]
v_mfma_f32_16x16x32_bf16 v[88:91], v[200:203], a[236:239], v[88:91]
v_mfma_f32_16x16x32_bf16 v[84:87], v[204:207], a[232:235], v[84:87]
v_mfma_f32_16x16x32_bf16 v[92:95], v[204:207], a[236:239], v[92:95]
v_add_u32 v236, 139264, v230
v_xor_b32 v237, 32, v236
s_waitcnt lgkmcnt(2)
v_mfma_f32_16x16x32_bf16 v[80:83], v[176:179], a[240:243], v[80:83]
v_mfma_f32_16x16x32_bf16 v[88:91], v[176:179], a[244:247], v[88:91]
s_waitcnt vmcnt(12) lgkmcnt(0)
s_barrier
ds_read_b64_tr_b16 v[192:193], v236 offset:0
ds_read_b64_tr_b16 v[194:195], v237 offset:512
ds_read_b64_tr_b16 v[196:197], v237 offset:0
ds_read_b64_tr_b16 v[198:199], v236 offset:512
ds_read_b64_tr_b16 v[200:201], v236 offset:4096
ds_read_b64_tr_b16 v[202:203], v237 offset:4608
v_mfma_f32_16x16x32_bf16 v[84:87], v[180:183], a[240:243], v[84:87]
v_mfma_f32_16x16x32_bf16 v[92:95], v[180:183], a[244:247], v[92:95]
ds_read_b64_tr_b16 v[204:205], v237 offset:4096
v_mfma_f32_16x16x32_bf16 v[80:83], v[184:187], a[248:251], v[80:83]
ds_read_b64_tr_b16 v[206:207], v236 offset:4608
v_mfma_f32_16x16x32_bf16 v[88:91], v[184:187], a[252:255], v[88:91]
ds_read_b64_tr_b16 v[176:177], v236 offset:8192
v_mfma_f32_16x16x32_bf16 v[84:87], v[188:191], a[248:251], v[84:87]
ds_read_b64_tr_b16 v[178:179], v237 offset:8704
v_mfma_f32_16x16x32_bf16 v[92:95], v[188:191], a[252:255], v[92:95]
ds_read_b64_tr_b16 v[180:181], v237 offset:8192
s_waitcnt lgkmcnt(7)
v_mfma_f32_16x16x32_bf16 a[16:19], v[192:195], a[160:163], a[16:19]
ds_read_b64_tr_b16 v[182:183], v236 offset:8704
v_mfma_f32_16x16x32_bf16 a[24:27], v[192:195], a[164:167], a[24:27]
ds_read_b64_tr_b16 v[184:185], v236 offset:12288
v_mfma_f32_16x16x32_bf16 a[20:23], v[196:199], a[160:163], a[20:23]
ds_read_b64_tr_b16 v[186:187], v237 offset:12800
s_add_u32 s52, s72, 3932160
s_add_u32 m0, s48, 114688
v_mfma_f32_16x16x32_bf16 a[28:31], v[196:199], a[164:167], a[28:31]
ds_read_b64_tr_b16 v[188:189], v237 offset:12288
buffer_load_dwordx4 v228, s[36:39], s52 offen lds
s_waitcnt lgkmcnt(7)
v_mfma_f32_16x16x32_bf16 a[16:19], v[200:203], a[168:171], a[16:19]
ds_read_b64_tr_b16 v[190:191], v236 offset:12800
v_max3_f32 v240, v240, v80, v81
v_mfma_f32_16x16x32_bf16 a[24:27], v[200:203], a[172:175], a[24:27]
ds_read_b64_tr_b16 v[192:193], v236 offset:16384
buffer_load_dwordx4 v229, s[36:39], s52 offen offset:1024 lds
v_mfma_f32_16x16x32_bf16 a[20:23], v[204:207], a[168:171], a[20:23]
ds_read_b64_tr_b16 v[194:195], v237 offset:16896
v_max3_f32 v241, v241, v88, v89
v_mfma_f32_16x16x32_bf16 a[28:31], v[204:207], a[172:175], a[28:31]
ds_read_b64_tr_b16 v[196:197], v237 offset:16384
s_add_u32 s52, s72, 4014080
s_add_u32 m0, s48, 122880
s_waitcnt lgkmcnt(7)
v_mfma_f32_16x16x32_bf16 a[16:19], v[176:179], a[176:179], a[16:19]
ds_read_b64_tr_b16 v[198:199], v236 offset:16896
buffer_load_dwordx4 v228, s[36:39], s52 offen lds
v_mfma_f32_16x16x32_bf16 a[24:27], v[176:179], a[180:183], a[24:27]
ds_read_b64_tr_b16 v[200:201], v236 offset:20480
v_max3_f32 v240, v240, v82, v83
v_mfma_f32_16x16x32_bf16 a[20:23], v[180:183], a[176:179], a[20:23]
ds_read_b64_tr_b16 v[202:203], v237 offset:20992
v_max3_f32 v241, v241, v90, v91
v_mfma_f32_16x16x32_bf16 a[28:31], v[180:183], a[180:183], a[28:31]
ds_read_b64_tr_b16 v[204:205], v237 offset:20480
buffer_load_dwordx4 v229, s[36:39], s52 offen offset:1024 lds
s_waitcnt lgkmcnt(7)
v_mfma_f32_16x16x32_bf16 a[16:19], v[184:187], a[184:187], a[16:19]
ds_read_b64_tr_b16 v[206:207], v236 offset:20992
v_max3_f32 v240, v240, v84, v85
v_mfma_f32_16x16x32_bf16 a[24:27], v[184:187], a[188:191], a[24:27]
s_add_u32 s52, s72, 4096000
s_add_u32 m0, s48, 131072
v_max3_f32 v241, v241, v92, v93
v_mfma_f32_16x16x32_bf16 a[20:23], v[188:191], a[184:187], a[20:23]
buffer_load_dwordx4 v228, s[36:39], s52 offen lds
v_mfma_f32_16x16x32_bf16 a[28:31], v[188:191], a[188:191], a[28:31]
s_add_u32 s53, s49, 65536
v_add_u32 v232, s53, v231
v_max3_f32 v240, v240, v86, v87
s_waitcnt lgkmcnt(4)
v_mfma_f32_16x16x32_bf16 a[16:19], v[192:195], a[192:195], a[16:19]
v_xor_b32 v233, 64, v232
v_max3_f32 v241, v241, v94, v95
v_mfma_f32_16x16x32_bf16 a[24:27], v[192:195], a[196:199], a[24:27]
buffer_load_dwordx4 v229, s[36:39], s52 offen offset:1024 lds
s_waitcnt vmcnt(12) lgkmcnt(0)
s_barrier
ds_read_b128 v[176:179], v232 offset:0
ds_read_b128 v[180:183], v232 offset:2048
ds_read_b128 v[184:187], v233 offset:0
v_mfma_f32_16x16x32_bf16 a[20:23], v[196:199], a[192:195], a[20:23]
s_add_u32 s52, s73, 3932160
s_add_u32 m0, s48, 139264
s_nop 0
buffer_load_dwordx4 v228, s[36:39], s52 offen lds
v_mfma_f32_16x16x32_bf16 a[28:31], v[196:199], a[196:199], a[28:31]
ds_read_b128 v[188:191], v233 offset:2048
v_mfma_f32_16x16x32_bf16 a[16:19], v[200:203], a[200:203], a[16:19]
v_mfma_f32_16x16x32_bf16 a[24:27], v[200:203], a[204:207], a[24:27]
ds_read_b128 v[192:195], v232 offset:8192
buffer_load_dwordx4 v229, s[36:39], s52 offen offset:1024 lds
v_mfma_f32_16x16x32_bf16 a[20:23], v[204:207], a[200:203], a[20:23]
v_mfma_f32_16x16x32_bf16 a[28:31], v[204:207], a[204:207], a[28:31]
ds_read_b128 v[196:199], v232 offset:10240
s_waitcnt lgkmcnt(4)
v_mfma_f32_16x16x32_bf16 v[96:99], v[176:179], a[208:211], 0
s_add_u32 s52, s73, 4014080
s_add_u32 m0, s48, 147456
v_mfma_f32_16x16x32_bf16 v[104:107], v[176:179], a[212:215], 0
ds_read_b128 v[200:203], v233 offset:8192
buffer_load_dwordx4 v228, s[36:39], s52 offen lds
v_mfma_f32_16x16x32_bf16 v[100:103], v[180:183], a[208:211], 0
v_mfma_f32_16x16x32_bf16 v[108:111], v[180:183], a[212:215], 0
ds_read_b128 v[204:207], v233 offset:10240
s_waitcnt lgkmcnt(4)
v_mfma_f32_16x16x32_bf16 v[96:99], v[184:187], a[216:219], v[96:99]
buffer_load_dwordx4 v229, s[36:39], s52 offen offset:1024 lds
v_mfma_f32_16x16x32_bf16 v[104:107], v[184:187], a[220:223], v[104:107]
ds_read_b128 v[176:179], v232 offset:16384
v_mfma_f32_16x16x32_bf16 v[100:103], v[188:191], a[216:219], v[100:103]
v_mfma_f32_16x16x32_bf16 v[108:111], v[188:191], a[220:223], v[108:111]
ds_read_b128 v[180:183], v232 offset:18432
s_add_u32 s52, s73, 4096000
s_add_u32 m0, s48, 155648
s_waitcnt lgkmcnt(4)
v_mfma_f32_16x16x32_bf16 v[96:99], v[192:195], a[224:227], v[96:99]
buffer_load_dwordx4 v228, s[36:39], s52 offen lds
v_mfma_f32_16x16x32_bf16 v[104:107], v[192:195], a[228:231], v[104:107]
ds_read_b128 v[184:187], v233 offset:16384
v_mfma_f32_16x16x32_bf16 v[100:103], v[196:199], a[224:227], v[100:103]
v_mfma_f32_16x16x32_bf16 v[108:111], v[196:199], a[228:231], v[108:111]
ds_read_b128 v[188:191], v233 offset:18432
s_waitcnt lgkmcnt(4)
v_mfma_f32_16x16x32_bf16 v[96:99], v[200:203], a[232:235], v[96:99]
buffer_load_dwordx4 v229, s[36:39], s52 offen offset:1024 lds
v_mfma_f32_16x16x32_bf16 v[104:107], v[200:203], a[236:239], v[104:107]
v_mfma_f32_16x16x32_bf16 v[100:103], v[204:207], a[232:235], v[100:103]
v_mfma_f32_16x16x32_bf16 v[108:111], v[204:207], a[236:239], v[108:111]
s_add_u32 s53, s49, 90112
v_add_u32 v232, s53, v231
s_waitcnt lgkmcnt(2)
v_mfma_f32_16x16x32_bf16 v[96:99], v[176:179], a[240:243], v[96:99]
v_xor_b32 v233, 64, v232
v_mfma_f32_16x16x32_bf16 v[104:107], v[176:179], a[244:247], v[104:107]
s_waitcnt vmcnt(12) lgkmcnt(0)
s_barrier
ds_read_b128 v[192:195], v232 offset:0
ds_read_b128 v[196:199], v232 offset:2048
ds_read_b128 v[200:203], v233 offset:0
v_mfma_f32_16x16x32_bf16 v[100:103], v[180:183], a[240:243], v[100:103]
s_mov_b32 s52, 4718592
s_add_u32 m0, s48, 65536
s_nop 0
buffer_load_dwordx4 v224, s[28:31], s52 offen nt lds
v_mfma_f32_16x16x32_bf16 v[108:111], v[180:183], a[244:247], v[108:111]
ds_read_b128 v[204:207], v233 offset:2048
v_mfma_f32_16x16x32_bf16 v[96:99], v[184:187], a[248:251], v[96:99]
buffer_load_dwordx4 v225, s[28:31], s52 offen offset:1024 nt lds
v_mfma_f32_16x16x32_bf16 v[104:107], v[184:187], a[252:255], v[104:107]
ds_read_b128 v[176:179], v232 offset:8192
s_add_u32 m0, s48, 73600
v_mfma_f32_16x16x32_bf16 v[100:103], v[188:191], a[248:251], v[100:103]
buffer_load_dwordx4 v224, s[28:31], s52 offen offset:128 nt lds
v_mfma_f32_16x16x32_bf16 v[108:111], v[188:191], a[252:255], v[108:111]
ds_read_b128 v[180:183], v232 offset:10240
s_waitcnt lgkmcnt(4)
v_mfma_f32_16x16x32_bf16 v[112:115], v[192:195], a[208:211], 0
buffer_load_dwordx4 v225, s[28:31], s52 offen offset:1152 nt lds
v_mfma_f32_16x16x32_bf16 v[120:123], v[192:195], a[212:215], 0
ds_read_b128 v[184:187], v233 offset:8192
s_add_u32 m0, s48, 81664
v_mfma_f32_16x16x32_bf16 v[116:119], v[196:199], a[208:211], 0
buffer_load_dwordx4 v224, s[28:31], s52 offen offset:256 nt lds
v_mfma_f32_16x16x32_bf16 v[124:127], v[196:199], a[212:215], 0
ds_read_b128 v[188:191], v233 offset:10240
v_max3_f32 v240, v240, v96, v97
s_waitcnt lgkmcnt(4)
v_mfma_f32_16x16x32_bf16 v[112:115], v[200:203], a[216:219], v[112:115]
v_max3_f32 v241, v241, v104, v105
v_max3_f32 v240, v240, v98, v99
v_mfma_f32_16x16x32_bf16 v[120:123], v[200:203], a[220:223], v[120:123]
ds_read_b128 v[192:195], v232 offset:16384
buffer_load_dwordx4 v225, s[28:31], s52 offen offset:1280 nt lds
v_mfma_f32_16x16x32_bf16 v[116:119], v[204:207], a[216:219], v[116:119]
v_max3_f32 v241, v241, v106, v107
v_max3_f32 v240, v240, v100, v101
v_mfma_f32_16x16x32_bf16 v[124:127], v[204:207], a[220:223], v[124:127]
ds_read_b128 v[196:199], v232 offset:18432
v_max3_f32 v241, v241, v108, v109
s_waitcnt lgkmcnt(4)
v_mfma_f32_16x16x32_bf16 v[112:115], v[176:179], a[224:227], v[112:115]
v_max3_f32 v240, v240, v102, v103
v_max3_f32 v241, v241, v110, v111
v_mfma_f32_16x16x32_bf16 v[120:123], v[176:179], a[228:231], v[120:123]
ds_read_b128 v[200:203], v233 offset:16384
v_mfma_f32_16x16x32_bf16 v[116:119], v[180:183], a[224:227], v[116:119]
v_mfma_f32_16x16x32_bf16 v[124:127], v[180:183], a[228:231], v[124:127]
ds_read_b128 v[204:207], v233 offset:18432
s_waitcnt lgkmcnt(4)
v_mfma_f32_16x16x32_bf16 v[112:115], v[184:187], a[232:235], v[112:115]
v_mfma_f32_16x16x32_bf16 v[120:123], v[184:187], a[236:239], v[120:123]
v_mfma_f32_16x16x32_bf16 v[116:119], v[188:191], a[232:235], v[116:119]
v_mfma_f32_16x16x32_bf16 v[124:127], v[188:191], a[236:239], v[124:127]
v_add_u32 v236, 114688, v230
v_xor_b32 v237, 32, v236
s_waitcnt lgkmcnt(2)
v_mfma_f32_16x16x32_bf16 v[112:115], v[192:195], a[240:243], v[112:115]
v_mfma_f32_16x16x32_bf16 v[120:123], v[192:195], a[244:247], v[120:123]
s_waitcnt vmcnt(12) lgkmcnt(0)
s_barrier
ds_read_b64_tr_b16 v[176:177], v236 offset:0
ds_read_b64_tr_b16 v[178:179], v237 offset:512
ds_read_b64_tr_b16 v[180:181], v237 offset:0
ds_read_b64_tr_b16 v[182:183], v236 offset:512
ds_read_b64_tr_b16 v[184:185], v236 offset:4096
ds_read_b64_tr_b16 v[186:187], v237 offset:4608
v_mfma_f32_16x16x32_bf16 v[116:119], v[196:199], a[240:243], v[116:119]
s_mov_b32 s52, 4743168
s_add_u32 m0, s48, 90112
s_nop 0
buffer_load_dwordx4 v224, s[28:31], s52 offen nt lds
v_mfma_f32_16x16x32_bf16 v[124:127], v[196:199], a[244:247], v[124:127]
ds_read_b64_tr_b16 v[188:189], v237 offset:4096
v_mfma_f32_16x16x32_bf16 v[112:115], v[200:203], a[248:251], v[112:115]
ds_read_b64_tr_b16 v[190:191], v236 offset:4608
buffer_load_dwordx4 v225, s[28:31], s52 offen offset:1024 nt lds
v_mfma_f32_16x16x32_bf16 v[120:123], v[200:203], a[252:255], v[120:123]
ds_read_b64_tr_b16 v[192:193], v236 offset:8192
s_add_u32 m0, s48, 98176
v_mfma_f32_16x16x32_bf16 v[116:119], v[204:207], a[248:251], v[116:119]
ds_read_b64_tr_b16 v[194:195], v237 offset:8704
buffer_load_dwordx4 v224, s[28:31], s52 offen offset:128 nt lds
v_mfma_f32_16x16x32_bf16 v[124:127], v[204:207], a[252:255], v[124:127]
ds_read_b64_tr_b16 v[196:197], v237 offset:8192
s_waitcnt lgkmcnt(7)
v_mfma_f32_16x16x32_bf16 a[32:35], v[176:179], a[160:163], a[32:35]
ds_read_b64_tr_b16 v[198:199], v236 offset:8704
buffer_load_dwordx4 v225, s[28:31], s52 offen offset:1152 nt lds
v_mfma_f32_16x16x32_bf16 a[40:43], v[176:179], a[164:167], a[40:43]
ds_read_b64_tr_b16 v[200:201], v236 offset:12288
s_add_u32 m0, s48, 106240
v_mfma_f32_16x16x32_bf16 a[36:39], v[180:183], a[160:163], a[36:39]
ds_read_b64_tr_b16 v[202:203], v237 offset:12800
buffer_load_dwordx4 v224, s[28:31], s52 offen offset:256 nt lds
v_max3_f32 v240, v240, v112, v113
v_max3_f32 v241, v241, v120, v121
v_max3_f32 v240, v240, v114, v115
v_max3_f32 v241, v241, v122, v123
v_max3_f32 v240, v240, v116, v117
v_mfma_f32_16x16x32_bf16 a[44:47], v[180:183], a[164:167], a[44:47]
ds_read_b64_tr_b16 v[204:205], v237 offset:12288
v_max3_f32 v241, v241, v124, v125
v_max3_f32 v240, v240, v118, v119
v_max3_f32 v241, v241, v126, v127
v_mov_b32 v246, v240
v_mov_b32 v247, v241
s_nop 0
v_permlane16_swap_b32 v246, v240
v_permlane16_swap_b32 v247, v241
s_waitcnt lgkmcnt(7)
v_mfma_f32_16x16x32_bf16 a[32:35], v[184:187], a[168:171], a[32:35]
ds_read_b64_tr_b16 v[206:207], v236 offset:12800
v_max_f32 v240, v240, v246
v_max_f32 v241, v241, v247
v_mov_b32 v246, v240
v_mov_b32 v247, v241
s_nop 0
v_permlane32_swap_b32 v246, v240
v_permlane32_swap_b32 v247, v241
v_max_f32 v240, v240, v246
v_mfma_f32_16x16x32_bf16 a[40:43], v[184:187], a[172:175], a[40:43]
ds_read_b64_tr_b16 v[176:177], v236 offset:16384
buffer_load_dwordx4 v225, s[28:31], s52 offen offset:1280 nt lds
v_max_f32 v241, v241, v247
v_accvgpr_mov_b32 a208, a160
v_accvgpr_mov_b32 a209, a161
v_accvgpr_mov_b32 a210, a162
v_accvgpr_mov_b32 a211, a163
v_mfma_f32_16x16x32_bf16 a[36:39], v[188:191], a[168:171], a[36:39]
ds_read_b64_tr_b16 v[178:179], v237 offset:16896
v_accvgpr_mov_b32 a212, a164
v_accvgpr_mov_b32 a213, a165
v_accvgpr_mov_b32 a214, a166
v_accvgpr_mov_b32 a215, a167
v_accvgpr_mov_b32 a216, a168
v_accvgpr_mov_b32 a217, a169
v_accvgpr_mov_b32 a218, a170
v_mfma_f32_16x16x32_bf16 a[44:47], v[188:191], a[172:175], a[44:47]
ds_read_b64_tr_b16 v[180:181], v237 offset:16384
v_accvgpr_mov_b32 a219, a171
v_accvgpr_mov_b32 a220, a172
v_accvgpr_mov_b32 a221, a173
v_accvgpr_mov_b32 a222, a174
v_accvgpr_mov_b32 a223, a175
v_accvgpr_mov_b32 a224, a176
v_accvgpr_mov_b32 a225, a177
s_waitcnt lgkmcnt(7)
v_mfma_f32_16x16x32_bf16 a[32:35], v[192:195], a[176:179], a[32:35]
ds_read_b64_tr_b16 v[182:183], v236 offset:16896
v_accvgpr_mov_b32 a226, a178
v_accvgpr_mov_b32 a227, a179
v_accvgpr_mov_b32 a228, a180
v_accvgpr_mov_b32 a229, a181
v_accvgpr_mov_b32 a230, a182
v_accvgpr_mov_b32 a231, a183
v_accvgpr_mov_b32 a232, a184
v_accvgpr_mov_b32 a233, a185
v_mfma_f32_16x16x32_bf16 a[40:43], v[192:195], a[180:183], a[40:43]
ds_read_b64_tr_b16 v[184:185], v236 offset:20480
v_accvgpr_mov_b32 a234, a186
v_accvgpr_mov_b32 a235, a187
v_accvgpr_mov_b32 a236, a188
v_accvgpr_mov_b32 a237, a189
v_accvgpr_mov_b32 a238, a190
v_accvgpr_mov_b32 a239, a191
v_accvgpr_mov_b32 a240, a192
v_mfma_f32_16x16x32_bf16 a[36:39], v[196:199], a[176:179], a[36:39]
ds_read_b64_tr_b16 v[186:187], v237 offset:20992
v_accvgpr_mov_b32 a241, a193
v_accvgpr_mov_b32 a242, a194
v_accvgpr_mov_b32 a243, a195
v_accvgpr_mov_b32 a244, a196
v_accvgpr_mov_b32 a245, a197
v_accvgpr_mov_b32 a246, a198
v_accvgpr_mov_b32 a247, a199
v_accvgpr_mov_b32 a248, a200
v_mfma_f32_16x16x32_bf16 a[44:47], v[196:199], a[180:183], a[44:47]
ds_read_b64_tr_b16 v[188:189], v237 offset:20480
v_accvgpr_mov_b32 a249, a201
v_accvgpr_mov_b32 a250, a202
v_accvgpr_mov_b32 a251, a203
v_accvgpr_mov_b32 a252, a204
v_accvgpr_mov_b32 a253, a205
v_accvgpr_mov_b32 a254, a206
v_accvgpr_mov_b32 a255, a207
ds_write_b64 v239, v[240:241] offset:57344
s_waitcnt lgkmcnt(8)
v_mfma_f32_16x16x32_bf16 a[32:35], v[200:203], a[184:187], a[32:35]
ds_read_b64_tr_b16 v[190:191], v236 offset:20992
v_mfma_f32_16x16x32_bf16 a[40:43], v[200:203], a[188:191], a[40:43]
v_mfma_f32_16x16x32_bf16 a[36:39], v[204:207], a[184:187], a[36:39]
v_mfma_f32_16x16x32_bf16 a[44:47], v[204:207], a[188:191], a[44:47]
v_add_u32 v236, 139264, v230
v_xor_b32 v237, 32, v236
s_waitcnt lgkmcnt(5)
v_mfma_f32_16x16x32_bf16 a[32:35], v[176:179], a[192:195], a[32:35]
v_mfma_f32_16x16x32_bf16 a[40:43], v[176:179], a[196:199], a[40:43]
s_waitcnt vmcnt(12) lgkmcnt(0)
s_barrier
ds_read_b64_tr_b16 v[192:193], v236 offset:0
ds_read_b64_tr_b16 v[194:195], v237 offset:512
ds_read_b64_tr_b16 v[196:197], v237 offset:0
ds_read_b64_tr_b16 v[198:199], v236 offset:512
ds_read_b64_tr_b16 v[200:201], v236 offset:4096
ds_read_b64_tr_b16 v[202:203], v237 offset:4608
v_mfma_f32_16x16x32_bf16 a[36:39], v[180:183], a[192:195], a[36:39]
ds_read_b64 v[246:247], v238 offset:57344
ds_read_b64 v[248:249], v238 offset:59392
s_waitcnt lgkmcnt(0)
v_max_f32 v246, v246, v248
v_max_f32 v247, v247, v249
v_mul_f32 v242, s51, v246
v_mul_f32 v243, s51, v247
v_mfma_f32_16x16x32_bf16 a[44:47], v[180:183], a[196:199], a[44:47]
ds_read_b64_tr_b16 v[204:205], v237 offset:4096
v_fma_f32 v0, v0, s51, -v242
v_fma_f32 v1, v1, s51, -v242
v_exp_f32 v0, v0
v_mfma_f32_16x16x32_bf16 a[32:35], v[184:187], a[200:203], a[32:35]
ds_read_b64_tr_b16 v[206:207], v236 offset:4608
v_exp_f32 v1, v1
v_fma_f32 v2, v2, s51, -v242
v_fma_f32 v3, v3, s51, -v242
v_add_f32 v244, v0, v1
v_mfma_f32_16x16x32_bf16 a[40:43], v[184:187], a[204:207], a[40:43]
ds_read_b64_tr_b16 v[176:177], v236 offset:8192
v_cvt_pk_bf16_f32 v0, v0, v1
v_exp_f32 v2, v2
v_exp_f32 v3, v3
v_mfma_f32_16x16x32_bf16 a[36:39], v[188:191], a[200:203], a[36:39]
ds_read_b64_tr_b16 v[178:179], v237 offset:8704
v_fma_f32 v4, v4, s51, -v242
v_fma_f32 v5, v5, s51, -v242
v_add_f32 v244, v244, v2
v_add_f32 v244, v244, v3
v_cvt_pk_bf16_f32 v1, v2, v3
v_mfma_f32_16x16x32_bf16 a[44:47], v[188:191], a[204:207], a[44:47]
ds_read_b64_tr_b16 v[180:181], v237 offset:8192
v_exp_f32 v4, v4
v_exp_f32 v5, v5
v_fma_f32 v6, v6, s51, -v242
v_mfma_f32_16x16x32_bf16 a[48:51], v[192:195], a[160:163], a[48:51]
ds_read_b64_tr_b16 v[182:183], v236 offset:8704
v_fma_f32 v7, v7, s51, -v242
v_add_f32 v244, v244, v4
v_add_f32 v244, v244, v5
v_cvt_pk_bf16_f32 v2, v4, v5
v_mfma_f32_16x16x32_bf16 a[56:59], v[192:195], a[164:167], a[56:59]
ds_read_b64_tr_b16 v[184:185], v236 offset:12288
v_exp_f32 v6, v6
v_exp_f32 v7, v7
v_fma_f32 v8, v8, s51, -v243
v_mfma_f32_16x16x32_bf16 a[52:55], v[196:199], a[160:163], a[52:55]
ds_read_b64_tr_b16 v[186:187], v237 offset:12800
s_add_u32 s52, s74, 3932160
s_add_u32 m0, s48, 114688
v_fma_f32 v9, v9, s51, -v243
v_add_f32 v244, v244, v6
v_add_f32 v244, v244, v7
v_cvt_pk_bf16_f32 v3, v6, v7
v_mfma_f32_16x16x32_bf16 a[60:63], v[196:199], a[164:167], a[60:63]
ds_read_b64_tr_b16 v[188:189], v237 offset:12288
buffer_load_dwordx4 v228, s[36:39], s52 offen lds
v_exp_f32 v8, v8
s_waitcnt lgkmcnt(7)
v_mfma_f32_16x16x32_bf16 a[48:51], v[200:203], a[168:171], a[48:51]
ds_read_b64_tr_b16 v[190:191], v236 offset:12800
v_exp_f32 v9, v9
v_fma_f32 v10, v10, s51, -v243
v_fma_f32 v11, v11, s51, -v243
v_add_f32 v245, v8, v9
v_mfma_f32_16x16x32_bf16 a[56:59], v[200:203], a[172:175], a[56:59]
ds_read_b64_tr_b16 v[192:193], v236 offset:16384
buffer_load_dwordx4 v229, s[36:39], s52 offen offset:1024 lds
v_cvt_pk_bf16_f32 v4, v8, v9
v_exp_f32 v10, v10
v_mfma_f32_16x16x32_bf16 a[52:55], v[204:207], a[168:171], a[52:55]
ds_read_b64_tr_b16 v[194:195], v237 offset:16896
v_exp_f32 v11, v11
v_fma_f32 v12, v12, s51, -v243
v_fma_f32 v13, v13, s51, -v243
v_add_f32 v245, v245, v10
v_mfma_f32_16x16x32_bf16 a[60:63], v[204:207], a[172:175], a[60:63]
ds_read_b64_tr_b16 v[196:197], v237 offset:16384
s_add_u32 s52, s74, 4014080
s_add_u32 m0, s48, 122880
v_add_f32 v245, v245, v11
v_cvt_pk_bf16_f32 v5, v10, v11
v_exp_f32 v12, v12
s_waitcnt lgkmcnt(7)
v_mfma_f32_16x16x32_bf16 a[48:51], v[176:179], a[176:179], a[48:51]
ds_read_b64_tr_b16 v[198:199], v236 offset:16896
buffer_load_dwordx4 v228, s[36:39], s52 offen lds
v_exp_f32 v13, v13
v_fma_f32 v14, v14, s51, -v243
v_mfma_f32_16x16x32_bf16 a[56:59], v[176:179], a[180:183], a[56:59]
ds_read_b64_tr_b16 v[200:201], v236 offset:20480
v_fma_f32 v15, v15, s51, -v243
v_add_f32 v245, v245, v12
v_add_f32 v245, v245, v13
v_cvt_pk_bf16_f32 v6, v12, v13
v_mfma_f32_16x16x32_bf16 a[52:55], v[180:183], a[176:179], a[52:55]
ds_read_b64_tr_b16 v[202:203], v237 offset:20992
v_exp_f32 v14, v14
v_exp_f32 v15, v15
v_add_f32 v245, v245, v14
v_mfma_f32_16x16x32_bf16 a[60:63], v[180:183], a[180:183], a[60:63]
ds_read_b64_tr_b16 v[204:205], v237 offset:20480
buffer_load_dwordx4 v229, s[36:39], s52 offen offset:1024 lds
v_add_f32 v245, v245, v15
v_cvt_pk_bf16_f32 v7, v14, v15
ds_write_b128 v239, v[0:3] offset:0
ds_write_b128 v239, v[4:7] offset:1024
s_waitcnt lgkmcnt(9)
v_mfma_f32_16x16x32_bf16 a[48:51], v[184:187], a[184:187], a[48:51]
ds_read_b64_tr_b16 v[206:207], v236 offset:20992
v_mfma_f32_16x16x32_bf16 a[56:59], v[184:187], a[188:191], a[56:59]
s_add_u32 s52, s74, 4096000
s_add_u32 m0, s48, 131072
v_mfma_f32_16x16x32_bf16 a[52:55], v[188:191], a[184:187], a[52:55]
buffer_load_dwordx4 v228, s[36:39], s52 offen lds
v_mfma_f32_16x16x32_bf16 a[60:63], v[188:191], a[188:191], a[60:63]
v_add_u32 v236, 65536, v250
v_xor_b32 v237, 32, v236
s_waitcnt lgkmcnt(6)
v_mfma_f32_16x16x32_bf16 a[48:51], v[192:195], a[192:195], a[48:51]
v_xor_b32 v232, 0x1000, v236
v_xor_b32 v233, 0x1000, v237
v_mfma_f32_16x16x32_bf16 a[56:59], v[192:195], a[196:199], a[56:59]
buffer_load_dwordx4 v229, s[36:39], s52 offen offset:1024 lds
s_waitcnt vmcnt(12) lgkmcnt(0)
s_barrier
ds_read_b64_tr_b16 v[176:177], v236 offset:0
ds_read_b64_tr_b16 v[178:179], v236 offset:2048
ds_read_b64_tr_b16 v[180:181], v237 offset:0
ds_read_b64_tr_b16 v[182:183], v237 offset:2048
ds_read_b64_tr_b16 v[184:185], v236 offset:8192
ds_read_b64_tr_b16 v[186:187], v236 offset:10240
v_mfma_f32_16x16x32_bf16 a[52:55], v[196:199], a[192:195], a[52:55]
s_mov_b32 s52, 4767744
s_add_u32 m0, s48, 139264
s_nop 0
buffer_load_dwordx4 v224, s[28:31], s52 offen nt lds
v_fma_f32 v16, v16, s51, -v242
v_fma_f32 v17, v17, s51, -v242
v_mfma_f32_16x16x32_bf16 a[60:63], v[196:199], a[196:199], a[60:63]
ds_read_b64_tr_b16 v[188:189], v237 offset:8192
v_exp_f32 v16, v16
v_exp_f32 v17, v17
v_fma_f32 v18, v18, s51, -v242
v_mfma_f32_16x16x32_bf16 a[48:51], v[200:203], a[200:203], a[48:51]
ds_read_b64_tr_b16 v[190:191], v237 offset:10240
buffer_load_dwordx4 v225, s[28:31], s52 offen offset:1024 nt lds
v_fma_f32 v19, v19, s51, -v242
v_add_f32 v244, v244, v16
v_add_f32 v244, v244, v17
v_mfma_f32_16x16x32_bf16 a[56:59], v[200:203], a[204:207], a[56:59]
ds_read_b64_tr_b16 v[192:193], v236 offset:16384
s_add_u32 m0, s48, 147328
v_cvt_pk_bf16_f32 v16, v16, v17
v_exp_f32 v18, v18
v_exp_f32 v19, v19
v_mfma_f32_16x16x32_bf16 a[52:55], v[204:207], a[200:203], a[52:55]
ds_read_b64_tr_b16 v[194:195], v236 offset:18432
buffer_load_dwordx4 v224, s[28:31], s52 offen offset:128 nt lds
v_fma_f32 v20, v20, s51, -v242
v_fma_f32 v21, v21, s51, -v242
v_add_f32 v244, v244, v18
v_mfma_f32_16x16x32_bf16 a[60:63], v[204:207], a[204:207], a[60:63]
ds_read_b64_tr_b16 v[196:197], v237 offset:16384
v_add_f32 v244, v244, v19
v_cvt_pk_bf16_f32 v17, v18, v19
v_exp_f32 v20, v20
s_waitcnt lgkmcnt(7)
v_mfma_f32_16x16x32_bf16 v[128:131], v[176:179], v[0:3], 0
ds_read_b64_tr_b16 v[198:199], v237 offset:18432
buffer_load_dwordx4 v225, s[28:31], s52 offen offset:1152 nt lds
v_exp_f32 v21, v21
v_fma_f32 v22, v22, s51, -v242
v_mfma_f32_16x16x32_bf16 v[136:139], v[176:179], v[4:7], 0
ds_read_b128 v[8:11], v234 offset:0
ds_read_b128 v[12:15], v234 offset:1024
s_add_u32 m0, s48, 155392
v_fma_f32 v23, v23, s51, -v242
v_add_f32 v244, v244, v20
v_add_f32 v244, v244, v21
v_mfma_f32_16x16x32_bf16 v[132:135], v[180:183], v[0:3], 0
ds_read_b64_tr_b16 v[200:201], v232 offset:0
ds_read_b64_tr_b16 v[202:203], v232 offset:2048
buffer_load_dwordx4 v224, s[28:31], s52 offen offset:256 nt lds
v_cvt_pk_bf16_f32 v18, v20, v21
v_mfma_f32_16x16x32_bf16 v[140:143], v[180:183], v[4:7], 0
ds_read_b64_tr_b16 v[204:205], v233 offset:0
v_exp_f32 v22, v22
v_exp_f32 v23, v23
v_fma_f32 v24, v24, s51, -v243
s_waitcnt lgkmcnt(9)
v_mfma_f32_16x16x32_bf16 v[144:147], v[184:187], v[0:3], 0
ds_read_b64_tr_b16 v[206:207], v233 offset:2048
v_fma_f32 v25, v25, s51, -v243
v_add_f32 v244, v244, v22
v_add_f32 v244, v244, v23
v_cvt_pk_bf16_f32 v19, v22, v23
v_exp_f32 v24, v24
v_mfma_f32_16x16x32_bf16 v[152:155], v[184:187], v[4:7], 0
ds_read_b64_tr_b16 v[176:177], v232 offset:8192
buffer_load_dwordx4 v225, s[28:31], s52 offen offset:1280 nt lds
v_exp_f32 v25, v25
v_fma_f32 v26, v26, s51, -v243
v_mfma_f32_16x16x32_bf16 v[148:151], v[188:191], v[0:3], 0
ds_read_b64_tr_b16 v[178:179], v232 offset:10240
v_fma_f32 v27, v27, s51, -v243
v_add_f32 v245, v245, v24
v_add_f32 v245, v245, v25
v_cvt_pk_bf16_f32 v20, v24, v25
v_mfma_f32_16x16x32_bf16 v[156:159], v[188:191], v[4:7], 0
ds_read_b64_tr_b16 v[180:181], v233 offset:8192
v_exp_f32 v26, v26
v_exp_f32 v27, v27
v_fma_f32 v28, v28, s51, -v243
s_waitcnt lgkmcnt(9)
v_mfma_f32_16x16x32_bf16 v[160:163], v[192:195], v[0:3], 0
ds_read_b64_tr_b16 v[182:183], v233 offset:10240
v_fma_f32 v29, v29, s51, -v243
v_add_f32 v245, v245, v26
v_add_f32 v245, v245, v27
v_cvt_pk_bf16_f32 v21, v26, v27
v_exp_f32 v28, v28
v_mfma_f32_16x16x32_bf16 v[168:171], v[192:195], v[4:7], 0
ds_read_b64_tr_b16 v[184:185], v232 offset:16384
v_exp_f32 v29, v29
v_fma_f32 v30, v30, s51, -v243
v_fma_f32 v31, v31, s51, -v243
v_add_f32 v245, v245, v28
v_mfma_f32_16x16x32_bf16 v[164:167], v[196:199], v[0:3], 0
ds_read_b64_tr_b16 v[186:187], v232 offset:18432
v_add_f32 v245, v245, v29
v_cvt_pk_bf16_f32 v22, v28, v29
v_exp_f32 v30, v30
v_mfma_f32_16x16x32_bf16 v[172:175], v[196:199], v[4:7], 0
ds_read_b64_tr_b16 v[188:189], v233 offset:16384
v_exp_f32 v31, v31
v_add_f32 v245, v245, v30
v_add_f32 v245, v245, v31
v_cvt_pk_bf16_f32 v23, v30, v31
ds_write_b128 v239, v[16:19] offset:8192
ds_write_b128 v239, v[20:23] offset:9216
s_waitcnt lgkmcnt(9)
v_mfma_f32_16x16x32_bf16 v[128:131], v[200:203], v[8:11], v[128:131]
ds_read_b64_tr_b16 v[190:191], v233 offset:18432
v_mfma_f32_16x16x32_bf16 v[136:139], v[200:203], v[12:15], v[136:139]
v_mfma_f32_16x16x32_bf16 v[132:135], v[204:207], v[8:11], v[132:135]
v_mfma_f32_16x16x32_bf16 v[140:143], v[204:207], v[12:15], v[140:143]
v_add_u32 v236, 90112, v250
v_xor_b32 v237, 32, v236
s_waitcnt lgkmcnt(6)
v_mfma_f32_16x16x32_bf16 v[144:147], v[176:179], v[8:11], v[144:147]
v_xor_b32 v232, 0x1000, v236
v_xor_b32 v233, 0x1000, v237
v_mfma_f32_16x16x32_bf16 v[152:155], v[176:179], v[12:15], v[152:155]
s_waitcnt vmcnt(12) lgkmcnt(0)
s_barrier
ds_read_b64_tr_b16 v[192:193], v236 offset:0
ds_read_b64_tr_b16 v[194:195], v236 offset:2048
ds_read_b64_tr_b16 v[196:197], v237 offset:0
ds_read_b64_tr_b16 v[198:199], v237 offset:2048
ds_read_b64_tr_b16 v[200:201], v236 offset:8192
ds_read_b64_tr_b16 v[202:203], v236 offset:10240
v_mfma_f32_16x16x32_bf16 v[148:151], v[180:183], v[8:11], v[148:151]
v_fma_f32 v32, v32, s51, -v242
v_fma_f32 v33, v33, s51, -v242
v_exp_f32 v32, v32
v_mfma_f32_16x16x32_bf16 v[156:159], v[180:183], v[12:15], v[156:159]
ds_read_b64_tr_b16 v[204:205], v237 offset:8192
v_exp_f32 v33, v33
v_mfma_f32_16x16x32_bf16 v[160:163], v[184:187], v[8:11], v[160:163]
ds_read_b64_tr_b16 v[206:207], v237 offset:10240
v_fma_f32 v34, v34, s51, -v242
v_fma_f32 v35, v35, s51, -v242
v_mfma_f32_16x16x32_bf16 v[168:171], v[184:187], v[12:15], v[168:171]
ds_read_b64_tr_b16 v[176:177], v236 offset:16384
v_add_f32 v244, v244, v32
v_add_f32 v244, v244, v33
v_mfma_f32_16x16x32_bf16 v[164:167], v[188:191], v[8:11], v[164:167]
ds_read_b64_tr_b16 v[178:179], v236 offset:18432
v_cvt_pk_bf16_f32 v32, v32, v33
v_exp_f32 v34, v34
v_mfma_f32_16x16x32_bf16 v[172:175], v[188:191], v[12:15], v[172:175]
ds_read_b64_tr_b16 v[180:181], v237 offset:16384
v_exp_f32 v35, v35
s_waitcnt lgkmcnt(7)
v_mfma_f32_16x16x32_bf16 v[128:131], v[192:195], v[16:19], v[128:131]
ds_read_b64_tr_b16 v[182:183], v237 offset:18432
v_fma_f32 v36, v36, s51, -v242
v_fma_f32 v37, v37, s51, -v242
v_mfma_f32_16x16x32_bf16 v[136:139], v[192:195], v[20:23], v[136:139]
ds_read_b128 v[24:27], v234 offset:8192
ds_read_b128 v[28:31], v234 offset:9216
v_add_f32 v244, v244, v34
v_mfma_f32_16x16x32_bf16 v[132:135], v[196:199], v[16:19], v[132:135]
ds_read_b64_tr_b16 v[184:185], v232 offset:0
ds_read_b64_tr_b16 v[186:187], v232 offset:2048
s_add_u32 s52, s75, 3932160
s_add_u32 m0, s48, 65536
v_mfma_f32_16x16x32_bf16 v[140:143], v[196:199], v[20:23], v[140:143]
ds_read_b64_tr_b16 v[188:189], v233 offset:0
buffer_load_dwordx4 v228, s[36:39], s52 offen lds
s_waitcnt lgkmcnt(9)
v_mfma_f32_16x16x32_bf16 v[144:147], v[200:203], v[16:19], v[144:147]
ds_read_b64_tr_b16 v[190:191], v233 offset:2048
v_add_f32 v244, v244, v35
v_cvt_pk_bf16_f32 v33, v34, v35
v_mfma_f32_16x16x32_bf16 v[152:155], v[200:203], v[20:23], v[152:155]
ds_read_b64_tr_b16 v[192:193], v232 offset:8192
buffer_load_dwordx4 v229, s[36:39], s52 offen offset:1024 lds
v_mfma_f32_16x16x32_bf16 v[148:151], v[204:207], v[16:19], v[148:151]
ds_read_b64_tr_b16 v[194:195], v232 offset:10240
v_exp_f32 v36, v36
v_mfma_f32_16x16x32_bf16 v[156:159], v[204:207], v[20:23], v[156:159]
ds_read_b64_tr_b16 v[196:197], v233 offset:8192
s_add_u32 s52, s75, 4014080
s_add_u32 m0, s48, 73728
s_waitcnt lgkmcnt(9)
v_mfma_f32_16x16x32_bf16 v[160:163], v[176:179], v[16:19], v[160:163]
ds_read_b64_tr_b16 v[198:199], v233 offset:10240
buffer_load_dwordx4 v228, s[36:39], s52 offen lds
v_mfma_f32_16x16x32_bf16 v[168:171], v[176:179], v[20:23], v[168:171]
ds_read_b64_tr_b16 v[200:201], v232 offset:16384
v_exp_f32 v37, v37
v_mfma_f32_16x16x32_bf16 v[164:167], v[180:183], v[16:19], v[164:167]
ds_read_b64_tr_b16 v[202:203], v232 offset:18432
v_fma_f32 v38, v38, s51, -v242
v_fma_f32 v39, v39, s51, -v242
v_mfma_f32_16x16x32_bf16 v[172:175], v[180:183], v[20:23], v[172:175]
ds_read_b64_tr_b16 v[204:205], v233 offset:16384
buffer_load_dwordx4 v229, s[36:39], s52 offen offset:1024 lds
s_waitcnt lgkmcnt(7)
v_mfma_f32_16x16x32_bf16 v[128:131], v[184:187], v[24:27], v[128:131]
ds_read_b64_tr_b16 v[206:207], v233 offset:18432
v_add_f32 v244, v244, v36
v_add_f32 v244, v244, v37
v_mfma_f32_16x16x32_bf16 v[136:139], v[184:187], v[28:31], v[136:139]
s_add_u32 s52, s75, 4096000
s_add_u32 m0, s48, 81920
v_cvt_pk_bf16_f32 v34, v36, v37
v_exp_f32 v38, v38
v_mfma_f32_16x16x32_bf16 v[132:135], v[188:191], v[24:27], v[132:135]
buffer_load_dwordx4 v228, s[36:39], s52 offen lds
v_mfma_f32_16x16x32_bf16 v[140:143], v[188:191], v[28:31], v[140:143]
v_add_u32 v236, 114688, v230
v_xor_b32 v237, 32, v236
v_exp_f32 v39, v39
s_waitcnt lgkmcnt(4)
v_mfma_f32_16x16x32_bf16 v[144:147], v[192:195], v[24:27], v[144:147]
v_fma_f32 v40, v40, s51, -v243
v_fma_f32 v41, v41, s51, -v243
v_add_f32 v244, v244, v38
v_mfma_f32_16x16x32_bf16 v[152:155], v[192:195], v[28:31], v[152:155]
buffer_load_dwordx4 v229, s[36:39], s52 offen offset:1024 lds
s_waitcnt vmcnt(12) lgkmcnt(0)
s_barrier
ds_read_b64_tr_b16 v[176:177], v236 offset:0
ds_read_b64_tr_b16 v[178:179], v237 offset:512
ds_read_b64_tr_b16 v[180:181], v237 offset:0
ds_read_b64_tr_b16 v[182:183], v236 offset:512
ds_read_b64_tr_b16 v[184:185], v236 offset:4096
ds_read_b64_tr_b16 v[186:187], v237 offset:4608
v_mfma_f32_16x16x32_bf16 v[148:151], v[196:199], v[24:27], v[148:151]
s_mov_b32 s52, 4792320
s_add_u32 m0, s48, 90112
s_nop 0
buffer_load_dwordx4 v224, s[28:31], s52 offen nt lds
v_add_f32 v244, v244, v39
v_mfma_f32_16x16x32_bf16 v[156:159], v[196:199], v[28:31], v[156:159]
ds_read_b64_tr_b16 v[188:189], v237 offset:4096
v_cvt_pk_bf16_f32 v35, v38, v39
v_exp_f32 v40, v40
v_mfma_f32_16x16x32_bf16 v[160:163], v[200:203], v[24:27], v[160:163]
ds_read_b64_tr_b16 v[190:191], v236 offset:4608
buffer_load_dwordx4 v225, s[28:31], s52 offen offset:1024 nt lds
v_mfma_f32_16x16x32_bf16 v[168:171], v[200:203], v[28:31], v[168:171]
ds_read_b64_tr_b16 v[192:193], v236 offset:8192
s_add_u32 m0, s48, 98176
v_exp_f32 v41, v41
v_mfma_f32_16x16x32_bf16 v[164:167], v[204:207], v[24:27], v[164:167]
ds_read_b64_tr_b16 v[194:195], v237 offset:8704
buffer_load_dwordx4 v224, s[28:31], s52 offen offset:128 nt lds
v_fma_f32 v42, v42, s51, -v243
v_mfma_f32_16x16x32_bf16 v[172:175], v[204:207], v[28:31], v[172:175]
ds_read_b64_tr_b16 v[196:197], v237 offset:8192
v_fma_f32 v43, v43, s51, -v243
v_add_f32 v245, v245, v40
v_add_f32 v245, v245, v41
s_waitcnt lgkmcnt(7)
v_mfma_f32_16x16x32_bf16 a[64:67], v[176:179], a[208:211], a[64:67]
ds_read_b64_tr_b16 v[198:199], v236 offset:8704
buffer_load_dwordx4 v225, s[28:31], s52 offen offset:1152 nt lds
v_cvt_pk_bf16_f32 v36, v40, v41
v_mfma_f32_16x16x32_bf16 a[72:75], v[176:179], a[212:215], a[72:75]
ds_read_b64_tr_b16 v[200:201], v236 offset:12288
s_add_u32 m0, s48, 106240
v_exp_f32 v42, v42
v_mfma_f32_16x16x32_bf16 a[68:71], v[180:183], a[208:211], a[68:71]
ds_read_b64_tr_b16 v[202:203], v237 offset:12800
buffer_load_dwordx4 v224, s[28:31], s52 offen offset:256 nt lds
v_mfma_f32_16x16x32_bf16 a[76:79], v[180:183], a[212:215], a[76:79]
ds_read_b64_tr_b16 v[204:205], v237 offset:12288
v_exp_f32 v43, v43
v_fma_f32 v44, v44, s51, -v243
s_waitcnt lgkmcnt(7)
v_mfma_f32_16x16x32_bf16 a[64:67], v[184:187], a[216:219], a[64:67]
ds_read_b64_tr_b16 v[206:207], v236 offset:12800
v_fma_f32 v45, v45, s51, -v243
v_add_f32 v245, v245, v42
v_add_f32 v245, v245, v43
v_mfma_f32_16x16x32_bf16 a[72:75], v[184:187], a[220:223], a[72:75]
ds_read_b64_tr_b16 v[176:177], v236 offset:16384
buffer_load_dwordx4 v225, s[28:31], s52 offen offset:1280 nt lds
v_cvt_pk_bf16_f32 v37, v42, v43
v_mfma_f32_16x16x32_bf16 a[68:71], v[188:191], a[216:219], a[68:71]
ds_read_b64_tr_b16 v[178:179], v237 offset:16896
v_exp_f32 v44, v44
v_mfma_f32_16x16x32_bf16 a[76:79], v[188:191], a[220:223], a[76:79]
ds_read_b64_tr_b16 v[180:181], v237 offset:16384
v_exp_f32 v45, v45
v_fma_f32 v46, v46, s51, -v243
s_waitcnt lgkmcnt(7)
v_mfma_f32_16x16x32_bf16 a[64:67], v[192:195], a[224:227], a[64:67]
ds_read_b64_tr_b16 v[182:183], v236 offset:16896
v_fma_f32 v47, v47, s51, -v243
v_add_f32 v245, v245, v44
v_add_f32 v245, v245, v45
v_mfma_f32_16x16x32_bf16 a[72:75], v[192:195], a[228:231], a[72:75]
ds_read_b64_tr_b16 v[184:185], v236 offset:20480
v_cvt_pk_bf16_f32 v38, v44, v45
v_exp_f32 v46, v46
v_mfma_f32_16x16x32_bf16 a[68:71], v[196:199], a[224:227], a[68:71]
ds_read_b64_tr_b16 v[186:187], v237 offset:20992
v_exp_f32 v47, v47
v_add_f32 v245, v245, v46
v_mfma_f32_16x16x32_bf16 a[76:79], v[196:199], a[228:231], a[76:79]
ds_read_b64_tr_b16 v[188:189], v237 offset:20480
v_add_f32 v245, v245, v47
v_cvt_pk_bf16_f32 v39, v46, v47
ds_write_b128 v239, v[32:35] offset:24576
ds_write_b128 v239, v[36:39] offset:25600
s_waitcnt lgkmcnt(9)
v_mfma_f32_16x16x32_bf16 a[64:67], v[200:203], a[232:235], a[64:67]
ds_read_b64_tr_b16 v[190:191], v236 offset:20992
v_mfma_f32_16x16x32_bf16 a[72:75], v[200:203], a[236:239], a[72:75]
v_mfma_f32_16x16x32_bf16 a[68:71], v[204:207], a[232:235], a[68:71]
v_mfma_f32_16x16x32_bf16 a[76:79], v[204:207], a[236:239], a[76:79]
v_add_u32 v236, 139264, v250
v_xor_b32 v237, 32, v236
s_waitcnt lgkmcnt(6)
v_mfma_f32_16x16x32_bf16 a[64:67], v[176:179], a[240:243], a[64:67]
v_xor_b32 v232, 0x1000, v236
v_xor_b32 v233, 0x1000, v237
v_mfma_f32_16x16x32_bf16 a[72:75], v[176:179], a[244:247], a[72:75]
s_waitcnt vmcnt(12) lgkmcnt(0)
s_barrier
v_bfe_u32 v208, v238, 4, 6
v_lshrrev_b32 v209, 3, v208
s_and_b32 s20, s90, 1
s_lshl_b32 s20, s20, 3
v_add_u32 v209, s20, v209
v_bfe_u32 v210, v208, 2, 1
v_and_b32 v212, 3, v208
v_lshlrev_b32 v211, 3, v212
v_lshl_or_b32 v211, v210, 6, v211
s_movk_i32 s20, 2560
v_mad_u32_u24 v211, v209, s20, v211
v_lshlrev_b32 v210, 12, v210
v_lshl_or_b32 v210, v212, 8, v210
v_lshl_or_b32 v210, v209, 4, v210
s_lshr_b32 s22, s90, 1
s_lshl_b32 s23, s22, 10
s_lshl_b32 s20, s58, 13
s_add_u32 s23, s23, s20
s_lshl_b32 s20, s92, 2
s_add_u32 s22, s22, s20
s_mul_i32 s22, s22, 40960
s_mul_i32 s20, s93, 1280
s_add_u32 s22, s22, s20
s_lshl_b32 s20, s58, 7
s_add_u32 s22, s22, s20
s_lshl_b32 s59, s90, 7
v_mov_b32 v216, 0
v_lshlrev_b32 v218, 3, v254
s_lshl_b32 s20, 1, s90
v_mov_b32 v219, s20
s_mov_b32 s94, 0x7ff00000
s_cmp_lt_u32 s58, 2
s_cselect_b32 s95, 65536, s94
v_bfe_u32 v212, v208, 3, 1
s_and_b32 s20, s90, 1
v_cmp_eq_u32 vcc, s20, v212
s_and_b32 s20, s58, 1
s_lshl_b32 s20, s20, 1
s_lshr_b32 s21, s90, 1
v_mov_b32 v212, s94
s_cmp_eq_u32 s20, s21
s_cselect_b32 s96, 1, 0
s_cselect_b64 s[98:99], vcc, 0
v_cndmask_b32 v213, v254, v212, s[98:99]
s_add_u32 s20, s20, 1
s_cmp_eq_u32 s20, s21
s_cselect_b32 s97, 1, 0
s_cselect_b64 s[98:99], vcc, 0
v_cndmask_b32 v214, v254, v212, s[98:99]
s_add_u32 s20, s20, 1
s_lshr_b32 s20, s58, 1
s_lshl_b32 s20, s20, 10
s_add_u32 s20, s20, 32768
v_lshlrev_b32 v215, 4, v208
v_add_u32 v215, s20, v215
v_bfe_u32 v212, v210, 12, 1
v_and_b32 v220, 0x3ff, v210
v_lshl_or_b32 v212, v212, 10, v220
s_lshr_b32 s20, s70, 7
s_sub_u32 s20, s58, s20
s_cmp_lt_i32 s20, 0
s_cselect_b32 s21, 10, 0
s_add_u32 s21, s21, s20
s_lshl_b32 s21, s21, 11
s_add_u32 s21, s21, 32768
v_add_u32 v220, s21, v212
s_add_u32 s20, s20, 4
s_cmp_lt_i32 s20, 0
s_cselect_b32 s21, 10, 0
s_add_u32 s21, s21, s20
s_lshl_b32 s21, s21, 11
s_add_u32 s21, s21, 32768
v_add_u32 v221, s21, v212
s_add_u32 s20, s20, 4
s_cmp_lt_i32 s20, 0
s_cselect_b32 s21, 10, 0
s_add_u32 s21, s21, s20
s_lshl_b32 s21, s21, 11
s_add_u32 s21, s21, 32768
v_add_u32 v222, s21, v212
s_add_u32 s20, s20, 4
ds_read_b64_tr_b16 v[192:193], v236 offset:0
ds_read_b64_tr_b16 v[194:195], v236 offset:2048
ds_read_b64_tr_b16 v[196:197], v237 offset:0
ds_read_b64_tr_b16 v[198:199], v237 offset:2048
ds_read_b64_tr_b16 v[200:201], v236 offset:8192
ds_read_b64_tr_b16 v[202:203], v236 offset:10240
v_mfma_f32_16x16x32_bf16 a[68:71], v[180:183], a[240:243], a[68:71]
v_fma_f32 v48, v48, s51, -v242
v_fma_f32 v49, v49, s51, -v242
v_exp_f32 v48, v48
v_mfma_f32_16x16x32_bf16 a[76:79], v[180:183], a[244:247], a[76:79]
ds_read_b64_tr_b16 v[204:205], v237 offset:8192
v_exp_f32 v49, v49
v_mfma_f32_16x16x32_bf16 a[64:67], v[184:187], a[248:251], a[64:67]
ds_read_b64_tr_b16 v[206:207], v237 offset:10240
v_fma_f32 v50, v50, s51, -v242
v_fma_f32 v51, v51, s51, -v242
v_mfma_f32_16x16x32_bf16 a[72:75], v[184:187], a[252:255], a[72:75]
ds_read_b64_tr_b16 v[176:177], v236 offset:16384
v_add_f32 v244, v244, v48
v_add_f32 v244, v244, v49
v_mfma_f32_16x16x32_bf16 a[68:71], v[188:191], a[248:251], a[68:71]
ds_read_b64_tr_b16 v[178:179], v236 offset:18432
v_cvt_pk_bf16_f32 v48, v48, v49
v_exp_f32 v50, v50
v_mfma_f32_16x16x32_bf16 a[76:79], v[188:191], a[252:255], a[76:79]
ds_read_b64_tr_b16 v[180:181], v237 offset:16384
v_exp_f32 v51, v51
s_waitcnt lgkmcnt(7)
v_mfma_f32_16x16x32_bf16 v[128:131], v[192:195], v[32:35], v[128:131]
ds_read_b64_tr_b16 v[182:183], v237 offset:18432
v_fma_f32 v52, v52, s51, -v242
v_fma_f32 v53, v53, s51, -v242
v_mfma_f32_16x16x32_bf16 v[136:139], v[192:195], v[36:39], v[136:139]
ds_read_b128 v[40:43], v234 offset:24576
ds_read_b128 v[44:47], v234 offset:25600
v_add_f32 v244, v244, v50
v_mfma_f32_16x16x32_bf16 v[132:135], v[196:199], v[32:35], v[132:135]
ds_read_b64_tr_b16 v[184:185], v232 offset:0
ds_read_b64_tr_b16 v[186:187], v232 offset:2048
s_add_u32 s52, s76, 3932160
s_add_u32 m0, s48, 114688
v_mfma_f32_16x16x32_bf16 v[140:143], v[196:199], v[36:39], v[140:143]
ds_read_b64_tr_b16 v[188:189], v233 offset:0
buffer_load_dwordx4 v228, s[36:39], s52 offen lds
s_waitcnt lgkmcnt(9)
v_mfma_f32_16x16x32_bf16 v[144:147], v[200:203], v[32:35], v[144:147]
ds_read_b64_tr_b16 v[190:191], v233 offset:2048
v_add_f32 v244, v244, v51
v_cvt_pk_bf16_f32 v49, v50, v51
v_mfma_f32_16x16x32_bf16 v[152:155], v[200:203], v[36:39], v[152:155]
ds_read_b64_tr_b16 v[192:193], v232 offset:8192
buffer_load_dwordx4 v229, s[36:39], s52 offen offset:1024 lds
v_mfma_f32_16x16x32_bf16 v[148:151], v[204:207], v[32:35], v[148:151]
ds_read_b64_tr_b16 v[194:195], v232 offset:10240
v_exp_f32 v52, v52
v_mfma_f32_16x16x32_bf16 v[156:159], v[204:207], v[36:39], v[156:159]
ds_read_b64_tr_b16 v[196:197], v233 offset:8192
s_add_u32 s52, s76, 4014080
s_add_u32 m0, s48, 122880
s_waitcnt lgkmcnt(9)
v_mfma_f32_16x16x32_bf16 v[160:163], v[176:179], v[32:35], v[160:163]
ds_read_b64_tr_b16 v[198:199], v233 offset:10240
buffer_load_dwordx4 v228, s[36:39], s52 offen lds
v_mfma_f32_16x16x32_bf16 v[168:171], v[176:179], v[36:39], v[168:171]
ds_read_b64_tr_b16 v[200:201], v232 offset:16384
v_exp_f32 v53, v53
v_mfma_f32_16x16x32_bf16 v[164:167], v[180:183], v[32:35], v[164:167]
ds_read_b64_tr_b16 v[202:203], v232 offset:18432
v_fma_f32 v54, v54, s51, -v242
v_fma_f32 v55, v55, s51, -v242
v_mfma_f32_16x16x32_bf16 v[172:175], v[180:183], v[36:39], v[172:175]
ds_read_b64_tr_b16 v[204:205], v233 offset:16384
buffer_load_dwordx4 v229, s[36:39], s52 offen offset:1024 lds
s_waitcnt lgkmcnt(7)
v_mfma_f32_16x16x32_bf16 v[128:131], v[184:187], v[40:43], v[128:131]
ds_read_b64_tr_b16 v[206:207], v233 offset:18432
v_add_f32 v244, v244, v52
v_add_f32 v244, v244, v53
v_mfma_f32_16x16x32_bf16 v[136:139], v[184:187], v[44:47], v[136:139]
s_add_u32 s52, s76, 4096000
s_add_u32 m0, s48, 131072
v_cvt_pk_bf16_f32 v50, v52, v53
v_exp_f32 v54, v54
v_mfma_f32_16x16x32_bf16 v[132:135], v[188:191], v[40:43], v[132:135]
buffer_load_dwordx4 v228, s[36:39], s52 offen lds
v_mfma_f32_16x16x32_bf16 v[140:143], v[188:191], v[44:47], v[140:143]
v_add_u32 v236, 65536, v230
v_xor_b32 v237, 32, v236
v_exp_f32 v55, v55
s_waitcnt lgkmcnt(4)
v_mfma_f32_16x16x32_bf16 v[144:147], v[192:195], v[40:43], v[144:147]
v_fma_f32 v56, v56, s51, -v243
v_fma_f32 v57, v57, s51, -v243
v_add_f32 v244, v244, v54
v_mfma_f32_16x16x32_bf16 v[152:155], v[192:195], v[44:47], v[152:155]
buffer_load_dwordx4 v229, s[36:39], s52 offen offset:1024 lds
s_waitcnt vmcnt(12) lgkmcnt(0)
s_barrier
ds_read_b64_tr_b16 v[176:177], v236 offset:0
ds_read_b64_tr_b16 v[178:179], v237 offset:512
ds_read_b64_tr_b16 v[180:181], v237 offset:0
ds_read_b64_tr_b16 v[182:183], v236 offset:512
ds_read_b64_tr_b16 v[184:185], v236 offset:4096
ds_read_b64_tr_b16 v[186:187], v237 offset:4608
v_mfma_f32_16x16x32_bf16 v[148:151], v[196:199], v[40:43], v[148:151]
s_mov_b32 s52, 4816896
s_add_u32 m0, s48, 139264
s_nop 0
buffer_load_dwordx4 v224, s[28:31], s52 offen nt lds
v_add_f32 v244, v244, v55
v_mfma_f32_16x16x32_bf16 v[156:159], v[196:199], v[44:47], v[156:159]
ds_read_b64_tr_b16 v[188:189], v237 offset:4096
v_cvt_pk_bf16_f32 v51, v54, v55
v_exp_f32 v56, v56
v_mfma_f32_16x16x32_bf16 v[160:163], v[200:203], v[40:43], v[160:163]
ds_read_b64_tr_b16 v[190:191], v236 offset:4608
buffer_load_dwordx4 v225, s[28:31], s52 offen offset:1024 nt lds
v_mfma_f32_16x16x32_bf16 v[168:171], v[200:203], v[44:47], v[168:171]
ds_read_b64_tr_b16 v[192:193], v236 offset:8192
s_add_u32 m0, s48, 147328
v_exp_f32 v57, v57
v_mfma_f32_16x16x32_bf16 v[164:167], v[204:207], v[40:43], v[164:167]
ds_read_b64_tr_b16 v[194:195], v237 offset:8704
buffer_load_dwordx4 v224, s[28:31], s52 offen offset:128 nt lds
v_fma_f32 v58, v58, s51, -v243
v_mfma_f32_16x16x32_bf16 v[172:175], v[204:207], v[44:47], v[172:175]
ds_read_b64_tr_b16 v[196:197], v237 offset:8192
v_fma_f32 v59, v59, s51, -v243
v_add_f32 v245, v245, v56
v_add_f32 v245, v245, v57
s_waitcnt lgkmcnt(7)
v_mfma_f32_16x16x32_bf16 a[80:83], v[176:179], a[208:211], a[80:83]
ds_read_b64_tr_b16 v[198:199], v236 offset:8704
buffer_load_dwordx4 v225, s[28:31], s52 offen offset:1152 nt lds
v_cvt_pk_bf16_f32 v52, v56, v57
v_mfma_f32_16x16x32_bf16 a[88:91], v[176:179], a[212:215], a[88:91]
ds_read_b64_tr_b16 v[200:201], v236 offset:12288
s_add_u32 m0, s48, 155392
v_exp_f32 v58, v58
v_mfma_f32_16x16x32_bf16 a[84:87], v[180:183], a[208:211], a[84:87]
ds_read_b64_tr_b16 v[202:203], v237 offset:12800
buffer_load_dwordx4 v224, s[28:31], s52 offen offset:256 nt lds
v_mfma_f32_16x16x32_bf16 a[92:95], v[180:183], a[212:215], a[92:95]
ds_read_b64_tr_b16 v[204:205], v237 offset:12288
v_exp_f32 v59, v59
v_fma_f32 v60, v60, s51, -v243
s_waitcnt lgkmcnt(7)
v_mfma_f32_16x16x32_bf16 a[80:83], v[184:187], a[216:219], a[80:83]
ds_read_b64_tr_b16 v[206:207], v236 offset:12800
v_fma_f32 v61, v61, s51, -v243
v_add_f32 v245, v245, v58
v_add_f32 v245, v245, v59
v_mfma_f32_16x16x32_bf16 a[88:91], v[184:187], a[220:223], a[88:91]
ds_read_b64_tr_b16 v[176:177], v236 offset:16384
buffer_load_dwordx4 v225, s[28:31], s52 offen offset:1280 nt lds
v_cvt_pk_bf16_f32 v53, v58, v59
v_mfma_f32_16x16x32_bf16 a[84:87], v[188:191], a[216:219], a[84:87]
ds_read_b64_tr_b16 v[178:179], v237 offset:16896
v_exp_f32 v60, v60
v_mfma_f32_16x16x32_bf16 a[92:95], v[188:191], a[220:223], a[92:95]
ds_read_b64_tr_b16 v[180:181], v237 offset:16384
v_exp_f32 v61, v61
v_fma_f32 v62, v62, s51, -v243
s_waitcnt lgkmcnt(7)
v_mfma_f32_16x16x32_bf16 a[80:83], v[192:195], a[224:227], a[80:83]
ds_read_b64_tr_b16 v[182:183], v236 offset:16896
v_fma_f32 v63, v63, s51, -v243
v_add_f32 v245, v245, v60
v_add_f32 v245, v245, v61
v_mfma_f32_16x16x32_bf16 a[88:91], v[192:195], a[228:231], a[88:91]
ds_read_b64_tr_b16 v[184:185], v236 offset:20480
v_cvt_pk_bf16_f32 v54, v60, v61
v_exp_f32 v62, v62
v_mfma_f32_16x16x32_bf16 a[84:87], v[196:199], a[224:227], a[84:87]
ds_read_b64_tr_b16 v[186:187], v237 offset:20992
v_exp_f32 v63, v63
v_add_f32 v245, v245, v62
v_mfma_f32_16x16x32_bf16 a[92:95], v[196:199], a[228:231], a[92:95]
ds_read_b64_tr_b16 v[188:189], v237 offset:20480
v_add_f32 v245, v245, v63
v_cvt_pk_bf16_f32 v55, v62, v63
ds_write_b128 v239, v[48:51] offset:8192
ds_write_b128 v239, v[52:55] offset:9216
s_waitcnt lgkmcnt(9)
v_mfma_f32_16x16x32_bf16 a[80:83], v[200:203], a[232:235], a[80:83]
ds_read_b64_tr_b16 v[190:191], v236 offset:20992
v_mfma_f32_16x16x32_bf16 a[88:91], v[200:203], a[236:239], a[88:91]
v_mfma_f32_16x16x32_bf16 a[84:87], v[204:207], a[232:235], a[84:87]
v_mfma_f32_16x16x32_bf16 a[92:95], v[204:207], a[236:239], a[92:95]
v_add_u32 v236, 90112, v250
v_xor_b32 v237, 32, v236
s_waitcnt lgkmcnt(6)
v_mfma_f32_16x16x32_bf16 a[80:83], v[176:179], a[240:243], a[80:83]
v_xor_b32 v232, 0x1000, v236
v_xor_b32 v233, 0x1000, v237
v_mfma_f32_16x16x32_bf16 a[88:91], v[176:179], a[244:247], a[88:91]
s_waitcnt vmcnt(12) lgkmcnt(0)
s_barrier
ds_read_b64_tr_b16 v[192:193], v236 offset:0
ds_read_b64_tr_b16 v[194:195], v236 offset:2048
ds_read_b64_tr_b16 v[196:197], v237 offset:0
ds_read_b64_tr_b16 v[198:199], v237 offset:2048
ds_read_b64_tr_b16 v[200:201], v236 offset:8192
ds_read_b64_tr_b16 v[202:203], v236 offset:10240
v_mfma_f32_16x16x32_bf16 a[84:87], v[180:183], a[240:243], a[84:87]
v_fma_f32 v64, v64, s51, -v242
v_fma_f32 v65, v65, s51, -v242
v_exp_f32 v64, v64
v_mfma_f32_16x16x32_bf16 a[92:95], v[180:183], a[244:247], a[92:95]
ds_read_b64_tr_b16 v[204:205], v237 offset:8192
v_exp_f32 v65, v65
v_mfma_f32_16x16x32_bf16 a[80:83], v[184:187], a[248:251], a[80:83]
ds_read_b64_tr_b16 v[206:207], v237 offset:10240
v_fma_f32 v66, v66, s51, -v242
v_fma_f32 v67, v67, s51, -v242
v_mfma_f32_16x16x32_bf16 a[88:91], v[184:187], a[252:255], a[88:91]
ds_read_b64_tr_b16 v[176:177], v236 offset:16384
v_add_f32 v244, v244, v64
v_add_f32 v244, v244, v65
v_mfma_f32_16x16x32_bf16 a[84:87], v[188:191], a[248:251], a[84:87]
ds_read_b64_tr_b16 v[178:179], v236 offset:18432
v_cvt_pk_bf16_f32 v64, v64, v65
v_exp_f32 v66, v66
v_mfma_f32_16x16x32_bf16 a[92:95], v[188:191], a[252:255], a[92:95]
ds_read_b64_tr_b16 v[180:181], v237 offset:16384
v_exp_f32 v67, v67
s_waitcnt lgkmcnt(7)
v_mfma_f32_16x16x32_bf16 v[128:131], v[192:195], v[48:51], v[128:131]
ds_read_b64_tr_b16 v[182:183], v237 offset:18432
v_fma_f32 v68, v68, s51, -v242
v_fma_f32 v69, v69, s51, -v242
v_mfma_f32_16x16x32_bf16 v[136:139], v[192:195], v[52:55], v[136:139]
ds_read_b128 v[56:59], v234 offset:8192
ds_read_b128 v[60:63], v234 offset:9216
v_add_f32 v244, v244, v66
v_mfma_f32_16x16x32_bf16 v[132:135], v[196:199], v[48:51], v[132:135]
ds_read_b64_tr_b16 v[184:185], v232 offset:0
ds_read_b64_tr_b16 v[186:187], v232 offset:2048
s_add_u32 s52, s77, 3932160
s_add_u32 m0, s48, 65536
v_mfma_f32_16x16x32_bf16 v[140:143], v[196:199], v[52:55], v[140:143]
ds_read_b64_tr_b16 v[188:189], v233 offset:0
buffer_load_dwordx4 v228, s[36:39], s52 offen lds
s_waitcnt lgkmcnt(9)
v_mfma_f32_16x16x32_bf16 v[144:147], v[200:203], v[48:51], v[144:147]
ds_read_b64_tr_b16 v[190:191], v233 offset:2048
v_add_f32 v244, v244, v67
v_cvt_pk_bf16_f32 v65, v66, v67
v_mfma_f32_16x16x32_bf16 v[152:155], v[200:203], v[52:55], v[152:155]
ds_read_b64_tr_b16 v[192:193], v232 offset:8192
buffer_load_dwordx4 v229, s[36:39], s52 offen offset:1024 lds
v_mfma_f32_16x16x32_bf16 v[148:151], v[204:207], v[48:51], v[148:151]
ds_read_b64_tr_b16 v[194:195], v232 offset:10240
v_exp_f32 v68, v68
v_mfma_f32_16x16x32_bf16 v[156:159], v[204:207], v[52:55], v[156:159]
ds_read_b64_tr_b16 v[196:197], v233 offset:8192
s_add_u32 s52, s77, 4014080
s_add_u32 m0, s48, 73728
s_waitcnt lgkmcnt(9)
v_mfma_f32_16x16x32_bf16 v[160:163], v[176:179], v[48:51], v[160:163]
ds_read_b64_tr_b16 v[198:199], v233 offset:10240
buffer_load_dwordx4 v228, s[36:39], s52 offen lds
v_mfma_f32_16x16x32_bf16 v[168:171], v[176:179], v[52:55], v[168:171]
ds_read_b64_tr_b16 v[200:201], v232 offset:16384
v_exp_f32 v69, v69
v_mfma_f32_16x16x32_bf16 v[164:167], v[180:183], v[48:51], v[164:167]
ds_read_b64_tr_b16 v[202:203], v232 offset:18432
v_fma_f32 v70, v70, s51, -v242
v_fma_f32 v71, v71, s51, -v242
v_mfma_f32_16x16x32_bf16 v[172:175], v[180:183], v[52:55], v[172:175]
ds_read_b64_tr_b16 v[204:205], v233 offset:16384
buffer_load_dwordx4 v229, s[36:39], s52 offen offset:1024 lds
s_waitcnt lgkmcnt(7)
v_mfma_f32_16x16x32_bf16 v[128:131], v[184:187], v[56:59], v[128:131]
ds_read_b64_tr_b16 v[206:207], v233 offset:18432
v_add_f32 v244, v244, v68
v_add_f32 v244, v244, v69
v_mfma_f32_16x16x32_bf16 v[136:139], v[184:187], v[60:63], v[136:139]
s_add_u32 s52, s77, 4096000
s_add_u32 m0, s48, 81920
v_cvt_pk_bf16_f32 v66, v68, v69
v_exp_f32 v70, v70
v_mfma_f32_16x16x32_bf16 v[132:135], v[188:191], v[56:59], v[132:135]
buffer_load_dwordx4 v228, s[36:39], s52 offen lds
v_mfma_f32_16x16x32_bf16 v[140:143], v[188:191], v[60:63], v[140:143]
v_add_u32 v236, 114688, v230
v_xor_b32 v237, 32, v236
v_exp_f32 v71, v71
s_waitcnt lgkmcnt(4)
v_mfma_f32_16x16x32_bf16 v[144:147], v[192:195], v[56:59], v[144:147]
v_fma_f32 v72, v72, s51, -v243
v_fma_f32 v73, v73, s51, -v243
v_add_f32 v244, v244, v70
v_mfma_f32_16x16x32_bf16 v[152:155], v[192:195], v[60:63], v[152:155]
buffer_load_dwordx4 v229, s[36:39], s52 offen offset:1024 lds
s_waitcnt vmcnt(12) lgkmcnt(0)
s_barrier
ds_read_b64_tr_b16 v[176:177], v236 offset:0
ds_read_b64_tr_b16 v[178:179], v237 offset:512
ds_read_b64_tr_b16 v[180:181], v237 offset:0
ds_read_b64_tr_b16 v[182:183], v236 offset:512
ds_read_b64_tr_b16 v[184:185], v236 offset:4096
ds_read_b64_tr_b16 v[186:187], v237 offset:4608
v_mfma_f32_16x16x32_bf16 v[148:151], v[196:199], v[56:59], v[148:151]
s_mov_b32 s52, 4841472
s_add_u32 m0, s48, 90112
s_nop 0
buffer_load_dwordx4 v224, s[28:31], s52 offen nt lds
v_add_f32 v244, v244, v71
v_mfma_f32_16x16x32_bf16 v[156:159], v[196:199], v[60:63], v[156:159]
ds_read_b64_tr_b16 v[188:189], v237 offset:4096
v_cvt_pk_bf16_f32 v67, v70, v71
v_exp_f32 v72, v72
v_mfma_f32_16x16x32_bf16 v[160:163], v[200:203], v[56:59], v[160:163]
ds_read_b64_tr_b16 v[190:191], v236 offset:4608
buffer_load_dwordx4 v225, s[28:31], s52 offen offset:1024 nt lds
v_mfma_f32_16x16x32_bf16 v[168:171], v[200:203], v[60:63], v[168:171]
ds_read_b64_tr_b16 v[192:193], v236 offset:8192
s_add_u32 m0, s48, 98176
v_exp_f32 v73, v73
v_mfma_f32_16x16x32_bf16 v[164:167], v[204:207], v[56:59], v[164:167]
ds_read_b64_tr_b16 v[194:195], v237 offset:8704
buffer_load_dwordx4 v224, s[28:31], s52 offen offset:128 nt lds
v_fma_f32 v74, v74, s51, -v243
v_mfma_f32_16x16x32_bf16 v[172:175], v[204:207], v[60:63], v[172:175]
ds_read_b64_tr_b16 v[196:197], v237 offset:8192
v_fma_f32 v75, v75, s51, -v243
v_add_f32 v245, v245, v72
v_add_f32 v245, v245, v73
s_waitcnt lgkmcnt(7)
v_mfma_f32_16x16x32_bf16 a[96:99], v[176:179], a[208:211], a[96:99]
ds_read_b64_tr_b16 v[198:199], v236 offset:8704
buffer_load_dwordx4 v225, s[28:31], s52 offen offset:1152 nt lds
v_cvt_pk_bf16_f32 v68, v72, v73
v_mfma_f32_16x16x32_bf16 a[104:107], v[176:179], a[212:215], a[104:107]
ds_read_b64_tr_b16 v[200:201], v236 offset:12288
s_add_u32 m0, s48, 106240
v_exp_f32 v74, v74
v_mfma_f32_16x16x32_bf16 a[100:103], v[180:183], a[208:211], a[100:103]
ds_read_b64_tr_b16 v[202:203], v237 offset:12800
buffer_load_dwordx4 v224, s[28:31], s52 offen offset:256 nt lds
v_mfma_f32_16x16x32_bf16 a[108:111], v[180:183], a[212:215], a[108:111]
ds_read_b64_tr_b16 v[204:205], v237 offset:12288
v_exp_f32 v75, v75
v_fma_f32 v76, v76, s51, -v243
s_waitcnt lgkmcnt(7)
v_mfma_f32_16x16x32_bf16 a[96:99], v[184:187], a[216:219], a[96:99]
ds_read_b64_tr_b16 v[206:207], v236 offset:12800
v_fma_f32 v77, v77, s51, -v243
v_add_f32 v245, v245, v74
v_add_f32 v245, v245, v75
v_mfma_f32_16x16x32_bf16 a[104:107], v[184:187], a[220:223], a[104:107]
ds_read_b64_tr_b16 v[176:177], v236 offset:16384
buffer_load_dwordx4 v225, s[28:31], s52 offen offset:1280 nt lds
v_cvt_pk_bf16_f32 v69, v74, v75
v_mfma_f32_16x16x32_bf16 a[100:103], v[188:191], a[216:219], a[100:103]
ds_read_b64_tr_b16 v[178:179], v237 offset:16896
v_exp_f32 v76, v76
v_mfma_f32_16x16x32_bf16 a[108:111], v[188:191], a[220:223], a[108:111]
ds_read_b64_tr_b16 v[180:181], v237 offset:16384
v_exp_f32 v77, v77
v_fma_f32 v78, v78, s51, -v243
s_waitcnt lgkmcnt(7)
v_mfma_f32_16x16x32_bf16 a[96:99], v[192:195], a[224:227], a[96:99]
ds_read_b64_tr_b16 v[182:183], v236 offset:16896
v_fma_f32 v79, v79, s51, -v243
v_add_f32 v245, v245, v76
v_add_f32 v245, v245, v77
v_mfma_f32_16x16x32_bf16 a[104:107], v[192:195], a[228:231], a[104:107]
ds_read_b64_tr_b16 v[184:185], v236 offset:20480
v_cvt_pk_bf16_f32 v70, v76, v77
v_exp_f32 v78, v78
v_mfma_f32_16x16x32_bf16 a[100:103], v[196:199], a[224:227], a[100:103]
ds_read_b64_tr_b16 v[186:187], v237 offset:20992
v_exp_f32 v79, v79
v_add_f32 v245, v245, v78
v_mfma_f32_16x16x32_bf16 a[108:111], v[196:199], a[228:231], a[108:111]
ds_read_b64_tr_b16 v[188:189], v237 offset:20480
v_add_f32 v245, v245, v79
v_cvt_pk_bf16_f32 v71, v78, v79
ds_write_b128 v239, v[64:67] offset:24576
ds_write_b128 v239, v[68:71] offset:25600
s_waitcnt lgkmcnt(9)
v_mfma_f32_16x16x32_bf16 a[96:99], v[200:203], a[232:235], a[96:99]
ds_read_b64_tr_b16 v[190:191], v236 offset:20992
v_mfma_f32_16x16x32_bf16 a[104:107], v[200:203], a[236:239], a[104:107]
v_mfma_f32_16x16x32_bf16 a[100:103], v[204:207], a[232:235], a[100:103]
v_mfma_f32_16x16x32_bf16 a[108:111], v[204:207], a[236:239], a[108:111]
v_add_u32 v236, 139264, v250
v_xor_b32 v237, 32, v236
s_waitcnt lgkmcnt(6)
v_mfma_f32_16x16x32_bf16 a[96:99], v[176:179], a[240:243], a[96:99]
v_xor_b32 v232, 0x1000, v236
v_xor_b32 v233, 0x1000, v237
v_mfma_f32_16x16x32_bf16 a[104:107], v[176:179], a[244:247], a[104:107]
s_waitcnt vmcnt(12) lgkmcnt(0)
s_barrier
ds_read_b64_tr_b16 v[192:193], v236 offset:0
ds_read_b64_tr_b16 v[194:195], v236 offset:2048
ds_read_b64_tr_b16 v[196:197], v237 offset:0
ds_read_b64_tr_b16 v[198:199], v237 offset:2048
ds_read_b64_tr_b16 v[200:201], v236 offset:8192
ds_read_b64_tr_b16 v[202:203], v236 offset:10240
v_mfma_f32_16x16x32_bf16 a[100:103], v[180:183], a[240:243], a[100:103]
v_fma_f32 v80, v80, s51, -v242
v_fma_f32 v81, v81, s51, -v242
v_exp_f32 v80, v80
v_mfma_f32_16x16x32_bf16 a[108:111], v[180:183], a[244:247], a[108:111]
ds_read_b64_tr_b16 v[204:205], v237 offset:8192
v_exp_f32 v81, v81
v_mfma_f32_16x16x32_bf16 a[96:99], v[184:187], a[248:251], a[96:99]
ds_read_b64_tr_b16 v[206:207], v237 offset:10240
v_fma_f32 v82, v82, s51, -v242
v_fma_f32 v83, v83, s51, -v242
v_mfma_f32_16x16x32_bf16 a[104:107], v[184:187], a[252:255], a[104:107]
ds_read_b64_tr_b16 v[176:177], v236 offset:16384
v_add_f32 v244, v244, v80
v_add_f32 v244, v244, v81
v_mfma_f32_16x16x32_bf16 a[100:103], v[188:191], a[248:251], a[100:103]
ds_read_b64_tr_b16 v[178:179], v236 offset:18432
v_cvt_pk_bf16_f32 v80, v80, v81
v_exp_f32 v82, v82
v_mfma_f32_16x16x32_bf16 a[108:111], v[188:191], a[252:255], a[108:111]
ds_read_b64_tr_b16 v[180:181], v237 offset:16384
v_exp_f32 v83, v83
s_waitcnt lgkmcnt(7)
v_mfma_f32_16x16x32_bf16 v[128:131], v[192:195], v[64:67], v[128:131]
ds_read_b64_tr_b16 v[182:183], v237 offset:18432
v_fma_f32 v84, v84, s51, -v242
v_fma_f32 v85, v85, s51, -v242
v_mfma_f32_16x16x32_bf16 v[136:139], v[192:195], v[68:71], v[136:139]
ds_read_b128 v[72:75], v234 offset:24576
ds_read_b128 v[76:79], v234 offset:25600
v_add_f32 v244, v244, v82
v_mfma_f32_16x16x32_bf16 v[132:135], v[196:199], v[64:67], v[132:135]
ds_read_b64_tr_b16 v[184:185], v232 offset:0
ds_read_b64_tr_b16 v[186:187], v232 offset:2048
s_add_u32 s52, s78, 3932160
s_add_u32 m0, s48, 114688
v_mfma_f32_16x16x32_bf16 v[140:143], v[196:199], v[68:71], v[140:143]
ds_read_b64_tr_b16 v[188:189], v233 offset:0
buffer_load_dwordx4 v228, s[36:39], s52 offen lds
s_waitcnt lgkmcnt(9)
v_mfma_f32_16x16x32_bf16 v[144:147], v[200:203], v[64:67], v[144:147]
ds_read_b64_tr_b16 v[190:191], v233 offset:2048
v_add_f32 v244, v244, v83
v_cvt_pk_bf16_f32 v81, v82, v83
v_mfma_f32_16x16x32_bf16 v[152:155], v[200:203], v[68:71], v[152:155]
ds_read_b64_tr_b16 v[192:193], v232 offset:8192
buffer_load_dwordx4 v229, s[36:39], s52 offen offset:1024 lds
v_mfma_f32_16x16x32_bf16 v[148:151], v[204:207], v[64:67], v[148:151]
ds_read_b64_tr_b16 v[194:195], v232 offset:10240
v_exp_f32 v84, v84
v_mfma_f32_16x16x32_bf16 v[156:159], v[204:207], v[68:71], v[156:159]
ds_read_b64_tr_b16 v[196:197], v233 offset:8192
s_add_u32 s52, s78, 4014080
s_add_u32 m0, s48, 122880
s_waitcnt lgkmcnt(9)
v_mfma_f32_16x16x32_bf16 v[160:163], v[176:179], v[64:67], v[160:163]
ds_read_b64_tr_b16 v[198:199], v233 offset:10240
buffer_load_dwordx4 v228, s[36:39], s52 offen lds
v_mfma_f32_16x16x32_bf16 v[168:171], v[176:179], v[68:71], v[168:171]
ds_read_b64_tr_b16 v[200:201], v232 offset:16384
v_exp_f32 v85, v85
v_mfma_f32_16x16x32_bf16 v[164:167], v[180:183], v[64:67], v[164:167]
ds_read_b64_tr_b16 v[202:203], v232 offset:18432
v_fma_f32 v86, v86, s51, -v242
v_fma_f32 v87, v87, s51, -v242
v_mfma_f32_16x16x32_bf16 v[172:175], v[180:183], v[68:71], v[172:175]
ds_read_b64_tr_b16 v[204:205], v233 offset:16384
buffer_load_dwordx4 v229, s[36:39], s52 offen offset:1024 lds
s_waitcnt lgkmcnt(7)
v_mfma_f32_16x16x32_bf16 v[128:131], v[184:187], v[72:75], v[128:131]
ds_read_b64_tr_b16 v[206:207], v233 offset:18432
v_add_f32 v244, v244, v84
v_add_f32 v244, v244, v85
v_mfma_f32_16x16x32_bf16 v[136:139], v[184:187], v[76:79], v[136:139]
s_add_u32 s52, s78, 4096000
s_add_u32 m0, s48, 131072
v_cvt_pk_bf16_f32 v82, v84, v85
v_exp_f32 v86, v86
v_mfma_f32_16x16x32_bf16 v[132:135], v[188:191], v[72:75], v[132:135]
buffer_load_dwordx4 v228, s[36:39], s52 offen lds
v_mfma_f32_16x16x32_bf16 v[140:143], v[188:191], v[76:79], v[140:143]
v_add_u32 v236, 65536, v230
v_xor_b32 v237, 32, v236
v_exp_f32 v87, v87
s_waitcnt lgkmcnt(4)
v_mfma_f32_16x16x32_bf16 v[144:147], v[192:195], v[72:75], v[144:147]
v_fma_f32 v88, v88, s51, -v243
v_fma_f32 v89, v89, s51, -v243
v_add_f32 v244, v244, v86
v_mfma_f32_16x16x32_bf16 v[152:155], v[192:195], v[76:79], v[152:155]
buffer_load_dwordx4 v229, s[36:39], s52 offen offset:1024 lds
s_waitcnt vmcnt(12) lgkmcnt(0)
s_barrier
ds_read_b64_tr_b16 v[176:177], v236 offset:0
ds_read_b64_tr_b16 v[178:179], v237 offset:512
ds_read_b64_tr_b16 v[180:181], v237 offset:0
ds_read_b64_tr_b16 v[182:183], v236 offset:512
ds_read_b64_tr_b16 v[184:185], v236 offset:4096
ds_read_b64_tr_b16 v[186:187], v237 offset:4608
v_mfma_f32_16x16x32_bf16 v[148:151], v[196:199], v[72:75], v[148:151]
s_mov_b32 s52, 4866048
s_add_u32 m0, s48, 139264
s_nop 0
buffer_load_dwordx4 v224, s[28:31], s52 offen nt lds
v_add_f32 v244, v244, v87
v_mfma_f32_16x16x32_bf16 v[156:159], v[196:199], v[76:79], v[156:159]
ds_read_b64_tr_b16 v[188:189], v237 offset:4096
v_cvt_pk_bf16_f32 v83, v86, v87
v_exp_f32 v88, v88
v_mfma_f32_16x16x32_bf16 v[160:163], v[200:203], v[72:75], v[160:163]
ds_read_b64_tr_b16 v[190:191], v236 offset:4608
buffer_load_dwordx4 v225, s[28:31], s52 offen offset:1024 nt lds
v_mfma_f32_16x16x32_bf16 v[168:171], v[200:203], v[76:79], v[168:171]
ds_read_b64_tr_b16 v[192:193], v236 offset:8192
s_add_u32 m0, s48, 147328
v_exp_f32 v89, v89
v_mfma_f32_16x16x32_bf16 v[164:167], v[204:207], v[72:75], v[164:167]
ds_read_b64_tr_b16 v[194:195], v237 offset:8704
buffer_load_dwordx4 v224, s[28:31], s52 offen offset:128 nt lds
v_fma_f32 v90, v90, s51, -v243
v_mfma_f32_16x16x32_bf16 v[172:175], v[204:207], v[76:79], v[172:175]
ds_read_b64_tr_b16 v[196:197], v237 offset:8192
v_fma_f32 v91, v91, s51, -v243
v_add_f32 v245, v245, v88
v_add_f32 v245, v245, v89
s_waitcnt lgkmcnt(7)
v_mfma_f32_16x16x32_bf16 a[112:115], v[176:179], a[208:211], a[112:115]
ds_read_b64_tr_b16 v[198:199], v236 offset:8704
buffer_load_dwordx4 v225, s[28:31], s52 offen offset:1152 nt lds
v_cvt_pk_bf16_f32 v84, v88, v89
v_mfma_f32_16x16x32_bf16 a[120:123], v[176:179], a[212:215], a[120:123]
ds_read_b64_tr_b16 v[200:201], v236 offset:12288
s_add_u32 m0, s48, 155392
v_exp_f32 v90, v90
v_mfma_f32_16x16x32_bf16 a[116:119], v[180:183], a[208:211], a[116:119]
ds_read_b64_tr_b16 v[202:203], v237 offset:12800
buffer_load_dwordx4 v224, s[28:31], s52 offen offset:256 nt lds
v_mfma_f32_16x16x32_bf16 a[124:127], v[180:183], a[212:215], a[124:127]
ds_read_b64_tr_b16 v[204:205], v237 offset:12288
v_exp_f32 v91, v91
v_fma_f32 v92, v92, s51, -v243
s_waitcnt lgkmcnt(7)
v_mfma_f32_16x16x32_bf16 a[112:115], v[184:187], a[216:219], a[112:115]
ds_read_b64_tr_b16 v[206:207], v236 offset:12800
v_fma_f32 v93, v93, s51, -v243
v_add_f32 v245, v245, v90
v_add_f32 v245, v245, v91
v_mfma_f32_16x16x32_bf16 a[120:123], v[184:187], a[220:223], a[120:123]
ds_read_b64_tr_b16 v[176:177], v236 offset:16384
buffer_load_dwordx4 v225, s[28:31], s52 offen offset:1280 nt lds
v_cvt_pk_bf16_f32 v85, v90, v91
v_mfma_f32_16x16x32_bf16 a[116:119], v[188:191], a[216:219], a[116:119]
ds_read_b64_tr_b16 v[178:179], v237 offset:16896
v_exp_f32 v92, v92
v_mfma_f32_16x16x32_bf16 a[124:127], v[188:191], a[220:223], a[124:127]
ds_read_b64_tr_b16 v[180:181], v237 offset:16384
v_exp_f32 v93, v93
v_fma_f32 v94, v94, s51, -v243
s_waitcnt lgkmcnt(7)
v_mfma_f32_16x16x32_bf16 a[112:115], v[192:195], a[224:227], a[112:115]
ds_read_b64_tr_b16 v[182:183], v236 offset:16896
v_fma_f32 v95, v95, s51, -v243
v_add_f32 v245, v245, v92
v_add_f32 v245, v245, v93
v_mfma_f32_16x16x32_bf16 a[120:123], v[192:195], a[228:231], a[120:123]
ds_read_b64_tr_b16 v[184:185], v236 offset:20480
v_cvt_pk_bf16_f32 v86, v92, v93
v_exp_f32 v94, v94
v_mfma_f32_16x16x32_bf16 a[116:119], v[196:199], a[224:227], a[116:119]
ds_read_b64_tr_b16 v[186:187], v237 offset:20992
v_exp_f32 v95, v95
v_add_f32 v245, v245, v94
v_mfma_f32_16x16x32_bf16 a[124:127], v[196:199], a[228:231], a[124:127]
ds_read_b64_tr_b16 v[188:189], v237 offset:20480
v_add_f32 v245, v245, v95
v_cvt_pk_bf16_f32 v87, v94, v95
ds_write_b128 v239, v[80:83] offset:8192
ds_write_b128 v239, v[84:87] offset:9216
s_waitcnt lgkmcnt(9)
v_mfma_f32_16x16x32_bf16 a[112:115], v[200:203], a[232:235], a[112:115]
ds_read_b64_tr_b16 v[190:191], v236 offset:20992
v_mfma_f32_16x16x32_bf16 a[120:123], v[200:203], a[236:239], a[120:123]
v_mfma_f32_16x16x32_bf16 a[116:119], v[204:207], a[232:235], a[116:119]
v_mfma_f32_16x16x32_bf16 a[124:127], v[204:207], a[236:239], a[124:127]
v_add_u32 v236, 90112, v250
v_xor_b32 v237, 32, v236
s_waitcnt lgkmcnt(6)
v_mfma_f32_16x16x32_bf16 a[112:115], v[176:179], a[240:243], a[112:115]
v_xor_b32 v232, 0x1000, v236
v_xor_b32 v233, 0x1000, v237
v_mfma_f32_16x16x32_bf16 a[120:123], v[176:179], a[244:247], a[120:123]
s_waitcnt vmcnt(12) lgkmcnt(0)
s_barrier
ds_read_b64_tr_b16 v[192:193], v236 offset:0
ds_read_b64_tr_b16 v[194:195], v236 offset:2048
ds_read_b64_tr_b16 v[196:197], v237 offset:0
ds_read_b64_tr_b16 v[198:199], v237 offset:2048
ds_read_b64_tr_b16 v[200:201], v236 offset:8192
ds_read_b64_tr_b16 v[202:203], v236 offset:10240
v_mfma_f32_16x16x32_bf16 a[116:119], v[180:183], a[240:243], a[116:119]
v_fma_f32 v96, v96, s51, -v242
v_fma_f32 v97, v97, s51, -v242
v_exp_f32 v96, v96
v_mfma_f32_16x16x32_bf16 a[124:127], v[180:183], a[244:247], a[124:127]
ds_read_b64_tr_b16 v[204:205], v237 offset:8192
v_exp_f32 v97, v97
v_mfma_f32_16x16x32_bf16 a[112:115], v[184:187], a[248:251], a[112:115]
ds_read_b64_tr_b16 v[206:207], v237 offset:10240
v_fma_f32 v98, v98, s51, -v242
v_fma_f32 v99, v99, s51, -v242
v_mfma_f32_16x16x32_bf16 a[120:123], v[184:187], a[252:255], a[120:123]
ds_read_b64_tr_b16 v[176:177], v236 offset:16384
v_add_f32 v244, v244, v96
v_add_f32 v244, v244, v97
v_mfma_f32_16x16x32_bf16 a[116:119], v[188:191], a[248:251], a[116:119]
ds_read_b64_tr_b16 v[178:179], v236 offset:18432
v_cvt_pk_bf16_f32 v96, v96, v97
v_exp_f32 v98, v98
v_mfma_f32_16x16x32_bf16 a[124:127], v[188:191], a[252:255], a[124:127]
ds_read_b64_tr_b16 v[180:181], v237 offset:16384
v_exp_f32 v99, v99
s_waitcnt lgkmcnt(7)
v_mfma_f32_16x16x32_bf16 v[128:131], v[192:195], v[80:83], v[128:131]
ds_read_b64_tr_b16 v[182:183], v237 offset:18432
v_fma_f32 v100, v100, s51, -v242
v_fma_f32 v101, v101, s51, -v242
v_mfma_f32_16x16x32_bf16 v[136:139], v[192:195], v[84:87], v[136:139]
ds_read_b128 v[88:91], v234 offset:8192
ds_read_b128 v[92:95], v234 offset:9216
v_add_f32 v244, v244, v98
v_mfma_f32_16x16x32_bf16 v[132:135], v[196:199], v[80:83], v[132:135]
ds_read_b64_tr_b16 v[184:185], v232 offset:0
ds_read_b64_tr_b16 v[186:187], v232 offset:2048
s_add_u32 s52, s79, 3932160
s_add_u32 m0, s48, 65536
v_mfma_f32_16x16x32_bf16 v[140:143], v[196:199], v[84:87], v[140:143]
ds_read_b64_tr_b16 v[188:189], v233 offset:0
buffer_load_dwordx4 v228, s[36:39], s52 offen lds
s_waitcnt lgkmcnt(9)
v_mfma_f32_16x16x32_bf16 v[144:147], v[200:203], v[80:83], v[144:147]
ds_read_b64_tr_b16 v[190:191], v233 offset:2048
v_add_f32 v244, v244, v99
v_cvt_pk_bf16_f32 v97, v98, v99
v_mfma_f32_16x16x32_bf16 v[152:155], v[200:203], v[84:87], v[152:155]
ds_read_b64_tr_b16 v[192:193], v232 offset:8192
buffer_load_dwordx4 v229, s[36:39], s52 offen offset:1024 lds
v_mfma_f32_16x16x32_bf16 v[148:151], v[204:207], v[80:83], v[148:151]
ds_read_b64_tr_b16 v[194:195], v232 offset:10240
v_exp_f32 v100, v100
v_mfma_f32_16x16x32_bf16 v[156:159], v[204:207], v[84:87], v[156:159]
ds_read_b64_tr_b16 v[196:197], v233 offset:8192
s_add_u32 s52, s79, 4014080
s_add_u32 m0, s48, 73728
s_waitcnt lgkmcnt(9)
v_mfma_f32_16x16x32_bf16 v[160:163], v[176:179], v[80:83], v[160:163]
ds_read_b64_tr_b16 v[198:199], v233 offset:10240
buffer_load_dwordx4 v228, s[36:39], s52 offen lds
v_mfma_f32_16x16x32_bf16 v[168:171], v[176:179], v[84:87], v[168:171]
ds_read_b64_tr_b16 v[200:201], v232 offset:16384
v_exp_f32 v101, v101
v_mfma_f32_16x16x32_bf16 v[164:167], v[180:183], v[80:83], v[164:167]
ds_read_b64_tr_b16 v[202:203], v232 offset:18432
v_fma_f32 v102, v102, s51, -v242
v_fma_f32 v103, v103, s51, -v242
v_mfma_f32_16x16x32_bf16 v[172:175], v[180:183], v[84:87], v[172:175]
ds_read_b64_tr_b16 v[204:205], v233 offset:16384
buffer_load_dwordx4 v229, s[36:39], s52 offen offset:1024 lds
s_waitcnt lgkmcnt(7)
v_mfma_f32_16x16x32_bf16 v[128:131], v[184:187], v[88:91], v[128:131]
ds_read_b64_tr_b16 v[206:207], v233 offset:18432
v_add_f32 v244, v244, v100
v_add_f32 v244, v244, v101
v_mfma_f32_16x16x32_bf16 v[136:139], v[184:187], v[92:95], v[136:139]
s_add_u32 s52, s79, 4096000
s_add_u32 m0, s48, 81920
v_cvt_pk_bf16_f32 v98, v100, v101
v_exp_f32 v102, v102
v_mfma_f32_16x16x32_bf16 v[132:135], v[188:191], v[88:91], v[132:135]
buffer_load_dwordx4 v228, s[36:39], s52 offen lds
v_mfma_f32_16x16x32_bf16 v[140:143], v[188:191], v[92:95], v[140:143]
v_add_u32 v236, 114688, v230
v_xor_b32 v237, 32, v236
v_exp_f32 v103, v103
s_waitcnt lgkmcnt(4)
v_mfma_f32_16x16x32_bf16 v[144:147], v[192:195], v[88:91], v[144:147]
v_fma_f32 v104, v104, s51, -v243
v_fma_f32 v105, v105, s51, -v243
v_add_f32 v244, v244, v102
v_mfma_f32_16x16x32_bf16 v[152:155], v[192:195], v[92:95], v[152:155]
buffer_load_dwordx4 v229, s[36:39], s52 offen offset:1024 lds
s_waitcnt vmcnt(12) lgkmcnt(0)
s_barrier
ds_read_b64_tr_b16 v[176:177], v236 offset:0
ds_read_b64_tr_b16 v[178:179], v237 offset:512
ds_read_b64_tr_b16 v[180:181], v237 offset:0
ds_read_b64_tr_b16 v[182:183], v236 offset:512
ds_read_b64_tr_b16 v[184:185], v236 offset:4096
ds_read_b64_tr_b16 v[186:187], v237 offset:4608
v_mfma_f32_16x16x32_bf16 v[148:151], v[196:199], v[88:91], v[148:151]
s_mov_b32 s52, 4890624
s_add_u32 m0, s48, 90112
s_nop 0
buffer_load_dwordx4 v224, s[28:31], s52 offen nt lds
v_add_f32 v244, v244, v103
v_mfma_f32_16x16x32_bf16 v[156:159], v[196:199], v[92:95], v[156:159]
ds_read_b64_tr_b16 v[188:189], v237 offset:4096
v_cvt_pk_bf16_f32 v99, v102, v103
v_exp_f32 v104, v104
v_mfma_f32_16x16x32_bf16 v[160:163], v[200:203], v[88:91], v[160:163]
ds_read_b64_tr_b16 v[190:191], v236 offset:4608
buffer_load_dwordx4 v225, s[28:31], s52 offen offset:1024 nt lds
v_mfma_f32_16x16x32_bf16 v[168:171], v[200:203], v[92:95], v[168:171]
ds_read_b64_tr_b16 v[192:193], v236 offset:8192
s_add_u32 m0, s48, 98176
v_exp_f32 v105, v105
v_mfma_f32_16x16x32_bf16 v[164:167], v[204:207], v[88:91], v[164:167]
ds_read_b64_tr_b16 v[194:195], v237 offset:8704
buffer_load_dwordx4 v224, s[28:31], s52 offen offset:128 nt lds
v_fma_f32 v106, v106, s51, -v243
v_mfma_f32_16x16x32_bf16 v[172:175], v[204:207], v[92:95], v[172:175]
ds_read_b64_tr_b16 v[196:197], v237 offset:8192
v_fma_f32 v107, v107, s51, -v243
v_add_f32 v245, v245, v104
v_add_f32 v245, v245, v105
s_waitcnt lgkmcnt(7)
v_mfma_f32_16x16x32_bf16 a[128:131], v[176:179], a[208:211], a[128:131]
ds_read_b64_tr_b16 v[198:199], v236 offset:8704
buffer_load_dwordx4 v225, s[28:31], s52 offen offset:1152 nt lds
v_cvt_pk_bf16_f32 v100, v104, v105
v_mfma_f32_16x16x32_bf16 a[136:139], v[176:179], a[212:215], a[136:139]
ds_read_b64_tr_b16 v[200:201], v236 offset:12288
s_add_u32 m0, s48, 106240
v_exp_f32 v106, v106
v_mfma_f32_16x16x32_bf16 a[132:135], v[180:183], a[208:211], a[132:135]
ds_read_b64_tr_b16 v[202:203], v237 offset:12800
buffer_load_dwordx4 v224, s[28:31], s52 offen offset:256 nt lds
v_mfma_f32_16x16x32_bf16 a[140:143], v[180:183], a[212:215], a[140:143]
ds_read_b64_tr_b16 v[204:205], v237 offset:12288
v_exp_f32 v107, v107
v_fma_f32 v108, v108, s51, -v243
s_waitcnt lgkmcnt(7)
v_mfma_f32_16x16x32_bf16 a[128:131], v[184:187], a[216:219], a[128:131]
ds_read_b64_tr_b16 v[206:207], v236 offset:12800
v_fma_f32 v109, v109, s51, -v243
v_add_f32 v245, v245, v106
v_add_f32 v245, v245, v107
v_mfma_f32_16x16x32_bf16 a[136:139], v[184:187], a[220:223], a[136:139]
ds_read_b64_tr_b16 v[176:177], v236 offset:16384
buffer_load_dwordx4 v225, s[28:31], s52 offen offset:1280 nt lds
v_cvt_pk_bf16_f32 v101, v106, v107
v_mfma_f32_16x16x32_bf16 a[132:135], v[188:191], a[216:219], a[132:135]
ds_read_b64_tr_b16 v[178:179], v237 offset:16896
v_exp_f32 v108, v108
v_mfma_f32_16x16x32_bf16 a[140:143], v[188:191], a[220:223], a[140:143]
ds_read_b64_tr_b16 v[180:181], v237 offset:16384
v_exp_f32 v109, v109
v_fma_f32 v110, v110, s51, -v243
s_waitcnt lgkmcnt(7)
v_mfma_f32_16x16x32_bf16 a[128:131], v[192:195], a[224:227], a[128:131]
ds_read_b64_tr_b16 v[182:183], v236 offset:16896
v_fma_f32 v111, v111, s51, -v243
v_add_f32 v245, v245, v108
v_add_f32 v245, v245, v109
v_mfma_f32_16x16x32_bf16 a[136:139], v[192:195], a[228:231], a[136:139]
ds_read_b64_tr_b16 v[184:185], v236 offset:20480
v_cvt_pk_bf16_f32 v102, v108, v109
v_exp_f32 v110, v110
v_mfma_f32_16x16x32_bf16 a[132:135], v[196:199], a[224:227], a[132:135]
ds_read_b64_tr_b16 v[186:187], v237 offset:20992
v_exp_f32 v111, v111
v_add_f32 v245, v245, v110
v_mfma_f32_16x16x32_bf16 a[140:143], v[196:199], a[228:231], a[140:143]
ds_read_b64_tr_b16 v[188:189], v237 offset:20480
v_add_f32 v245, v245, v111
v_cvt_pk_bf16_f32 v103, v110, v111
ds_write_b128 v239, v[96:99] offset:24576
ds_write_b128 v239, v[100:103] offset:25600
s_waitcnt lgkmcnt(9)
v_mfma_f32_16x16x32_bf16 a[128:131], v[200:203], a[232:235], a[128:131]
ds_read_b64_tr_b16 v[190:191], v236 offset:20992
v_mfma_f32_16x16x32_bf16 a[136:139], v[200:203], a[236:239], a[136:139]
v_mfma_f32_16x16x32_bf16 a[132:135], v[204:207], a[232:235], a[132:135]
v_mfma_f32_16x16x32_bf16 a[140:143], v[204:207], a[236:239], a[140:143]
v_add_u32 v236, 139264, v250
v_xor_b32 v237, 32, v236
s_waitcnt lgkmcnt(6)
v_mfma_f32_16x16x32_bf16 a[128:131], v[176:179], a[240:243], a[128:131]
v_xor_b32 v232, 0x1000, v236
v_xor_b32 v233, 0x1000, v237
v_mfma_f32_16x16x32_bf16 a[136:139], v[176:179], a[244:247], a[136:139]
s_waitcnt vmcnt(12) lgkmcnt(0)
s_barrier
ds_read_b64_tr_b16 v[192:193], v236 offset:0
ds_read_b64_tr_b16 v[194:195], v236 offset:2048
ds_read_b64_tr_b16 v[196:197], v237 offset:0
ds_read_b64_tr_b16 v[198:199], v237 offset:2048
ds_read_b64_tr_b16 v[200:201], v236 offset:8192
ds_read_b64_tr_b16 v[202:203], v236 offset:10240
v_mfma_f32_16x16x32_bf16 a[132:135], v[180:183], a[240:243], a[132:135]
v_fma_f32 v112, v112, s51, -v242
v_fma_f32 v113, v113, s51, -v242
v_exp_f32 v112, v112
v_mfma_f32_16x16x32_bf16 a[140:143], v[180:183], a[244:247], a[140:143]
ds_read_b64_tr_b16 v[204:205], v237 offset:8192
v_exp_f32 v113, v113
v_mfma_f32_16x16x32_bf16 a[128:131], v[184:187], a[248:251], a[128:131]
ds_read_b64_tr_b16 v[206:207], v237 offset:10240
v_fma_f32 v114, v114, s51, -v242
v_fma_f32 v115, v115, s51, -v242
v_mfma_f32_16x16x32_bf16 a[136:139], v[184:187], a[252:255], a[136:139]
ds_read_b64_tr_b16 v[176:177], v236 offset:16384
v_add_f32 v244, v244, v112
v_add_f32 v244, v244, v113
v_mfma_f32_16x16x32_bf16 a[132:135], v[188:191], a[248:251], a[132:135]
ds_read_b64_tr_b16 v[178:179], v236 offset:18432
v_cvt_pk_bf16_f32 v112, v112, v113
v_exp_f32 v114, v114
v_mfma_f32_16x16x32_bf16 a[140:143], v[188:191], a[252:255], a[140:143]
ds_read_b64_tr_b16 v[180:181], v237 offset:16384
v_exp_f32 v115, v115
s_waitcnt lgkmcnt(7)
v_mfma_f32_16x16x32_bf16 v[128:131], v[192:195], v[96:99], v[128:131]
ds_read_b64_tr_b16 v[182:183], v237 offset:18432
v_fma_f32 v116, v116, s51, -v242
v_fma_f32 v117, v117, s51, -v242
v_mfma_f32_16x16x32_bf16 v[136:139], v[192:195], v[100:103], v[136:139]
ds_read_b128 v[104:107], v234 offset:24576
ds_read_b128 v[108:111], v234 offset:25600
v_add_f32 v244, v244, v114
v_mfma_f32_16x16x32_bf16 v[132:135], v[196:199], v[96:99], v[132:135]
ds_read_b64_tr_b16 v[184:185], v232 offset:0
ds_read_b64_tr_b16 v[186:187], v232 offset:2048
s_add_u32 s52, s70, 5898240
s_add_u32 m0, s48, 114688
v_mfma_f32_16x16x32_bf16 v[140:143], v[196:199], v[100:103], v[140:143]
ds_read_b64_tr_b16 v[188:189], v233 offset:0
buffer_load_dwordx4 v228, s[36:39], s52 offen lds
s_waitcnt lgkmcnt(9)
v_mfma_f32_16x16x32_bf16 v[144:147], v[200:203], v[96:99], v[144:147]
ds_read_b64_tr_b16 v[190:191], v233 offset:2048
v_add_f32 v244, v244, v115
v_cvt_pk_bf16_f32 v113, v114, v115
v_mfma_f32_16x16x32_bf16 v[152:155], v[200:203], v[100:103], v[152:155]
ds_read_b64_tr_b16 v[192:193], v232 offset:8192
buffer_load_dwordx4 v229, s[36:39], s52 offen offset:1024 lds
v_mfma_f32_16x16x32_bf16 v[148:151], v[204:207], v[96:99], v[148:151]
ds_read_b64_tr_b16 v[194:195], v232 offset:10240
v_exp_f32 v116, v116
v_mfma_f32_16x16x32_bf16 v[156:159], v[204:207], v[100:103], v[156:159]
ds_read_b64_tr_b16 v[196:197], v233 offset:8192
s_add_u32 s52, s70, 5980160
s_add_u32 m0, s48, 122880
v_exp_f32 v117, v117
s_waitcnt lgkmcnt(9)
v_mfma_f32_16x16x32_bf16 v[160:163], v[176:179], v[96:99], v[160:163]
ds_read_b64_tr_b16 v[198:199], v233 offset:10240
buffer_load_dwordx4 v228, s[36:39], s52 offen lds
v_mfma_f32_16x16x32_bf16 v[168:171], v[176:179], v[100:103], v[168:171]
ds_read_b64_tr_b16 v[200:201], v232 offset:16384
v_fma_f32 v118, v118, s51, -v242
v_fma_f32 v119, v119, s51, -v242
v_mfma_f32_16x16x32_bf16 v[164:167], v[180:183], v[96:99], v[164:167]
ds_read_b64_tr_b16 v[202:203], v232 offset:18432
v_add_f32 v244, v244, v116
v_add_f32 v244, v244, v117
v_cvt_pk_bf16_f32 v114, v116, v117
v_mfma_f32_16x16x32_bf16 v[172:175], v[180:183], v[100:103], v[172:175]
ds_read_b64_tr_b16 v[204:205], v233 offset:16384
buffer_load_dwordx4 v229, s[36:39], s52 offen offset:1024 lds
s_waitcnt lgkmcnt(7)
v_mfma_f32_16x16x32_bf16 v[128:131], v[184:187], v[104:107], v[128:131]
ds_read_b64_tr_b16 v[206:207], v233 offset:18432
v_exp_f32 v118, v118
v_mfma_f32_16x16x32_bf16 v[136:139], v[184:187], v[108:111], v[136:139]
s_add_u32 s52, s70, 6062080
s_add_u32 m0, s48, 131072
v_exp_f32 v119, v119
v_fma_f32 v120, v120, s51, -v243
v_mfma_f32_16x16x32_bf16 v[132:135], v[188:191], v[104:107], v[132:135]
buffer_load_dwordx4 v228, s[36:39], s52 offen lds
v_fma_f32 v121, v121, s51, -v243
v_add_f32 v244, v244, v118
v_mfma_f32_16x16x32_bf16 v[140:143], v[188:191], v[108:111], v[140:143]
v_add_u32 v236, 65536, v230
v_xor_b32 v237, 32, v236
v_add_f32 v244, v244, v119
s_waitcnt lgkmcnt(4)
v_mfma_f32_16x16x32_bf16 v[144:147], v[192:195], v[104:107], v[144:147]
v_cvt_pk_bf16_f32 v115, v118, v119
v_exp_f32 v120, v120
v_mfma_f32_16x16x32_bf16 v[152:155], v[192:195], v[108:111], v[152:155]
buffer_load_dwordx4 v229, s[36:39], s52 offen offset:1024 lds
v_exp_f32 v121, v121
s_waitcnt vmcnt(12) lgkmcnt(0)
s_barrier
ds_read_b64_tr_b16 v[176:177], v236 offset:0
ds_read_b64_tr_b16 v[178:179], v237 offset:512
ds_read_b64_tr_b16 v[180:181], v237 offset:0
ds_read_b64_tr_b16 v[182:183], v236 offset:512
ds_read_b64_tr_b16 v[184:185], v236 offset:4096
ds_read_b64_tr_b16 v[186:187], v237 offset:4608
v_mfma_f32_16x16x32_bf16 v[148:151], v[196:199], v[104:107], v[148:151]
s_add_u32 s52, s71, 5898240
s_add_u32 m0, s48, 139264
s_nop 0
buffer_load_dwordx4 v228, s[36:39], s52 offen lds
v_fma_f32 v122, v122, s51, -v243
v_mfma_f32_16x16x32_bf16 v[156:159], v[196:199], v[108:111], v[156:159]
ds_read_b64_tr_b16 v[188:189], v237 offset:4096
v_fma_f32 v123, v123, s51, -v243
v_add_f32 v245, v245, v120
v_add_f32 v245, v245, v121
v_mfma_f32_16x16x32_bf16 v[160:163], v[200:203], v[104:107], v[160:163]
ds_read_b64_tr_b16 v[190:191], v236 offset:4608
v_cvt_pk_bf16_f32 v116, v120, v121
v_exp_f32 v122, v122
v_mfma_f32_16x16x32_bf16 v[168:171], v[200:203], v[108:111], v[168:171]
ds_read_b64_tr_b16 v[192:193], v236 offset:8192
buffer_load_dwordx4 v229, s[36:39], s52 offen offset:1024 lds
v_exp_f32 v123, v123
v_mfma_f32_16x16x32_bf16 v[164:167], v[204:207], v[104:107], v[164:167]
ds_read_b64_tr_b16 v[194:195], v237 offset:8704
v_fma_f32 v124, v124, s51, -v243
v_fma_f32 v125, v125, s51, -v243
v_add_f32 v245, v245, v122
v_mfma_f32_16x16x32_bf16 v[172:175], v[204:207], v[108:111], v[172:175]
ds_read_b64_tr_b16 v[196:197], v237 offset:8192
v_add_f32 v245, v245, v123
v_cvt_pk_bf16_f32 v117, v122, v123
s_waitcnt lgkmcnt(7)
v_mfma_f32_16x16x32_bf16 a[144:147], v[176:179], a[208:211], a[144:147]
ds_read_b64_tr_b16 v[198:199], v236 offset:8704
s_add_u32 s52, s71, 5980160
s_add_u32 m0, s48, 147456
v_exp_f32 v124, v124
v_mfma_f32_16x16x32_bf16 a[152:155], v[176:179], a[212:215], a[152:155]
ds_read_b64_tr_b16 v[200:201], v236 offset:12288
buffer_load_dwordx4 v228, s[36:39], s52 offen lds
v_exp_f32 v125, v125
v_mfma_f32_16x16x32_bf16 a[148:151], v[180:183], a[208:211], a[148:151]
ds_read_b64_tr_b16 v[202:203], v237 offset:12800
v_fma_f32 v126, v126, s51, -v243
v_fma_f32 v127, v127, s51, -v243
v_add_f32 v245, v245, v124
v_mfma_f32_16x16x32_bf16 a[156:159], v[180:183], a[212:215], a[156:159]
ds_read_b64_tr_b16 v[204:205], v237 offset:12288
v_add_f32 v245, v245, v125
v_cvt_pk_bf16_f32 v118, v124, v125
s_waitcnt lgkmcnt(7)
v_mfma_f32_16x16x32_bf16 a[144:147], v[184:187], a[216:219], a[144:147]
ds_read_b64_tr_b16 v[206:207], v236 offset:12800
buffer_load_dwordx4 v229, s[36:39], s52 offen offset:1024 lds
v_exp_f32 v126, v126
v_mfma_f32_16x16x32_bf16 a[152:155], v[184:187], a[220:223], a[152:155]
ds_read_b64_tr_b16 v[176:177], v236 offset:16384
v_exp_f32 v127, v127
v_add_f32 v245, v245, v126
v_mfma_f32_16x16x32_bf16 a[148:151], v[188:191], a[216:219], a[148:151]
ds_read_b64_tr_b16 v[178:179], v237 offset:16896
v_add_f32 v245, v245, v127
v_cvt_pk_bf16_f32 v119, v126, v127
v_mov_b32 v246, v244
v_mfma_f32_16x16x32_bf16 a[156:159], v[188:191], a[220:223], a[156:159]
ds_read_b64_tr_b16 v[180:181], v237 offset:16384
s_add_u32 s52, s71, 6062080
s_add_u32 m0, s48, 155648
v_mov_b32 v247, v245
v_permlane16_swap_b32 v246, v244
s_waitcnt lgkmcnt(7)
v_mfma_f32_16x16x32_bf16 a[144:147], v[192:195], a[224:227], a[144:147]
ds_read_b64_tr_b16 v[182:183], v236 offset:16896
buffer_load_dwordx4 v228, s[36:39], s52 offen lds
v_permlane16_swap_b32 v247, v245
v_mfma_f32_16x16x32_bf16 a[152:155], v[192:195], a[228:231], a[152:155]
ds_read_b64_tr_b16 v[184:185], v236 offset:20480
v_add_f32 v244, v244, v246
v_add_f32 v245, v245, v247
v_mov_b32 v246, v244
v_mfma_f32_16x16x32_bf16 a[148:151], v[196:199], a[224:227], a[148:151]
ds_read_b64_tr_b16 v[186:187], v237 offset:20992
v_mov_b32 v247, v245
v_permlane32_swap_b32 v246, v244
s_nop 0
v_permlane32_swap_b32 v247, v245
v_mfma_f32_16x16x32_bf16 a[156:159], v[196:199], a[228:231], a[156:159]
ds_read_b64_tr_b16 v[188:189], v237 offset:20480
v_add_f32 v244, v244, v246
v_add_f32 v245, v245, v247
ds_write_b128 v239, v[112:115] offset:8192
ds_write_b128 v239, v[116:119] offset:9216
ds_write_b64 v239, v[244:245] offset:58368
s_waitcnt lgkmcnt(10)
v_mfma_f32_16x16x32_bf16 a[144:147], v[200:203], a[232:235], a[144:147]
ds_read_b64_tr_b16 v[190:191], v236 offset:20992
buffer_load_dwordx4 v229, s[36:39], s52 offen offset:1024 lds
v_mfma_f32_16x16x32_bf16 a[152:155], v[200:203], a[236:239], a[152:155]
v_mfma_f32_16x16x32_bf16 a[148:151], v[204:207], a[232:235], a[148:151]
v_mfma_f32_16x16x32_bf16 a[156:159], v[204:207], a[236:239], a[156:159]
v_add_u32 v236, 90112, v250
v_xor_b32 v237, 32, v236
s_waitcnt lgkmcnt(7)
v_mfma_f32_16x16x32_bf16 a[144:147], v[176:179], a[240:243], a[144:147]
v_xor_b32 v232, 0x1000, v236
v_xor_b32 v233, 0x1000, v237
v_mfma_f32_16x16x32_bf16 a[152:155], v[176:179], a[244:247], a[152:155]
s_waitcnt vmcnt(12) lgkmcnt(0)
s_barrier
ds_read_b64_tr_b16 v[192:193], v236 offset:0
ds_read_b64_tr_b16 v[194:195], v236 offset:2048
ds_read_b64_tr_b16 v[196:197], v237 offset:0
ds_read_b64_tr_b16 v[198:199], v237 offset:2048
ds_read_b64_tr_b16 v[200:201], v236 offset:8192
ds_read_b64_tr_b16 v[202:203], v236 offset:10240
v_mfma_f32_16x16x32_bf16 a[148:151], v[180:183], a[240:243], a[148:151]
s_add_u32 s52, s72, 5898240
s_add_u32 m0, s48, 65536
s_nop 0
buffer_load_dwordx4 v228, s[36:39], s52 offen lds
v_mfma_f32_16x16x32_bf16 a[156:159], v[180:183], a[244:247], a[156:159]
ds_read_b64_tr_b16 v[204:205], v237 offset:8192
v_mfma_f32_16x16x32_bf16 a[144:147], v[184:187], a[248:251], a[144:147]
ds_read_b64_tr_b16 v[206:207], v237 offset:10240
v_mfma_f32_16x16x32_bf16 a[152:155], v[184:187], a[252:255], a[152:155]
ds_read_b64_tr_b16 v[176:177], v236 offset:16384
buffer_load_dwordx4 v229, s[36:39], s52 offen offset:1024 lds
v_mfma_f32_16x16x32_bf16 a[148:151], v[188:191], a[248:251], a[148:151]
ds_read_b64_tr_b16 v[178:179], v236 offset:18432
v_mfma_f32_16x16x32_bf16 a[156:159], v[188:191], a[252:255], a[156:159]
ds_read_b64_tr_b16 v[180:181], v237 offset:16384
s_waitcnt lgkmcnt(7)
v_mfma_f32_16x16x32_bf16 v[128:131], v[192:195], v[112:115], v[128:131]
ds_read_b64_tr_b16 v[182:183], v237 offset:18432
s_add_u32 s52, s72, 5980160
s_add_u32 m0, s48, 73728
v_mfma_f32_16x16x32_bf16 v[136:139], v[192:195], v[116:119], v[136:139]
ds_read_b128 v[120:123], v234 offset:8192
ds_read_b128 v[124:127], v234 offset:9216
buffer_load_dwordx4 v228, s[36:39], s52 offen lds
v_mfma_f32_16x16x32_bf16 v[132:135], v[196:199], v[112:115], v[132:135]
ds_read_b64_tr_b16 v[184:185], v232 offset:0
ds_read_b64_tr_b16 v[186:187], v232 offset:2048
v_mfma_f32_16x16x32_bf16 v[140:143], v[196:199], v[116:119], v[140:143]
ds_read_b64_tr_b16 v[188:189], v233 offset:0
s_waitcnt lgkmcnt(9)
v_mfma_f32_16x16x32_bf16 v[144:147], v[200:203], v[112:115], v[144:147]
ds_read_b64_tr_b16 v[190:191], v233 offset:2048
buffer_load_dwordx4 v229, s[36:39], s52 offen offset:1024 lds
v_mfma_f32_16x16x32_bf16 v[152:155], v[200:203], v[116:119], v[152:155]
ds_read_b64_tr_b16 v[192:193], v232 offset:8192
v_mfma_f32_16x16x32_bf16 v[148:151], v[204:207], v[112:115], v[148:151]
ds_read_b64_tr_b16 v[194:195], v232 offset:10240
v_mfma_f32_16x16x32_bf16 v[156:159], v[204:207], v[116:119], v[156:159]
ds_read_b64_tr_b16 v[196:197], v233 offset:8192
s_add_u32 s52, s72, 6062080
s_add_u32 m0, s48, 81920
s_waitcnt lgkmcnt(9)
v_mfma_f32_16x16x32_bf16 v[160:163], v[176:179], v[112:115], v[160:163]
ds_read_b64_tr_b16 v[198:199], v233 offset:10240
buffer_load_dwordx4 v228, s[36:39], s52 offen lds
v_mfma_f32_16x16x32_bf16 v[168:171], v[176:179], v[116:119], v[168:171]
ds_read_b64_tr_b16 v[200:201], v232 offset:16384
v_mfma_f32_16x16x32_bf16 v[164:167], v[180:183], v[112:115], v[164:167]
ds_read_b64_tr_b16 v[202:203], v232 offset:18432
v_mfma_f32_16x16x32_bf16 v[172:175], v[180:183], v[116:119], v[172:175]
ds_read_b64_tr_b16 v[204:205], v233 offset:16384
s_waitcnt lgkmcnt(7)
v_mfma_f32_16x16x32_bf16 v[128:131], v[184:187], v[120:123], v[128:131]
ds_read_b64_tr_b16 v[206:207], v233 offset:18432
buffer_load_dwordx4 v229, s[36:39], s52 offen offset:1024 lds
v_mfma_f32_16x16x32_bf16 v[136:139], v[184:187], v[124:127], v[136:139]
v_mfma_f32_16x16x32_bf16 v[132:135], v[188:191], v[120:123], v[132:135]
v_mfma_f32_16x16x32_bf16 v[140:143], v[188:191], v[124:127], v[140:143]
s_waitcnt lgkmcnt(4)
v_mfma_f32_16x16x32_bf16 v[144:147], v[192:195], v[120:123], v[144:147]
v_mfma_f32_16x16x32_bf16 v[152:155], v[192:195], v[124:127], v[152:155]
s_waitcnt lgkmcnt(0)
s_barrier
s_add_u32 s52, s73, 5898240
s_add_u32 m0, s48, 90112
s_nop 0
buffer_load_dwordx4 v228, s[36:39], s52 offen lds
ds_read_b64 v[246:247], v238 offset:58368
ds_read_b64 v[248:249], v238 offset:60416
s_waitcnt lgkmcnt(0)
v_add_f32 v246, v246, v248
v_add_f32 v247, v247, v249
v_rcp_f32 v248, v246
v_rcp_f32 v249, v247
v_mfma_f32_16x16x32_bf16 v[148:151], v[196:199], v[120:123], v[148:151]
buffer_load_dwordx4 v229, s[36:39], s52 offen offset:1024 lds
v_mfma_f32_16x16x32_bf16 v[156:159], v[196:199], v[124:127], v[156:159]
s_add_u32 s52, s73, 5980160
s_add_u32 m0, s48, 98304
s_nop 0
buffer_load_dwordx4 v228, s[36:39], s52 offen lds
v_mfma_f32_16x16x32_bf16 v[160:163], v[200:203], v[120:123], v[160:163]
buffer_load_dwordx4 v229, s[36:39], s52 offen offset:1024 lds
v_mfma_f32_16x16x32_bf16 v[168:171], v[200:203], v[124:127], v[168:171]
s_add_u32 s52, s73, 6062080
s_add_u32 m0, s48, 106496
s_nop 0
buffer_load_dwordx4 v228, s[36:39], s52 offen lds
v_add_u32 v236, 114688, v230
v_xor_b32 v237, 32, v236
v_mfma_f32_16x16x32_bf16 v[164:167], v[204:207], v[120:123], v[164:167]
buffer_load_dwordx4 v229, s[36:39], s52 offen offset:1024 lds
v_mfma_f32_16x16x32_bf16 v[172:175], v[204:207], v[124:127], v[172:175]
v_mul_f32 v128, v128, v248
v_mul_f32 v129, v129, v248
v_mul_f32 v130, v130, v248
v_mul_f32 v131, v131, v248
v_mul_f32 v132, v132, v248
v_mul_f32 v133, v133, v248
v_mul_f32 v134, v134, v248
v_mul_f32 v135, v135, v248
v_cvt_pk_bf16_f32 v128, v128, v129
v_cvt_pk_bf16_f32 v129, v130, v131
v_cvt_pk_bf16_f32 v130, v132, v133
v_cvt_pk_bf16_f32 v131, v134, v135
v_mul_f32 v136, v136, v249
v_mul_f32 v137, v137, v249
v_mul_f32 v138, v138, v249
v_mul_f32 v139, v139, v249
v_mul_f32 v140, v140, v249
v_mul_f32 v141, v141, v249
v_mul_f32 v142, v142, v249
v_mul_f32 v143, v143, v249
v_cvt_pk_bf16_f32 v136, v136, v137
v_cvt_pk_bf16_f32 v137, v138, v139
v_cvt_pk_bf16_f32 v138, v140, v141
v_cvt_pk_bf16_f32 v139, v142, v143
v_mul_f32 v144, v144, v248
v_mul_f32 v145, v145, v248
v_mul_f32 v146, v146, v248
v_mul_f32 v147, v147, v248
v_mul_f32 v148, v148, v248
v_mul_f32 v149, v149, v248
v_mul_f32 v150, v150, v248
v_mul_f32 v151, v151, v248
v_cvt_pk_bf16_f32 v144, v144, v145
v_cvt_pk_bf16_f32 v145, v146, v147
v_cvt_pk_bf16_f32 v146, v148, v149
v_cvt_pk_bf16_f32 v147, v150, v151
v_mul_f32 v152, v152, v249
v_mul_f32 v153, v153, v249
v_mul_f32 v154, v154, v249
v_mul_f32 v155, v155, v249
v_mul_f32 v156, v156, v249
v_mul_f32 v157, v157, v249
v_mul_f32 v158, v158, v249
v_mul_f32 v159, v159, v249
v_cvt_pk_bf16_f32 v152, v152, v153
v_cvt_pk_bf16_f32 v153, v154, v155
v_cvt_pk_bf16_f32 v154, v156, v157
v_cvt_pk_bf16_f32 v155, v158, v159
v_mul_f32 v160, v160, v248
v_mul_f32 v161, v161, v248
v_mul_f32 v162, v162, v248
v_mul_f32 v163, v163, v248
v_mul_f32 v164, v164, v248
v_mul_f32 v165, v165, v248
v_mul_f32 v166, v166, v248
v_mul_f32 v167, v167, v248
v_cvt_pk_bf16_f32 v160, v160, v161
v_cvt_pk_bf16_f32 v161, v162, v163
v_cvt_pk_bf16_f32 v162, v164, v165
v_cvt_pk_bf16_f32 v163, v166, v167
v_mul_f32 v168, v168, v249
v_mul_f32 v169, v169, v249
v_mul_f32 v170, v170, v249
v_mul_f32 v171, v171, v249
v_mul_f32 v172, v172, v249
v_mul_f32 v173, v173, v249
v_mul_f32 v174, v174, v249
v_mul_f32 v175, v175, v249
v_cvt_pk_bf16_f32 v168, v168, v169
v_cvt_pk_bf16_f32 v169, v170, v171
v_cvt_pk_bf16_f32 v170, v172, v173
v_cvt_pk_bf16_f32 v171, v174, v175
ds_write_b64 v251, v[128:129] offset:0
ds_write_b64 v251, v[130:131] offset:512
ds_write_b64 v251, v[136:137] offset:1024
ds_write_b64 v251, v[138:139] offset:1536
ds_write_b64 v251, v[144:145] offset:8192
ds_write_b64 v251, v[146:147] offset:8704
ds_write_b64 v251, v[152:153] offset:9216
ds_write_b64 v251, v[154:155] offset:9728
ds_write_b64 v251, v[160:161] offset:16384
ds_write_b64 v251, v[162:163] offset:16896
ds_write_b64 v251, v[168:169] offset:17408
ds_write_b64 v251, v[170:171] offset:17920
s_waitcnt vmcnt(18) lgkmcnt(0)
s_barrier
ds_read_b128 a[160:163], v238 offset:0
ds_read_b128 a[164:167], v238 offset:1024
ds_read_b64_tr_b16 v[176:177], v236 offset:0
ds_read_b64_tr_b16 v[178:179], v237 offset:512
ds_read_b64_tr_b16 v[180:181], v237 offset:0
ds_read_b64_tr_b16 v[182:183], v236 offset:512
ds_read_b128 a[168:171], v238 offset:2048
ds_read_b128 a[172:175], v238 offset:3072
ds_read_b64_tr_b16 v[184:185], v236 offset:4096
ds_read_b64_tr_b16 v[186:187], v237 offset:4608
ds_read_b64_tr_b16 v[188:189], v237 offset:4096
ds_read_b64_tr_b16 v[190:191], v236 offset:4608
ds_read_b128 a[176:179], v238 offset:8192
ds_read_b128 a[180:183], v238 offset:9216
ds_read_b64_tr_b16 v[192:193], v236 offset:8192
ds_read_b64_tr_b16 v[194:195], v237 offset:8704
ds_read_b64_tr_b16 v[196:197], v237 offset:8192
ds_read_b64_tr_b16 v[198:199], v236 offset:8704
s_waitcnt lgkmcnt(12)
v_mfma_f32_16x16x32_bf16 a[0:3], v[176:179], a[160:163], a[0:3]
v_mfma_f32_16x16x32_bf16 a[8:11], v[176:179], a[164:167], a[8:11]
ds_read_b128 a[184:187], v238 offset:10240
ds_read_b128 a[188:191], v238 offset:11264
v_mfma_f32_16x16x32_bf16 a[4:7], v[180:183], a[160:163], a[4:7]
ds_read_b64_tr_b16 v[200:201], v236 offset:12288
ds_read_b64_tr_b16 v[202:203], v237 offset:12800
v_mfma_f32_16x16x32_bf16 a[12:15], v[180:183], a[164:167], a[12:15]
ds_read_b64_tr_b16 v[204:205], v237 offset:12288
s_waitcnt lgkmcnt(11)
v_mfma_f32_16x16x32_bf16 a[0:3], v[184:187], a[168:171], a[0:3]
ds_read_b64_tr_b16 v[206:207], v236 offset:12800
v_mfma_f32_16x16x32_bf16 a[8:11], v[184:187], a[172:175], a[8:11]
ds_read_b128 a[192:195], v238 offset:16384
ds_read_b128 a[196:199], v238 offset:17408
v_mfma_f32_16x16x32_bf16 a[4:7], v[188:191], a[168:171], a[4:7]
ds_read_b64_tr_b16 v[176:177], v236 offset:16384
ds_read_b64_tr_b16 v[178:179], v237 offset:16896
v_mfma_f32_16x16x32_bf16 a[12:15], v[188:191], a[172:175], a[12:15]
ds_read_b64_tr_b16 v[180:181], v237 offset:16384
s_waitcnt lgkmcnt(11)
v_mfma_f32_16x16x32_bf16 a[0:3], v[192:195], a[176:179], a[0:3]
ds_read_b64_tr_b16 v[182:183], v236 offset:16896
v_mfma_f32_16x16x32_bf16 a[8:11], v[192:195], a[180:183], a[8:11]
ds_read_b128 a[200:203], v238 offset:18432
ds_read_b128 a[204:207], v238 offset:19456
v_mfma_f32_16x16x32_bf16 a[4:7], v[196:199], a[176:179], a[4:7]
ds_read_b64_tr_b16 v[184:185], v236 offset:20480
ds_read_b64_tr_b16 v[186:187], v237 offset:20992
v_mfma_f32_16x16x32_bf16 a[12:15], v[196:199], a[180:183], a[12:15]
ds_read_b64_tr_b16 v[188:189], v237 offset:20480
s_waitcnt lgkmcnt(11)
v_mfma_f32_16x16x32_bf16 a[0:3], v[200:203], a[184:187], a[0:3]
ds_read_b64_tr_b16 v[190:191], v236 offset:20992
v_mfma_f32_16x16x32_bf16 a[8:11], v[200:203], a[188:191], a[8:11]
v_mfma_f32_16x16x32_bf16 a[4:7], v[204:207], a[184:187], a[4:7]
v_mfma_f32_16x16x32_bf16 a[12:15], v[204:207], a[188:191], a[12:15]
v_add_u32 v236, 139264, v230
v_xor_b32 v237, 32, v236
s_waitcnt lgkmcnt(6)
v_mfma_f32_16x16x32_bf16 a[0:3], v[176:179], a[192:195], a[0:3]
v_mfma_f32_16x16x32_bf16 a[8:11], v[176:179], a[196:199], a[8:11]
s_waitcnt vmcnt(12) lgkmcnt(0)
s_barrier
ds_read_b64_tr_b16 v[192:193], v236 offset:0
ds_read_b64_tr_b16 v[194:195], v237 offset:512
ds_read_b64_tr_b16 v[196:197], v237 offset:0
ds_read_b64_tr_b16 v[198:199], v236 offset:512
ds_read_b64_tr_b16 v[200:201], v236 offset:4096
ds_read_b64_tr_b16 v[202:203], v237 offset:4608
v_mfma_f32_16x16x32_bf16 a[4:7], v[180:183], a[192:195], a[4:7]
s_add_u32 s52, s74, 5898240
s_add_u32 m0, s48, 114688
s_nop 0
buffer_load_dwordx4 v228, s[36:39], s52 offen lds
v_mfma_f32_16x16x32_bf16 a[12:15], v[180:183], a[196:199], a[12:15]
ds_read_b64_tr_b16 v[204:205], v237 offset:4096
v_mfma_f32_16x16x32_bf16 a[0:3], v[184:187], a[200:203], a[0:3]
ds_read_b64_tr_b16 v[206:207], v236 offset:4608
v_mfma_f32_16x16x32_bf16 a[8:11], v[184:187], a[204:207], a[8:11]
ds_read_b64_tr_b16 v[176:177], v236 offset:8192
buffer_load_dwordx4 v229, s[36:39], s52 offen offset:1024 lds
v_mfma_f32_16x16x32_bf16 a[4:7], v[188:191], a[200:203], a[4:7]
ds_read_b64_tr_b16 v[178:179], v237 offset:8704
v_mfma_f32_16x16x32_bf16 a[12:15], v[188:191], a[204:207], a[12:15]
ds_read_b64_tr_b16 v[180:181], v237 offset:8192
s_waitcnt lgkmcnt(7)
v_mfma_f32_16x16x32_bf16 a[16:19], v[192:195], a[160:163], a[16:19]
ds_read_b64_tr_b16 v[182:183], v236 offset:8704
s_add_u32 s52, s74, 5980160
s_add_u32 m0, s48, 122880
v_mfma_f32_16x16x32_bf16 a[24:27], v[192:195], a[164:167], a[24:27]
ds_read_b64_tr_b16 v[184:185], v236 offset:12288
buffer_load_dwordx4 v228, s[36:39], s52 offen lds
v_mfma_f32_16x16x32_bf16 a[20:23], v[196:199], a[160:163], a[20:23]
ds_read_b64_tr_b16 v[186:187], v237 offset:12800
s_lshl_b32 s54, s70, 6
v_accvgpr_read_b32 v128, a0
v_accvgpr_read_b32 v129, a1
v_mfma_f32_16x16x32_bf16 a[28:31], v[196:199], a[164:167], a[28:31]
ds_read_b64_tr_b16 v[188:189], v237 offset:12288
v_accvgpr_read_b32 v130, a2
v_accvgpr_read_b32 v131, a3
s_waitcnt lgkmcnt(7)
v_mfma_f32_16x16x32_bf16 a[16:19], v[200:203], a[168:171], a[16:19]
ds_read_b64_tr_b16 v[190:191], v236 offset:12800
buffer_load_dwordx4 v229, s[36:39], s52 offen offset:1024 lds
v_mfma_f32_16x16x32_bf16 a[24:27], v[200:203], a[172:175], a[24:27]
ds_read_b64_tr_b16 v[192:193], v236 offset:16384
v_accvgpr_read_b32 v132, a4
v_accvgpr_read_b32 v133, a5
v_mfma_f32_16x16x32_bf16 a[20:23], v[204:207], a[168:171], a[20:23]
ds_read_b64_tr_b16 v[194:195], v237 offset:16896
v_accvgpr_read_b32 v134, a6
v_accvgpr_read_b32 v135, a7
v_mfma_f32_16x16x32_bf16 a[28:31], v[204:207], a[172:175], a[28:31]
ds_read_b64_tr_b16 v[196:197], v237 offset:16384
s_add_u32 s52, s74, 6062080
s_add_u32 m0, s48, 131072
v_cvt_pk_bf16_f32 v0, v128, v129
s_waitcnt lgkmcnt(7)
v_mfma_f32_16x16x32_bf16 a[16:19], v[176:179], a[176:179], a[16:19]
ds_read_b64_tr_b16 v[198:199], v236 offset:16896
buffer_load_dwordx4 v228, s[36:39], s52 offen lds
v_mfma_f32_16x16x32_bf16 a[24:27], v[176:179], a[180:183], a[24:27]
ds_read_b64_tr_b16 v[200:201], v236 offset:20480
v_cvt_pk_bf16_f32 v1, v130, v131
v_cvt_pk_bf16_f32 v2, v132, v133
v_mfma_f32_16x16x32_bf16 a[20:23], v[180:183], a[176:179], a[20:23]
ds_read_b64_tr_b16 v[202:203], v237 offset:20992
v_cvt_pk_bf16_f32 v3, v134, v135
buffer_store_dwordx4 v[0:3], v213, s[44:47], s54 offen sc1
v_mfma_f32_16x16x32_bf16 a[28:31], v[180:183], a[180:183], a[28:31]
ds_read_b64_tr_b16 v[204:205], v237 offset:20480
v_accvgpr_read_b32 v136, a8
v_accvgpr_read_b32 v137, a9
s_waitcnt lgkmcnt(7)
v_mfma_f32_16x16x32_bf16 a[16:19], v[184:187], a[184:187], a[16:19]
ds_read_b64_tr_b16 v[206:207], v236 offset:20992
buffer_load_dwordx4 v229, s[36:39], s52 offen offset:1024 lds
v_mfma_f32_16x16x32_bf16 a[24:27], v[184:187], a[188:191], a[24:27]
v_accvgpr_read_b32 v138, a10
v_accvgpr_read_b32 v139, a11
v_accvgpr_read_b32 v140, a12
v_mfma_f32_16x16x32_bf16 a[20:23], v[188:191], a[184:187], a[20:23]
v_accvgpr_read_b32 v141, a13
v_accvgpr_read_b32 v142, a14
v_accvgpr_read_b32 v143, a15
v_mfma_f32_16x16x32_bf16 a[28:31], v[188:191], a[188:191], a[28:31]
v_add_u32 v236, 65536, v230
v_xor_b32 v237, 32, v236
v_cvt_pk_bf16_f32 v4, v136, v137
s_waitcnt lgkmcnt(4)
v_mfma_f32_16x16x32_bf16 a[16:19], v[192:195], a[192:195], a[16:19]
v_cvt_pk_bf16_f32 v5, v138, v139
v_cvt_pk_bf16_f32 v6, v140, v141
v_cvt_pk_bf16_f32 v7, v142, v143
v_mfma_f32_16x16x32_bf16 a[24:27], v[192:195], a[196:199], a[24:27]
buffer_store_dwordx4 v[4:7], v214, s[44:47], s54 offen offset:1024 sc1
s_waitcnt vmcnt(14) lgkmcnt(0)
s_barrier
ds_read_b64_tr_b16 v[176:177], v236 offset:0
ds_read_b64_tr_b16 v[178:179], v237 offset:512
ds_read_b64_tr_b16 v[180:181], v237 offset:0
ds_read_b64_tr_b16 v[182:183], v236 offset:512
ds_read_b64_tr_b16 v[184:185], v236 offset:4096
ds_read_b64_tr_b16 v[186:187], v237 offset:4608
v_mfma_f32_16x16x32_bf16 a[20:23], v[196:199], a[192:195], a[20:23]
s_add_u32 s52, s75, 5898240
s_add_u32 m0, s48, 139264
s_nop 0
buffer_load_dwordx4 v228, s[36:39], s52 offen lds
v_mfma_f32_16x16x32_bf16 a[28:31], v[196:199], a[196:199], a[28:31]
ds_read_b64_tr_b16 v[188:189], v237 offset:4096
v_mfma_f32_16x16x32_bf16 a[16:19], v[200:203], a[200:203], a[16:19]
ds_read_b64_tr_b16 v[190:191], v236 offset:4608
v_mfma_f32_16x16x32_bf16 a[24:27], v[200:203], a[204:207], a[24:27]
ds_read_b64_tr_b16 v[192:193], v236 offset:8192
buffer_load_dwordx4 v229, s[36:39], s52 offen offset:1024 lds
v_mfma_f32_16x16x32_bf16 a[20:23], v[204:207], a[200:203], a[20:23]
ds_read_b64_tr_b16 v[194:195], v237 offset:8704
v_mfma_f32_16x16x32_bf16 a[28:31], v[204:207], a[204:207], a[28:31]
ds_read_b64_tr_b16 v[196:197], v237 offset:8192
s_waitcnt lgkmcnt(7)
v_mfma_f32_16x16x32_bf16 a[32:35], v[176:179], a[160:163], a[32:35]
ds_read_b64_tr_b16 v[198:199], v236 offset:8704
s_add_u32 s52, s75, 5980160
s_add_u32 m0, s48, 147456
v_mfma_f32_16x16x32_bf16 a[40:43], v[176:179], a[164:167], a[40:43]
ds_read_b64_tr_b16 v[200:201], v236 offset:12288
buffer_load_dwordx4 v228, s[36:39], s52 offen lds
v_mfma_f32_16x16x32_bf16 a[36:39], v[180:183], a[160:163], a[36:39]
ds_read_b64_tr_b16 v[202:203], v237 offset:12800
s_lshl_b32 s54, s71, 6
v_accvgpr_read_b32 v144, a16
v_accvgpr_read_b32 v145, a17
v_mfma_f32_16x16x32_bf16 a[44:47], v[180:183], a[164:167], a[44:47]
ds_read_b64_tr_b16 v[204:205], v237 offset:12288
v_accvgpr_read_b32 v146, a18
v_accvgpr_read_b32 v147, a19
s_waitcnt lgkmcnt(7)
v_mfma_f32_16x16x32_bf16 a[32:35], v[184:187], a[168:171], a[32:35]
ds_read_b64_tr_b16 v[206:207], v236 offset:12800
buffer_load_dwordx4 v229, s[36:39], s52 offen offset:1024 lds
v_mfma_f32_16x16x32_bf16 a[40:43], v[184:187], a[172:175], a[40:43]
ds_read_b64_tr_b16 v[176:177], v236 offset:16384
v_accvgpr_read_b32 v148, a20
v_accvgpr_read_b32 v149, a21
v_mfma_f32_16x16x32_bf16 a[36:39], v[188:191], a[168:171], a[36:39]
ds_read_b64_tr_b16 v[178:179], v237 offset:16896
v_accvgpr_read_b32 v150, a22
v_accvgpr_read_b32 v151, a23
v_mfma_f32_16x16x32_bf16 a[44:47], v[188:191], a[172:175], a[44:47]
ds_read_b64_tr_b16 v[180:181], v237 offset:16384
s_add_u32 s52, s75, 6062080
s_add_u32 m0, s48, 155648
v_cvt_pk_bf16_f32 v8, v144, v145
s_waitcnt lgkmcnt(7)
v_mfma_f32_16x16x32_bf16 a[32:35], v[192:195], a[176:179], a[32:35]
ds_read_b64_tr_b16 v[182:183], v236 offset:16896
buffer_load_dwordx4 v228, s[36:39], s52 offen lds
v_mfma_f32_16x16x32_bf16 a[40:43], v[192:195], a[180:183], a[40:43]
ds_read_b64_tr_b16 v[184:185], v236 offset:20480
v_cvt_pk_bf16_f32 v9, v146, v147
v_cvt_pk_bf16_f32 v10, v148, v149
v_mfma_f32_16x16x32_bf16 a[36:39], v[196:199], a[176:179], a[36:39]
ds_read_b64_tr_b16 v[186:187], v237 offset:20992
v_cvt_pk_bf16_f32 v11, v150, v151
buffer_store_dwordx4 v[8:11], v213, s[44:47], s54 offen sc1
v_mfma_f32_16x16x32_bf16 a[44:47], v[196:199], a[180:183], a[44:47]
ds_read_b64_tr_b16 v[188:189], v237 offset:20480
v_accvgpr_read_b32 v152, a24
v_accvgpr_read_b32 v153, a25
s_waitcnt lgkmcnt(7)
v_mfma_f32_16x16x32_bf16 a[32:35], v[200:203], a[184:187], a[32:35]
ds_read_b64_tr_b16 v[190:191], v236 offset:20992
buffer_load_dwordx4 v229, s[36:39], s52 offen offset:1024 lds
v_mfma_f32_16x16x32_bf16 a[40:43], v[200:203], a[188:191], a[40:43]
v_accvgpr_read_b32 v154, a26
v_accvgpr_read_b32 v155, a27
v_accvgpr_read_b32 v156, a28
v_mfma_f32_16x16x32_bf16 a[36:39], v[204:207], a[184:187], a[36:39]
v_accvgpr_read_b32 v157, a29
v_accvgpr_read_b32 v158, a30
v_accvgpr_read_b32 v159, a31
v_mfma_f32_16x16x32_bf16 a[44:47], v[204:207], a[188:191], a[44:47]
v_add_u32 v236, 90112, v230
v_xor_b32 v237, 32, v236
v_cvt_pk_bf16_f32 v12, v152, v153
s_waitcnt lgkmcnt(4)
v_mfma_f32_16x16x32_bf16 a[32:35], v[176:179], a[192:195], a[32:35]
v_cvt_pk_bf16_f32 v13, v154, v155
v_cvt_pk_bf16_f32 v14, v156, v157
v_cvt_pk_bf16_f32 v15, v158, v159
v_mfma_f32_16x16x32_bf16 a[40:43], v[176:179], a[196:199], a[40:43]
buffer_store_dwordx4 v[12:15], v214, s[44:47], s54 offen offset:1024 sc1
s_waitcnt vmcnt(16) lgkmcnt(0)
s_barrier
ds_read_b64_tr_b16 v[192:193], v236 offset:0
ds_read_b64_tr_b16 v[194:195], v237 offset:512
ds_read_b64_tr_b16 v[196:197], v237 offset:0
ds_read_b64_tr_b16 v[198:199], v236 offset:512
ds_read_b64_tr_b16 v[200:201], v236 offset:4096
ds_read_b64_tr_b16 v[202:203], v237 offset:4608
v_mfma_f32_16x16x32_bf16 a[36:39], v[180:183], a[192:195], a[36:39]
s_add_u32 s52, s76, 5898240
s_add_u32 m0, s48, 65536
s_nop 0
buffer_load_dwordx4 v228, s[36:39], s52 offen lds
v_mfma_f32_16x16x32_bf16 a[44:47], v[180:183], a[196:199], a[44:47]
ds_read_b64_tr_b16 v[204:205], v237 offset:4096
v_mfma_f32_16x16x32_bf16 a[32:35], v[184:187], a[200:203], a[32:35]
ds_read_b64_tr_b16 v[206:207], v236 offset:4608
v_mfma_f32_16x16x32_bf16 a[40:43], v[184:187], a[204:207], a[40:43]
ds_read_b64_tr_b16 v[176:177], v236 offset:8192
buffer_load_dwordx4 v229, s[36:39], s52 offen offset:1024 lds
v_mfma_f32_16x16x32_bf16 a[36:39], v[188:191], a[200:203], a[36:39]
ds_read_b64_tr_b16 v[178:179], v237 offset:8704
v_mfma_f32_16x16x32_bf16 a[44:47], v[188:191], a[204:207], a[44:47]
ds_read_b64_tr_b16 v[180:181], v237 offset:8192
s_waitcnt lgkmcnt(7)
v_mfma_f32_16x16x32_bf16 a[48:51], v[192:195], a[160:163], a[48:51]
ds_read_b64_tr_b16 v[182:183], v236 offset:8704
s_add_u32 s52, s76, 5980160
s_add_u32 m0, s48, 73728
v_mfma_f32_16x16x32_bf16 a[56:59], v[192:195], a[164:167], a[56:59]
ds_read_b64_tr_b16 v[184:185], v236 offset:12288
buffer_load_dwordx4 v228, s[36:39], s52 offen lds
v_mfma_f32_16x16x32_bf16 a[52:55], v[196:199], a[160:163], a[52:55]
ds_read_b64_tr_b16 v[186:187], v237 offset:12800
s_lshl_b32 s54, s72, 6
v_accvgpr_read_b32 v160, a32
v_accvgpr_read_b32 v161, a33
v_mfma_f32_16x16x32_bf16 a[60:63], v[196:199], a[164:167], a[60:63]
ds_read_b64_tr_b16 v[188:189], v237 offset:12288
v_accvgpr_read_b32 v162, a34
v_accvgpr_read_b32 v163, a35
s_waitcnt lgkmcnt(7)
v_mfma_f32_16x16x32_bf16 a[48:51], v[200:203], a[168:171], a[48:51]
ds_read_b64_tr_b16 v[190:191], v236 offset:12800
buffer_load_dwordx4 v229, s[36:39], s52 offen offset:1024 lds
v_mfma_f32_16x16x32_bf16 a[56:59], v[200:203], a[172:175], a[56:59]
ds_read_b64_tr_b16 v[192:193], v236 offset:16384
v_accvgpr_read_b32 v164, a36
v_accvgpr_read_b32 v165, a37
v_mfma_f32_16x16x32_bf16 a[52:55], v[204:207], a[168:171], a[52:55]
ds_read_b64_tr_b16 v[194:195], v237 offset:16896
v_accvgpr_read_b32 v166, a38
v_accvgpr_read_b32 v167, a39
v_mfma_f32_16x16x32_bf16 a[60:63], v[204:207], a[172:175], a[60:63]
ds_read_b64_tr_b16 v[196:197], v237 offset:16384
s_add_u32 s52, s76, 6062080
s_add_u32 m0, s48, 81920
v_cvt_pk_bf16_f32 v16, v160, v161
s_waitcnt lgkmcnt(7)
v_mfma_f32_16x16x32_bf16 a[48:51], v[176:179], a[176:179], a[48:51]
ds_read_b64_tr_b16 v[198:199], v236 offset:16896
buffer_load_dwordx4 v228, s[36:39], s52 offen lds
v_mfma_f32_16x16x32_bf16 a[56:59], v[176:179], a[180:183], a[56:59]
ds_read_b64_tr_b16 v[200:201], v236 offset:20480
v_cvt_pk_bf16_f32 v17, v162, v163
v_cvt_pk_bf16_f32 v18, v164, v165
v_mfma_f32_16x16x32_bf16 a[52:55], v[180:183], a[176:179], a[52:55]
ds_read_b64_tr_b16 v[202:203], v237 offset:20992
v_cvt_pk_bf16_f32 v19, v166, v167
buffer_store_dwordx4 v[16:19], v213, s[44:47], s54 offen sc1
v_mfma_f32_16x16x32_bf16 a[60:63], v[180:183], a[180:183], a[60:63]
ds_read_b64_tr_b16 v[204:205], v237 offset:20480
v_accvgpr_read_b32 v168, a40
v_accvgpr_read_b32 v169, a41
s_waitcnt lgkmcnt(7)
v_mfma_f32_16x16x32_bf16 a[48:51], v[184:187], a[184:187], a[48:51]
ds_read_b64_tr_b16 v[206:207], v236 offset:20992
buffer_load_dwordx4 v229, s[36:39], s52 offen offset:1024 lds
v_mfma_f32_16x16x32_bf16 a[56:59], v[184:187], a[188:191], a[56:59]
v_accvgpr_read_b32 v170, a42
v_accvgpr_read_b32 v171, a43
v_accvgpr_read_b32 v172, a44
v_mfma_f32_16x16x32_bf16 a[52:55], v[188:191], a[184:187], a[52:55]
v_accvgpr_read_b32 v173, a45
v_accvgpr_read_b32 v174, a46
v_accvgpr_read_b32 v175, a47
v_mfma_f32_16x16x32_bf16 a[60:63], v[188:191], a[188:191], a[60:63]
v_add_u32 v236, 114688, v230
v_xor_b32 v237, 32, v236
v_cvt_pk_bf16_f32 v20, v168, v169
s_waitcnt lgkmcnt(4)
v_mfma_f32_16x16x32_bf16 a[48:51], v[192:195], a[192:195], a[48:51]
v_cvt_pk_bf16_f32 v21, v170, v171
v_cvt_pk_bf16_f32 v22, v172, v173
v_cvt_pk_bf16_f32 v23, v174, v175
v_mfma_f32_16x16x32_bf16 a[56:59], v[192:195], a[196:199], a[56:59]
buffer_store_dwordx4 v[20:23], v214, s[44:47], s54 offen offset:1024 sc1
s_waitcnt vmcnt(17) lgkmcnt(0)
s_barrier
ds_read_b64_tr_b16 v[176:177], v236 offset:0
ds_read_b64_tr_b16 v[178:179], v237 offset:512
ds_read_b64_tr_b16 v[180:181], v237 offset:0
ds_read_b64_tr_b16 v[182:183], v236 offset:512
ds_read_b64_tr_b16 v[184:185], v236 offset:4096
ds_read_b64_tr_b16 v[186:187], v237 offset:4608
v_mfma_f32_16x16x32_bf16 a[52:55], v[196:199], a[192:195], a[52:55]
s_add_u32 s52, s77, 5898240
s_add_u32 m0, s48, 90112
s_nop 0
buffer_load_dwordx4 v228, s[36:39], s52 offen lds
v_mfma_f32_16x16x32_bf16 a[60:63], v[196:199], a[196:199], a[60:63]
ds_read_b64_tr_b16 v[188:189], v237 offset:4096
v_mfma_f32_16x16x32_bf16 a[48:51], v[200:203], a[200:203], a[48:51]
ds_read_b64_tr_b16 v[190:191], v236 offset:4608
v_mfma_f32_16x16x32_bf16 a[56:59], v[200:203], a[204:207], a[56:59]
ds_read_b64_tr_b16 v[192:193], v236 offset:8192
buffer_load_dwordx4 v229, s[36:39], s52 offen offset:1024 lds
v_mfma_f32_16x16x32_bf16 a[52:55], v[204:207], a[200:203], a[52:55]
ds_read_b64_tr_b16 v[194:195], v237 offset:8704
v_mfma_f32_16x16x32_bf16 a[60:63], v[204:207], a[204:207], a[60:63]
ds_read_b64_tr_b16 v[196:197], v237 offset:8192
s_waitcnt lgkmcnt(7)
v_mfma_f32_16x16x32_bf16 a[64:67], v[176:179], a[160:163], a[64:67]
ds_read_b64_tr_b16 v[198:199], v236 offset:8704
s_add_u32 s52, s77, 5980160
s_add_u32 m0, s48, 98304
v_mfma_f32_16x16x32_bf16 a[72:75], v[176:179], a[164:167], a[72:75]
ds_read_b64_tr_b16 v[200:201], v236 offset:12288
buffer_load_dwordx4 v228, s[36:39], s52 offen lds
v_mfma_f32_16x16x32_bf16 a[68:71], v[180:183], a[160:163], a[68:71]
ds_read_b64_tr_b16 v[202:203], v237 offset:12800
s_lshl_b32 s54, s73, 6
v_accvgpr_read_b32 v128, a48
v_accvgpr_read_b32 v129, a49
v_mfma_f32_16x16x32_bf16 a[76:79], v[180:183], a[164:167], a[76:79]
ds_read_b64_tr_b16 v[204:205], v237 offset:12288
v_accvgpr_read_b32 v130, a50
v_accvgpr_read_b32 v131, a51
s_waitcnt lgkmcnt(7)
v_mfma_f32_16x16x32_bf16 a[64:67], v[184:187], a[168:171], a[64:67]
ds_read_b64_tr_b16 v[206:207], v236 offset:12800
buffer_load_dwordx4 v229, s[36:39], s52 offen offset:1024 lds
v_mfma_f32_16x16x32_bf16 a[72:75], v[184:187], a[172:175], a[72:75]
ds_read_b64_tr_b16 v[176:177], v236 offset:16384
v_accvgpr_read_b32 v132, a52
v_accvgpr_read_b32 v133, a53
v_mfma_f32_16x16x32_bf16 a[68:71], v[188:191], a[168:171], a[68:71]
ds_read_b64_tr_b16 v[178:179], v237 offset:16896
v_accvgpr_read_b32 v134, a54
v_accvgpr_read_b32 v135, a55
v_mfma_f32_16x16x32_bf16 a[76:79], v[188:191], a[172:175], a[76:79]
ds_read_b64_tr_b16 v[180:181], v237 offset:16384
s_add_u32 s52, s77, 6062080
s_add_u32 m0, s48, 106496
v_cvt_pk_bf16_f32 v24, v128, v129
s_waitcnt lgkmcnt(7)
v_mfma_f32_16x16x32_bf16 a[64:67], v[192:195], a[176:179], a[64:67]
ds_read_b64_tr_b16 v[182:183], v236 offset:16896
buffer_load_dwordx4 v228, s[36:39], s52 offen lds
v_mfma_f32_16x16x32_bf16 a[72:75], v[192:195], a[180:183], a[72:75]
ds_read_b64_tr_b16 v[184:185], v236 offset:20480
v_cvt_pk_bf16_f32 v25, v130, v131
v_cvt_pk_bf16_f32 v26, v132, v133
v_mfma_f32_16x16x32_bf16 a[68:71], v[196:199], a[176:179], a[68:71]
ds_read_b64_tr_b16 v[186:187], v237 offset:20992
v_cvt_pk_bf16_f32 v27, v134, v135
buffer_store_dwordx4 v[24:27], v213, s[44:47], s54 offen sc1
v_mfma_f32_16x16x32_bf16 a[76:79], v[196:199], a[180:183], a[76:79]
ds_read_b64_tr_b16 v[188:189], v237 offset:20480
v_accvgpr_read_b32 v136, a56
v_accvgpr_read_b32 v137, a57
s_waitcnt lgkmcnt(7)
v_mfma_f32_16x16x32_bf16 a[64:67], v[200:203], a[184:187], a[64:67]
ds_read_b64_tr_b16 v[190:191], v236 offset:20992
buffer_load_dwordx4 v229, s[36:39], s52 offen offset:1024 lds
v_mfma_f32_16x16x32_bf16 a[72:75], v[200:203], a[188:191], a[72:75]
v_accvgpr_read_b32 v138, a58
v_accvgpr_read_b32 v139, a59
v_accvgpr_read_b32 v140, a60
v_mfma_f32_16x16x32_bf16 a[68:71], v[204:207], a[184:187], a[68:71]
v_accvgpr_read_b32 v141, a61
v_accvgpr_read_b32 v142, a62
v_accvgpr_read_b32 v143, a63
v_mfma_f32_16x16x32_bf16 a[76:79], v[204:207], a[188:191], a[76:79]
v_add_u32 v236, 139264, v230
v_xor_b32 v237, 32, v236
v_cvt_pk_bf16_f32 v28, v136, v137
s_waitcnt lgkmcnt(4)
v_mfma_f32_16x16x32_bf16 a[64:67], v[176:179], a[192:195], a[64:67]
v_cvt_pk_bf16_f32 v29, v138, v139
v_cvt_pk_bf16_f32 v30, v140, v141
v_cvt_pk_bf16_f32 v31, v142, v143
v_mfma_f32_16x16x32_bf16 a[72:75], v[176:179], a[196:199], a[72:75]
buffer_store_dwordx4 v[28:31], v214, s[44:47], s54 offen offset:1024 sc1
s_waitcnt vmcnt(17) lgkmcnt(0)
s_barrier
ds_read_b64_tr_b16 v[192:193], v236 offset:0
ds_read_b64_tr_b16 v[194:195], v237 offset:512
ds_read_b64_tr_b16 v[196:197], v237 offset:0
ds_read_b64_tr_b16 v[198:199], v236 offset:512
ds_read_b64_tr_b16 v[200:201], v236 offset:4096
ds_read_b64_tr_b16 v[202:203], v237 offset:4608
v_mfma_f32_16x16x32_bf16 a[68:71], v[180:183], a[192:195], a[68:71]
s_add_u32 s52, s78, 5898240
s_add_u32 m0, s48, 114688
s_nop 0
buffer_load_dwordx4 v228, s[36:39], s52 offen lds
v_mfma_f32_16x16x32_bf16 a[76:79], v[180:183], a[196:199], a[76:79]
ds_read_b64_tr_b16 v[204:205], v237 offset:4096
v_mfma_f32_16x16x32_bf16 a[64:67], v[184:187], a[200:203], a[64:67]
ds_read_b64_tr_b16 v[206:207], v236 offset:4608
v_mfma_f32_16x16x32_bf16 a[72:75], v[184:187], a[204:207], a[72:75]
ds_read_b64_tr_b16 v[176:177], v236 offset:8192
buffer_load_dwordx4 v229, s[36:39], s52 offen offset:1024 lds
v_mfma_f32_16x16x32_bf16 a[68:71], v[188:191], a[200:203], a[68:71]
ds_read_b64_tr_b16 v[178:179], v237 offset:8704
v_mfma_f32_16x16x32_bf16 a[76:79], v[188:191], a[204:207], a[76:79]
ds_read_b64_tr_b16 v[180:181], v237 offset:8192
s_waitcnt lgkmcnt(7)
v_mfma_f32_16x16x32_bf16 a[80:83], v[192:195], a[160:163], a[80:83]
ds_read_b64_tr_b16 v[182:183], v236 offset:8704
s_add_u32 s52, s78, 5980160
s_add_u32 m0, s48, 122880
v_mfma_f32_16x16x32_bf16 a[88:91], v[192:195], a[164:167], a[88:91]
ds_read_b64_tr_b16 v[184:185], v236 offset:12288
buffer_load_dwordx4 v228, s[36:39], s52 offen lds
v_mfma_f32_16x16x32_bf16 a[84:87], v[196:199], a[160:163], a[84:87]
ds_read_b64_tr_b16 v[186:187], v237 offset:12800
s_lshl_b32 s54, s74, 6
v_accvgpr_read_b32 v144, a64
v_accvgpr_read_b32 v145, a65
v_mfma_f32_16x16x32_bf16 a[92:95], v[196:199], a[164:167], a[92:95]
ds_read_b64_tr_b16 v[188:189], v237 offset:12288
v_accvgpr_read_b32 v146, a66
v_accvgpr_read_b32 v147, a67
s_waitcnt lgkmcnt(7)
v_mfma_f32_16x16x32_bf16 a[80:83], v[200:203], a[168:171], a[80:83]
ds_read_b64_tr_b16 v[190:191], v236 offset:12800
buffer_load_dwordx4 v229, s[36:39], s52 offen offset:1024 lds
v_mfma_f32_16x16x32_bf16 a[88:91], v[200:203], a[172:175], a[88:91]
ds_read_b64_tr_b16 v[192:193], v236 offset:16384
v_accvgpr_read_b32 v148, a68
v_accvgpr_read_b32 v149, a69
v_mfma_f32_16x16x32_bf16 a[84:87], v[204:207], a[168:171], a[84:87]
ds_read_b64_tr_b16 v[194:195], v237 offset:16896
v_accvgpr_read_b32 v150, a70
v_accvgpr_read_b32 v151, a71
v_mfma_f32_16x16x32_bf16 a[92:95], v[204:207], a[172:175], a[92:95]
ds_read_b64_tr_b16 v[196:197], v237 offset:16384
s_add_u32 s52, s78, 6062080
s_add_u32 m0, s48, 131072
v_cvt_pk_bf16_f32 v32, v144, v145
s_waitcnt lgkmcnt(7)
v_mfma_f32_16x16x32_bf16 a[80:83], v[176:179], a[176:179], a[80:83]
ds_read_b64_tr_b16 v[198:199], v236 offset:16896
buffer_load_dwordx4 v228, s[36:39], s52 offen lds
v_mfma_f32_16x16x32_bf16 a[88:91], v[176:179], a[180:183], a[88:91]
ds_read_b64_tr_b16 v[200:201], v236 offset:20480
v_cvt_pk_bf16_f32 v33, v146, v147
v_cvt_pk_bf16_f32 v34, v148, v149
v_mfma_f32_16x16x32_bf16 a[84:87], v[180:183], a[176:179], a[84:87]
ds_read_b64_tr_b16 v[202:203], v237 offset:20992
v_cvt_pk_bf16_f32 v35, v150, v151
buffer_store_dwordx4 v[32:35], v213, s[44:47], s54 offen sc1
v_mfma_f32_16x16x32_bf16 a[92:95], v[180:183], a[180:183], a[92:95]
ds_read_b64_tr_b16 v[204:205], v237 offset:20480
v_accvgpr_read_b32 v152, a72
v_accvgpr_read_b32 v153, a73
s_waitcnt lgkmcnt(7)
v_mfma_f32_16x16x32_bf16 a[80:83], v[184:187], a[184:187], a[80:83]
ds_read_b64_tr_b16 v[206:207], v236 offset:20992
buffer_load_dwordx4 v229, s[36:39], s52 offen offset:1024 lds
v_mfma_f32_16x16x32_bf16 a[88:91], v[184:187], a[188:191], a[88:91]
v_accvgpr_read_b32 v154, a74
v_accvgpr_read_b32 v155, a75
v_accvgpr_read_b32 v156, a76
v_mfma_f32_16x16x32_bf16 a[84:87], v[188:191], a[184:187], a[84:87]
v_accvgpr_read_b32 v157, a77
v_accvgpr_read_b32 v158, a78
v_accvgpr_read_b32 v159, a79
v_mfma_f32_16x16x32_bf16 a[92:95], v[188:191], a[188:191], a[92:95]
v_add_u32 v236, 65536, v230
v_xor_b32 v237, 32, v236
v_cvt_pk_bf16_f32 v36, v152, v153
s_waitcnt lgkmcnt(4)
v_mfma_f32_16x16x32_bf16 a[80:83], v[192:195], a[192:195], a[80:83]
v_cvt_pk_bf16_f32 v37, v154, v155
v_cvt_pk_bf16_f32 v38, v156, v157
v_cvt_pk_bf16_f32 v39, v158, v159
v_mfma_f32_16x16x32_bf16 a[88:91], v[192:195], a[196:199], a[88:91]
buffer_store_dwordx4 v[36:39], v214, s[44:47], s54 offen offset:1024 sc1
s_waitcnt vmcnt(17) lgkmcnt(0)
s_barrier
ds_read_b64_tr_b16 v[176:177], v236 offset:0
ds_read_b64_tr_b16 v[178:179], v237 offset:512
ds_read_b64_tr_b16 v[180:181], v237 offset:0
ds_read_b64_tr_b16 v[182:183], v236 offset:512
ds_read_b64_tr_b16 v[184:185], v236 offset:4096
ds_read_b64_tr_b16 v[186:187], v237 offset:4608
v_mfma_f32_16x16x32_bf16 a[84:87], v[196:199], a[192:195], a[84:87]
s_add_u32 s52, s79, 5898240
s_add_u32 m0, s48, 139264
s_nop 0
buffer_load_dwordx4 v228, s[36:39], s52 offen lds
v_mfma_f32_16x16x32_bf16 a[92:95], v[196:199], a[196:199], a[92:95]
ds_read_b64_tr_b16 v[188:189], v237 offset:4096
v_mfma_f32_16x16x32_bf16 a[80:83], v[200:203], a[200:203], a[80:83]
ds_read_b64_tr_b16 v[190:191], v236 offset:4608
v_mfma_f32_16x16x32_bf16 a[88:91], v[200:203], a[204:207], a[88:91]
ds_read_b64_tr_b16 v[192:193], v236 offset:8192
buffer_load_dwordx4 v229, s[36:39], s52 offen offset:1024 lds
v_mfma_f32_16x16x32_bf16 a[84:87], v[204:207], a[200:203], a[84:87]
ds_read_b64_tr_b16 v[194:195], v237 offset:8704
v_mfma_f32_16x16x32_bf16 a[92:95], v[204:207], a[204:207], a[92:95]
ds_read_b64_tr_b16 v[196:197], v237 offset:8192
s_waitcnt lgkmcnt(7)
v_mfma_f32_16x16x32_bf16 a[96:99], v[176:179], a[160:163], a[96:99]
ds_read_b64_tr_b16 v[198:199], v236 offset:8704
s_add_u32 s52, s79, 5980160
s_add_u32 m0, s48, 147456
v_mfma_f32_16x16x32_bf16 a[104:107], v[176:179], a[164:167], a[104:107]
ds_read_b64_tr_b16 v[200:201], v236 offset:12288
buffer_load_dwordx4 v228, s[36:39], s52 offen lds
v_mfma_f32_16x16x32_bf16 a[100:103], v[180:183], a[160:163], a[100:103]
ds_read_b64_tr_b16 v[202:203], v237 offset:12800
s_lshl_b32 s54, s75, 6
v_accvgpr_read_b32 v160, a80
v_accvgpr_read_b32 v161, a81
v_mfma_f32_16x16x32_bf16 a[108:111], v[180:183], a[164:167], a[108:111]
ds_read_b64_tr_b16 v[204:205], v237 offset:12288
v_accvgpr_read_b32 v162, a82
v_accvgpr_read_b32 v163, a83
s_waitcnt lgkmcnt(7)
v_mfma_f32_16x16x32_bf16 a[96:99], v[184:187], a[168:171], a[96:99]
ds_read_b64_tr_b16 v[206:207], v236 offset:12800
buffer_load_dwordx4 v229, s[36:39], s52 offen offset:1024 lds
v_mfma_f32_16x16x32_bf16 a[104:107], v[184:187], a[172:175], a[104:107]
ds_read_b64_tr_b16 v[176:177], v236 offset:16384
v_accvgpr_read_b32 v164, a84
v_accvgpr_read_b32 v165, a85
v_mfma_f32_16x16x32_bf16 a[100:103], v[188:191], a[168:171], a[100:103]
ds_read_b64_tr_b16 v[178:179], v237 offset:16896
v_accvgpr_read_b32 v166, a86
v_accvgpr_read_b32 v167, a87
v_mfma_f32_16x16x32_bf16 a[108:111], v[188:191], a[172:175], a[108:111]
ds_read_b64_tr_b16 v[180:181], v237 offset:16384
s_add_u32 s52, s79, 6062080
s_add_u32 m0, s48, 155648
v_cvt_pk_bf16_f32 v40, v160, v161
s_waitcnt lgkmcnt(7)
v_mfma_f32_16x16x32_bf16 a[96:99], v[192:195], a[176:179], a[96:99]
ds_read_b64_tr_b16 v[182:183], v236 offset:16896
buffer_load_dwordx4 v228, s[36:39], s52 offen lds
v_mfma_f32_16x16x32_bf16 a[104:107], v[192:195], a[180:183], a[104:107]
ds_read_b64_tr_b16 v[184:185], v236 offset:20480
v_cvt_pk_bf16_f32 v41, v162, v163
v_cvt_pk_bf16_f32 v42, v164, v165
v_mfma_f32_16x16x32_bf16 a[100:103], v[196:199], a[176:179], a[100:103]
ds_read_b64_tr_b16 v[186:187], v237 offset:20992
v_cvt_pk_bf16_f32 v43, v166, v167
buffer_store_dwordx4 v[40:43], v213, s[44:47], s54 offen sc1
v_mfma_f32_16x16x32_bf16 a[108:111], v[196:199], a[180:183], a[108:111]
ds_read_b64_tr_b16 v[188:189], v237 offset:20480
v_accvgpr_read_b32 v168, a88
v_accvgpr_read_b32 v169, a89
s_waitcnt lgkmcnt(7)
v_mfma_f32_16x16x32_bf16 a[96:99], v[200:203], a[184:187], a[96:99]
ds_read_b64_tr_b16 v[190:191], v236 offset:20992
buffer_load_dwordx4 v229, s[36:39], s52 offen offset:1024 lds
v_mfma_f32_16x16x32_bf16 a[104:107], v[200:203], a[188:191], a[104:107]
v_accvgpr_read_b32 v170, a90
v_accvgpr_read_b32 v171, a91
v_accvgpr_read_b32 v172, a92
v_mfma_f32_16x16x32_bf16 a[100:103], v[204:207], a[184:187], a[100:103]
v_accvgpr_read_b32 v173, a93
v_accvgpr_read_b32 v174, a94
v_accvgpr_read_b32 v175, a95
v_mfma_f32_16x16x32_bf16 a[108:111], v[204:207], a[188:191], a[108:111]
v_add_u32 v236, 90112, v230
v_xor_b32 v237, 32, v236
v_cvt_pk_bf16_f32 v44, v168, v169
s_waitcnt lgkmcnt(4)
v_mfma_f32_16x16x32_bf16 a[96:99], v[176:179], a[192:195], a[96:99]
v_cvt_pk_bf16_f32 v45, v170, v171
v_cvt_pk_bf16_f32 v46, v172, v173
v_cvt_pk_bf16_f32 v47, v174, v175
v_mfma_f32_16x16x32_bf16 a[104:107], v[176:179], a[196:199], a[104:107]
buffer_store_dwordx4 v[44:47], v214, s[44:47], s54 offen offset:1024 sc1
s_waitcnt vmcnt(17) lgkmcnt(0)
s_barrier
ds_read_b64_tr_b16 v[192:193], v236 offset:0
ds_read_b64_tr_b16 v[194:195], v237 offset:512
ds_read_b64_tr_b16 v[196:197], v237 offset:0
ds_read_b64_tr_b16 v[198:199], v236 offset:512
ds_read_b64_tr_b16 v[200:201], v236 offset:4096
ds_read_b64_tr_b16 v[202:203], v237 offset:4608
v_mfma_f32_16x16x32_bf16 a[100:103], v[180:183], a[192:195], a[100:103]
v_mfma_f32_16x16x32_bf16 a[108:111], v[180:183], a[196:199], a[108:111]
ds_read_b64_tr_b16 v[204:205], v237 offset:4096
v_mfma_f32_16x16x32_bf16 a[96:99], v[184:187], a[200:203], a[96:99]
ds_read_b64_tr_b16 v[206:207], v236 offset:4608
v_mfma_f32_16x16x32_bf16 a[104:107], v[184:187], a[204:207], a[104:107]
ds_read_b64_tr_b16 v[176:177], v236 offset:8192
v_mfma_f32_16x16x32_bf16 a[100:103], v[188:191], a[200:203], a[100:103]
ds_read_b64_tr_b16 v[178:179], v237 offset:8704
v_mfma_f32_16x16x32_bf16 a[108:111], v[188:191], a[204:207], a[108:111]
ds_read_b64_tr_b16 v[180:181], v237 offset:8192
s_waitcnt lgkmcnt(7)
v_mfma_f32_16x16x32_bf16 a[112:115], v[192:195], a[160:163], a[112:115]
ds_read_b64_tr_b16 v[182:183], v236 offset:8704
v_mfma_f32_16x16x32_bf16 a[120:123], v[192:195], a[164:167], a[120:123]
ds_read_b64_tr_b16 v[184:185], v236 offset:12288
v_mfma_f32_16x16x32_bf16 a[116:119], v[196:199], a[160:163], a[116:119]
ds_read_b64_tr_b16 v[186:187], v237 offset:12800
s_lshl_b32 s54, s76, 6
v_accvgpr_read_b32 v128, a96
v_mfma_f32_16x16x32_bf16 a[124:127], v[196:199], a[164:167], a[124:127]
ds_read_b64_tr_b16 v[188:189], v237 offset:12288
v_accvgpr_read_b32 v129, a97
v_accvgpr_read_b32 v130, a98
s_waitcnt lgkmcnt(7)
v_mfma_f32_16x16x32_bf16 a[112:115], v[200:203], a[168:171], a[112:115]
ds_read_b64_tr_b16 v[190:191], v236 offset:12800
v_accvgpr_read_b32 v131, a99
v_accvgpr_read_b32 v132, a100
v_mfma_f32_16x16x32_bf16 a[120:123], v[200:203], a[172:175], a[120:123]
ds_read_b64_tr_b16 v[192:193], v236 offset:16384
v_accvgpr_read_b32 v133, a101
v_accvgpr_read_b32 v134, a102
v_mfma_f32_16x16x32_bf16 a[116:119], v[204:207], a[168:171], a[116:119]
ds_read_b64_tr_b16 v[194:195], v237 offset:16896
v_accvgpr_read_b32 v135, a103
v_cvt_pk_bf16_f32 v48, v128, v129
v_mfma_f32_16x16x32_bf16 a[124:127], v[204:207], a[172:175], a[124:127]
ds_read_b64_tr_b16 v[196:197], v237 offset:16384
v_cvt_pk_bf16_f32 v49, v130, v131
s_waitcnt lgkmcnt(7)
v_mfma_f32_16x16x32_bf16 a[112:115], v[176:179], a[176:179], a[112:115]
ds_read_b64_tr_b16 v[198:199], v236 offset:16896
v_cvt_pk_bf16_f32 v50, v132, v133
v_cvt_pk_bf16_f32 v51, v134, v135
v_mfma_f32_16x16x32_bf16 a[120:123], v[176:179], a[180:183], a[120:123]
ds_read_b64_tr_b16 v[200:201], v236 offset:20480
buffer_store_dwordx4 v[48:51], v213, s[44:47], s54 offen sc1
v_mfma_f32_16x16x32_bf16 a[116:119], v[180:183], a[176:179], a[116:119]
ds_read_b64_tr_b16 v[202:203], v237 offset:20992
v_accvgpr_read_b32 v136, a104
v_mfma_f32_16x16x32_bf16 a[124:127], v[180:183], a[180:183], a[124:127]
ds_read_b64_tr_b16 v[204:205], v237 offset:20480
v_accvgpr_read_b32 v137, a105
s_waitcnt lgkmcnt(7)
v_mfma_f32_16x16x32_bf16 a[112:115], v[184:187], a[184:187], a[112:115]
ds_read_b64_tr_b16 v[206:207], v236 offset:20992
v_accvgpr_read_b32 v138, a106
v_accvgpr_read_b32 v139, a107
v_mfma_f32_16x16x32_bf16 a[120:123], v[184:187], a[188:191], a[120:123]
v_accvgpr_read_b32 v140, a108
v_accvgpr_read_b32 v141, a109
v_mfma_f32_16x16x32_bf16 a[116:119], v[188:191], a[184:187], a[116:119]
v_accvgpr_read_b32 v142, a110
v_accvgpr_read_b32 v143, a111
v_cvt_pk_bf16_f32 v52, v136, v137
v_mfma_f32_16x16x32_bf16 a[124:127], v[188:191], a[188:191], a[124:127]
v_add_u32 v236, 114688, v230
v_xor_b32 v237, 32, v236
s_waitcnt lgkmcnt(4)
v_mfma_f32_16x16x32_bf16 a[112:115], v[192:195], a[192:195], a[112:115]
v_cvt_pk_bf16_f32 v53, v138, v139
v_cvt_pk_bf16_f32 v54, v140, v141
v_cvt_pk_bf16_f32 v55, v142, v143
v_mfma_f32_16x16x32_bf16 a[120:123], v[192:195], a[196:199], a[120:123]
buffer_store_dwordx4 v[52:55], v214, s[44:47], s54 offen offset:1024 sc1
s_waitcnt vmcnt(11) lgkmcnt(0)
s_barrier
ds_read_b64_tr_b16 v[176:177], v236 offset:0
ds_read_b64_tr_b16 v[178:179], v237 offset:512
ds_read_b64_tr_b16 v[180:181], v237 offset:0
ds_read_b64_tr_b16 v[182:183], v236 offset:512
ds_read_b64_tr_b16 v[184:185], v236 offset:4096
ds_read_b64_tr_b16 v[186:187], v237 offset:4608
v_mfma_f32_16x16x32_bf16 a[116:119], v[196:199], a[192:195], a[116:119]
v_mfma_f32_16x16x32_bf16 a[124:127], v[196:199], a[196:199], a[124:127]
ds_read_b64_tr_b16 v[188:189], v237 offset:4096
v_mfma_f32_16x16x32_bf16 a[112:115], v[200:203], a[200:203], a[112:115]
ds_read_b64_tr_b16 v[190:191], v236 offset:4608
v_mfma_f32_16x16x32_bf16 a[120:123], v[200:203], a[204:207], a[120:123]
ds_read_b64_tr_b16 v[192:193], v236 offset:8192
v_mfma_f32_16x16x32_bf16 a[116:119], v[204:207], a[200:203], a[116:119]
ds_read_b64_tr_b16 v[194:195], v237 offset:8704
v_mfma_f32_16x16x32_bf16 a[124:127], v[204:207], a[204:207], a[124:127]
ds_read_b64_tr_b16 v[196:197], v237 offset:8192
s_waitcnt lgkmcnt(7)
v_mfma_f32_16x16x32_bf16 a[128:131], v[176:179], a[160:163], a[128:131]
ds_read_b64_tr_b16 v[198:199], v236 offset:8704
v_mfma_f32_16x16x32_bf16 a[136:139], v[176:179], a[164:167], a[136:139]
ds_read_b64_tr_b16 v[200:201], v236 offset:12288
v_mfma_f32_16x16x32_bf16 a[132:135], v[180:183], a[160:163], a[132:135]
ds_read_b64_tr_b16 v[202:203], v237 offset:12800
s_lshl_b32 s54, s77, 6
v_accvgpr_read_b32 v144, a112
v_mfma_f32_16x16x32_bf16 a[140:143], v[180:183], a[164:167], a[140:143]
ds_read_b64_tr_b16 v[204:205], v237 offset:12288
v_accvgpr_read_b32 v145, a113
v_accvgpr_read_b32 v146, a114
s_waitcnt lgkmcnt(7)
v_mfma_f32_16x16x32_bf16 a[128:131], v[184:187], a[168:171], a[128:131]
ds_read_b64_tr_b16 v[206:207], v236 offset:12800
v_accvgpr_read_b32 v147, a115
v_accvgpr_read_b32 v148, a116
v_mfma_f32_16x16x32_bf16 a[136:139], v[184:187], a[172:175], a[136:139]
ds_read_b64_tr_b16 v[176:177], v236 offset:16384
v_accvgpr_read_b32 v149, a117
v_accvgpr_read_b32 v150, a118
v_mfma_f32_16x16x32_bf16 a[132:135], v[188:191], a[168:171], a[132:135]
ds_read_b64_tr_b16 v[178:179], v237 offset:16896
v_accvgpr_read_b32 v151, a119
v_cvt_pk_bf16_f32 v56, v144, v145
v_mfma_f32_16x16x32_bf16 a[140:143], v[188:191], a[172:175], a[140:143]
ds_read_b64_tr_b16 v[180:181], v237 offset:16384
v_cvt_pk_bf16_f32 v57, v146, v147
s_waitcnt lgkmcnt(7)
v_mfma_f32_16x16x32_bf16 a[128:131], v[192:195], a[176:179], a[128:131]
ds_read_b64_tr_b16 v[182:183], v236 offset:16896
v_cvt_pk_bf16_f32 v58, v148, v149
v_cvt_pk_bf16_f32 v59, v150, v151
v_mfma_f32_16x16x32_bf16 a[136:139], v[192:195], a[180:183], a[136:139]
ds_read_b64_tr_b16 v[184:185], v236 offset:20480
buffer_store_dwordx4 v[56:59], v213, s[44:47], s54 offen sc1
v_mfma_f32_16x16x32_bf16 a[132:135], v[196:199], a[176:179], a[132:135]
ds_read_b64_tr_b16 v[186:187], v237 offset:20992
v_accvgpr_read_b32 v152, a120
v_mfma_f32_16x16x32_bf16 a[140:143], v[196:199], a[180:183], a[140:143]
ds_read_b64_tr_b16 v[188:189], v237 offset:20480
v_accvgpr_read_b32 v153, a121
s_waitcnt lgkmcnt(7)
v_mfma_f32_16x16x32_bf16 a[128:131], v[200:203], a[184:187], a[128:131]
ds_read_b64_tr_b16 v[190:191], v236 offset:20992
v_accvgpr_read_b32 v154, a122
v_accvgpr_read_b32 v155, a123
v_mfma_f32_16x16x32_bf16 a[136:139], v[200:203], a[188:191], a[136:139]
v_accvgpr_read_b32 v156, a124
v_accvgpr_read_b32 v157, a125
v_mfma_f32_16x16x32_bf16 a[132:135], v[204:207], a[184:187], a[132:135]
v_accvgpr_read_b32 v158, a126
v_accvgpr_read_b32 v159, a127
v_cvt_pk_bf16_f32 v60, v152, v153
v_mfma_f32_16x16x32_bf16 a[140:143], v[204:207], a[188:191], a[140:143]
v_add_u32 v236, 139264, v230
v_xor_b32 v237, 32, v236
s_waitcnt lgkmcnt(4)
v_mfma_f32_16x16x32_bf16 a[128:131], v[176:179], a[192:195], a[128:131]
v_cvt_pk_bf16_f32 v61, v154, v155
v_cvt_pk_bf16_f32 v62, v156, v157
v_cvt_pk_bf16_f32 v63, v158, v159
v_mfma_f32_16x16x32_bf16 a[136:139], v[176:179], a[196:199], a[136:139]
buffer_store_dwordx4 v[60:63], v214, s[44:47], s54 offen offset:1024 sc1
s_waitcnt vmcnt(5) lgkmcnt(0)
s_barrier
ds_read_b64_tr_b16 v[192:193], v236 offset:0
ds_read_b64_tr_b16 v[194:195], v237 offset:512
ds_read_b64_tr_b16 v[196:197], v237 offset:0
ds_read_b64_tr_b16 v[198:199], v236 offset:512
ds_read_b64_tr_b16 v[200:201], v236 offset:4096
ds_read_b64_tr_b16 v[202:203], v237 offset:4608
v_mfma_f32_16x16x32_bf16 a[132:135], v[180:183], a[192:195], a[132:135]
v_mfma_f32_16x16x32_bf16 a[140:143], v[180:183], a[196:199], a[140:143]
ds_read_b64_tr_b16 v[204:205], v237 offset:4096
v_mfma_f32_16x16x32_bf16 a[128:131], v[184:187], a[200:203], a[128:131]
ds_read_b64_tr_b16 v[206:207], v236 offset:4608
v_mfma_f32_16x16x32_bf16 a[136:139], v[184:187], a[204:207], a[136:139]
ds_read_b64_tr_b16 v[176:177], v236 offset:8192
v_mfma_f32_16x16x32_bf16 a[132:135], v[188:191], a[200:203], a[132:135]
ds_read_b64_tr_b16 v[178:179], v237 offset:8704
v_mfma_f32_16x16x32_bf16 a[140:143], v[188:191], a[204:207], a[140:143]
ds_read_b64_tr_b16 v[180:181], v237 offset:8192
s_waitcnt lgkmcnt(7)
v_mfma_f32_16x16x32_bf16 a[144:147], v[192:195], a[160:163], a[144:147]
ds_read_b64_tr_b16 v[182:183], v236 offset:8704
v_mfma_f32_16x16x32_bf16 a[152:155], v[192:195], a[164:167], a[152:155]
ds_read_b64_tr_b16 v[184:185], v236 offset:12288
v_mfma_f32_16x16x32_bf16 a[148:151], v[196:199], a[160:163], a[148:151]
ds_read_b64_tr_b16 v[186:187], v237 offset:12800
s_lshl_b32 s54, s78, 6
v_accvgpr_read_b32 v160, a128
v_mfma_f32_16x16x32_bf16 a[156:159], v[196:199], a[164:167], a[156:159]
ds_read_b64_tr_b16 v[188:189], v237 offset:12288
v_accvgpr_read_b32 v161, a129
s_waitcnt lgkmcnt(7)
v_mfma_f32_16x16x32_bf16 a[144:147], v[200:203], a[168:171], a[144:147]
ds_read_b64_tr_b16 v[190:191], v236 offset:12800
v_accvgpr_read_b32 v162, a130
v_accvgpr_read_b32 v163, a131
v_mfma_f32_16x16x32_bf16 a[152:155], v[200:203], a[172:175], a[152:155]
ds_read_b64_tr_b16 v[192:193], v236 offset:16384
v_accvgpr_read_b32 v164, a132
v_mfma_f32_16x16x32_bf16 a[148:151], v[204:207], a[168:171], a[148:151]
ds_read_b64_tr_b16 v[194:195], v237 offset:16896
v_accvgpr_read_b32 v165, a133
v_accvgpr_read_b32 v166, a134
v_mfma_f32_16x16x32_bf16 a[156:159], v[204:207], a[172:175], a[156:159]
ds_read_b64_tr_b16 v[196:197], v237 offset:16384
v_accvgpr_read_b32 v167, a135
s_waitcnt lgkmcnt(7)
v_mfma_f32_16x16x32_bf16 a[144:147], v[176:179], a[176:179], a[144:147]
ds_read_b64_tr_b16 v[198:199], v236 offset:16896
v_cvt_pk_bf16_f32 v64, v160, v161
v_cvt_pk_bf16_f32 v65, v162, v163
v_mfma_f32_16x16x32_bf16 a[152:155], v[176:179], a[180:183], a[152:155]
ds_read_b64_tr_b16 v[200:201], v236 offset:20480
v_cvt_pk_bf16_f32 v66, v164, v165
v_mfma_f32_16x16x32_bf16 a[148:151], v[180:183], a[176:179], a[148:151]
ds_read_b64_tr_b16 v[202:203], v237 offset:20992
v_cvt_pk_bf16_f32 v67, v166, v167
v_mfma_f32_16x16x32_bf16 a[156:159], v[180:183], a[180:183], a[156:159]
ds_read_b64_tr_b16 v[204:205], v237 offset:20480
buffer_store_dwordx4 v[64:67], v213, s[44:47], s54 offen sc1
s_waitcnt lgkmcnt(7)
v_mfma_f32_16x16x32_bf16 a[144:147], v[184:187], a[184:187], a[144:147]
ds_read_b64_tr_b16 v[206:207], v236 offset:20992
v_accvgpr_read_b32 v168, a136
v_accvgpr_read_b32 v169, a137
v_mfma_f32_16x16x32_bf16 a[152:155], v[184:187], a[188:191], a[152:155]
v_accvgpr_read_b32 v170, a138
v_accvgpr_read_b32 v171, a139
v_mfma_f32_16x16x32_bf16 a[148:151], v[188:191], a[184:187], a[148:151]
v_accvgpr_read_b32 v172, a140
v_accvgpr_read_b32 v173, a141
v_accvgpr_read_b32 v174, a142
v_mfma_f32_16x16x32_bf16 a[156:159], v[188:191], a[188:191], a[156:159]
v_accvgpr_read_b32 v175, a143
v_cvt_pk_bf16_f32 v68, v168, v169
s_waitcnt lgkmcnt(4)
v_mfma_f32_16x16x32_bf16 a[144:147], v[192:195], a[192:195], a[144:147]
v_cvt_pk_bf16_f32 v69, v170, v171
v_cvt_pk_bf16_f32 v70, v172, v173
v_cvt_pk_bf16_f32 v71, v174, v175
v_mfma_f32_16x16x32_bf16 a[152:155], v[192:195], a[196:199], a[152:155]
buffer_store_dwordx4 v[68:71], v214, s[44:47], s54 offen offset:1024 sc1
s_waitcnt lgkmcnt(0)
s_barrier
v_mfma_f32_16x16x32_bf16 a[148:151], v[196:199], a[192:195], a[148:151]
v_mfma_f32_16x16x32_bf16 a[156:159], v[196:199], a[196:199], a[156:159]
v_mfma_f32_16x16x32_bf16 a[144:147], v[200:203], a[200:203], a[144:147]
v_mfma_f32_16x16x32_bf16 a[152:155], v[200:203], a[204:207], a[152:155]
v_mfma_f32_16x16x32_bf16 a[148:151], v[204:207], a[200:203], a[148:151]
v_mfma_f32_16x16x32_bf16 a[156:159], v[204:207], a[204:207], a[156:159]
s_lshl_b32 s54, s79, 6
s_nop 3
v_accvgpr_read_b32 v128, a144
v_accvgpr_read_b32 v129, a145
v_accvgpr_read_b32 v130, a146
v_accvgpr_read_b32 v131, a147
v_accvgpr_read_b32 v132, a148
v_accvgpr_read_b32 v133, a149
v_accvgpr_read_b32 v134, a150
v_accvgpr_read_b32 v135, a151
v_cvt_pk_bf16_f32 v72, v128, v129
v_cvt_pk_bf16_f32 v73, v130, v131
v_cvt_pk_bf16_f32 v74, v132, v133
v_cvt_pk_bf16_f32 v75, v134, v135
buffer_store_dwordx4 v[72:75], v213, s[44:47], s54 offen sc1
v_accvgpr_read_b32 v136, a152
v_accvgpr_read_b32 v137, a153
v_accvgpr_read_b32 v138, a154
v_accvgpr_read_b32 v139, a155
v_accvgpr_read_b32 v140, a156
v_accvgpr_read_b32 v141, a157
v_accvgpr_read_b32 v142, a158
v_accvgpr_read_b32 v143, a159
v_cvt_pk_bf16_f32 v76, v136, v137
v_cvt_pk_bf16_f32 v77, v138, v139
v_cvt_pk_bf16_f32 v78, v140, v141
v_cvt_pk_bf16_f32 v79, v142, v143
buffer_store_dwordx4 v[76:79], v214, s[44:47], s54 offen offset:1024 sc1
buffer_load_dword v217, v216, s[8:11], s59 offen sc1
s_cmp_eq_u32 s96, 0
s_cbranch_scc1 L_own0
ds_write_b128 v215, v[0:3] offset:0
ds_write_b128 v215, v[8:11] offset:2048
ds_write_b128 v215, v[16:19] offset:4096
ds_write_b128 v215, v[24:27] offset:6144
ds_write_b128 v215, v[32:35] offset:8192
ds_write_b128 v215, v[40:43] offset:10240
ds_write_b128 v215, v[48:51] offset:12288
ds_write_b128 v215, v[56:59] offset:14336
ds_write_b128 v215, v[64:67] offset:16384
ds_write_b128 v215, v[72:75] offset:18432
L_own0:
s_cmp_eq_u32 s97, 0
s_cbranch_scc1 L_own1
ds_write_b128 v215, v[4:7] offset:0
ds_write_b128 v215, v[12:15] offset:2048
ds_write_b128 v215, v[20:23] offset:4096
ds_write_b128 v215, v[28:31] offset:6144
ds_write_b128 v215, v[36:39] offset:8192
ds_write_b128 v215, v[44:47] offset:10240
ds_write_b128 v215, v[52:55] offset:12288
ds_write_b128 v215, v[60:63] offset:14336
ds_write_b128 v215, v[68:71] offset:16384
ds_write_b128 v215, v[76:79] offset:18432
L_own1:
s_waitcnt vmcnt(1) lgkmcnt(0)
s_barrier
s_cmp_eq_u32 s58, 0
s_cbranch_scc0 L_sig_skip
s_mov_b32 s21, 0
L_rdy_loop:
v_readfirstlane_b32 s20, v252
s_add_u32 s21, s21, 1
s_cmp_ge_u32 s21, 0x40000
s_cbranch_scc1 L_rdy_ok
s_cmp_ge_u32 s20, 8
s_cbranch_scc1 L_rdy_ok
buffer_load_dword v252, v216, s[12:15], 0 offen sc1
s_waitcnt vmcnt(0)
s_branch L_rdy_loop
L_rdy_ok:
s_mov_b64 exec, 0xff
buffer_atomic_add v219, v218, s[8:11], 0 offen sc1
s_mov_b64 exec, -1
s_waitcnt vmcnt(1)
s_branch L_sig_done
L_sig_skip:
s_waitcnt vmcnt(0)
L_sig_done:
v_or_b32 v217, v217, v219
s_mov_b32 s21, 0
s_lshl_b32 s3, 1, s90
s_mov_b32 s101, 1
ds_read_b128 v[116:119], v220
ds_read_b128 v[120:123], v221
ds_read_b128 v[124:127], v222
v_readfirstlane_b32 s100, v217
s_mov_b32 s52, 0xffff0000
s_nop 1
s_andn2_b32 s20, s100, s3
s_cselect_b32 s60, 1, 0
s_ff1_i32_b32 s20, s20
s_lshl_b32 s53, s60, s20
s_or_b32 s3, s3, s53
s_mul_i32 s20, s20, 81920
s_add_u32 s20, s20, s23
s_cmp_eq_u32 s60, 0
s_cselect_b32 s20, s94, s20
s_add_u32 s53, s20, 32768
s_add_u32 s54, s20, s95
buffer_load_dwordx4 v[0:3], v210, s[16:19], s20 offen sc1
buffer_load_dwordx4 v[4:7], v210, s[16:19], s53 offen sc1
buffer_load_dwordx4 v[8:11], v210, s[16:19], s54 offen sc1
buffer_load_dword v88, v216, s[8:11], s59 offen sc1
s_waitcnt lgkmcnt(0)
v_lshlrev_b32 v128, 16, v116
v_and_b32 v129, s52, v116
v_lshlrev_b32 v130, 16, v117
v_and_b32 v131, s52, v117
v_lshlrev_b32 v132, 16, v118
v_and_b32 v133, s52, v118
v_lshlrev_b32 v134, 16, v119
v_and_b32 v135, s52, v119
v_lshlrev_b32 v136, 16, v120
v_and_b32 v137, s52, v120
v_lshlrev_b32 v138, 16, v121
v_and_b32 v139, s52, v121
v_lshlrev_b32 v140, 16, v122
v_and_b32 v141, s52, v122
v_lshlrev_b32 v142, 16, v123
v_and_b32 v143, s52, v123
v_lshlrev_b32 v144, 16, v124
v_and_b32 v145, s52, v124
v_lshlrev_b32 v146, 16, v125
v_and_b32 v147, s52, v125
v_lshlrev_b32 v148, 16, v126
v_and_b32 v149, s52, v126
v_lshlrev_b32 v150, 16, v127
v_and_b32 v151, s52, v127
L_pass:
s_andn2_b32 s20, s100, s3
s_cselect_b32 s61, 1, 0
s_ff1_i32_b32 s20, s20
s_lshl_b32 s53, s61, s20
s_or_b32 s3, s3, s53
s_mul_i32 s20, s20, 81920
s_add_u32 s20, s20, s23
s_cmp_eq_u32 s61, 0
s_cselect_b32 s20, s94, s20
s_add_u32 s53, s20, 32768
s_add_u32 s54, s20, s95
buffer_load_dwordx4 v[12:15], v210, s[16:19], s20 offen sc1
buffer_load_dwordx4 v[16:19], v210, s[16:19], s53 offen sc1
buffer_load_dwordx4 v[20:23], v210, s[16:19], s54 offen sc1
buffer_load_dword v89, v216, s[8:11], s59 offen sc1
s_waitcnt vmcnt(4)
v_readfirstlane_b32 s20, v88
s_cmp_eq_u32 s60, 0
s_cbranch_scc1 L_acc00
v_lshlrev_b32 v108, 16, v0
v_and_b32 v109, s52, v0
v_lshlrev_b32 v110, 16, v1
v_and_b32 v111, s52, v1
v_lshlrev_b32 v112, 16, v2
v_and_b32 v113, s52, v2
v_lshlrev_b32 v114, 16, v3
v_and_b32 v115, s52, v3
v_add_f32 v128, v128, v108
v_add_f32 v129, v129, v109
v_add_f32 v130, v130, v110
v_add_f32 v131, v131, v111
v_add_f32 v132, v132, v112
v_add_f32 v133, v133, v113
v_add_f32 v134, v134, v114
v_add_f32 v135, v135, v115
v_lshlrev_b32 v108, 16, v4
v_and_b32 v109, s52, v4
v_lshlrev_b32 v110, 16, v5
v_and_b32 v111, s52, v5
v_lshlrev_b32 v112, 16, v6
v_and_b32 v113, s52, v6
v_lshlrev_b32 v114, 16, v7
v_and_b32 v115, s52, v7
v_add_f32 v136, v136, v108
v_add_f32 v137, v137, v109
v_add_f32 v138, v138, v110
v_add_f32 v139, v139, v111
v_add_f32 v140, v140, v112
v_add_f32 v141, v141, v113
v_add_f32 v142, v142, v114
v_add_f32 v143, v143, v115
v_lshlrev_b32 v108, 16, v8
v_and_b32 v109, s52, v8
v_lshlrev_b32 v110, 16, v9
v_and_b32 v111, s52, v9
v_lshlrev_b32 v112, 16, v10
v_and_b32 v113, s52, v10
v_lshlrev_b32 v114, 16, v11
v_and_b32 v115, s52, v11
v_add_f32 v144, v144, v108
v_add_f32 v145, v145, v109
v_add_f32 v146, v146, v110
v_add_f32 v147, v147, v111
v_add_f32 v148, v148, v112
v_add_f32 v149, v149, v113
v_add_f32 v150, v150, v114
v_add_f32 v151, v151, v115
s_add_u32 s101, s101, 1
s_cmp_eq_u32 s101, 8
s_cbranch_scc1 L_all
L_acc00:
s_nop 0
s_or_b32 s100, s100, s20
s_andn2_b32 s20, s100, s3
s_cselect_b32 s60, 1, 0
s_ff1_i32_b32 s20, s20
s_lshl_b32 s53, s60, s20
s_or_b32 s3, s3, s53
s_mul_i32 s20, s20, 81920
s_add_u32 s20, s20, s23
s_cmp_eq_u32 s60, 0
s_cselect_b32 s20, s94, s20
s_add_u32 s53, s20, 32768
s_add_u32 s54, s20, s95
buffer_load_dwordx4 v[0:3], v210, s[16:19], s20 offen sc1
buffer_load_dwordx4 v[4:7], v210, s[16:19], s53 offen sc1
buffer_load_dwordx4 v[8:11], v210, s[16:19], s54 offen sc1
buffer_load_dword v88, v216, s[8:11], s59 offen sc1
s_waitcnt vmcnt(4)
v_readfirstlane_b32 s20, v89
s_cmp_eq_u32 s61, 0
s_cbranch_scc1 L_acc10
v_lshlrev_b32 v108, 16, v12
v_and_b32 v109, s52, v12
v_lshlrev_b32 v110, 16, v13
v_and_b32 v111, s52, v13
v_lshlrev_b32 v112, 16, v14
v_and_b32 v113, s52, v14
v_lshlrev_b32 v114, 16, v15
v_and_b32 v115, s52, v15
v_add_f32 v128, v128, v108
v_add_f32 v129, v129, v109
v_add_f32 v130, v130, v110
v_add_f32 v131, v131, v111
v_add_f32 v132, v132, v112
v_add_f32 v133, v133, v113
v_add_f32 v134, v134, v114
v_add_f32 v135, v135, v115
v_lshlrev_b32 v108, 16, v16
v_and_b32 v109, s52, v16
v_lshlrev_b32 v110, 16, v17
v_and_b32 v111, s52, v17
v_lshlrev_b32 v112, 16, v18
v_and_b32 v113, s52, v18
v_lshlrev_b32 v114, 16, v19
v_and_b32 v115, s52, v19
v_add_f32 v136, v136, v108
v_add_f32 v137, v137, v109
v_add_f32 v138, v138, v110
v_add_f32 v139, v139, v111
v_add_f32 v140, v140, v112
v_add_f32 v141, v141, v113
v_add_f32 v142, v142, v114
v_add_f32 v143, v143, v115
v_lshlrev_b32 v108, 16, v20
v_and_b32 v109, s52, v20
v_lshlrev_b32 v110, 16, v21
v_and_b32 v111, s52, v21
v_lshlrev_b32 v112, 16, v22
v_and_b32 v113, s52, v22
v_lshlrev_b32 v114, 16, v23
v_and_b32 v115, s52, v23
v_add_f32 v144, v144, v108
v_add_f32 v145, v145, v109
v_add_f32 v146, v146, v110
v_add_f32 v147, v147, v111
v_add_f32 v148, v148, v112
v_add_f32 v149, v149, v113
v_add_f32 v150, v150, v114
v_add_f32 v151, v151, v115
s_add_u32 s101, s101, 1
s_cmp_eq_u32 s101, 8
s_cbranch_scc1 L_all
L_acc10:
s_nop 0
s_or_b32 s100, s100, s20
s_add_u32 s21, s21, 1
s_cmp_ge_u32 s21, 0x20000
s_cselect_b32 s100, 0xff, s100
s_branch L_pass
L_all:
v_cvt_pk_bf16_f32 v116, v128, v129
v_cvt_pk_bf16_f32 v117, v130, v131
v_cvt_pk_bf16_f32 v118, v132, v133
v_cvt_pk_bf16_f32 v119, v134, v135
buffer_store_dwordx2 v[116:117], v211, s[4:7], s22 offen offset:0
buffer_store_dwordx2 v[118:119], v211, s[4:7], s22 offen offset:32
v_cvt_pk_bf16_f32 v120, v136, v137
v_cvt_pk_bf16_f32 v121, v138, v139
v_cvt_pk_bf16_f32 v122, v140, v141
v_cvt_pk_bf16_f32 v123, v142, v143
buffer_store_dwordx2 v[120:121], v211, s[4:7], s22 offen offset:512
buffer_store_dwordx2 v[122:123], v211, s[4:7], s22 offen offset:544
s_cmp_lt_u32 s58, 2
s_cbranch_scc0 L_fin
v_cvt_pk_bf16_f32 v124, v144, v145
v_cvt_pk_bf16_f32 v125, v146, v147
v_cvt_pk_bf16_f32 v126, v148, v149
v_cvt_pk_bf16_f32 v127, v150, v151
buffer_store_dwordx2 v[124:125], v211, s[4:7], s22 offen offset:1024
buffer_store_dwordx2 v[126:127], v211, s[4:7], s22 offen offset:1056
L_fin:
s_endpgm
L_main_end:
.section .rodata,"a"
.p2align 6
.amdhsa_kernel concat_heads__gqa_block_cached__gqa_block_cached__near_ridge_kernel
  .amdhsa_next_free_vgpr 512
  .amdhsa_next_free_sgpr 102
  .amdhsa_accum_offset 256
  .amdhsa_group_segment_fixed_size 0
  .amdhsa_kernarg_size 104
  .amdhsa_user_sgpr_count 2
  .amdhsa_user_sgpr_kernarg_segment_ptr 1
  .amdhsa_system_sgpr_workgroup_id_x 1
  .amdhsa_float_denorm_mode_32 3
.end_amdhsa_kernel
```
